```python
import torch

def _softmax(x, axis=-1):
    return torch.softmax(x, dim=axis)

def _gelu(x):
    return torch.nn.functional.gelu(x, approximate='tanh')

def _silu(x):
    return torch.nn.functional.silu(x)

def _sigmoid(x):
    return torch.sigmoid(x)

def _layernorm(x, axis=-1, eps=1e-05):
    m = x.mean(dim=axis, keepdim=True)
    v = x.var(dim=axis, keepdim=True, unbiased=False)
    return (x - m) / torch.sqrt(v + eps)

def _scatter_add(tgt, idx, src, axis=0):
    return tgt.clone().index_add_(axis, idx, src)

def _segment_sum(src, seg, n):
    out = torch.zeros((n,) + src.shape[1:], dtype=src.dtype)
    return out.index_add_(0, seg, src)

def _pad(x, pw):
    flat = tuple((v for pair in reversed(pw) for v in pair))
    return torch.nn.functional.pad(x, flat)
kernel_name = 'parallel_sum__ssm_conv_h3__mixer_gmlp__prompt'

def setup_inputs():

    _w = lambda a: (lambda t: t.to(torch.bfloat16) if t.is_floating_point() else t)(torch.as_tensor(a))

    def _A_setup():
        B, S, D = (1, 2048, 1024)
        ks = 4
        return {'q': _w((lambda *s: torch.randn(*s, dtype=torch.bfloat16) * 0.05)(B, S, D)), 'k': _w((lambda *s: torch.randn(*s, dtype=torch.bfloat16) * 0.8)(B, S, D)), 'v': _w((lambda *s: torch.randn(*s, dtype=torch.bfloat16) * 0.8)(B, S, D)), 'shift_k': _w((lambda *s: torch.randn(*s, dtype=torch.bfloat16) * 0.8)(D, ks) * 0.5), 'ssm_k': _w((lambda *s: torch.randn(*s, dtype=torch.bfloat16) * 3.2)(D, S) * (1.0 / S ** 0.5)), 'ssm_D': _w((lambda *s: torch.randn(*s, dtype=torch.bfloat16) * 0.8)(D))}
    _A_in = _A_setup()

    def _B_setup():
        B, S, D, F = (1, 2048, 1024, 3584)
        Fh = F // 2
        return {'x': _w((lambda *s: torch.randn(*s, dtype=torch.bfloat16) * 0.05)(B, S, D)), 'w_in': _w((lambda *s: torch.randn(*s, dtype=torch.bfloat16) * 0.4)(D, 2 * Fh)), 'w_sp': _w(0.01 * (lambda *s: torch.randn(*s, dtype=torch.bfloat16) * 0.4)(S, S)), 'b_sp': _w(1.0 + 0.01 * (lambda *s: torch.randn(*s, dtype=torch.bfloat16) * 0.05)(S)), 'w_out': _w((lambda *s: torch.randn(*s, dtype=torch.bfloat16) * 0.05)(Fh, D))}
    _B_in = _B_setup()
    return {'A_q': _A_in['q'], 'A_k': _A_in['k'], 'A_v': _A_in['v'], 'A_shift_k': _A_in['shift_k'], 'A_ssm_k': _A_in['ssm_k'], 'A_ssm_D': _A_in['ssm_D'], 'B_x': _B_in['x'], 'B_w_in': _B_in['w_in'], 'B_w_sp': _B_in['w_sp'], 'B_b_sp': _B_in['b_sp'], 'B_w_out': _B_in['w_out']}

def reference(A_q, A_k, A_v, A_shift_k, A_ssm_k, A_ssm_D, B_x, B_w_in, B_w_sp, B_b_sp, B_w_out):

    def _A_ref(q, k, v, shift_k, ssm_k, ssm_D):
        B, S, D = q.shape
        ks = shift_k.shape[-1]
        k_pad = _pad(k, ((0, 0), (ks - 1, 0), (0, 0)))
        k_shift = torch.zeros_like(k)
        for t in range(ks):
            k_shift = k_shift + k_pad[:, t:t + S, :] * shift_k[:, ks - 1 - t][None, None, :]
        kv = k_shift * v
        L = 2 * S
        kv_pad = _pad(kv, ((0, 0), (0, S), (0, 0)))
        kf_pad = _pad(ssm_k, ((0, 0), (0, S)))
        kv_f = (lambda x, axes=(-2, -1): torch.fft.rfft2(x.float(), dim=axes))(kv_pad[:, None, :, :], axes=(1, 2))
        kf_f = (lambda x, axes=(-2, -1): torch.fft.rfft2(x.float(), dim=axes))(kf_pad[:, None, :], axes=(1, 2))
        kf_f = (lambda x, *d: x.permute(*d))(kf_f, 1, 2, 0)
        y_f = kv_f * kf_f[None, :, :, :]
        y = (lambda x, s, axes=(-2, -1): torch.fft.irfft2(x, s=s, dim=axes).to(torch.bfloat16))(y_f, (1, L), axes=(1, 2))[:, 0, :S, :]
        y = y + kv * ssm_D[None, None, :]
        return q * y

    def _B_ref(x, w_in, w_sp, b_sp, w_out):
        B, S, D = x.shape
        F = w_in.shape[-1]
        Fh = F // 2
        z = _gelu(torch.einsum('bsd,df->bsf', x, w_in))
        z1 = z[..., :Fh].clone()
        z2 = _layernorm(z[..., Fh:], axis=-1)
        g = torch.einsum('ts,bsf->btf', w_sp, z2) + b_sp[None, :, None]
        return torch.einsum('bsf,fd->bsd', z1 * g, w_out)
    x = A_q
    xn = _layernorm(x, axis=-1)
    return x + _A_ref(xn, A_k, A_v, A_shift_k, A_ssm_k, A_ssm_D) + _B_ref(xn, B_w_in, B_w_sp, B_b_sp, B_w_out)
```

```asm
; @launch kernel=mega_kernel grid=(256,1,1) block=(512,1,1) lds=163840
.amdgcn_target "amdgcn-amd-amdhsa--gfx950"
.text
.globl mega_kernel
.p2align 8
.type mega_kernel,@function
mega_kernel:
    s_cmp_ge_u32 s2, 256
    s_cbranch_scc1 mega_kernel_end
    s_load_dwordx4 s[4:7], s[0:1], 56
    s_load_dwordx2 s[8:9], s[0:1], 72
    s_load_dwordx2 s[10:11], s[0:1], 104
    v_lshrrev_b32 v1, 6, v0
    v_and_b32 v0, 63, v0
    v_readfirstlane_b32 s3, v1
    s_and_b32 s14, s2, 7
    s_lshr_b32 s15, s2, 3
    s_cmp_ge_u32 s15, 28
    s_cbranch_scc1 mega_kernel_helper
    s_and_b32 s12, s14, 3
    s_lshl_b32 s12, s12, 2
    s_and_b32 s13, s15, 3
    s_add_u32 s12, s12, s13
    s_lshr_b32 s13, s14, 2
    s_mul_i32 s13, s13, 7
    s_lshr_b32 s15, s15, 2
    s_add_u32 s13, s13, s15
    s_and_b32 s38, s3, 3
    s_cmp_lt_u32 s3, 4
    s_cbranch_scc1 mega_kernel_cons
    s_load_dwordx2 s[44:45], s[0:1], 0
    s_load_dwordx2 s[84:85], s[0:1], 8
    s_load_dwordx4 s[56:59], s[0:1], 16
    s_load_dwordx2 s[54:55], s[0:1], 96
    s_mul_i32 s36, s38, 16384
    s_add_u32 s37, s36, 65536
    s_mov_b32 s39, 0
    s_mov_b32 s24, 0
    s_mov_b32 s25, 64512
    s_mov_b32 s26, 129024
    s_mov_b32 s27, 193536
    s_mov_b32 s28, 0
    s_mov_b32 s29, 27648
    s_mov_b32 s30, 227328
    s_mov_b32 s31, 254976
    v_lshrrev_b32 v6, 3, v0
    v_bfe_u32 v7, v6, 1, 1
    v_and_b32 v1, 4, v6
    v_or_b32 v7, v7, v1
    s_and_b32 s40, s38, 1
    s_lshl_b32 s40, s40, 1
    s_lshr_b32 s41, s38, 1
    s_lshl_b32 s41, s41, 2
    s_or_b32 s40, s40, s41
    v_xor_b32 v7, s40, v7
    v_and_b32 v1, 7, v0
    v_xor_b32 v7, v7, v1
    v_lshlrev_b32 v7, 4, v7
    s_lshl_b32 s41, s38, 3
    v_add_u32 v6, s41, v6
    v_lshl_add_u32 v2, v6, 11, v7
    v_lshl_add_u32 v4, v6, 12, v7
    v_lshrrev_b32 v6, 4, v0
    s_and_b32 s40, s38, 1
    s_lshl_b32 s40, s40, 2
    v_or_b32 v7, s40, v6
    v_bfe_u32 v1, v0, 1, 3
    v_xor_b32 v7, v7, v1
    v_lshlrev_b32 v7, 5, v7
    v_and_b32 v1, 1, v0
    v_lshl_or_b32 v7, v1, 4, v7
    v_add_u32 v6, s41, v6
    v_mul_u32_u24 v6, 7168, v6
    v_add_u32 v3, v6, v7
    s_lshl_b32 s40, s38, 12
    v_lshl_add_u32 v5, v0, 4, s40
    s_waitcnt lgkmcnt(0)
    s_add_u32 s97, s12, s13
    s_and_b32 s97, s97, 3
    s_lshr_b32 s53, s12, 2
    s_lshl_b32 s53, s53, 2
    s_xor_b32 s8, s53, s97
    s_lshl_b32 s40, s12, 18
    s_lshl_b32 s41, s8, 7
    s_add_u32 s40, s40, s41
    s_add_u32 s16, s44, s40
    s_addc_u32 s17, s45, 0
    s_and_b32 s17, s17, 0xffff
    s_mov_b32 s18, 262144
    s_mov_b32 s19, 0x20000
    s_mul_i32 s41, s8, 458752
    s_lshl_b32 s40, s13, 8
    s_add_u32 s40, s40, s41
    s_add_u32 s40, s40, 3584
    s_add_u32 s20, s4, s40
    s_addc_u32 s21, s5, 0
    s_and_b32 s21, s21, 0xffff
    s_mov_b32 s22, 458752
    s_mov_b32 s23, 0x20000
    s_mov_b32 s93, 128
    s_mov_b32 s94, -1920
    s_mov_b32 s95, 458752
    s_mov_b32 s96, -6881280
    v_xor_b32 v24, 64, v2
    v_add_u32 v24, 32768, v24
    v_xor_b32 v26, 64, v4
    v_add_u32 v26, 65536, v26
    v_add_u32 v25, 114688, v3
    v_add_u32 v27, 8192, v5
    s_add_u32 m0, s36, s39
    s_xor_b32 s8, s53, s97
    buffer_load_dwordx4 v2, s[16:19], s24 offen offset:0 lds
    buffer_load_dwordx4 v2, s[16:19], s25 offen offset:1024 lds
    buffer_load_dwordx4 v2, s[16:19], s26 offen offset:2048 lds
    buffer_load_dwordx4 v2, s[16:19], s27 offen offset:3072 lds
    s_add_u32 s53, s53, 1
    s_and_b32 s53, s53, 15
    s_xor_b32 s9, s53, s97
    s_sub_u32 s8, s9, s8
    s_ashr_i32 s9, s8, 31
    s_mul_i32 s14, s8, 458752
    s_lshl_b32 s8, s8, 7
    s_add_u32 s16, s16, s8
    s_addc_u32 s17, s17, s9
    s_add_u32 m0, s37, s39
    s_add_u32 s39, s39, 4096
    buffer_load_dwordx4 v3, s[20:23], s28 offen offset:0 lds
    buffer_load_dwordx4 v3, s[20:23], s29 offen offset:1024 lds
    buffer_load_dwordx4 v3, s[20:23], s30 offen offset:2048 lds
    buffer_load_dwordx4 v3, s[20:23], s31 offen offset:3072 lds
    s_add_u32 s20, s20, s14
    s_addc_u32 s21, s21, s9
    s_and_b32 s39, s39, 16383
    s_add_u32 m0, s36, s39
    s_xor_b32 s8, s53, s97
    buffer_load_dwordx4 v2, s[16:19], s24 offen offset:0 lds
    buffer_load_dwordx4 v2, s[16:19], s25 offen offset:1024 lds
    buffer_load_dwordx4 v2, s[16:19], s26 offen offset:2048 lds
    buffer_load_dwordx4 v2, s[16:19], s27 offen offset:3072 lds
    s_add_u32 s53, s53, 1
    s_and_b32 s53, s53, 15
    s_xor_b32 s9, s53, s97
    s_sub_u32 s8, s9, s8
    s_ashr_i32 s9, s8, 31
    s_mul_i32 s14, s8, 458752
    s_lshl_b32 s8, s8, 7
    s_add_u32 s16, s16, s8
    s_addc_u32 s17, s17, s9
    s_add_u32 m0, s37, s39
    s_add_u32 s39, s39, 4096
    buffer_load_dwordx4 v3, s[20:23], s28 offen offset:0 lds
    buffer_load_dwordx4 v3, s[20:23], s29 offen offset:1024 lds
    buffer_load_dwordx4 v3, s[20:23], s30 offen offset:2048 lds
    buffer_load_dwordx4 v3, s[20:23], s31 offen offset:3072 lds
    s_add_u32 s20, s20, s14
    s_addc_u32 s21, s21, s9
    s_and_b32 s39, s39, 16383
    s_add_u32 m0, s36, s39
    s_xor_b32 s8, s53, s97
    buffer_load_dwordx4 v2, s[16:19], s24 offen offset:0 lds
    buffer_load_dwordx4 v2, s[16:19], s25 offen offset:1024 lds
    buffer_load_dwordx4 v2, s[16:19], s26 offen offset:2048 lds
    buffer_load_dwordx4 v2, s[16:19], s27 offen offset:3072 lds
    s_add_u32 s53, s53, 1
    s_and_b32 s53, s53, 15
    s_xor_b32 s9, s53, s97
    s_sub_u32 s8, s9, s8
    s_ashr_i32 s9, s8, 31
    s_mul_i32 s14, s8, 458752
    s_lshl_b32 s8, s8, 7
    s_add_u32 s16, s16, s8
    s_addc_u32 s17, s17, s9
    s_add_u32 m0, s37, s39
    s_add_u32 s39, s39, 4096
    buffer_load_dwordx4 v3, s[20:23], s28 offen offset:0 lds
    buffer_load_dwordx4 v3, s[20:23], s29 offen offset:1024 lds
    buffer_load_dwordx4 v3, s[20:23], s30 offen offset:2048 lds
    buffer_load_dwordx4 v3, s[20:23], s31 offen offset:3072 lds
    s_add_u32 s20, s20, s14
    s_addc_u32 s21, s21, s9
    s_and_b32 s39, s39, 16383
    s_add_u32 m0, s36, s39
    s_xor_b32 s8, s53, s97
    buffer_load_dwordx4 v2, s[16:19], s24 offen offset:0 lds
    buffer_load_dwordx4 v2, s[16:19], s25 offen offset:1024 lds
    buffer_load_dwordx4 v2, s[16:19], s26 offen offset:2048 lds
    buffer_load_dwordx4 v2, s[16:19], s27 offen offset:3072 lds
    s_add_u32 s53, s53, 1
    s_and_b32 s53, s53, 15
    s_xor_b32 s9, s53, s97
    s_sub_u32 s8, s9, s8
    s_ashr_i32 s9, s8, 31
    s_mul_i32 s14, s8, 458752
    s_lshl_b32 s8, s8, 7
    s_add_u32 s16, s16, s8
    s_addc_u32 s17, s17, s9
    s_add_u32 m0, s37, s39
    s_add_u32 s39, s39, 4096
    buffer_load_dwordx4 v3, s[20:23], s28 offen offset:0 lds
    buffer_load_dwordx4 v3, s[20:23], s29 offen offset:1024 lds
    buffer_load_dwordx4 v3, s[20:23], s30 offen offset:2048 lds
    buffer_load_dwordx4 v3, s[20:23], s31 offen offset:3072 lds
    s_add_u32 s20, s20, s14
    s_addc_u32 s21, s21, s9
    s_and_b32 s39, s39, 16383
    s_add_u32 s48, s10, 0x600000
    s_addc_u32 s49, s11, 0
    s_and_b32 s49, s49, 0xffff
    s_mov_b32 s50, 524288
    s_mov_b32 s51, 0x20000
    s_lshl_b32 s46, s13, 8
    s_add_u32 s46, s46, 0x7c000
    v_lshlrev_b32 v8, 2, v0
    s_cmp_lt_u32 s38, 2
    s_cbranch_scc1 mega_kernel_d2
    s_cmp_eq_u32 s38, 3
    s_cbranch_scc1 mega_kernel_s1
    s_lshl_b32 s47, s13, 1
    s_lshl_b32 s41, s47, 11
    v_lshl_add_u32 v10, v0, 4, s41
    s_lshl_b32 s40, s12, 18
    s_add_u32 s32, s44, s40
    s_addc_u32 s33, s45, 0
    s_and_b32 s33, s33, 0xffff
    s_mov_b32 s34, 262144
    s_mov_b32 s35, 0x20000
    s_mov_b32 s24, 57344
    s_mov_b32 s25, 114688
    s_mov_b32 s26, 172032
    s_mov_b32 s27, 229376
    s_lshr_b32 s40, s2, 3
    s_lshl_b32 s40, s40, 17
    s_and_b32 s41, s2, 7
    s_lshl_b32 s41, s41, 8
    s_add_u32 s40, s40, s41
    v_lshrrev_b32 v1, 1, v0
    v_lshlrev_b32 v1, 11, v1
    v_and_b32 v6, 1, v0
    v_lshl_add_u32 v6, v6, 7, v1
    v_add_u32 v24, s40, v6
    s_bfe_u32 s92, s2, 0x20003
    s_mov_b32 s28, 65536
    s_mov_b32 s16, s84
    s_and_b32 s17, s85, 0xffff
    s_mov_b32 s18, 4194304
    s_mov_b32 s19, 0x20000
    s_mov_b32 s88, s54
    s_and_b32 s89, s55, 0xffff
    s_mov_b32 s90, 128
    s_mov_b32 s91, 0x20000
    v_lshrrev_b32 v6, 4, v0
    v_mul_u32_u24 v7, 28, v6
    v_add_u32 v7, s47, v7
    v_and_b32 v1, 15, v0
    v_cmp_eq_u32 vcc, 0, v1
    v_lshlrev_b32 v7, 3, v7
    v_mov_b32 v1, 0x80000000
    v_cndmask_b32 v16, v1, v7, vcc
    s_add_u32 s40, s47, 112
    v_lshl_add_u32 v7, v0, 7, s40
    v_cmp_gt_u32 vcc, 128, v7
    v_lshlrev_b32 v7, 3, v7
    s_lshl_b32 s40, s12, 9
    v_cndmask_b32 v17, v1, v7, vcc
    s_add_u32 s40, s40, 0
    v_lshl_add_u32 v15, v0, 2, s40
    v_lshlrev_b32 v20, 4, v0
    v_lshlrev_b32 v21, 3, v0
    v_lshlrev_b32 v28, 2, v0
    v_and_b32 v1, 31, v0
    v_lshlrev_b32 v18, 2, v1
    v_lshlrev_b32 v23, 4, v1
    s_lshl_b32 s97, s12, 10
    s_add_u32 s97, s97, 0x78000
    s_lshl_b32 s98, s13, 13
    s_add_u32 s98, s98, 0x40000
    s_and_b32 s47, s12, 3
    v_bfe_u32 v7, v0, 2, 2
    v_and_b32 v1, 1, v6
    v_lshl_or_b32 v1, v1, 2, v7
    v_lshlrev_b32 v6, 14, v6
    v_lshl_add_u32 v6, v7, 8, v6
    v_and_b32 v7, 3, v0
    v_lshl_add_u32 v6, v7, 3, v6
    v_add_u32 v6, 65536, v6
    v_xor_b32 v7, 0, v1
    v_lshl_add_u32 v11, v7, 5, v6
    v_xor_b32 v7, 1, v1
    v_lshl_add_u32 v12, v7, 5, v6
    v_xor_b32 v7, 2, v1
    v_lshl_add_u32 v13, v7, 5, v6
    v_xor_b32 v7, 3, v1
    v_lshl_add_u32 v14, v7, 5, v6
    v_mov_b32 v72, 0x3f803f80
    v_mov_b32 v73, 0x3f803f80
    v_mov_b32 v74, 0x3f803f80
    v_mov_b32 v75, 0x3f803f80
    v_and_b32 v1, 31, v0
    v_lshrrev_b32 v6, 5, v0
    v_lshlrev_b32 v7, 4, v1
    v_lshl_add_u32 v170, v6, 10, v7
    v_lshlrev_b32 v7, 3, v1
    v_lshl_add_u32 v7, v6, 2, v7
    v_add_u32 v171, 137216, v7
    s_waitcnt vmcnt(24)
    s_barrier
    buffer_load_dwordx4 v[32:35], v10, s[32:35], 0 offen offset:0
    buffer_load_dwordx4 v[36:39], v10, s[32:35], 0 offen offset:1024
    buffer_load_dwordx4 v[40:43], v10, s[32:35], s24 offen offset:0
    buffer_load_dwordx4 v[44:47], v10, s[32:35], s24 offen offset:1024
    buffer_load_dwordx4 v[48:51], v10, s[32:35], s25 offen offset:0
    buffer_load_dwordx4 v[52:55], v10, s[32:35], s25 offen offset:1024
    buffer_load_dwordx4 v[56:59], v10, s[32:35], s26 offen offset:0
    buffer_load_dwordx4 v[60:63], v10, s[32:35], s26 offen offset:1024
    buffer_load_dwordx4 v[64:67], v10, s[32:35], s27 offen offset:0
    buffer_load_dwordx4 v[68:71], v10, s[32:35], s27 offen offset:1024
    s_branch mega_kernel_s0_cs0
mega_kernel_s0_cs0_k:
    s_waitcnt vmcnt(26)
    s_barrier
    s_waitcnt vmcnt(18)
    s_barrier
    s_waitcnt vmcnt(10)
    s_barrier
    s_barrier
    s_barrier
    s_waitcnt vmcnt(0)
    v_dot2_f32_bf16 v192, v32, v72, 0
    v_dot2_f32_bf16 v194, v32, v32, 0
    v_dot2_f32_bf16 v193, v33, v72, 0
    v_dot2_f32_bf16 v195, v33, v33, 0
    v_dot2_f32_bf16 v192, v34, v72, v192
    v_dot2_f32_bf16 v194, v34, v34, v194
    v_dot2_f32_bf16 v193, v35, v72, v193
    v_dot2_f32_bf16 v195, v35, v35, v195
    v_dot2_f32_bf16 v192, v36, v72, v192
    v_dot2_f32_bf16 v194, v36, v36, v194
    v_dot2_f32_bf16 v193, v37, v72, v193
    v_dot2_f32_bf16 v195, v37, v37, v195
    v_dot2_f32_bf16 v192, v38, v72, v192
    v_dot2_f32_bf16 v194, v38, v38, v194
    v_dot2_f32_bf16 v193, v39, v72, v193
    v_dot2_f32_bf16 v195, v39, v39, v195
    s_nop 2
    v_add_f32 v192, v192, v193
    v_add_f32 v194, v194, v195
    v_dot2_f32_bf16 v196, v40, v72, 0
    v_dot2_f32_bf16 v198, v40, v40, 0
    v_dot2_f32_bf16 v197, v41, v72, 0
    v_dot2_f32_bf16 v199, v41, v41, 0
    v_dot2_f32_bf16 v196, v42, v72, v196
    v_dot2_f32_bf16 v198, v42, v42, v198
    v_dot2_f32_bf16 v197, v43, v72, v197
    v_dot2_f32_bf16 v199, v43, v43, v199
    v_dot2_f32_bf16 v196, v44, v72, v196
    v_dot2_f32_bf16 v198, v44, v44, v198
    v_dot2_f32_bf16 v197, v45, v72, v197
    v_dot2_f32_bf16 v199, v45, v45, v199
    v_dot2_f32_bf16 v196, v46, v72, v196
    v_dot2_f32_bf16 v198, v46, v46, v198
    v_dot2_f32_bf16 v197, v47, v72, v197
    v_dot2_f32_bf16 v199, v47, v47, v199
    s_nop 2
    v_add_f32 v196, v196, v197
    v_add_f32 v198, v198, v199
    v_dot2_f32_bf16 v200, v48, v72, 0
    v_dot2_f32_bf16 v202, v48, v48, 0
    v_dot2_f32_bf16 v201, v49, v72, 0
    v_dot2_f32_bf16 v203, v49, v49, 0
    v_dot2_f32_bf16 v200, v50, v72, v200
    v_dot2_f32_bf16 v202, v50, v50, v202
    v_dot2_f32_bf16 v201, v51, v72, v201
    v_dot2_f32_bf16 v203, v51, v51, v203
    v_dot2_f32_bf16 v200, v52, v72, v200
    v_dot2_f32_bf16 v202, v52, v52, v202
    v_dot2_f32_bf16 v201, v53, v72, v201
    v_dot2_f32_bf16 v203, v53, v53, v203
    v_dot2_f32_bf16 v200, v54, v72, v200
    v_dot2_f32_bf16 v202, v54, v54, v202
    v_dot2_f32_bf16 v201, v55, v72, v201
    v_dot2_f32_bf16 v203, v55, v55, v203
    s_nop 2
    v_add_f32 v200, v200, v201
    v_add_f32 v202, v202, v203
    buffer_load_dword v19, v18, s[88:91], 0 offen sc1
    s_barrier
    v_dot2_f32_bf16 v204, v56, v72, 0
    v_dot2_f32_bf16 v206, v56, v56, 0
    v_dot2_f32_bf16 v205, v57, v72, 0
    v_dot2_f32_bf16 v207, v57, v57, 0
    v_dot2_f32_bf16 v204, v58, v72, v204
    v_dot2_f32_bf16 v206, v58, v58, v206
    v_dot2_f32_bf16 v205, v59, v72, v205
    v_dot2_f32_bf16 v207, v59, v59, v207
    v_dot2_f32_bf16 v204, v60, v72, v204
    v_dot2_f32_bf16 v206, v60, v60, v206
    v_dot2_f32_bf16 v205, v61, v72, v205
    v_dot2_f32_bf16 v207, v61, v61, v207
    v_dot2_f32_bf16 v204, v62, v72, v204
    v_dot2_f32_bf16 v206, v62, v62, v206
    v_dot2_f32_bf16 v205, v63, v72, v205
    v_dot2_f32_bf16 v207, v63, v63, v207
    s_nop 2
    v_add_f32 v204, v204, v205
    v_add_f32 v206, v206, v207
    v_dot2_f32_bf16 v208, v64, v72, 0
    v_dot2_f32_bf16 v210, v64, v64, 0
    v_dot2_f32_bf16 v209, v65, v72, 0
    v_dot2_f32_bf16 v211, v65, v65, 0
    v_dot2_f32_bf16 v208, v66, v72, v208
    v_dot2_f32_bf16 v210, v66, v66, v210
    v_dot2_f32_bf16 v209, v67, v72, v209
    v_dot2_f32_bf16 v211, v67, v67, v211
    v_dot2_f32_bf16 v208, v68, v72, v208
    v_dot2_f32_bf16 v210, v68, v68, v210
    v_dot2_f32_bf16 v209, v69, v72, v209
    v_dot2_f32_bf16 v211, v69, v69, v211
    v_dot2_f32_bf16 v208, v70, v72, v208
    v_dot2_f32_bf16 v210, v70, v70, v210
    v_dot2_f32_bf16 v209, v71, v72, v209
    v_dot2_f32_bf16 v211, v71, v71, v211
    s_nop 2
    v_add_f32 v208, v208, v209
    v_add_f32 v210, v210, v211
    s_barrier
    s_nop 1
    v_permlane32_swap_b32 v192, v194
    v_permlane32_swap_b32 v196, v198
    v_permlane32_swap_b32 v200, v202
    v_permlane32_swap_b32 v204, v206
    v_permlane32_swap_b32 v208, v210
    s_nop 1
    v_add_f32 v192, v192, v194
    v_add_f32 v196, v196, v198
    v_add_f32 v200, v200, v202
    v_add_f32 v204, v204, v206
    v_add_f32 v208, v208, v210
    v_mov_b32 v209, v208
    s_nop 1
    v_permlane16_swap_b32 v192, v196
    v_permlane16_swap_b32 v200, v204
    v_permlane16_swap_b32 v208, v209
    s_nop 1
    v_add_f32 v192, v192, v196
    v_add_f32 v200, v200, v204
    v_add_f32 v208, v208, v209
    v_add_f32_dpp v192, v192, v192 quad_perm:[1,0,3,2] row_mask:0xf bank_mask:0xf
    v_add_f32_dpp v200, v200, v200 quad_perm:[1,0,3,2] row_mask:0xf bank_mask:0xf
    v_add_f32_dpp v208, v208, v208 quad_perm:[1,0,3,2] row_mask:0xf bank_mask:0xf
    v_add_f32_dpp v192, v192, v192 quad_perm:[2,3,0,1] row_mask:0xf bank_mask:0xf
    v_add_f32_dpp v200, v200, v200 quad_perm:[2,3,0,1] row_mask:0xf bank_mask:0xf
    v_add_f32_dpp v208, v208, v208 quad_perm:[2,3,0,1] row_mask:0xf bank_mask:0xf
    v_add_f32_dpp v192, v192, v192 row_half_mirror row_mask:0xf bank_mask:0xf
    v_add_f32_dpp v200, v200, v200 row_half_mirror row_mask:0xf bank_mask:0xf
    v_add_f32_dpp v208, v208, v208 row_half_mirror row_mask:0xf bank_mask:0xf
    v_add_f32_dpp v192, v192, v192 row_mirror row_mask:0xf bank_mask:0xf
    v_add_f32_dpp v200, v200, v200 row_mirror row_mask:0xf bank_mask:0xf
    v_add_f32_dpp v208, v208, v208 row_mirror row_mask:0xf bank_mask:0xf
    v_mov_b32 v209, v208
    s_nop 1
    v_permlane32_swap_b32 v192, v200
    v_permlane32_swap_b32 v208, v209
    s_nop 1
    v_mul_f32 v192, 0x3a800000, v192
    v_mul_f32 v200, 0x3a800000, v200
    v_fma_f32 v200, -v192, v192, v200
    v_max_f32 v200, 0, v200
    v_add_f32 v200, 0x3727c5ac, v200
    v_rsq_f32 v195, v200
    s_nop 0
    v_mul_f32_e64 v194, -v192, v195
    v_mul_f32 v208, 0x3a800000, v208
    v_mul_f32 v209, 0x3a800000, v209
    v_fma_f32 v209, -v208, v208, v209
    v_max_f32 v209, 0, v209
    v_add_f32 v209, 0x3727c5ac, v209
    v_rsq_f32 v197, v209
    s_nop 0
    v_mul_f32_e64 v196, -v208, v197
    s_waitcnt vmcnt(0)
    v_cmp_eq_u32 vcc, 0, v19
    s_cbranch_vccnz mega_kernel_s0_gt_s
mega_kernel_s0_gt_k:
    s_barrier
    buffer_store_dwordx2 v[194:195], v16, s[48:51], s97 offen sc1
    buffer_store_dwordx2 v[196:197], v17, s[48:51], s97 offen sc1
    s_mov_b32 vcc_lo, 0xffff
    s_mov_b32 vcc_hi, 0xffff
    v_cndmask_b32 v108, v112, v108, vcc
    v_cndmask_b32 v116, v120, v116, vcc
    s_mov_b32 vcc_lo, -1
    s_mov_b32 vcc_hi, 0
    v_cndmask_b32 v108, v116, v108, vcc
    buffer_store_dword v108, v15, s[48:51], s98 offen sc1
    s_barrier
    s_barrier
    s_barrier
    s_add_u32 s99, s98, 4096
    buffer_load_dwordx4 v[128:131], v20, s[48:51], s98 offen offset:0 sc1
    buffer_load_dwordx4 v[132:135], v20, s[48:51], s98 offen offset:1024 sc1
    buffer_load_dwordx4 v[136:139], v20, s[48:51], s98 offen offset:2048 sc1
    buffer_load_dwordx4 v[140:143], v20, s[48:51], s98 offen offset:3072 sc1
    buffer_load_dwordx4 v[144:147], v20, s[48:51], s99 offen offset:0 sc1
    buffer_load_dwordx4 v[148:151], v20, s[48:51], s99 offen offset:1024 sc1
    buffer_load_dwordx4 v[152:155], v20, s[48:51], s99 offen offset:2048 sc1
    buffer_load_dwordx4 v[156:159], v20, s[48:51], s99 offen offset:3072 sc1
    buffer_load_dwordx4 v[160:163], v20, s[48:51], s97 offen sc1
    s_barrier
    s_barrier
    s_waitcnt vmcnt(0)
    v_max3_u32 v176, v128, v129, v130
    v_max3_u32 v176, v176, v131, v132
    v_max3_u32 v176, v176, v133, v134
    v_max3_u32 v176, v176, v135, v136
    v_max3_u32 v176, v176, v137, v138
    v_max3_u32 v176, v176, v139, v140
    v_max3_u32 v176, v176, v141, v142
    v_max3_u32 v176, v176, v143, v144
    v_max3_u32 v176, v176, v145, v146
    v_max3_u32 v176, v176, v147, v148
    v_max3_u32 v176, v176, v149, v150
    v_max3_u32 v176, v176, v151, v152
    v_max3_u32 v176, v176, v153, v154
    v_max3_u32 v176, v176, v155, v156
    v_max3_u32 v176, v176, v157, v158
    v_max3_u32 v176, v176, v159, v160
    v_max3_u32 v176, v176, v161, v162
    v_max_u32 v176, v176, v163
    v_cmp_eq_u32 vcc, -1, v176
    s_cbranch_vccnz mega_kernel_s0_pl0_s
mega_kernel_s0_pl0_k:
    v_add_u32 v1, 135168, v21
    ds_write2_b32 v1, v161, v163 offset0:0 offset1:1
    ds_write2_b32 v1, v160, v162 offset0:128 offset1:129
    v_add_f32 v128, v128, v144
    v_add_f32 v129, v129, v145
    v_add_f32 v130, v130, v146
    v_add_f32 v131, v131, v147
    v_add_f32 v132, v132, v148
    v_add_f32 v133, v133, v149
    v_add_f32 v134, v134, v150
    v_add_f32 v135, v135, v151
    v_add_f32 v136, v136, v152
    v_add_f32 v137, v137, v153
    v_add_f32 v138, v138, v154
    v_add_f32 v139, v139, v155
    v_add_f32 v140, v140, v156
    v_add_f32 v141, v141, v157
    v_add_f32 v142, v142, v158
    v_add_f32 v143, v143, v159
    s_barrier
    v_add_f32 v128, v128, v136
    v_add_f32 v129, v129, v137
    v_add_f32 v130, v130, v138
    v_add_f32 v131, v131, v139
    v_add_f32 v132, v132, v140
    v_add_f32 v133, v133, v141
    v_add_f32 v134, v134, v142
    v_add_f32 v135, v135, v143
    v_add_f32 v128, v128, v132
    v_add_f32 v129, v129, v133
    v_add_f32 v130, v130, v134
    v_add_f32 v131, v131, v135
    v_lshrrev_b32 v1, 5, v0
    v_lshl_add_u32 v1, v1, 3, v23
    v_permlane32_swap_b32 v128, v130
    v_permlane32_swap_b32 v129, v131
    v_add_u32 v1, 136192, v1
    s_nop 0
    v_add_f32 v128, v128, v130
    v_add_f32 v129, v129, v131
    ds_write_b64 v1, v[128:129]
    s_waitcnt lgkmcnt(0)
    s_barrier
    s_barrier
    s_branch mega_kernel_s0_cs16
mega_kernel_s0_cs16_k:
    s_barrier
    v_add_u32 v1, 131072, v21
    s_lshl_b32 s40, s12, 14
    s_add_u32 s29, s40, 0x0
    ds_read_b64 v[176:177], v1
    ds_read_b64 v[178:179], v1 offset:1024
    s_lshl_b32 s40, s13, 10
    s_add_u32 s40, s40, s29
    s_add_u32 s30, s29, 4096
    s_add_u32 s31, s29, 8192
    s_add_u32 s28, s29, 12288
    s_waitcnt lgkmcnt(0)
    v_add_f32 v176, v176, v178
    v_add_f32 v177, v177, v179
    buffer_store_dwordx2 v[176:177], v21, s[48:51], s40 offen sc1
    s_barrier
    s_barrier
    s_barrier
    s_barrier
    s_add_u32 s98, s98, 114688
    s_mov_b32 vcc_lo, 0xffff
    s_mov_b32 vcc_hi, 0xffff
    v_cndmask_b32 v108, v112, v108, vcc
    v_cndmask_b32 v116, v120, v116, vcc
    s_mov_b32 vcc_lo, -1
    s_mov_b32 vcc_hi, 0
    v_cndmask_b32 v108, v116, v108, vcc
    buffer_store_dword v108, v15, s[48:51], s98 offen sc1
    buffer_load_dwordx4 v[128:131], v170, s[48:51], s29 offen offset:0 sc1
    buffer_load_dwordx4 v[132:135], v170, s[48:51], s29 offen offset:2048 sc1
    buffer_load_dwordx4 v[136:139], v170, s[48:51], s30 offen offset:0 sc1
    buffer_load_dwordx4 v[140:143], v170, s[48:51], s30 offen offset:2048 sc1
    buffer_load_dwordx4 v[144:147], v170, s[48:51], s31 offen offset:0 sc1
    buffer_load_dwordx4 v[148:151], v170, s[48:51], s31 offen offset:2048 sc1
    buffer_load_dwordx4 v[152:155], v170, s[48:51], s28 offen offset:0 sc1
    s_barrier
    s_waitcnt vmcnt(0)
    v_add_f32 v156, v128, v132
    v_add_f32 v157, v129, v133
    v_add_f32 v158, v130, v134
    v_add_f32 v159, v131, v135
    v_add_f32 v156, v156, v136
    v_add_f32 v157, v157, v137
    v_add_f32 v158, v158, v138
    v_add_f32 v159, v159, v139
    v_add_f32 v156, v156, v140
    v_add_f32 v157, v157, v141
    v_add_f32 v158, v158, v142
    v_add_f32 v159, v159, v143
    v_add_f32 v156, v156, v144
    v_add_f32 v157, v157, v145
    v_add_f32 v158, v158, v146
    v_add_f32 v159, v159, v147
    v_add_f32 v156, v156, v148
    v_add_f32 v157, v157, v149
    v_add_f32 v158, v158, v150
    v_add_f32 v159, v159, v151
    v_add_f32 v156, v156, v152
    v_add_f32 v157, v157, v153
    v_add_f32 v158, v158, v154
    v_add_f32 v159, v159, v155
    s_nop 1
    v_permlane32_swap_b32 v156, v158
    v_permlane32_swap_b32 v157, v159
    s_nop 1
    v_add_f32 v156, v156, v158
    v_add_f32 v157, v157, v159
    v_cmp_u_f32 vcc, v156, v157
    v_add_u32 v1, 137216, v28
    s_cbranch_vccnz mega_kernel_s0_st_slow
mega_kernel_s0_st_ok:
    v_mul_f32 v156, 0x3a124925, v156
    v_mul_f32 v157, 0x3a124925, v157
    v_fma_f32 v157, -v156, v156, v157
    v_max_f32 v157, 0, v157
    v_add_f32 v157, 0x3727c5ac, v157
    v_rsq_f32 v129, v157
    s_nop 0
    v_mul_f32_e64 v128, -v156, v129
    ds_write2_b32 v171, v129, v128 offset0:0 offset1:128
    s_waitcnt lgkmcnt(0)
    s_barrier
    s_barrier
    s_barrier
    s_barrier
    s_barrier
    s_add_u32 s99, s98, 4096
    buffer_load_dwordx4 v[128:131], v20, s[48:51], s98 offen offset:0 sc1
    buffer_load_dwordx4 v[132:135], v20, s[48:51], s98 offen offset:1024 sc1
    buffer_load_dwordx4 v[136:139], v20, s[48:51], s98 offen offset:2048 sc1
    buffer_load_dwordx4 v[140:143], v20, s[48:51], s98 offen offset:3072 sc1
    buffer_load_dwordx4 v[144:147], v20, s[48:51], s99 offen offset:0 sc1
    buffer_load_dwordx4 v[148:151], v20, s[48:51], s99 offen offset:1024 sc1
    buffer_load_dwordx4 v[152:155], v20, s[48:51], s99 offen offset:2048 sc1
    buffer_load_dwordx4 v[156:159], v20, s[48:51], s99 offen offset:3072 sc1
    s_barrier
    buffer_load_dword v29, v28, s[48:51], s46 offen sc1
    s_barrier
    s_waitcnt vmcnt(1)
    v_max3_u32 v176, v128, v129, v130
    v_max3_u32 v176, v176, v131, v132
    v_max3_u32 v176, v176, v133, v134
    v_max3_u32 v176, v176, v135, v136
    v_max3_u32 v176, v176, v137, v138
    v_max3_u32 v176, v176, v139, v140
    v_max3_u32 v176, v176, v141, v142
    v_max3_u32 v176, v176, v143, v144
    v_max3_u32 v176, v176, v145, v146
    v_max3_u32 v176, v176, v147, v148
    v_max3_u32 v176, v176, v149, v150
    v_max3_u32 v176, v176, v151, v152
    v_max3_u32 v176, v176, v153, v154
    v_max3_u32 v176, v176, v155, v156
    v_max3_u32 v176, v176, v157, v158
    v_max_u32 v176, v176, v159
    v_cmp_eq_u32 vcc, -1, v176
    s_cbranch_vccnz mega_kernel_s0_pl1_s
mega_kernel_s0_pl1_k:
    v_add_f32 v128, v128, v144
    v_add_f32 v129, v129, v145
    v_add_f32 v130, v130, v146
    v_add_f32 v131, v131, v147
    v_add_f32 v132, v132, v148
    v_add_f32 v133, v133, v149
    v_add_f32 v134, v134, v150
    v_add_f32 v135, v135, v151
    v_add_f32 v136, v136, v152
    v_add_f32 v137, v137, v153
    v_add_f32 v138, v138, v154
    v_add_f32 v139, v139, v155
    v_add_f32 v140, v140, v156
    v_add_f32 v141, v141, v157
    v_add_f32 v142, v142, v158
    v_add_f32 v143, v143, v159
    s_waitcnt vmcnt(0)
    v_cmp_eq_u32 vcc, -1, v29
    s_cbranch_vccnz mega_kernel_s0_zf_s
mega_kernel_s0_zf_k:
    s_barrier
    v_add_f32 v128, v128, v136
    v_add_f32 v129, v129, v137
    v_add_f32 v130, v130, v138
    v_add_f32 v131, v131, v139
    v_add_f32 v132, v132, v140
    v_add_f32 v133, v133, v141
    v_add_f32 v134, v134, v142
    v_add_f32 v135, v135, v143
    v_add_f32 v128, v128, v132
    v_add_f32 v129, v129, v133
    v_add_f32 v130, v130, v134
    v_add_f32 v131, v131, v135
    v_lshrrev_b32 v1, 5, v0
    v_lshl_add_u32 v1, v1, 3, v23
    v_permlane32_swap_b32 v128, v130
    v_permlane32_swap_b32 v129, v131
    v_add_u32 v1, 136704, v1
    s_nop 0
    v_add_f32 v128, v128, v130
    v_add_f32 v129, v129, v131
    ds_write_b64 v1, v[128:129]
    s_waitcnt lgkmcnt(0)
    s_barrier
    s_barrier
    s_barrier
    s_barrier
    s_barrier
    s_barrier
    s_barrier
    s_barrier
    s_barrier
    s_barrier
    s_barrier
    s_barrier
    s_barrier
    s_barrier
    s_barrier
    s_barrier
    s_barrier
    s_barrier
    s_barrier
    s_barrier
    s_barrier
    s_barrier
    s_barrier
    s_barrier
    s_barrier
    s_barrier
    s_barrier
    s_barrier
    s_barrier
    s_load_dwordx2 s[96:97], s[0:1], 0
    s_and_b32 s40, s2, 4
    s_lshl_b32 s40, s40, 1
    s_lshr_b32 s41, s2, 5
    s_add_u32 s40, s40, s41
    s_cmp_ge_u32 s2, 96
    s_addc_u32 s40, s40, 0
    s_lshl_b32 s40, s40, 7
    s_lshl_b32 s98, s12, 18
    s_add_u32 s98, s98, s40
    v_lshrrev_b32 v6, 3, v0
    v_bfe_u32 v7, v0, 4, 1
    v_or_b32 v7, 0, v7
    v_and_b32 v1, 7, v0
    v_xor_b32 v7, v7, v1
    v_lshlrev_b32 v7, 4, v7
    v_lshl_add_u32 v28, v6, 11, v7
    v_add_u32 v28, 0, v28
    v_xor_b32 v29, 64, v28
    v_add_u32 v29, 32768, v29
    s_barrier
    s_load_dwordx2 s[94:95], s[0:1], 80
    s_lshl_b32 s31, s2, 14
    s_add_u32 s31, s31, 0
    v_lshlrev_b32 v30, 7, v0
    s_waitcnt lgkmcnt(0)
    s_add_u32 s88, s96, s98
    s_addc_u32 s89, s97, 0
    s_and_b32 s89, s89, 0xffff
    s_mov_b32 s90, 260224
    s_mov_b32 s91, 0x20000
    s_barrier
    s_waitcnt lgkmcnt(0)
    s_mov_b32 s32, s94
    s_and_b32 s33, s95, 0xffff
    s_mov_b32 s34, 3670016
    s_mov_b32 s35, 0x20000
    s_mov_b32 m0, 147456
    s_mov_b32 s41, 0
    buffer_load_dwordx4 v28, s[88:91], s41 offen  lds
    s_mov_b32 m0, 149504
    s_mov_b32 s41, 0
    buffer_load_dwordx4 v29, s[88:91], s41 offen  lds
    s_mov_b32 m0, 151552
    s_mov_b32 s41, 65536
    buffer_load_dwordx4 v28, s[88:91], s41 offen  lds
    s_mov_b32 m0, 153600
    s_mov_b32 s41, 65536
    buffer_load_dwordx4 v29, s[88:91], s41 offen  lds
    s_mov_b32 m0, 155648
    s_mov_b32 s41, 131072
    buffer_load_dwordx4 v28, s[88:91], s41 offen  lds
    s_mov_b32 m0, 157696
    s_mov_b32 s41, 131072
    buffer_load_dwordx4 v29, s[88:91], s41 offen  lds
    s_mov_b32 m0, 159744
    s_mov_b32 s41, 196608
    buffer_load_dwordx4 v28, s[88:91], s41 offen  lds
    s_mov_b32 m0, 161792
    s_mov_b32 s41, 196608
    buffer_load_dwordx4 v29, s[88:91], s41 offen  lds
    s_barrier
    buffer_load_dword v31, v30, s[32:35], s31 offen
    s_load_dwordx2 s[4:5], s[0:1], 0
    s_load_dwordx4 s[56:59], s[0:1], 80
    s_and_b32 s38, s3, 3
    s_and_b32 s12, s2, 3
    s_lshl_b32 s12, s12, 2
    s_bfe_u32 s13, s2, 0x20003
    s_add_u32 s12, s12, s13
    s_and_b32 s13, s2, 4
    s_lshl_b32 s13, s13, 1
    s_lshr_b32 s40, s2, 5
    s_add_u32 s13, s13, s40
    v_lshrrev_b32 v6, 3, v0
    v_bfe_u32 v7, v0, 4, 1
    s_lshl_b32 s40, s38, 1
    v_or_b32 v7, s40, v7
    v_and_b32 v1, 7, v0
    v_xor_b32 v7, v7, v1
    v_lshlrev_b32 v7, 4, v7
    s_lshl_b32 s41, s38, 3
    v_add_u32 v1, s41, v6
    v_lshl_add_u32 v2, v1, 11, v7
    s_lshl_b32 s44, s12, 18
    s_cmp_ge_u32 s2, 96
    s_addc_u32 s45, s13, 0
    s_lshl_b32 s45, s45, 7
    s_add_u32 s44, s44, s45
    s_lshl_b32 s36, s38, 12
    v_lshl_add_u32 v3, v0, 4, s36
    v_bfe_u32 v7, v0, 4, 2
    v_bfe_u32 v1, v0, 1, 2
    v_xor_b32 v7, v7, v1
    v_lshlrev_b32 v7, 5, v7
    v_and_b32 v1, 1, v0
    v_lshl_or_b32 v7, v1, 4, v7
    s_lshl_b32 s41, s38, 4
    v_add_u32 v1, s41, v6
    v_lshl_add_u32 v4, v1, 11, v7
    v_lshrrev_b32 v6, 4, v0
    v_lshlrev_b32 v7, 2, v6
    v_and_b32 v1, 15, v0
    v_xor_b32 v7, v7, v1
    v_lshlrev_b32 v7, 4, v7
    v_add_u32 v1, s41, v6
    v_lshl_add_u32 v5, v1, 12, v7
    s_lshl_b32 s37, s38, 11
    s_add_u32 s37, s37, 114688
    s_mov_b32 s39, 0
    s_mov_b32 s43, 0
    s_mul_i32 s40, s12, 458752
    s_add_u32 s40, s40, 0x3000000
    v_mov_b32 v1, 0x80000000
    v_lshlrev_b32 v8, 2, v0
    v_cmp_gt_u32 vcc, 8, v0
    s_lshl_b32 s46, s12, 8
    s_add_u32 s46, s46, 0x7d000
    v_cndmask_b32 v9, v1, v8, vcc
    s_lshl_b32 s47, s13, 5
    s_add_u32 s47, s47, 0x7e000
    v_mov_b32 v11, 98304
    v_mov_b32 v6, 0
    v_mov_b32 v7, 0
    ds_write_b64 v11, v[6:7]
    v_cmp_gt_u32 vcc, 14, v0
    v_lshlrev_b32 v8, 7, v0
    s_lshl_b32 s46, s12, 14
    v_cndmask_b32 v8, v1, v8, vcc
    s_add_u32 s46, s46, 0x3800
    s_waitcnt lgkmcnt(0)
    s_add_u32 s16, s10, s40
    s_addc_u32 s17, s11, 0
    s_and_b32 s17, s17, 0xffff
    s_mov_b32 s18, 458752
    s_mov_b32 s19, 0x20000
    s_add_u32 s20, s56, s45
    s_addc_u32 s21, s57, 0
    s_and_b32 s21, s21, 0xffff
    s_mov_b32 s22, 3670016
    s_mov_b32 s23, 0x20000
    s_add_u32 s48, s10, 0x600000
    s_addc_u32 s49, s11, 0
    s_and_b32 s49, s49, 0xffff
    s_mov_b32 s50, 524288
    s_mov_b32 s51, 0x20000
    s_lshr_b32 s40, s13, 3
    s_sub_u32 s54, s13, s40
    s_and_b32 s41, s13, 7
    s_lshl_b32 s40, s40, 2
    s_add_u32 s40, s40, s41
    s_mul_i32 s40, s40, 57344
    s_add_u32 s40, s40, 0x780000
    s_add_u32 s28, s10, s40
    s_addc_u32 s29, s11, 0
    s_and_b32 s29, s29, 0xffff
    s_mov_b32 s30, 0
    s_mov_b32 s31, 0x20000
    s_cmp_lt_u32 s41, 4
    s_cselect_b32 s30, 57344, 0
    s_cselect_b32 s40, 16, 8
    s_sub_u32 s41, 6, s41
    s_lshl_b32 s41, s41, 5
    v_lshlrev_b32 v6, 2, v0
    v_add_u32 v7, s41, v6
    v_cmp_gt_u32 vcc, 8, v0
    s_lshl_b32 s26, s38, 10
    s_add_u32 s27, s26, 102400
    v_cndmask_b32 v9, v7, v6, vcc
    v_cmp_gt_u32 vcc, s40, v0
    s_mov_b32 s25, 0
    s_mul_i32 s41, s38, 49152
    v_cndmask_b32 v9, v1, v9, vcc
    v_lshlrev_b32 v12, 4, v0
    v_subrev_u32 v13, s41, v5
    s_and_b32 s41, s13, 7
    s_lshr_b32 s40, s41, 1
    s_add_u32 s40, s40, 6
    s_lshl_b32 s40, s40, 7
    s_cmp_lt_u32 s41, 4
    s_cselect_b32 s41, 3, 2
    s_cmp_eq_u32 s38, 0
    s_cselect_b32 s41, s41, 0
    s_and_b32 s47, s45, 0x380
    s_lshl_b32 s47, s47, 1
    v_lshl_add_u32 v6, v0, 7, s47
    v_mov_b32 v7, s40
    v_cmp_gt_u32 vcc, 2, v0
    s_and_b32 s47, s13, 8
    s_lshl_b32 s47, s47, 8
    s_add_u32 s47, s47, 0x7e000
    v_cndmask_b32 v9, v7, v6, vcc
    v_cmp_gt_u32 vcc, s41, v0
    s_nop 1
    v_cndmask_b32 v9, v1, v9, vcc
    s_lshl_b32 s35, s54, 18
    s_mov_b32 s43, 16384
    s_mov_b32 s39, 32768
    s_add_u32 m0, s37, s43
    s_add_u32 s24, s35, 15360
    buffer_load_dwordx4 v4, s[20:23], s35 offen lds
    buffer_load_dwordx4 v4, s[20:23], s24 offen offset:1024 lds
    s_add_u32 s35, s35, 131072
    s_add_u32 s43, s43, 8192
    s_add_u32 m0, s37, s43
    s_add_u32 s24, s35, 15360
    buffer_load_dwordx4 v4, s[20:23], s35 offen lds
    buffer_load_dwordx4 v4, s[20:23], s24 offen offset:1024 lds
    s_add_u32 s35, s35, 131072
    s_add_u32 s43, s43, 8192
    s_barrier
    s_lshl_b32 s45, s54, 12
    s_add_u32 s45, s45, s26
    s_mov_b32 m0, s27
    s_mov_b32 s25, 4096
    buffer_load_dwordx4 v12, s[28:31], s45 offen sc1 lds
    s_waitcnt vmcnt(6)
    s_barrier
    s_barrier
    s_branch mega_kernel_clj
.p2align 7
mega_kernel_s1:
    s_lshl_b32 s47, s13, 1
    s_add_u32 s47, s47, 1
    s_lshl_b32 s41, s47, 11
    v_lshl_add_u32 v10, v0, 4, s41
    s_lshl_b32 s40, s12, 18
    s_add_u32 s32, s44, s40
    s_addc_u32 s33, s45, 0
    s_and_b32 s33, s33, 0xffff
    s_mov_b32 s34, 262144
    s_mov_b32 s35, 0x20000
    s_mov_b32 s24, 57344
    s_mov_b32 s25, 114688
    s_mov_b32 s26, 172032
    s_mov_b32 s27, 229376
    s_lshr_b32 s40, s2, 3
    s_lshl_b32 s40, s40, 17
    s_and_b32 s41, s2, 7
    s_lshl_b32 s41, s41, 8
    s_add_u32 s40, s40, s41
    v_lshrrev_b32 v1, 1, v0
    v_lshlrev_b32 v1, 11, v1
    v_and_b32 v6, 1, v0
    v_lshl_add_u32 v6, v6, 7, v1
    v_add_u32 v24, s40, v6
    s_bfe_u32 s92, s2, 0x20003
    s_mov_b32 s28, 65536
    s_mov_b32 s16, s56
    s_and_b32 s17, s57, 0xffff
    s_mov_b32 s18, 4194304
    s_mov_b32 s19, 0x20000
    s_mov_b32 s88, s54
    s_and_b32 s89, s55, 0xffff
    s_mov_b32 s90, 128
    s_mov_b32 s91, 0x20000
    v_lshrrev_b32 v6, 4, v0
    v_mul_u32_u24 v7, 28, v6
    v_add_u32 v7, s47, v7
    v_and_b32 v1, 15, v0
    v_cmp_eq_u32 vcc, 0, v1
    v_lshlrev_b32 v7, 3, v7
    v_mov_b32 v1, 0x80000000
    v_cndmask_b32 v16, v1, v7, vcc
    s_add_u32 s40, s47, 112
    v_lshl_add_u32 v7, v0, 7, s40
    v_cmp_gt_u32 vcc, 128, v7
    v_lshlrev_b32 v7, 3, v7
    s_lshl_b32 s40, s12, 9
    v_cndmask_b32 v17, v1, v7, vcc
    s_add_u32 s40, s40, 256
    v_lshl_add_u32 v15, v0, 2, s40
    v_lshlrev_b32 v20, 4, v0
    v_lshlrev_b32 v21, 3, v0
    v_lshlrev_b32 v28, 2, v0
    v_and_b32 v1, 31, v0
    v_lshlrev_b32 v18, 2, v1
    v_lshlrev_b32 v23, 4, v1
    s_lshl_b32 s97, s12, 10
    s_add_u32 s97, s97, 0x78000
    s_lshl_b32 s98, s13, 13
    s_add_u32 s98, s98, 0x40000
    s_and_b32 s47, s12, 3
    v_bfe_u32 v7, v0, 2, 2
    v_and_b32 v1, 1, v6
    v_lshl_or_b32 v1, v1, 2, v7
    v_lshlrev_b32 v6, 14, v6
    v_lshl_add_u32 v6, v7, 8, v6
    v_and_b32 v7, 3, v0
    v_lshl_add_u32 v6, v7, 3, v6
    v_add_u32 v6, 65536, v6
    v_xor_b32 v7, 4, v1
    v_lshl_add_u32 v11, v7, 5, v6
    v_xor_b32 v7, 5, v1
    v_lshl_add_u32 v12, v7, 5, v6
    v_xor_b32 v7, 6, v1
    v_lshl_add_u32 v13, v7, 5, v6
    v_xor_b32 v7, 7, v1
    v_lshl_add_u32 v14, v7, 5, v6
    v_mov_b32 v72, 0x3f803f80
    v_mov_b32 v73, 0x3f803f80
    v_mov_b32 v74, 0x3f803f80
    v_mov_b32 v75, 0x3f803f80
    v_and_b32 v1, 31, v0
    v_lshrrev_b32 v6, 5, v0
    v_lshlrev_b32 v7, 4, v1
    v_lshl_add_u32 v170, v6, 10, v7
    v_lshlrev_b32 v7, 3, v1
    v_lshl_add_u32 v7, v6, 2, v7
    v_add_u32 v171, 137472, v7
    s_sub_u32 s40, s13, 7
    s_cselect_b32 s36, s13, s40
    s_load_dwordx2 s[94:95], s[0:1], 80
    s_waitcnt lgkmcnt(0)
    s_mov_b32 s20, s94
    s_and_b32 s21, s95, 0xffff
    s_mov_b32 s22, 3670016
    s_mov_b32 s23, 0x20000
    s_lshl_b32 s40, s13, 4
    s_add_u32 s96, s40, s12
    s_lshl_b32 s40, s96, 14
    v_lshrrev_b32 v1, 3, v0
    v_and_b32 v6, 7, v0
    v_lshlrev_b32 v7, 4, v6
    v_lshl_add_u32 v224, v1, 11, v7
    buffer_load_dwordx4 v[216:219], v224, s[20:23], s40 offen offset:384
    buffer_load_dwordx4 v[220:223], v224, s[20:23], s40 offen offset:1408
    v_lshrrev_b32 v6, 1, v6
    v_mul_u32_u24 v6, 57344, v6
    v_lshl_add_u32 v6, v1, 5, v6
    v_and_b32 v7, 16, v7
    v_add_u32 v225, v6, v7
    s_waitcnt vmcnt(26)
    s_barrier
    buffer_load_dwordx4 v[32:35], v10, s[32:35], 0 offen offset:0
    buffer_load_dwordx4 v[36:39], v10, s[32:35], 0 offen offset:1024
    buffer_load_dwordx4 v[40:43], v10, s[32:35], s24 offen offset:0
    buffer_load_dwordx4 v[44:47], v10, s[32:35], s24 offen offset:1024
    buffer_load_dwordx4 v[48:51], v10, s[32:35], s25 offen offset:0
    buffer_load_dwordx4 v[52:55], v10, s[32:35], s25 offen offset:1024
    buffer_load_dwordx4 v[56:59], v10, s[32:35], s26 offen offset:0
    buffer_load_dwordx4 v[60:63], v10, s[32:35], s26 offen offset:1024
    buffer_load_dwordx4 v[64:67], v10, s[32:35], s27 offen offset:0
    buffer_load_dwordx4 v[68:71], v10, s[32:35], s27 offen offset:1024
    s_branch mega_kernel_s1_cs0
mega_kernel_s1_cs0_k:
    s_waitcnt vmcnt(28)
    s_barrier
    s_waitcnt vmcnt(20)
    s_barrier
    s_waitcnt vmcnt(12)
    s_barrier
    s_barrier
    s_barrier
    s_waitcnt vmcnt(0)
    v_dot2_f32_bf16 v192, v32, v72, 0
    v_dot2_f32_bf16 v194, v32, v32, 0
    v_dot2_f32_bf16 v193, v33, v72, 0
    v_dot2_f32_bf16 v195, v33, v33, 0
    v_dot2_f32_bf16 v192, v34, v72, v192
    v_dot2_f32_bf16 v194, v34, v34, v194
    v_dot2_f32_bf16 v193, v35, v72, v193
    v_dot2_f32_bf16 v195, v35, v35, v195
    v_dot2_f32_bf16 v192, v36, v72, v192
    v_dot2_f32_bf16 v194, v36, v36, v194
    v_dot2_f32_bf16 v193, v37, v72, v193
    v_dot2_f32_bf16 v195, v37, v37, v195
    v_dot2_f32_bf16 v192, v38, v72, v192
    v_dot2_f32_bf16 v194, v38, v38, v194
    v_dot2_f32_bf16 v193, v39, v72, v193
    v_dot2_f32_bf16 v195, v39, v39, v195
    s_nop 2
    v_add_f32 v192, v192, v193
    v_add_f32 v194, v194, v195
    v_dot2_f32_bf16 v196, v40, v72, 0
    v_dot2_f32_bf16 v198, v40, v40, 0
    v_dot2_f32_bf16 v197, v41, v72, 0
    v_dot2_f32_bf16 v199, v41, v41, 0
    v_dot2_f32_bf16 v196, v42, v72, v196
    v_dot2_f32_bf16 v198, v42, v42, v198
    v_dot2_f32_bf16 v197, v43, v72, v197
    v_dot2_f32_bf16 v199, v43, v43, v199
    v_dot2_f32_bf16 v196, v44, v72, v196
    v_dot2_f32_bf16 v198, v44, v44, v198
    v_dot2_f32_bf16 v197, v45, v72, v197
    v_dot2_f32_bf16 v199, v45, v45, v199
    v_dot2_f32_bf16 v196, v46, v72, v196
    v_dot2_f32_bf16 v198, v46, v46, v198
    v_dot2_f32_bf16 v197, v47, v72, v197
    v_dot2_f32_bf16 v199, v47, v47, v199
    s_nop 2
    v_add_f32 v196, v196, v197
    v_add_f32 v198, v198, v199
    v_dot2_f32_bf16 v200, v48, v72, 0
    v_dot2_f32_bf16 v202, v48, v48, 0
    v_dot2_f32_bf16 v201, v49, v72, 0
    v_dot2_f32_bf16 v203, v49, v49, 0
    v_dot2_f32_bf16 v200, v50, v72, v200
    v_dot2_f32_bf16 v202, v50, v50, v202
    v_dot2_f32_bf16 v201, v51, v72, v201
    v_dot2_f32_bf16 v203, v51, v51, v203
    v_dot2_f32_bf16 v200, v52, v72, v200
    v_dot2_f32_bf16 v202, v52, v52, v202
    v_dot2_f32_bf16 v201, v53, v72, v201
    v_dot2_f32_bf16 v203, v53, v53, v203
    v_dot2_f32_bf16 v200, v54, v72, v200
    v_dot2_f32_bf16 v202, v54, v54, v202
    v_dot2_f32_bf16 v201, v55, v72, v201
    v_dot2_f32_bf16 v203, v55, v55, v203
    s_nop 2
    v_add_f32 v200, v200, v201
    v_add_f32 v202, v202, v203
    s_barrier
    v_dot2_f32_bf16 v204, v56, v72, 0
    v_dot2_f32_bf16 v206, v56, v56, 0
    v_dot2_f32_bf16 v205, v57, v72, 0
    v_dot2_f32_bf16 v207, v57, v57, 0
    v_dot2_f32_bf16 v204, v58, v72, v204
    v_dot2_f32_bf16 v206, v58, v58, v206
    v_dot2_f32_bf16 v205, v59, v72, v205
    v_dot2_f32_bf16 v207, v59, v59, v207
    v_dot2_f32_bf16 v204, v60, v72, v204
    v_dot2_f32_bf16 v206, v60, v60, v206
    v_dot2_f32_bf16 v205, v61, v72, v205
    v_dot2_f32_bf16 v207, v61, v61, v207
    v_dot2_f32_bf16 v204, v62, v72, v204
    v_dot2_f32_bf16 v206, v62, v62, v206
    v_dot2_f32_bf16 v205, v63, v72, v205
    v_dot2_f32_bf16 v207, v63, v63, v207
    s_nop 2
    v_add_f32 v204, v204, v205
    v_add_f32 v206, v206, v207
    v_dot2_f32_bf16 v208, v64, v72, 0
    v_dot2_f32_bf16 v210, v64, v64, 0
    v_dot2_f32_bf16 v209, v65, v72, 0
    v_dot2_f32_bf16 v211, v65, v65, 0
    v_dot2_f32_bf16 v208, v66, v72, v208
    v_dot2_f32_bf16 v210, v66, v66, v210
    v_dot2_f32_bf16 v209, v67, v72, v209
    v_dot2_f32_bf16 v211, v67, v67, v211
    v_dot2_f32_bf16 v208, v68, v72, v208
    v_dot2_f32_bf16 v210, v68, v68, v210
    v_dot2_f32_bf16 v209, v69, v72, v209
    v_dot2_f32_bf16 v211, v69, v69, v211
    v_dot2_f32_bf16 v208, v70, v72, v208
    v_dot2_f32_bf16 v210, v70, v70, v210
    v_dot2_f32_bf16 v209, v71, v72, v209
    v_dot2_f32_bf16 v211, v71, v71, v211
    s_nop 2
    v_add_f32 v208, v208, v209
    v_add_f32 v210, v210, v211
    s_barrier
    s_nop 1
    v_permlane32_swap_b32 v192, v194
    v_permlane32_swap_b32 v196, v198
    v_permlane32_swap_b32 v200, v202
    v_permlane32_swap_b32 v204, v206
    v_permlane32_swap_b32 v208, v210
    s_nop 1
    v_add_f32 v192, v192, v194
    v_add_f32 v196, v196, v198
    v_add_f32 v200, v200, v202
    v_add_f32 v204, v204, v206
    v_add_f32 v208, v208, v210
    v_mov_b32 v209, v208
    s_nop 1
    v_permlane16_swap_b32 v192, v196
    v_permlane16_swap_b32 v200, v204
    v_permlane16_swap_b32 v208, v209
    s_nop 1
    v_add_f32 v192, v192, v196
    v_add_f32 v200, v200, v204
    v_add_f32 v208, v208, v209
    v_add_f32_dpp v192, v192, v192 quad_perm:[1,0,3,2] row_mask:0xf bank_mask:0xf
    v_add_f32_dpp v200, v200, v200 quad_perm:[1,0,3,2] row_mask:0xf bank_mask:0xf
    v_add_f32_dpp v208, v208, v208 quad_perm:[1,0,3,2] row_mask:0xf bank_mask:0xf
    v_add_f32_dpp v192, v192, v192 quad_perm:[2,3,0,1] row_mask:0xf bank_mask:0xf
    v_add_f32_dpp v200, v200, v200 quad_perm:[2,3,0,1] row_mask:0xf bank_mask:0xf
    v_add_f32_dpp v208, v208, v208 quad_perm:[2,3,0,1] row_mask:0xf bank_mask:0xf
    v_add_f32_dpp v192, v192, v192 row_half_mirror row_mask:0xf bank_mask:0xf
    v_add_f32_dpp v200, v200, v200 row_half_mirror row_mask:0xf bank_mask:0xf
    v_add_f32_dpp v208, v208, v208 row_half_mirror row_mask:0xf bank_mask:0xf
    v_add_f32_dpp v192, v192, v192 row_mirror row_mask:0xf bank_mask:0xf
    v_add_f32_dpp v200, v200, v200 row_mirror row_mask:0xf bank_mask:0xf
    v_add_f32_dpp v208, v208, v208 row_mirror row_mask:0xf bank_mask:0xf
    v_mov_b32 v209, v208
    s_nop 1
    v_permlane32_swap_b32 v192, v200
    v_permlane32_swap_b32 v208, v209
    s_nop 1
    v_mul_f32 v192, 0x3a800000, v192
    v_mul_f32 v200, 0x3a800000, v200
    v_fma_f32 v200, -v192, v192, v200
    v_max_f32 v200, 0, v200
    v_add_f32 v200, 0x3727c5ac, v200
    v_rsq_f32 v195, v200
    s_nop 0
    v_mul_f32_e64 v194, -v192, v195
    v_mul_f32 v208, 0x3a800000, v208
    v_mul_f32 v209, 0x3a800000, v209
    v_fma_f32 v209, -v208, v208, v209
    v_max_f32 v209, 0, v209
    v_add_f32 v209, 0x3727c5ac, v209
    v_rsq_f32 v197, v209
    s_nop 0
    v_mul_f32_e64 v196, -v208, v197
    s_barrier
    buffer_store_dwordx2 v[194:195], v16, s[48:51], s97 offen sc1
    buffer_store_dwordx2 v[196:197], v17, s[48:51], s97 offen sc1
    s_mov_b32 vcc_lo, 0xffff
    s_mov_b32 vcc_hi, 0xffff
    v_cndmask_b32 v108, v112, v108, vcc
    v_cndmask_b32 v116, v120, v116, vcc
    s_mov_b32 vcc_lo, -1
    s_mov_b32 vcc_hi, 0
    v_cndmask_b32 v108, v116, v108, vcc
    buffer_store_dword v108, v15, s[48:51], s98 offen sc1
    s_barrier
    s_add_u32 s32, s10, 0x780000
    s_addc_u32 s33, s11, 0
    s_and_b32 s33, s33, 0xffff
    s_mov_b32 s34, 458752
    s_mov_b32 s35, 0x20000
    s_lshl_b32 s40, s96, 8
    s_add_u32 s41, s40, 229376
    s_waitcnt vmcnt(13)
    buffer_store_dwordx4 v[216:219], v225, s[32:35], s40 offen sc1
    buffer_store_dwordx4 v[220:223], v225, s[32:35], s41 offen sc1
    s_barrier
    s_barrier
    s_barrier
    s_barrier
    s_barrier
    s_barrier
    s_barrier
    s_branch mega_kernel_s1_cs16
mega_kernel_s1_cs16_k:
    s_barrier
    v_add_u32 v1, 131584, v21
    s_lshl_b32 s40, s12, 14
    s_add_u32 s29, s40, 0x200
    ds_read_b64 v[176:177], v1
    ds_read_b64 v[178:179], v1 offset:1024
    s_lshl_b32 s40, s13, 10
    s_add_u32 s40, s40, s29
    s_add_u32 s30, s29, 4096
    s_add_u32 s31, s29, 8192
    s_add_u32 s28, s29, 12288
    s_waitcnt lgkmcnt(0)
    v_add_f32 v176, v176, v178
    v_add_f32 v177, v177, v179
    buffer_store_dwordx2 v[176:177], v21, s[48:51], s40 offen sc1
    s_barrier
    s_barrier
    s_barrier
    s_barrier
    s_add_u32 s98, s98, 114688
    s_mov_b32 vcc_lo, 0xffff
    s_mov_b32 vcc_hi, 0xffff
    v_cndmask_b32 v108, v112, v108, vcc
    v_cndmask_b32 v116, v120, v116, vcc
    s_mov_b32 vcc_lo, -1
    s_mov_b32 vcc_hi, 0
    v_cndmask_b32 v108, v116, v108, vcc
    buffer_store_dword v108, v15, s[48:51], s98 offen sc1
    buffer_load_dwordx4 v[128:131], v170, s[48:51], s29 offen offset:0 sc1
    buffer_load_dwordx4 v[132:135], v170, s[48:51], s29 offen offset:2048 sc1
    buffer_load_dwordx4 v[136:139], v170, s[48:51], s30 offen offset:0 sc1
    buffer_load_dwordx4 v[140:143], v170, s[48:51], s30 offen offset:2048 sc1
    buffer_load_dwordx4 v[144:147], v170, s[48:51], s31 offen offset:0 sc1
    buffer_load_dwordx4 v[148:151], v170, s[48:51], s31 offen offset:2048 sc1
    buffer_load_dwordx4 v[152:155], v170, s[48:51], s28 offen offset:0 sc1
    s_barrier
    s_waitcnt vmcnt(0)
    v_add_f32 v156, v128, v132
    v_add_f32 v157, v129, v133
    v_add_f32 v158, v130, v134
    v_add_f32 v159, v131, v135
    v_add_f32 v156, v156, v136
    v_add_f32 v157, v157, v137
    v_add_f32 v158, v158, v138
    v_add_f32 v159, v159, v139
    v_add_f32 v156, v156, v140
    v_add_f32 v157, v157, v141
    v_add_f32 v158, v158, v142
    v_add_f32 v159, v159, v143
    v_add_f32 v156, v156, v144
    v_add_f32 v157, v157, v145
    v_add_f32 v158, v158, v146
    v_add_f32 v159, v159, v147
    v_add_f32 v156, v156, v148
    v_add_f32 v157, v157, v149
    v_add_f32 v158, v158, v150
    v_add_f32 v159, v159, v151
    v_add_f32 v156, v156, v152
    v_add_f32 v157, v157, v153
    v_add_f32 v158, v158, v154
    v_add_f32 v159, v159, v155
    s_nop 1
    v_permlane32_swap_b32 v156, v158
    v_permlane32_swap_b32 v157, v159
    s_nop 1
    v_add_f32 v156, v156, v158
    v_add_f32 v157, v157, v159
    v_cmp_u_f32 vcc, v156, v157
    v_add_u32 v1, 137472, v28
    s_cbranch_vccnz mega_kernel_s1_st_slow
mega_kernel_s1_st_ok:
    v_mul_f32 v156, 0x3a124925, v156
    v_mul_f32 v157, 0x3a124925, v157
    v_fma_f32 v157, -v156, v156, v157
    v_max_f32 v157, 0, v157
    v_add_f32 v157, 0x3727c5ac, v157
    v_rsq_f32 v129, v157
    s_nop 0
    v_mul_f32_e64 v128, -v156, v129
    ds_write2_b32 v171, v129, v128 offset0:0 offset1:128
    s_waitcnt lgkmcnt(0)
    s_barrier
    s_lshl_b32 s40, s12, 19
    s_add_u32 s16, s6, s40
    s_addc_u32 s17, s7, 0
    s_and_b32 s17, s17, 0xffff
    s_mov_b32 s18, 524288
    s_mov_b32 s19, 0x20000
    s_lshl_b32 s40, s13, 19
    s_add_u32 s40, s40, 0x2000000
    s_add_u32 s20, s10, s40
    s_addc_u32 s21, s11, 0
    s_and_b32 s21, s21, 0xffff
    s_mov_b32 s22, 524288
    s_mov_b32 s23, 0x20000
    v_lshlrev_b32 v25, 12, v0
    v_lshlrev_b32 v26, 7, v0
    s_mov_b32 s37, 0
    s_mov_b32 s39, 0
    s_barrier
    s_barrier
    s_barrier
    s_barrier
    s_barrier
    s_barrier
    s_barrier
    s_barrier
    s_barrier
    s_barrier
    s_barrier
    s_barrier
    s_barrier
    s_barrier
    s_barrier
    s_barrier
    s_barrier
    s_barrier
    s_barrier
    s_barrier
    s_barrier
    s_barrier
    s_barrier
    s_barrier
    s_barrier
    s_barrier
    s_barrier
    s_barrier
    s_barrier
    s_barrier
    s_barrier
    s_barrier
    s_barrier
    s_barrier
    s_barrier
    s_barrier
    s_load_dwordx2 s[96:97], s[0:1], 0
    s_and_b32 s40, s2, 4
    s_lshl_b32 s40, s40, 1
    s_lshr_b32 s41, s2, 5
    s_add_u32 s40, s40, s41
    s_cmp_ge_u32 s2, 96
    s_addc_u32 s40, s40, 0
    s_lshl_b32 s40, s40, 7
    s_lshl_b32 s98, s12, 18
    s_add_u32 s98, s98, s40
    v_lshrrev_b32 v6, 3, v0
    v_bfe_u32 v7, v0, 4, 1
    v_or_b32 v7, 2, v7
    v_and_b32 v1, 7, v0
    v_xor_b32 v7, v7, v1
    v_lshlrev_b32 v7, 4, v7
    v_lshl_add_u32 v28, v6, 11, v7
    v_add_u32 v28, 16384, v28
    v_xor_b32 v29, 64, v28
    v_add_u32 v29, 32768, v29
    s_barrier
    s_load_dwordx2 s[94:95], s[0:1], 80
    s_lshl_b32 s31, s2, 14
    s_add_u32 s31, s31, 8192
    v_lshlrev_b32 v30, 7, v0
    s_waitcnt lgkmcnt(0)
    s_add_u32 s88, s96, s98
    s_addc_u32 s89, s97, 0
    s_and_b32 s89, s89, 0xffff
    s_mov_b32 s90, 260224
    s_mov_b32 s91, 0x20000
    s_barrier
    s_waitcnt lgkmcnt(0)
    s_mov_b32 s32, s94
    s_and_b32 s33, s95, 0xffff
    s_mov_b32 s34, 3670016
    s_mov_b32 s35, 0x20000
    s_mov_b32 m0, 148480
    s_mov_b32 s41, 0
    buffer_load_dwordx4 v28, s[88:91], s41 offen  lds
    s_mov_b32 m0, 150528
    s_mov_b32 s41, 0
    buffer_load_dwordx4 v29, s[88:91], s41 offen  lds
    s_mov_b32 m0, 152576
    s_mov_b32 s41, 65536
    buffer_load_dwordx4 v28, s[88:91], s41 offen  lds
    s_mov_b32 m0, 154624
    s_mov_b32 s41, 65536
    buffer_load_dwordx4 v29, s[88:91], s41 offen  lds
    s_mov_b32 m0, 156672
    s_mov_b32 s41, 131072
    buffer_load_dwordx4 v28, s[88:91], s41 offen  lds
    s_mov_b32 m0, 158720
    s_mov_b32 s41, 131072
    buffer_load_dwordx4 v29, s[88:91], s41 offen  lds
    s_mov_b32 m0, 160768
    s_mov_b32 s41, 196608
    buffer_load_dwordx4 v28, s[88:91], s41 offen  lds
    s_mov_b32 m0, 162816
    s_mov_b32 s41, 196608
    buffer_load_dwordx4 v29, s[88:91], s41 offen  lds
    s_barrier
    buffer_load_dword v31, v30, s[32:35], s31 offen
    s_load_dwordx2 s[4:5], s[0:1], 0
    s_load_dwordx4 s[56:59], s[0:1], 80
    s_and_b32 s38, s3, 3
    s_and_b32 s12, s2, 3
    s_lshl_b32 s12, s12, 2
    s_bfe_u32 s13, s2, 0x20003
    s_add_u32 s12, s12, s13
    s_and_b32 s13, s2, 4
    s_lshl_b32 s13, s13, 1
    s_lshr_b32 s40, s2, 5
    s_add_u32 s13, s13, s40
    v_lshrrev_b32 v6, 3, v0
    v_bfe_u32 v7, v0, 4, 1
    s_lshl_b32 s40, s38, 1
    v_or_b32 v7, s40, v7
    v_and_b32 v1, 7, v0
    v_xor_b32 v7, v7, v1
    v_lshlrev_b32 v7, 4, v7
    s_lshl_b32 s41, s38, 3
    v_add_u32 v1, s41, v6
    v_lshl_add_u32 v2, v1, 11, v7
    s_lshl_b32 s44, s12, 18
    s_cmp_ge_u32 s2, 96
    s_addc_u32 s45, s13, 0
    s_lshl_b32 s45, s45, 7
    s_add_u32 s44, s44, s45
    s_lshl_b32 s36, s38, 12
    v_lshl_add_u32 v3, v0, 4, s36
    v_bfe_u32 v7, v0, 4, 2
    v_bfe_u32 v1, v0, 1, 2
    v_xor_b32 v7, v7, v1
    v_lshlrev_b32 v7, 5, v7
    v_and_b32 v1, 1, v0
    v_lshl_or_b32 v7, v1, 4, v7
    s_lshl_b32 s41, s38, 4
    v_add_u32 v1, s41, v6
    v_lshl_add_u32 v4, v1, 11, v7
    v_lshrrev_b32 v6, 4, v0
    v_lshlrev_b32 v7, 2, v6
    v_and_b32 v1, 15, v0
    v_xor_b32 v7, v7, v1
    v_lshlrev_b32 v7, 4, v7
    v_add_u32 v1, s41, v6
    v_lshl_add_u32 v5, v1, 12, v7
    s_lshl_b32 s37, s38, 11
    s_add_u32 s37, s37, 114688
    s_mov_b32 s39, 0
    s_mov_b32 s43, 0
    s_mul_i32 s40, s12, 458752
    s_add_u32 s40, s40, 0x3000000
    v_mov_b32 v1, 0x80000000
    v_lshlrev_b32 v8, 2, v0
    v_cmp_gt_u32 vcc, 8, v0
    s_lshl_b32 s46, s12, 8
    s_add_u32 s46, s46, 0x7d000
    v_cndmask_b32 v9, v1, v8, vcc
    s_lshl_b32 s47, s13, 5
    s_add_u32 s47, s47, 0x7e000
    v_mov_b32 v11, 98304
    v_mov_b32 v6, 0
    v_mov_b32 v7, 0
    ds_write_b64 v11, v[6:7]
    v_cmp_gt_u32 vcc, 14, v0
    v_lshlrev_b32 v8, 7, v0
    s_lshl_b32 s46, s12, 14
    v_cndmask_b32 v8, v1, v8, vcc
    s_add_u32 s46, s46, 0x3800
    s_waitcnt lgkmcnt(0)
    s_add_u32 s16, s10, s40
    s_addc_u32 s17, s11, 0
    s_and_b32 s17, s17, 0xffff
    s_mov_b32 s18, 458752
    s_mov_b32 s19, 0x20000
    s_add_u32 s20, s56, s45
    s_addc_u32 s21, s57, 0
    s_and_b32 s21, s21, 0xffff
    s_mov_b32 s22, 3670016
    s_mov_b32 s23, 0x20000
    s_add_u32 s48, s10, 0x600000
    s_addc_u32 s49, s11, 0
    s_and_b32 s49, s49, 0xffff
    s_mov_b32 s50, 524288
    s_mov_b32 s51, 0x20000
    s_lshr_b32 s40, s13, 3
    s_sub_u32 s54, s13, s40
    s_and_b32 s41, s13, 7
    s_lshl_b32 s40, s40, 2
    s_add_u32 s40, s40, s41
    s_mul_i32 s40, s40, 57344
    s_add_u32 s40, s40, 0x780000
    s_add_u32 s28, s10, s40
    s_addc_u32 s29, s11, 0
    s_and_b32 s29, s29, 0xffff
    s_mov_b32 s30, 0
    s_mov_b32 s31, 0x20000
    s_cmp_lt_u32 s41, 4
    s_cselect_b32 s30, 57344, 0
    s_cselect_b32 s40, 16, 8
    s_sub_u32 s41, 6, s41
    s_lshl_b32 s41, s41, 5
    v_lshlrev_b32 v6, 2, v0
    v_add_u32 v7, s41, v6
    v_cmp_gt_u32 vcc, 8, v0
    s_lshl_b32 s26, s38, 10
    s_add_u32 s27, s26, 102400
    v_cndmask_b32 v9, v7, v6, vcc
    v_cmp_gt_u32 vcc, s40, v0
    s_mov_b32 s25, 0
    s_mul_i32 s41, s38, 49152
    v_cndmask_b32 v9, v1, v9, vcc
    v_lshlrev_b32 v12, 4, v0
    v_subrev_u32 v13, s41, v5
    s_and_b32 s41, s13, 7
    s_lshr_b32 s40, s41, 1
    s_add_u32 s40, s40, 6
    s_lshl_b32 s40, s40, 7
    s_cmp_lt_u32 s41, 4
    s_cselect_b32 s41, 3, 2
    s_cmp_eq_u32 s38, 0
    s_cselect_b32 s41, s41, 0
    s_and_b32 s47, s45, 0x380
    s_lshl_b32 s47, s47, 1
    v_lshl_add_u32 v6, v0, 7, s47
    v_mov_b32 v7, s40
    v_cmp_gt_u32 vcc, 2, v0
    s_and_b32 s47, s13, 8
    s_lshl_b32 s47, s47, 8
    s_add_u32 s47, s47, 0x7e000
    v_cndmask_b32 v9, v7, v6, vcc
    v_cmp_gt_u32 vcc, s41, v0
    s_nop 1
    v_cndmask_b32 v9, v1, v9, vcc
    s_lshl_b32 s35, s54, 18
    s_mov_b32 s43, 16384
    s_mov_b32 s39, 32768
    s_add_u32 m0, s37, s43
    s_add_u32 s24, s35, 15360
    buffer_load_dwordx4 v4, s[20:23], s35 offen lds
    buffer_load_dwordx4 v4, s[20:23], s24 offen offset:1024 lds
    s_add_u32 s35, s35, 131072
    s_add_u32 s43, s43, 8192
    s_add_u32 m0, s37, s43
    s_add_u32 s24, s35, 15360
    buffer_load_dwordx4 v4, s[20:23], s35 offen lds
    buffer_load_dwordx4 v4, s[20:23], s24 offen offset:1024 lds
    s_add_u32 s35, s35, 131072
    s_add_u32 s43, s43, 8192
    s_barrier
    s_lshl_b32 s45, s54, 12
    s_add_u32 s45, s45, s26
    s_mov_b32 m0, s27
    s_mov_b32 s25, 4096
    buffer_load_dwordx4 v12, s[28:31], s45 offen sc1 lds
    s_waitcnt vmcnt(6)
    s_barrier
    s_barrier
    s_branch mega_kernel_clj
.p2align 7
mega_kernel_d2:
    s_waitcnt vmcnt(24)
    s_barrier
    s_add_u32 m0, s36, s39
    s_waitcnt vmcnt(16)
    s_barrier
    buffer_load_dwordx4 v2, s[16:19], s24 offen offset:0 lds
    s_xor_b32 s8, s53, s97
    s_add_u32 s53, s53, 1
    buffer_load_dwordx4 v2, s[16:19], s25 offen offset:1024 lds
    s_and_b32 s53, s53, 15
    s_xor_b32 s9, s53, s97
    buffer_load_dwordx4 v2, s[16:19], s26 offen offset:2048 lds
    s_sub_u32 s8, s9, s8
    s_ashr_i32 s9, s8, 31
    buffer_load_dwordx4 v2, s[16:19], s27 offen offset:3072 lds
    s_add_u32 m0, m0, 32768
    s_mul_i32 s14, s8, 458752
    buffer_load_dwordx4 v24, s[16:19], s24 offen offset:0 lds
    s_lshl_b32 s8, s8, 7
    buffer_load_dwordx4 v24, s[16:19], s25 offen offset:1024 lds
    buffer_load_dwordx4 v24, s[16:19], s26 offen offset:2048 lds
    buffer_load_dwordx4 v24, s[16:19], s27 offen offset:3072 lds
    s_add_u32 m0, s37, s39
    s_add_u32 s39, s39, 4096
    buffer_load_dwordx4 v3, s[20:23], s28 offen offset:0 lds
    s_add_u32 s16, s16, s8
    s_addc_u32 s17, s17, s9
    buffer_load_dwordx4 v3, s[20:23], s29 offen offset:1024 lds
    s_and_b32 s39, s39, 16383
    buffer_load_dwordx4 v3, s[20:23], s30 offen offset:2048 lds
    buffer_load_dwordx4 v3, s[20:23], s31 offen offset:3072 lds
    s_add_u32 m0, m0, 32768
    s_nop 0
    buffer_load_dwordx4 v25, s[20:23], s28 offen offset:0 lds
    buffer_load_dwordx4 v25, s[20:23], s29 offen offset:1024 lds
    buffer_load_dwordx4 v25, s[20:23], s30 offen offset:2048 lds
    buffer_load_dwordx4 v25, s[20:23], s31 offen offset:3072 lds
    s_add_u32 m0, s36, s39
    s_waitcnt vmcnt(24)
    s_barrier
    buffer_load_dwordx4 v2, s[16:19], s24 offen offset:0 lds
    s_add_u32 s20, s20, s14
    s_addc_u32 s21, s21, s9
    buffer_load_dwordx4 v2, s[16:19], s25 offen offset:1024 lds
    s_xor_b32 s8, s53, s97
    s_add_u32 s53, s53, 1
    buffer_load_dwordx4 v2, s[16:19], s26 offen offset:2048 lds
    s_and_b32 s53, s53, 15
    s_xor_b32 s9, s53, s97
    buffer_load_dwordx4 v2, s[16:19], s27 offen offset:3072 lds
    s_add_u32 m0, m0, 32768
    s_sub_u32 s8, s9, s8
    buffer_load_dwordx4 v24, s[16:19], s24 offen offset:0 lds
    s_ashr_i32 s9, s8, 31
    s_mul_i32 s14, s8, 458752
    buffer_load_dwordx4 v24, s[16:19], s25 offen offset:1024 lds
    s_lshl_b32 s8, s8, 7
    buffer_load_dwordx4 v24, s[16:19], s26 offen offset:2048 lds
    buffer_load_dwordx4 v24, s[16:19], s27 offen offset:3072 lds
    s_add_u32 m0, s37, s39
    s_add_u32 s39, s39, 4096
    buffer_load_dwordx4 v3, s[20:23], s28 offen offset:0 lds
    s_add_u32 s16, s16, s8
    s_addc_u32 s17, s17, s9
    buffer_load_dwordx4 v3, s[20:23], s29 offen offset:1024 lds
    s_and_b32 s39, s39, 16383
    buffer_load_dwordx4 v3, s[20:23], s30 offen offset:2048 lds
    buffer_load_dwordx4 v3, s[20:23], s31 offen offset:3072 lds
    s_add_u32 m0, m0, 32768
    s_nop 0
    buffer_load_dwordx4 v25, s[20:23], s28 offen offset:0 lds
    buffer_load_dwordx4 v25, s[20:23], s29 offen offset:1024 lds
    s_mov_b32 s42, 8
mega_kernel_l0:
    buffer_load_dwordx4 v25, s[20:23], s30 offen offset:2048 lds
    buffer_load_dwordx4 v25, s[20:23], s31 offen offset:3072 lds
    s_add_u32 m0, s36, s39
    s_waitcnt vmcnt(32)
    s_barrier
    buffer_load_dwordx4 v2, s[16:19], s24 offen offset:0 lds
    s_add_u32 s20, s20, s14
    s_addc_u32 s21, s21, s9
    buffer_load_dwordx4 v2, s[16:19], s25 offen offset:1024 lds
    s_xor_b32 s8, s53, s97
    s_add_u32 s53, s53, 1
    buffer_load_dwordx4 v2, s[16:19], s26 offen offset:2048 lds
    s_and_b32 s53, s53, 15
    s_xor_b32 s9, s53, s97
    buffer_load_dwordx4 v2, s[16:19], s27 offen offset:3072 lds
    s_add_u32 m0, m0, 32768
    s_sub_u32 s8, s9, s8
    buffer_load_dwordx4 v24, s[16:19], s24 offen offset:0 lds
    s_ashr_i32 s9, s8, 31
    s_mul_i32 s14, s8, 458752
    buffer_load_dwordx4 v24, s[16:19], s25 offen offset:1024 lds
    s_lshl_b32 s8, s8, 7
    buffer_load_dwordx4 v24, s[16:19], s26 offen offset:2048 lds
    buffer_load_dwordx4 v24, s[16:19], s27 offen offset:3072 lds
    s_add_u32 m0, s37, s39
    s_add_u32 s39, s39, 4096
    buffer_load_dwordx4 v3, s[20:23], s28 offen offset:0 lds
    s_add_u32 s16, s16, s8
    s_addc_u32 s17, s17, s9
    buffer_load_dwordx4 v3, s[20:23], s29 offen offset:1024 lds
    s_and_b32 s39, s39, 16383
    buffer_load_dwordx4 v3, s[20:23], s30 offen offset:2048 lds
    buffer_load_dwordx4 v3, s[20:23], s31 offen offset:3072 lds
    s_add_u32 m0, m0, 32768
    s_nop 0
    buffer_load_dwordx4 v25, s[20:23], s28 offen offset:0 lds
    buffer_load_dwordx4 v25, s[20:23], s29 offen offset:1024 lds
    s_sub_u32 s42, s42, 1
    s_cbranch_scc0 mega_kernel_l0
    buffer_load_dwordx4 v25, s[20:23], s30 offen offset:2048 lds
    buffer_load_dwordx4 v25, s[20:23], s31 offen offset:3072 lds
    s_add_u32 m0, s36, s39
    s_waitcnt vmcnt(32)
    s_barrier
    buffer_load_dwordx4 v2, s[16:19], s24 offen offset:0 lds
    s_add_u32 s20, s20, s14
    s_addc_u32 s21, s21, s9
    buffer_load_dwordx4 v2, s[16:19], s25 offen offset:1024 lds
    buffer_load_dwordx4 v2, s[16:19], s26 offen offset:2048 lds
    buffer_load_dwordx4 v2, s[16:19], s27 offen offset:3072 lds
    s_add_u32 m0, m0, 32768
    s_nop 0
    buffer_load_dwordx4 v24, s[16:19], s24 offen offset:0 lds
    buffer_load_dwordx4 v24, s[16:19], s25 offen offset:1024 lds
    buffer_load_dwordx4 v24, s[16:19], s26 offen offset:2048 lds
    buffer_load_dwordx4 v24, s[16:19], s27 offen offset:3072 lds
    s_add_u32 m0, s37, s39
    s_add_u32 s39, s39, 4096
    buffer_load_dwordx4 v3, s[20:23], s28 offen offset:0 lds
    s_lshr_b32 s53, s12, 2
    s_lshl_b32 s53, s53, 2
    buffer_load_dwordx4 v3, s[20:23], s29 offen offset:1024 lds
    s_xor_b32 s8, s53, s97
    s_lshl_b32 s40, s12, 18
    buffer_load_dwordx4 v3, s[20:23], s30 offen offset:2048 lds
    s_lshl_b32 s41, s8, 7
    s_add_u32 s40, s40, s41
    buffer_load_dwordx4 v3, s[20:23], s31 offen offset:3072 lds
    s_add_u32 m0, m0, 32768
    s_add_u32 s16, s44, s40
    s_addc_u32 s17, s45, 0
    buffer_load_dwordx4 v25, s[20:23], s28 offen offset:0 lds
    s_and_b32 s17, s17, 0xffff
    s_mov_b32 s18, 262144
    buffer_load_dwordx4 v25, s[20:23], s29 offen offset:1024 lds
    s_mov_b32 s19, 0x20000
    s_add_u32 s53, s53, 12
    buffer_load_dwordx4 v25, s[20:23], s30 offen offset:2048 lds
    s_and_b32 s53, s53, 15
    s_and_b32 s39, s39, 16383
    buffer_load_dwordx4 v25, s[20:23], s31 offen offset:3072 lds
    s_add_u32 m0, s36, s39
    s_waitcnt vmcnt(32)
    s_barrier
    s_xor_b32 s8, s53, s97
    s_mul_i32 s41, s8, 458752
    s_lshl_b32 s40, s13, 8
    s_add_u32 s40, s40, s41
    s_add_u32 s20, s4, s40
    s_addc_u32 s21, s5, 0
    s_and_b32 s21, s21, 0xffff
    s_mov_b32 s22, 458752
    s_mov_b32 s23, 0x20000
    s_xor_b32 s8, s53, s97
    s_add_u32 s53, s53, 1
    s_and_b32 s53, s53, 15
    s_xor_b32 s9, s53, s97
    s_sub_u32 s8, s9, s8
    s_ashr_i32 s9, s8, 31
    s_mul_i32 s14, s8, 458752
    s_lshl_b32 s8, s8, 7
    s_add_u32 m0, s37, s39
    s_add_u32 s39, s39, 4096
    s_nop 0
    buffer_load_dwordx4 v3, s[20:23], s28 offen offset:0 lds
    s_and_b32 s39, s39, 16383
    buffer_load_dwordx4 v3, s[20:23], s29 offen offset:1024 lds
    buffer_load_dwordx4 v3, s[20:23], s30 offen offset:2048 lds
    buffer_load_dwordx4 v3, s[20:23], s31 offen offset:3072 lds
    s_add_u32 m0, m0, 32768
    s_nop 0
    buffer_load_dwordx4 v25, s[20:23], s28 offen offset:0 lds
    buffer_load_dwordx4 v25, s[20:23], s29 offen offset:1024 lds
    buffer_load_dwordx4 v25, s[20:23], s30 offen offset:2048 lds
    buffer_load_dwordx4 v25, s[20:23], s31 offen offset:3072 lds
    s_add_u32 m0, s36, s39
    s_waitcnt vmcnt(24)
    s_barrier
    s_add_u32 s20, s20, s14
    s_addc_u32 s21, s21, s9
    s_xor_b32 s8, s53, s97
    s_add_u32 s53, s53, 1
    s_and_b32 s53, s53, 15
    s_xor_b32 s9, s53, s97
    s_sub_u32 s8, s9, s8
    s_ashr_i32 s9, s8, 31
    s_mul_i32 s14, s8, 458752
    s_lshl_b32 s8, s8, 7
    s_add_u32 m0, s37, s39
    s_add_u32 s39, s39, 4096
    s_nop 0
    buffer_load_dwordx4 v3, s[20:23], s28 offen offset:0 lds
    s_and_b32 s39, s39, 16383
    buffer_load_dwordx4 v3, s[20:23], s29 offen offset:1024 lds
    buffer_load_dwordx4 v3, s[20:23], s30 offen offset:2048 lds
    buffer_load_dwordx4 v3, s[20:23], s31 offen offset:3072 lds
    s_add_u32 m0, m0, 32768
    s_nop 0
    buffer_load_dwordx4 v25, s[20:23], s28 offen offset:0 lds
    buffer_load_dwordx4 v25, s[20:23], s29 offen offset:1024 lds
    buffer_load_dwordx4 v25, s[20:23], s30 offen offset:2048 lds
    buffer_load_dwordx4 v25, s[20:23], s31 offen offset:3072 lds
    s_add_u32 m0, s36, s39
    s_waitcnt vmcnt(16)
    s_barrier
    s_add_u32 s20, s20, s14
    s_addc_u32 s21, s21, s9
    s_xor_b32 s8, s53, s97
    s_add_u32 s53, s53, 1
    s_and_b32 s53, s53, 15
    s_xor_b32 s9, s53, s97
    s_sub_u32 s8, s9, s8
    s_ashr_i32 s9, s8, 31
    s_mul_i32 s14, s8, 458752
    s_lshl_b32 s8, s8, 7
    s_add_u32 m0, s37, s39
    s_add_u32 s39, s39, 4096
    s_nop 0
    buffer_load_dwordx4 v3, s[20:23], s28 offen offset:0 lds
    s_and_b32 s39, s39, 16383
    buffer_load_dwordx4 v3, s[20:23], s29 offen offset:1024 lds
    buffer_load_dwordx4 v3, s[20:23], s30 offen offset:2048 lds
    buffer_load_dwordx4 v3, s[20:23], s31 offen offset:3072 lds
    s_add_u32 m0, m0, 32768
    s_nop 0
    buffer_load_dwordx4 v25, s[20:23], s28 offen offset:0 lds
    buffer_load_dwordx4 v25, s[20:23], s29 offen offset:1024 lds
    buffer_load_dwordx4 v25, s[20:23], s30 offen offset:2048 lds
    buffer_load_dwordx4 v25, s[20:23], s31 offen offset:3072 lds
    s_add_u32 m0, s36, s39
    s_waitcnt vmcnt(16)
    s_barrier
    s_add_u32 s20, s20, s14
    s_addc_u32 s21, s21, s9
    s_xor_b32 s8, s53, s97
    s_add_u32 s53, s53, 1
    s_and_b32 s53, s53, 15
    s_xor_b32 s9, s53, s97
    s_sub_u32 s8, s9, s8
    s_ashr_i32 s9, s8, 31
    s_mul_i32 s14, s8, 458752
    s_lshl_b32 s8, s8, 7
    s_add_u32 m0, s37, s39
    s_add_u32 s39, s39, 4096
    s_nop 0
    buffer_load_dwordx4 v3, s[20:23], s28 offen offset:0 lds
    s_and_b32 s39, s39, 16383
    buffer_load_dwordx4 v3, s[20:23], s29 offen offset:1024 lds
    buffer_load_dwordx4 v3, s[20:23], s30 offen offset:2048 lds
    buffer_load_dwordx4 v3, s[20:23], s31 offen offset:3072 lds
    s_add_u32 m0, m0, 32768
    s_nop 0
    buffer_load_dwordx4 v25, s[20:23], s28 offen offset:0 lds
    buffer_load_dwordx4 v25, s[20:23], s29 offen offset:1024 lds
    buffer_load_dwordx4 v25, s[20:23], s30 offen offset:2048 lds
    buffer_load_dwordx4 v25, s[20:23], s31 offen offset:3072 lds
    s_add_u32 m0, s36, s39
    s_barrier
    s_waitcnt vmcnt(16)
    s_barrier
    buffer_load_dwordx4 v2, s[16:19], s24 offen offset:0 lds
    s_add_u32 s20, s20, s14
    s_addc_u32 s21, s21, s9
    buffer_load_dwordx4 v2, s[16:19], s25 offen offset:1024 lds
    s_xor_b32 s8, s53, s97
    s_add_u32 s53, s53, 1
    buffer_load_dwordx4 v2, s[16:19], s26 offen offset:2048 lds
    s_and_b32 s53, s53, 15
    s_xor_b32 s9, s53, s97
    buffer_load_dwordx4 v2, s[16:19], s27 offen offset:3072 lds
    s_add_u32 m0, m0, 32768
    s_sub_u32 s8, s9, s8
    buffer_load_dwordx4 v24, s[16:19], s24 offen offset:0 lds
    s_ashr_i32 s9, s8, 31
    s_mul_i32 s14, s8, 458752
    buffer_load_dwordx4 v24, s[16:19], s25 offen offset:1024 lds
    s_lshl_b32 s8, s8, 7
    buffer_load_dwordx4 v24, s[16:19], s26 offen offset:2048 lds
    buffer_load_dwordx4 v24, s[16:19], s27 offen offset:3072 lds
    s_add_u32 m0, s37, s39
    s_add_u32 s39, s39, 4096
    buffer_load_dwordx4 v3, s[20:23], s28 offen offset:0 lds
    s_add_u32 s16, s16, s8
    s_addc_u32 s17, s17, s9
    buffer_load_dwordx4 v3, s[20:23], s29 offen offset:1024 lds
    s_and_b32 s39, s39, 16383
    buffer_load_dwordx4 v3, s[20:23], s30 offen offset:2048 lds
    buffer_load_dwordx4 v3, s[20:23], s31 offen offset:3072 lds
    s_add_u32 m0, m0, 32768
    s_nop 0
    buffer_load_dwordx4 v25, s[20:23], s28 offen offset:0 lds
    buffer_load_dwordx4 v25, s[20:23], s29 offen offset:1024 lds
    buffer_load_dwordx4 v25, s[20:23], s30 offen offset:2048 lds
    buffer_load_dwordx4 v25, s[20:23], s31 offen offset:3072 lds
    s_add_u32 m0, s36, s39
    s_waitcnt vmcnt(24)
    s_barrier
    buffer_load_dwordx4 v2, s[16:19], s24 offen offset:0 lds
    s_add_u32 s20, s20, s14
    s_addc_u32 s21, s21, s9
    buffer_load_dwordx4 v2, s[16:19], s25 offen offset:1024 lds
    s_xor_b32 s8, s53, s97
    s_add_u32 s53, s53, 1
    buffer_load_dwordx4 v2, s[16:19], s26 offen offset:2048 lds
    s_and_b32 s53, s53, 15
    s_xor_b32 s9, s53, s97
    buffer_load_dwordx4 v2, s[16:19], s27 offen offset:3072 lds
    s_add_u32 m0, m0, 32768
    s_sub_u32 s8, s9, s8
    buffer_load_dwordx4 v24, s[16:19], s24 offen offset:0 lds
    s_ashr_i32 s9, s8, 31
    s_mul_i32 s14, s8, 458752
    buffer_load_dwordx4 v24, s[16:19], s25 offen offset:1024 lds
    s_lshl_b32 s8, s8, 7
    buffer_load_dwordx4 v24, s[16:19], s26 offen offset:2048 lds
    buffer_load_dwordx4 v24, s[16:19], s27 offen offset:3072 lds
    s_add_u32 m0, s37, s39
    s_add_u32 s39, s39, 4096
    buffer_load_dwordx4 v3, s[20:23], s28 offen offset:0 lds
    s_add_u32 s16, s16, s8
    s_addc_u32 s17, s17, s9
    buffer_load_dwordx4 v3, s[20:23], s29 offen offset:1024 lds
    s_and_b32 s39, s39, 16383
    buffer_load_dwordx4 v3, s[20:23], s30 offen offset:2048 lds
    buffer_load_dwordx4 v3, s[20:23], s31 offen offset:3072 lds
    s_add_u32 m0, m0, 32768
    s_nop 0
    buffer_load_dwordx4 v25, s[20:23], s28 offen offset:0 lds
    buffer_load_dwordx4 v25, s[20:23], s29 offen offset:1024 lds
    s_mov_b32 s42, 8
mega_kernel_l1:
    buffer_load_dwordx4 v25, s[20:23], s30 offen offset:2048 lds
    buffer_load_dwordx4 v25, s[20:23], s31 offen offset:3072 lds
    s_add_u32 m0, s36, s39
    s_waitcnt vmcnt(32)
    s_barrier
    buffer_load_dwordx4 v2, s[16:19], s24 offen offset:0 lds
    s_add_u32 s20, s20, s14
    s_addc_u32 s21, s21, s9
    buffer_load_dwordx4 v2, s[16:19], s25 offen offset:1024 lds
    s_xor_b32 s8, s53, s97
    s_add_u32 s53, s53, 1
    buffer_load_dwordx4 v2, s[16:19], s26 offen offset:2048 lds
    s_and_b32 s53, s53, 15
    s_xor_b32 s9, s53, s97
    buffer_load_dwordx4 v2, s[16:19], s27 offen offset:3072 lds
    s_add_u32 m0, m0, 32768
    s_sub_u32 s8, s9, s8
    buffer_load_dwordx4 v24, s[16:19], s24 offen offset:0 lds
    s_ashr_i32 s9, s8, 31
    s_mul_i32 s14, s8, 458752
    buffer_load_dwordx4 v24, s[16:19], s25 offen offset:1024 lds
    s_lshl_b32 s8, s8, 7
    buffer_load_dwordx4 v24, s[16:19], s26 offen offset:2048 lds
    buffer_load_dwordx4 v24, s[16:19], s27 offen offset:3072 lds
    s_add_u32 m0, s37, s39
    s_add_u32 s39, s39, 4096
    buffer_load_dwordx4 v3, s[20:23], s28 offen offset:0 lds
    s_add_u32 s16, s16, s8
    s_addc_u32 s17, s17, s9
    buffer_load_dwordx4 v3, s[20:23], s29 offen offset:1024 lds
    s_and_b32 s39, s39, 16383
    buffer_load_dwordx4 v3, s[20:23], s30 offen offset:2048 lds
    buffer_load_dwordx4 v3, s[20:23], s31 offen offset:3072 lds
    s_add_u32 m0, m0, 32768
    s_nop 0
    buffer_load_dwordx4 v25, s[20:23], s28 offen offset:0 lds
    buffer_load_dwordx4 v25, s[20:23], s29 offen offset:1024 lds
    s_sub_u32 s42, s42, 1
    s_cbranch_scc0 mega_kernel_l1
    buffer_load_dwordx4 v25, s[20:23], s30 offen offset:2048 lds
    buffer_load_dwordx4 v25, s[20:23], s31 offen offset:3072 lds
    s_add_u32 m0, s36, s39
    s_waitcnt vmcnt(32)
    s_barrier
    buffer_load_dwordx4 v2, s[16:19], s24 offen offset:0 lds
    s_add_u32 s20, s20, s14
    s_addc_u32 s21, s21, s9
    buffer_load_dwordx4 v2, s[16:19], s25 offen offset:1024 lds
    buffer_load_dwordx4 v2, s[16:19], s26 offen offset:2048 lds
    buffer_load_dwordx4 v2, s[16:19], s27 offen offset:3072 lds
    s_add_u32 m0, m0, 32768
    s_nop 0
    buffer_load_dwordx4 v24, s[16:19], s24 offen offset:0 lds
    buffer_load_dwordx4 v24, s[16:19], s25 offen offset:1024 lds
    buffer_load_dwordx4 v24, s[16:19], s26 offen offset:2048 lds
    buffer_load_dwordx4 v24, s[16:19], s27 offen offset:3072 lds
    s_add_u32 m0, s37, s39
    s_add_u32 s39, s39, 4096
    buffer_load_dwordx4 v3, s[20:23], s28 offen offset:0 lds
    s_lshl_b32 s40, s12, 19
    s_mov_b32 s53, 0
    buffer_load_dwordx4 v3, s[20:23], s29 offen offset:1024 lds
    s_lshl_b32 s41, s97, 7
    s_add_u32 s40, s40, s41
    buffer_load_dwordx4 v3, s[20:23], s30 offen offset:2048 lds
    s_add_u32 s16, s6, s40
    s_addc_u32 s17, s7, 0
    buffer_load_dwordx4 v3, s[20:23], s31 offen offset:3072 lds
    s_add_u32 m0, m0, 32768
    s_and_b32 s17, s17, 0xffff
    buffer_load_dwordx4 v25, s[20:23], s28 offen offset:0 lds
    s_mov_b32 s18, 524288
    s_mov_b32 s19, 0x20000
    s_mov_b32 s24, 0
    buffer_load_dwordx4 v25, s[20:23], s29 offen offset:1024 lds
    s_mov_b32 s25, 130048
    s_mov_b32 s26, 260096
    buffer_load_dwordx4 v25, s[20:23], s30 offen offset:2048 lds
    s_mov_b32 s27, 390144
    s_and_b32 s39, s39, 16383
    buffer_load_dwordx4 v25, s[20:23], s31 offen offset:3072 lds
    s_add_u32 m0, s36, s39
    s_waitcnt vmcnt(32)
    s_barrier
    buffer_load_dwordx4 v4, s[16:19], s24 offen offset:0 lds
    s_lshl_b32 s40, s13, 19
    s_add_u32 s40, s40, 0x2000000
    s_lshl_b32 s41, s97, 14
    buffer_load_dwordx4 v4, s[16:19], s25 offen offset:1024 lds
    s_add_u32 s40, s40, s41
    s_add_u32 s20, s10, s40
    s_addc_u32 s21, s11, 0
    buffer_load_dwordx4 v4, s[16:19], s26 offen offset:2048 lds
    s_and_b32 s21, s21, 0xffff
    s_mov_b32 s22, 16384
    s_mov_b32 s23, 0x20000
    buffer_load_dwordx4 v4, s[16:19], s27 offen offset:3072 lds
    s_add_u32 m0, m0, 32768
    s_xor_b32 s8, s53, s97
    buffer_load_dwordx4 v26, s[16:19], s24 offen offset:0 lds
    s_add_u32 s53, s53, 1
    s_and_b32 s53, s53, 31
    s_xor_b32 s9, s53, s97
    buffer_load_dwordx4 v26, s[16:19], s25 offen offset:1024 lds
    s_sub_u32 s8, s9, s8
    s_ashr_i32 s9, s8, 31
    buffer_load_dwordx4 v26, s[16:19], s26 offen offset:2048 lds
    s_mul_i32 s14, s8, 16384
    s_lshl_b32 s8, s8, 7
    buffer_load_dwordx4 v26, s[16:19], s27 offen offset:3072 lds
    s_add_u32 m0, s37, s39
    s_add_u32 s39, s39, 4096
    buffer_load_dwordx4 v5, s[20:23], 0 offen offset:0 sc1 lds
    s_add_u32 s16, s16, s8
    s_addc_u32 s17, s17, s9
    buffer_load_dwordx4 v5, s[20:23], 0 offen offset:1024 sc1 lds
    s_and_b32 s39, s39, 16383
    buffer_load_dwordx4 v5, s[20:23], 0 offen offset:2048 sc1 lds
    buffer_load_dwordx4 v5, s[20:23], 0 offen offset:3072 sc1 lds
    s_add_u32 m0, m0, 32768
    s_nop 0
    buffer_load_dwordx4 v27, s[20:23], 0 offen offset:0 sc1 lds
    buffer_load_dwordx4 v27, s[20:23], 0 offen offset:1024 sc1 lds
    s_mov_b32 s42, 29
mega_kernel_l2:
    buffer_load_dwordx4 v27, s[20:23], 0 offen offset:2048 sc1 lds
    buffer_load_dwordx4 v27, s[20:23], 0 offen offset:3072 sc1 lds
    s_add_u32 m0, s36, s39
    s_waitcnt vmcnt(32)
    s_barrier
    buffer_load_dwordx4 v4, s[16:19], s24 offen offset:0 lds
    s_add_u32 s20, s20, s14
    s_addc_u32 s21, s21, s9
    buffer_load_dwordx4 v4, s[16:19], s25 offen offset:1024 lds
    s_xor_b32 s8, s53, s97
    s_add_u32 s53, s53, 1
    buffer_load_dwordx4 v4, s[16:19], s26 offen offset:2048 lds
    s_and_b32 s53, s53, 31
    s_xor_b32 s9, s53, s97
    buffer_load_dwordx4 v4, s[16:19], s27 offen offset:3072 lds
    s_add_u32 m0, m0, 32768
    s_sub_u32 s8, s9, s8
    buffer_load_dwordx4 v26, s[16:19], s24 offen offset:0 lds
    s_ashr_i32 s9, s8, 31
    s_mul_i32 s14, s8, 16384
    buffer_load_dwordx4 v26, s[16:19], s25 offen offset:1024 lds
    s_lshl_b32 s8, s8, 7
    buffer_load_dwordx4 v26, s[16:19], s26 offen offset:2048 lds
    buffer_load_dwordx4 v26, s[16:19], s27 offen offset:3072 lds
    s_add_u32 m0, s37, s39
    s_add_u32 s39, s39, 4096
    buffer_load_dwordx4 v5, s[20:23], 0 offen offset:0 sc1 lds
    s_add_u32 s16, s16, s8
    s_addc_u32 s17, s17, s9
    buffer_load_dwordx4 v5, s[20:23], 0 offen offset:1024 sc1 lds
    s_and_b32 s39, s39, 16383
    buffer_load_dwordx4 v5, s[20:23], 0 offen offset:2048 sc1 lds
    buffer_load_dwordx4 v5, s[20:23], 0 offen offset:3072 sc1 lds
    s_add_u32 m0, m0, 32768
    s_nop 0
    buffer_load_dwordx4 v27, s[20:23], 0 offen offset:0 sc1 lds
    buffer_load_dwordx4 v27, s[20:23], 0 offen offset:1024 sc1 lds
    s_sub_u32 s42, s42, 1
    s_cbranch_scc0 mega_kernel_l2
    buffer_load_dwordx4 v27, s[20:23], 0 offen offset:2048 sc1 lds
    buffer_load_dwordx4 v27, s[20:23], 0 offen offset:3072 sc1 lds
    s_add_u32 m0, s36, s39
    s_waitcnt vmcnt(32)
    s_barrier
    buffer_load_dwordx4 v4, s[16:19], s24 offen offset:0 lds
    s_add_u32 s20, s20, s14
    s_addc_u32 s21, s21, s9
    buffer_load_dwordx4 v4, s[16:19], s25 offen offset:1024 lds
    buffer_load_dwordx4 v4, s[16:19], s26 offen offset:2048 lds
    buffer_load_dwordx4 v4, s[16:19], s27 offen offset:3072 lds
    s_add_u32 m0, m0, 32768
    s_nop 0
    buffer_load_dwordx4 v26, s[16:19], s24 offen offset:0 lds
    buffer_load_dwordx4 v26, s[16:19], s25 offen offset:1024 lds
    buffer_load_dwordx4 v26, s[16:19], s26 offen offset:2048 lds
    buffer_load_dwordx4 v26, s[16:19], s27 offen offset:3072 lds
    s_add_u32 m0, s37, s39
    s_add_u32 s39, s39, 4096
    buffer_load_dwordx4 v5, s[20:23], 0 offen offset:0 sc1 lds
    s_and_b32 s39, s39, 16383
    buffer_load_dwordx4 v5, s[20:23], 0 offen offset:1024 sc1 lds
    buffer_load_dwordx4 v5, s[20:23], 0 offen offset:2048 sc1 lds
    buffer_load_dwordx4 v5, s[20:23], 0 offen offset:3072 sc1 lds
    s_add_u32 m0, m0, 32768
    s_nop 0
    buffer_load_dwordx4 v27, s[20:23], 0 offen offset:0 sc1 lds
    buffer_load_dwordx4 v27, s[20:23], 0 offen offset:1024 sc1 lds
    buffer_load_dwordx4 v27, s[20:23], 0 offen offset:2048 sc1 lds
    buffer_load_dwordx4 v27, s[20:23], 0 offen offset:3072 sc1 lds
    s_waitcnt vmcnt(32)
    s_barrier
    s_load_dwordx2 s[4:5], s[0:1], 0
    s_load_dwordx4 s[56:59], s[0:1], 80
    s_and_b32 s38, s3, 3
    s_and_b32 s12, s2, 3
    s_lshl_b32 s12, s12, 2
    s_bfe_u32 s13, s2, 0x20003
    s_add_u32 s12, s12, s13
    s_and_b32 s13, s2, 4
    s_lshl_b32 s13, s13, 1
    s_lshr_b32 s40, s2, 5
    s_add_u32 s13, s13, s40
    v_lshrrev_b32 v6, 3, v0
    v_bfe_u32 v7, v0, 4, 1
    s_lshl_b32 s40, s38, 1
    v_or_b32 v7, s40, v7
    v_and_b32 v1, 7, v0
    v_xor_b32 v7, v7, v1
    v_lshlrev_b32 v7, 4, v7
    s_lshl_b32 s41, s38, 3
    v_add_u32 v1, s41, v6
    v_lshl_add_u32 v2, v1, 11, v7
    s_lshl_b32 s44, s12, 18
    s_cmp_ge_u32 s2, 96
    s_addc_u32 s45, s13, 0
    s_lshl_b32 s45, s45, 7
    s_add_u32 s44, s44, s45
    s_lshl_b32 s36, s38, 12
    v_lshl_add_u32 v3, v0, 4, s36
    v_bfe_u32 v7, v0, 4, 2
    v_bfe_u32 v1, v0, 1, 2
    v_xor_b32 v7, v7, v1
    v_lshlrev_b32 v7, 5, v7
    v_and_b32 v1, 1, v0
    v_lshl_or_b32 v7, v1, 4, v7
    s_lshl_b32 s41, s38, 4
    v_add_u32 v1, s41, v6
    v_lshl_add_u32 v4, v1, 11, v7
    v_lshrrev_b32 v6, 4, v0
    v_lshlrev_b32 v7, 2, v6
    v_and_b32 v1, 15, v0
    v_xor_b32 v7, v7, v1
    v_lshlrev_b32 v7, 4, v7
    v_add_u32 v1, s41, v6
    v_lshl_add_u32 v5, v1, 12, v7
    s_lshl_b32 s37, s38, 11
    s_add_u32 s37, s37, 114688
    s_mov_b32 s39, 0
    s_mov_b32 s43, 0
    s_mul_i32 s40, s12, 458752
    s_add_u32 s40, s40, 0x3000000
    v_mov_b32 v1, 0x80000000
    v_lshlrev_b32 v8, 2, v0
    v_cmp_gt_u32 vcc, 8, v0
    s_lshl_b32 s46, s12, 8
    s_add_u32 s46, s46, 0x7d000
    v_cndmask_b32 v9, v1, v8, vcc
    s_lshl_b32 s47, s13, 5
    s_add_u32 s47, s47, 0x7e000
    v_mov_b32 v11, 98304
    v_mov_b32 v6, 0
    v_mov_b32 v7, 0
    ds_write_b64 v11, v[6:7]
    v_cmp_gt_u32 vcc, 14, v0
    v_lshlrev_b32 v8, 7, v0
    s_lshl_b32 s46, s12, 14
    v_cndmask_b32 v8, v1, v8, vcc
    s_add_u32 s46, s46, 0x3800
    s_waitcnt lgkmcnt(0)
    s_add_u32 s16, s10, s40
    s_addc_u32 s17, s11, 0
    s_and_b32 s17, s17, 0xffff
    s_mov_b32 s18, 458752
    s_mov_b32 s19, 0x20000
    s_add_u32 s20, s56, s45
    s_addc_u32 s21, s57, 0
    s_and_b32 s21, s21, 0xffff
    s_mov_b32 s22, 3670016
    s_mov_b32 s23, 0x20000
    s_add_u32 s48, s10, 0x600000
    s_addc_u32 s49, s11, 0
    s_and_b32 s49, s49, 0xffff
    s_mov_b32 s50, 524288
    s_mov_b32 s51, 0x20000
    s_lshr_b32 s40, s13, 3
    s_sub_u32 s54, s13, s40
    s_and_b32 s41, s13, 7
    s_lshl_b32 s40, s40, 2
    s_add_u32 s40, s40, s41
    s_mul_i32 s40, s40, 57344
    s_add_u32 s40, s40, 0x780000
    s_add_u32 s28, s10, s40
    s_addc_u32 s29, s11, 0
    s_and_b32 s29, s29, 0xffff
    s_mov_b32 s30, 0
    s_mov_b32 s31, 0x20000
    s_cmp_lt_u32 s41, 4
    s_cselect_b32 s30, 57344, 0
    s_cselect_b32 s40, 16, 8
    s_sub_u32 s41, 6, s41
    s_lshl_b32 s41, s41, 5
    v_lshlrev_b32 v6, 2, v0
    v_add_u32 v7, s41, v6
    v_cmp_gt_u32 vcc, 8, v0
    s_lshl_b32 s26, s38, 10
    s_add_u32 s27, s26, 102400
    v_cndmask_b32 v9, v7, v6, vcc
    v_cmp_gt_u32 vcc, s40, v0
    s_mov_b32 s25, 0
    s_mul_i32 s41, s38, 49152
    v_cndmask_b32 v9, v1, v9, vcc
    v_lshlrev_b32 v12, 4, v0
    v_subrev_u32 v13, s41, v5
    s_and_b32 s41, s13, 7
    s_lshr_b32 s40, s41, 1
    s_add_u32 s40, s40, 6
    s_lshl_b32 s40, s40, 7
    s_cmp_lt_u32 s41, 4
    s_cselect_b32 s41, 3, 2
    s_cmp_eq_u32 s38, 0
    s_cselect_b32 s41, s41, 0
    s_and_b32 s47, s45, 0x380
    s_lshl_b32 s47, s47, 1
    v_lshl_add_u32 v6, v0, 7, s47
    v_mov_b32 v7, s40
    v_cmp_gt_u32 vcc, 2, v0
    s_and_b32 s47, s13, 8
    s_lshl_b32 s47, s47, 8
    s_add_u32 s47, s47, 0x7e000
    v_cndmask_b32 v9, v7, v6, vcc
    v_cmp_gt_u32 vcc, s41, v0
    s_nop 1
    v_cndmask_b32 v9, v1, v9, vcc
    s_lshl_b32 s35, s54, 18
    s_mov_b32 s43, 16384
    s_mov_b32 s39, 32768
    s_add_u32 m0, s37, s43
    s_add_u32 s24, s35, 15360
    buffer_load_dwordx4 v4, s[20:23], s35 offen lds
    buffer_load_dwordx4 v4, s[20:23], s24 offen offset:1024 lds
    s_add_u32 s35, s35, 131072
    s_add_u32 s43, s43, 8192
    s_add_u32 m0, s37, s43
    s_add_u32 s24, s35, 15360
    buffer_load_dwordx4 v4, s[20:23], s35 offen lds
    buffer_load_dwordx4 v4, s[20:23], s24 offen offset:1024 lds
    s_add_u32 s35, s35, 131072
    s_add_u32 s43, s43, 8192
    s_waitcnt vmcnt(20)
    s_barrier
    s_lshl_b32 s45, s54, 12
    s_add_u32 s45, s45, s26
    s_mov_b32 m0, s27
    s_mov_b32 s25, 4096
    buffer_load_dwordx4 v12, s[28:31], s45 offen sc1 lds
    s_waitcnt vmcnt(5)
    s_barrier
    s_barrier
mega_kernel_clj:
    s_mov_b32 s52, 0x80000
    s_cmp_lg_u32 s38, 0
    s_cbranch_scc1 mega_kernel_pr
mega_kernel_pa:
    s_sleep 4
    buffer_load_dword v10, v8, s[48:51], s46 offen sc1
    s_waitcnt vmcnt(0)
mega_kernel_pb:
    v_cmp_ne_u32 vcc, -1, v10
    s_and_b32 s33, vcc_lo, 0x3fff
    s_bitset0_b32 s33, s54
    s_bcnt1_i32_b32 s34, s33
    s_sub_u32 s52, s52, 1
    s_cselect_b32 s34, 14, s34
    s_cmp_lt_u32 s34, 4
    s_cbranch_scc1 mega_kernel_pa
mega_kernel_pg:
    s_xor_b32 s34, s33, 0x3fff
    s_bitset0_b32 s34, s54
    s_lshl_b32 s34, s34, 16
    s_or_b32 s32, s33, s34
    v_mov_b32 v1, s32
    ds_write_b32 v11, v1
    s_branch mega_kernel_pw
mega_kernel_pr:
    ds_read_b32 v1, v11
    s_sub_u32 s52, s52, 1
    s_cbranch_scc1 mega_kernel_pw
    s_waitcnt lgkmcnt(0)
    v_readfirstlane_b32 s32, v1
    s_cmp_eq_u32 s32, 0
    s_cbranch_scc1 mega_kernel_pr
mega_kernel_pw:
    s_ff1_i32_b32 s33, s32
    s_bitset0_b32 s32, s33
    s_and_b32 s33, s33, 15
    s_lshl_b32 s34, s33, 15
    s_lshl_b32 s35, s33, 18
    s_lshl_b32 s45, s33, 12
    s_add_u32 s45, s45, s26
    s_add_u32 m0, s36, s39
    s_add_u32 s24, s35, 15360
    buffer_load_dwordx4 v3, s[16:19], s34 offen offset:0 sc1 lds
    buffer_load_dwordx4 v3, s[16:19], s34 offen offset:1024 sc1 lds
    buffer_load_dwordx4 v3, s[16:19], s34 offen offset:2048 sc1 lds
    buffer_load_dwordx4 v3, s[16:19], s34 offen offset:3072 sc1 lds
    s_add_u32 m0, s37, s43
    s_add_u32 s39, s39, 16384
    buffer_load_dwordx4 v4, s[20:23], s35 offen lds
    buffer_load_dwordx4 v4, s[20:23], s24 offen offset:1024 lds
    s_add_u32 s43, s43, 8192
    s_cmp_eq_u32 s43, 49152
    s_cselect_b32 s43, 0, s43
    s_cmp_eq_u32 s39, 98304
    s_cselect_b32 s39, 0, s39
    s_waitcnt vmcnt(6)
    s_barrier
    s_add_u32 m0, s27, s25
    s_add_u32 s25, s25, 4096
    buffer_load_dwordx4 v12, s[28:31], s45 offen sc1 lds
    s_cmp_eq_u32 s25, 12288
    s_cselect_b32 s25, 0, s25
    s_add_u32 s34, s34, 16384
    s_add_u32 s35, s35, 131072
    s_add_u32 m0, s36, s39
    s_add_u32 s24, s35, 15360
    buffer_load_dwordx4 v3, s[16:19], s34 offen offset:0 sc1 lds
    buffer_load_dwordx4 v3, s[16:19], s34 offen offset:1024 sc1 lds
    buffer_load_dwordx4 v3, s[16:19], s34 offen offset:2048 sc1 lds
    buffer_load_dwordx4 v3, s[16:19], s34 offen offset:3072 sc1 lds
    s_add_u32 m0, s37, s43
    s_add_u32 s39, s39, 16384
    buffer_load_dwordx4 v4, s[20:23], s35 offen lds
    buffer_load_dwordx4 v4, s[20:23], s24 offen offset:1024 lds
    s_add_u32 s43, s43, 8192
    s_cmp_eq_u32 s43, 49152
    s_cselect_b32 s43, 0, s43
    s_cmp_eq_u32 s39, 98304
    s_cselect_b32 s39, 0, s39
    s_ff1_i32_b32 s33, s32
    s_bitset0_b32 s32, s33
    s_and_b32 s33, s33, 15
    s_lshl_b32 s34, s33, 15
    s_lshl_b32 s35, s33, 18
    s_lshl_b32 s45, s33, 12
    s_add_u32 s45, s45, s26
    s_add_u32 m0, s36, s39
    s_add_u32 s24, s35, 15360
    buffer_load_dwordx4 v3, s[16:19], s34 offen offset:0 sc1 lds
    buffer_load_dwordx4 v3, s[16:19], s34 offen offset:1024 sc1 lds
    buffer_load_dwordx4 v3, s[16:19], s34 offen offset:2048 sc1 lds
    buffer_load_dwordx4 v3, s[16:19], s34 offen offset:3072 sc1 lds
    s_add_u32 m0, s37, s43
    s_add_u32 s39, s39, 16384
    buffer_load_dwordx4 v4, s[20:23], s35 offen lds
    buffer_load_dwordx4 v4, s[20:23], s24 offen offset:1024 lds
    s_add_u32 s43, s43, 8192
    s_cmp_eq_u32 s43, 49152
    s_cselect_b32 s43, 0, s43
    s_cmp_eq_u32 s39, 98304
    s_cselect_b32 s39, 0, s39
    s_waitcnt vmcnt(19)
    s_barrier
    s_add_u32 m0, s27, s25
    s_add_u32 s25, s25, 4096
    buffer_load_dwordx4 v12, s[28:31], s45 offen sc1 lds
    s_cmp_eq_u32 s25, 12288
    s_cselect_b32 s25, 0, s25
    s_add_u32 s34, s34, 16384
    s_add_u32 s35, s35, 131072
    s_add_u32 m0, s36, s39
    s_add_u32 s24, s35, 15360
    buffer_load_dwordx4 v3, s[16:19], s34 offen offset:0 sc1 lds
    buffer_load_dwordx4 v3, s[16:19], s34 offen offset:1024 sc1 lds
    buffer_load_dwordx4 v3, s[16:19], s34 offen offset:2048 sc1 lds
    buffer_load_dwordx4 v3, s[16:19], s34 offen offset:3072 sc1 lds
    s_add_u32 m0, s37, s43
    s_add_u32 s39, s39, 16384
    buffer_load_dwordx4 v4, s[20:23], s35 offen lds
    buffer_load_dwordx4 v4, s[20:23], s24 offen offset:1024 lds
    s_add_u32 s43, s43, 8192
    s_cmp_eq_u32 s43, 49152
    s_cselect_b32 s43, 0, s43
    s_cmp_eq_u32 s39, 98304
    s_cselect_b32 s39, 0, s39
    s_ff1_i32_b32 s33, s32
    s_bitset0_b32 s32, s33
    s_and_b32 s33, s33, 15
    s_lshl_b32 s34, s33, 15
    s_lshl_b32 s35, s33, 18
    s_lshl_b32 s45, s33, 12
    s_add_u32 s45, s45, s26
    s_add_u32 m0, s36, s39
    s_add_u32 s24, s35, 15360
    buffer_load_dwordx4 v3, s[16:19], s34 offen offset:0 sc1 lds
    buffer_load_dwordx4 v3, s[16:19], s34 offen offset:1024 sc1 lds
    buffer_load_dwordx4 v3, s[16:19], s34 offen offset:2048 sc1 lds
    buffer_load_dwordx4 v3, s[16:19], s34 offen offset:3072 sc1 lds
    s_add_u32 m0, s37, s43
    s_add_u32 s39, s39, 16384
    buffer_load_dwordx4 v4, s[20:23], s35 offen lds
    buffer_load_dwordx4 v4, s[20:23], s24 offen offset:1024 lds
    s_add_u32 s43, s43, 8192
    s_cmp_eq_u32 s43, 49152
    s_cselect_b32 s43, 0, s43
    s_cmp_eq_u32 s39, 98304
    s_cselect_b32 s39, 0, s39
    s_waitcnt vmcnt(25)
    s_barrier
    s_add_u32 m0, s27, s25
    s_add_u32 s25, s25, 4096
    buffer_load_dwordx4 v12, s[28:31], s45 offen sc1 lds
    s_cmp_eq_u32 s25, 12288
    s_cselect_b32 s25, 0, s25
    s_add_u32 s34, s34, 16384
    s_add_u32 s35, s35, 131072
    s_add_u32 m0, s36, s39
    s_add_u32 s24, s35, 15360
    buffer_load_dwordx4 v3, s[16:19], s34 offen offset:0 sc1 lds
    buffer_load_dwordx4 v3, s[16:19], s34 offen offset:1024 sc1 lds
    buffer_load_dwordx4 v3, s[16:19], s34 offen offset:2048 sc1 lds
    buffer_load_dwordx4 v3, s[16:19], s34 offen offset:3072 sc1 lds
    s_add_u32 m0, s37, s43
    s_add_u32 s39, s39, 16384
    buffer_load_dwordx4 v4, s[20:23], s35 offen lds
    buffer_load_dwordx4 v4, s[20:23], s24 offen offset:1024 lds
    s_add_u32 s43, s43, 8192
    s_cmp_eq_u32 s43, 49152
    s_cselect_b32 s43, 0, s43
    s_cmp_eq_u32 s39, 98304
    s_cselect_b32 s39, 0, s39
    s_waitcnt vmcnt(26)
    s_barrier
    buffer_load_dword v10, v8, s[48:51], s46 offen sc1
    s_ff1_i32_b32 s33, s32
    s_bitset0_b32 s32, s33
    s_and_b32 s33, s33, 15
    s_lshl_b32 s34, s33, 15
    s_lshl_b32 s35, s33, 18
    s_lshl_b32 s45, s33, 12
    s_add_u32 s45, s45, s26
    s_add_u32 m0, s36, s39
    s_add_u32 s24, s35, 15360
    buffer_load_dwordx4 v3, s[16:19], s34 offen offset:0 sc1 lds
    buffer_load_dwordx4 v3, s[16:19], s34 offen offset:1024 sc1 lds
    buffer_load_dwordx4 v3, s[16:19], s34 offen offset:2048 sc1 lds
    buffer_load_dwordx4 v3, s[16:19], s34 offen offset:3072 sc1 lds
    s_add_u32 m0, s37, s43
    s_add_u32 s39, s39, 16384
    buffer_load_dwordx4 v4, s[20:23], s35 offen lds
    buffer_load_dwordx4 v4, s[20:23], s24 offen offset:1024 lds
    s_add_u32 s43, s43, 8192
    s_cmp_eq_u32 s43, 49152
    s_cselect_b32 s43, 0, s43
    s_cmp_eq_u32 s39, 98304
    s_cselect_b32 s39, 0, s39
    s_waitcnt vmcnt(26)
    s_barrier
    s_add_u32 m0, s27, s25
    s_add_u32 s25, s25, 4096
    buffer_load_dwordx4 v12, s[28:31], s45 offen sc1 lds
    s_cmp_eq_u32 s25, 12288
    s_cselect_b32 s25, 0, s25
    s_add_u32 s34, s34, 16384
    s_add_u32 s35, s35, 131072
    s_add_u32 m0, s36, s39
    s_add_u32 s24, s35, 15360
    buffer_load_dwordx4 v3, s[16:19], s34 offen offset:0 sc1 lds
    buffer_load_dwordx4 v3, s[16:19], s34 offen offset:1024 sc1 lds
    buffer_load_dwordx4 v3, s[16:19], s34 offen offset:2048 sc1 lds
    buffer_load_dwordx4 v3, s[16:19], s34 offen offset:3072 sc1 lds
    s_add_u32 m0, s37, s43
    s_add_u32 s39, s39, 16384
    buffer_load_dwordx4 v4, s[20:23], s35 offen lds
    buffer_load_dwordx4 v4, s[20:23], s24 offen offset:1024 lds
    s_add_u32 s43, s43, 8192
    s_cmp_eq_u32 s43, 49152
    s_cselect_b32 s43, 0, s43
    s_cmp_eq_u32 s39, 98304
    s_cselect_b32 s39, 0, s39
    s_waitcnt vmcnt(27)
    s_barrier
    s_waitcnt vmcnt(13)
    v_cmp_ne_u32 vcc, -1, v10
    s_and_b32 s33, vcc_lo, 0x3fff
    s_cmp_lg_u32 s33, 0x3fff
    s_cbranch_scc1 mega_kernel_pf_s
mega_kernel_pf_k:
    s_ff1_i32_b32 s33, s32
    s_bitset0_b32 s32, s33
    s_and_b32 s33, s33, 15
    s_lshl_b32 s34, s33, 15
    s_lshl_b32 s35, s33, 18
    s_lshl_b32 s45, s33, 12
    s_add_u32 s45, s45, s26
    s_add_u32 m0, s36, s39
    s_add_u32 s24, s35, 15360
    buffer_load_dwordx4 v3, s[16:19], s34 offen offset:0 sc1 lds
    buffer_load_dwordx4 v3, s[16:19], s34 offen offset:1024 sc1 lds
    buffer_load_dwordx4 v3, s[16:19], s34 offen offset:2048 sc1 lds
    buffer_load_dwordx4 v3, s[16:19], s34 offen offset:3072 sc1 lds
    s_add_u32 m0, s37, s43
    s_add_u32 s39, s39, 16384
    buffer_load_dwordx4 v4, s[20:23], s35 offen lds
    buffer_load_dwordx4 v4, s[20:23], s24 offen offset:1024 lds
    s_add_u32 s43, s43, 8192
    s_cmp_eq_u32 s43, 49152
    s_cselect_b32 s43, 0, s43
    s_cmp_eq_u32 s39, 98304
    s_cselect_b32 s39, 0, s39
    s_waitcnt vmcnt(26)
    s_barrier
    s_add_u32 m0, s27, s25
    s_add_u32 s25, s25, 4096
    buffer_load_dwordx4 v12, s[28:31], s45 offen sc1 lds
    s_cmp_eq_u32 s25, 12288
    s_cselect_b32 s25, 0, s25
    s_add_u32 s34, s34, 16384
    s_add_u32 s35, s35, 131072
    s_add_u32 m0, s36, s39
    s_add_u32 s24, s35, 15360
    buffer_load_dwordx4 v3, s[16:19], s34 offen offset:0 sc1 lds
    buffer_load_dwordx4 v3, s[16:19], s34 offen offset:1024 sc1 lds
    buffer_load_dwordx4 v3, s[16:19], s34 offen offset:2048 sc1 lds
    buffer_load_dwordx4 v3, s[16:19], s34 offen offset:3072 sc1 lds
    s_add_u32 m0, s37, s43
    s_add_u32 s39, s39, 16384
    buffer_load_dwordx4 v4, s[20:23], s35 offen lds
    buffer_load_dwordx4 v4, s[20:23], s24 offen offset:1024 lds
    s_add_u32 s43, s43, 8192
    s_cmp_eq_u32 s43, 49152
    s_cselect_b32 s43, 0, s43
    s_cmp_eq_u32 s39, 98304
    s_cselect_b32 s39, 0, s39
    s_waitcnt vmcnt(27)
    s_barrier
    s_mov_b32 s42, 7
mega_kernel_cl0:
    s_ff1_i32_b32 s33, s32
    s_bitset0_b32 s32, s33
    s_and_b32 s33, s33, 15
    s_lshl_b32 s34, s33, 15
    s_lshl_b32 s35, s33, 18
    s_lshl_b32 s45, s33, 12
    s_add_u32 s45, s45, s26
    s_add_u32 m0, s36, s39
    s_add_u32 s24, s35, 15360
    buffer_load_dwordx4 v3, s[16:19], s34 offen offset:0 sc1 lds
    buffer_load_dwordx4 v3, s[16:19], s34 offen offset:1024 sc1 lds
    buffer_load_dwordx4 v3, s[16:19], s34 offen offset:2048 sc1 lds
    buffer_load_dwordx4 v3, s[16:19], s34 offen offset:3072 sc1 lds
    s_add_u32 m0, s37, s43
    s_add_u32 s39, s39, 16384
    buffer_load_dwordx4 v4, s[20:23], s35 offen lds
    buffer_load_dwordx4 v4, s[20:23], s24 offen offset:1024 lds
    s_add_u32 s43, s43, 8192
    s_cmp_eq_u32 s43, 49152
    s_cselect_b32 s43, 0, s43
    s_cmp_eq_u32 s39, 98304
    s_cselect_b32 s39, 0, s39
    s_waitcnt vmcnt(25)
    s_barrier
    s_add_u32 m0, s27, s25
    s_add_u32 s25, s25, 4096
    buffer_load_dwordx4 v12, s[28:31], s45 offen sc1 lds
    s_cmp_eq_u32 s25, 12288
    s_cselect_b32 s25, 0, s25
    s_add_u32 s34, s34, 16384
    s_add_u32 s35, s35, 131072
    s_add_u32 m0, s36, s39
    s_add_u32 s24, s35, 15360
    buffer_load_dwordx4 v3, s[16:19], s34 offen offset:0 sc1 lds
    buffer_load_dwordx4 v3, s[16:19], s34 offen offset:1024 sc1 lds
    buffer_load_dwordx4 v3, s[16:19], s34 offen offset:2048 sc1 lds
    buffer_load_dwordx4 v3, s[16:19], s34 offen offset:3072 sc1 lds
    s_add_u32 m0, s37, s43
    s_add_u32 s39, s39, 16384
    buffer_load_dwordx4 v4, s[20:23], s35 offen lds
    buffer_load_dwordx4 v4, s[20:23], s24 offen offset:1024 lds
    s_add_u32 s43, s43, 8192
    s_cmp_eq_u32 s43, 49152
    s_cselect_b32 s43, 0, s43
    s_cmp_eq_u32 s39, 98304
    s_cselect_b32 s39, 0, s39
    s_waitcnt vmcnt(26)
    s_barrier
    s_sub_u32 s42, s42, 1
    s_cmp_lg_u32 s42, 0
    s_cbranch_scc1 mega_kernel_cl0
    buffer_load_dword v10, v9, s[48:51], s47 offen sc1
    s_ff1_i32_b32 s33, s32
    s_bitset0_b32 s32, s33
    s_and_b32 s33, s33, 15
    s_lshl_b32 s34, s33, 15
    s_lshl_b32 s35, s33, 18
    s_lshl_b32 s45, s33, 12
    s_add_u32 s45, s45, s26
    s_add_u32 m0, s36, s39
    s_add_u32 s24, s35, 15360
    buffer_load_dwordx4 v3, s[16:19], s34 offen offset:0 sc1 lds
    buffer_load_dwordx4 v3, s[16:19], s34 offen offset:1024 sc1 lds
    buffer_load_dwordx4 v3, s[16:19], s34 offen offset:2048 sc1 lds
    buffer_load_dwordx4 v3, s[16:19], s34 offen offset:3072 sc1 lds
    s_add_u32 m0, s37, s43
    s_add_u32 s39, s39, 16384
    buffer_load_dwordx4 v4, s[20:23], s35 offen lds
    buffer_load_dwordx4 v4, s[20:23], s24 offen offset:1024 lds
    s_add_u32 s43, s43, 8192
    s_cmp_eq_u32 s43, 49152
    s_cselect_b32 s43, 0, s43
    s_cmp_eq_u32 s39, 98304
    s_cselect_b32 s39, 0, s39
    s_waitcnt vmcnt(26)
    s_barrier
    s_add_u32 m0, s27, s25
    s_add_u32 s25, s25, 4096
    buffer_load_dwordx4 v12, s[28:31], s45 offen sc1 lds
    s_cmp_eq_u32 s25, 12288
    s_cselect_b32 s25, 0, s25
    s_add_u32 s34, s34, 16384
    s_add_u32 s35, s35, 131072
    s_add_u32 m0, s36, s39
    s_add_u32 s24, s35, 15360
    buffer_load_dwordx4 v3, s[16:19], s34 offen offset:0 sc1 lds
    buffer_load_dwordx4 v3, s[16:19], s34 offen offset:1024 sc1 lds
    buffer_load_dwordx4 v3, s[16:19], s34 offen offset:2048 sc1 lds
    buffer_load_dwordx4 v3, s[16:19], s34 offen offset:3072 sc1 lds
    s_add_u32 m0, s37, s43
    s_add_u32 s39, s39, 16384
    buffer_load_dwordx4 v4, s[20:23], s35 offen lds
    buffer_load_dwordx4 v4, s[20:23], s24 offen offset:1024 lds
    s_add_u32 s43, s43, 8192
    s_cmp_eq_u32 s43, 49152
    s_cselect_b32 s43, 0, s43
    s_cmp_eq_u32 s39, 98304
    s_cselect_b32 s39, 0, s39
    s_waitcnt vmcnt(27)
    s_barrier
    buffer_load_dword v14, v9, s[48:51], s47 offen sc1
    s_waitcnt vmcnt(21)
    s_barrier
    s_mov_b32 s55, 0
    s_waitcnt vmcnt(14)
    v_cmp_eq_u32 vcc, -1, v10
    s_cbranch_vccnz mega_kernel_yf_s
mega_kernel_yf_k:
    s_cmp_eq_u32 s38, 0
    s_cbranch_scc1 mega_kernel_y0
    s_waitcnt vmcnt(15)
    s_barrier
    s_waitcnt vmcnt(7)
    s_barrier
    s_waitcnt vmcnt(1)
    s_barrier
    s_waitcnt vmcnt(0)
    s_barrier
    s_branch mega_kernel_y1
mega_kernel_y0:
    s_and_b32 s40, s44, 0x780
    s_lshl_b32 s40, s40, 11
    s_lshl_b32 s41, s12, 8
    s_add_u32 s40, s40, s41
    s_add_u32 s40, s40, 0x2800000
    s_add_u32 s16, s10, s40
    s_addc_u32 s17, s11, 0
    s_and_b32 s17, s17, 0xffff
    s_mov_b32 s18, 262144
    s_mov_b32 s19, 0x20000
    s_add_u32 m0, s36, 81920
    s_mov_b32 s41, 0
    buffer_load_dwordx4 v5, s[16:19], s41 offen offset:0 sc1 lds
    s_mov_b32 s41, 15360
    buffer_load_dwordx4 v5, s[16:19], s41 offen offset:1024 sc1 lds
    s_mov_b32 s41, 30720
    buffer_load_dwordx4 v5, s[16:19], s41 offen offset:2048 sc1 lds
    s_mov_b32 s41, 46080
    buffer_load_dwordx4 v5, s[16:19], s41 offen offset:3072 sc1 lds
    s_add_u32 m0, s36, 86016
    s_mov_b32 s41, 65536
    buffer_load_dwordx4 v5, s[16:19], s41 offen offset:0 sc1 lds
    s_mov_b32 s41, 80896
    buffer_load_dwordx4 v5, s[16:19], s41 offen offset:1024 sc1 lds
    s_mov_b32 s41, 96256
    buffer_load_dwordx4 v5, s[16:19], s41 offen offset:2048 sc1 lds
    s_mov_b32 s41, 111616
    buffer_load_dwordx4 v5, s[16:19], s41 offen offset:3072 sc1 lds
    s_add_u32 m0, s36, 90112
    s_mov_b32 s41, 131072
    buffer_load_dwordx4 v5, s[16:19], s41 offen offset:0 sc1 lds
    s_mov_b32 s41, 146432
    buffer_load_dwordx4 v5, s[16:19], s41 offen offset:1024 sc1 lds
    s_mov_b32 s41, 161792
    buffer_load_dwordx4 v5, s[16:19], s41 offen offset:2048 sc1 lds
    s_mov_b32 s41, 177152
    buffer_load_dwordx4 v5, s[16:19], s41 offen offset:3072 sc1 lds
    s_add_u32 m0, s36, 94208
    s_mov_b32 s41, 196608
    buffer_load_dwordx4 v5, s[16:19], s41 offen offset:0 sc1 lds
    s_mov_b32 s41, 211968
    buffer_load_dwordx4 v5, s[16:19], s41 offen offset:1024 sc1 lds
    s_mov_b32 s41, 227328
    buffer_load_dwordx4 v5, s[16:19], s41 offen offset:2048 sc1 lds
    s_mov_b32 s41, 242688
    buffer_load_dwordx4 v5, s[16:19], s41 offen offset:3072 sc1 lds
    s_lshr_b32 s40, s13, 3
    s_lshl_b32 s40, s40, 21
    s_and_b32 s41, s13, 7
    s_lshl_b32 s41, s41, 16
    s_add_u32 s40, s40, s41
    s_lshl_b32 s41, s12, 8
    s_add_u32 s40, s40, s41
    s_add_u32 s40, s40, 0x28c0000
    s_cmp_lg_u32 s30, 0
    s_cselect_b32 s41, 65536, 0
    s_add_u32 s16, s10, s40
    s_addc_u32 s17, s11, 0
    s_and_b32 s17, s17, 0xffff
    s_mov_b32 s18, s41
    s_mov_b32 s19, 0x20000
    s_add_u32 m0, s26, 98304
    s_mov_b32 s41, 0
    buffer_load_dwordx4 v13, s[16:19], s41 offen offset:0 sc1 lds
    s_mov_b32 s41, 15360
    buffer_load_dwordx4 v13, s[16:19], s41 offen offset:1024 sc1 lds
    s_mov_b32 s41, 30720
    buffer_load_dwordx4 v13, s[16:19], s41 offen offset:2048 sc1 lds
    s_mov_b32 s41, 46080
    buffer_load_dwordx4 v13, s[16:19], s41 offen offset:3072 sc1 lds
    s_cmp_gt_u32 s55, 0
    s_cbranch_scc1 mega_kernel_yb25
    s_waitcnt vmcnt(35)
    s_barrier
mega_kernel_yb25:
    s_cmp_gt_u32 s55, 1
    s_cbranch_scc1 mega_kernel_yb26
    s_waitcnt vmcnt(27)
    s_barrier
mega_kernel_yb26:
    s_waitcnt vmcnt(21)
    s_barrier
    s_waitcnt vmcnt(0)
    s_barrier
mega_kernel_y1:
    s_branch mega_kernel_cfin
.p2align 7
mega_kernel_cons:
    s_getpc_b64 s[40:41]
mega_kernel_pc:
    s_sub_u32 s40, s40, mega_kernel_pc-mega_kernel
    s_subb_u32 s41, s41, 0
    s_lshr_b32 s42, s2, 3
    s_lshl_b32 s42, s42, 2
    s_add_u32 s42, s42, s38
    s_lshl_b32 s42, s42, 13
    s_cmp_ge_u32 s42, mega_kernel_end-mega_kernel
    s_cbranch_scc1 mega_kernel_pcx
    v_lshl_add_u32 v208, v0, 7, s42
    v_min_u32 v208, mega_kernel_end-mega_kernel, v208
    v_mov_b32 v209, s41
    v_add_co_u32 v208, vcc, s40, v208
    s_nop 1
    v_addc_co_u32 v209, vcc, 0, v209, vcc
    global_load_dword v249, v[208:209], off
mega_kernel_pcx:
    s_lshr_b32 s42, s38, 1
    s_and_b32 s43, s38, 1
    v_lshrrev_b32 v208, 4, v0
    v_and_b32 v209, 15, v0
    v_lshrrev_b32 v210, 2, v209
    v_and_b32 v211, 3, v0
    v_lshl_add_u32 v211, v210, 3, v211
    s_lshl_b32 s40, s12, 7
    s_lshl_b32 s41, s42, 6
    s_add_u32 s40, s40, s41
    v_add_u32 v211, s40, v211
    v_lshlrev_b32 v211, 1, v211
    s_waitcnt lgkmcnt(0)
    s_mov_b32 s16, s8
    s_and_b32 s17, s9, 0xffff
    s_mov_b32 s18, 4096
    s_mov_b32 s19, 0x20000
    buffer_load_ushort v252, v211, s[16:19], 0 offen offset:0
    buffer_load_ushort v253, v211, s[16:19], 0 offen offset:8
    buffer_load_ushort v254, v211, s[16:19], 0 offen offset:64
    buffer_load_ushort v255, v211, s[16:19], 0 offen offset:72
    s_mov_b32 s45, 16384
    v_lshrrev_b32 v211, 1, v209
    v_xor_b32 v211, v211, v208
    v_lshlrev_b32 v211, 4, v211
    v_mad_u32_u24 v211, v210, s45, v211
    v_and_b32 v212, 3, v0
    v_lshl_add_u32 v211, v212, 7, v211
    s_lshl_b32 s40, s42, 11
    v_add_u32 v2, s40, v211
    v_xor_b32 v3, 64, v2
    v_bfe_u32 v211, v0, 2, 2
    v_and_b32 v213, 1, v208
    v_lshl_or_b32 v213, v213, 2, v211
    v_mul_u32_u24 v214, s45, v208
    v_lshl_add_u32 v214, v211, 8, v214
    v_lshl_add_u32 v214, v212, 3, v214
    v_add_u32 v214, 65536, v214
    s_lshl_b32 s44, s43, 2
    s_add_u32 s45, s44, 0
    v_xor_b32 v215, s45, v213
    v_lshl_add_u32 v4, v215, 5, v214
    s_add_u32 s45, s44, 1
    v_xor_b32 v215, s45, v213
    v_lshl_add_u32 v5, v215, 5, v214
    s_add_u32 s45, s44, 2
    v_xor_b32 v215, s45, v213
    v_lshl_add_u32 v6, v215, 5, v214
    s_add_u32 s45, s44, 3
    v_xor_b32 v215, s45, v213
    v_lshl_add_u32 v7, v215, 5, v214
    v_lshlrev_b32 v9, 4, v0
    s_mul_i32 s40, s43, 16384
    s_add_u32 s40, s40, 65536
    v_add_u32 v8, s40, v9
    v_mov_b32 v15, 0xbdd2d3e8
    s_lshl_b32 s40, s12, 4
    s_add_u32 s40, s40, s13
    s_lshl_b32 s40, s40, 10
    s_lshl_b32 s41, s38, 8
    s_add_u32 s40, s40, s41
    v_add_u32 v10, s40, v9
    v_cmp_gt_u32 vcc, 16, v0
    v_mov_b32 v211, 0x80000000
    s_lshl_b32 s40, s12, 14
    v_cndmask_b32 v10, v211, v10, vcc
    s_lshl_b32 s41, s42, 9
    s_add_u32 s40, s40, s41
    v_lshl_add_u32 v11, v0, 3, s40
    s_lshl_b32 s40, s38, 2
    v_cmp_eq_u32 vcc, 0, v0
    v_mov_b32 v14, s40
    s_lshl_b32 s46, s13, 8
    v_cndmask_b32 v14, v211, v14, vcc
    s_lshl_b32 s40, s12, 4
    s_add_u32 s46, s46, s40
    s_add_u32 s46, s46, 0x7c000
    s_lshl_b32 s53, s12, 8
    s_lshl_b32 s40, s13, 2
    s_add_u32 s53, s53, s40
    s_mul_i32 s40, s38, 60
    s_add_u32 s53, s53, s40
    s_add_u32 s53, s53, 0x7d000
    v_bfe_u32 v211, v0, 3, 1
    v_lshlrev_b32 v211, 8, v211
    v_lshl_add_u32 v211, v208, 6, v211
    v_bfe_u32 v212, v0, 2, 1
    v_lshl_add_u32 v211, v212, 5, v211
    s_mul_i32 s40, s43, 1024
    s_lshl_b32 s41, s42, 9
    s_add_u32 s40, s40, s41
    s_add_u32 s40, s40, 131072
    v_add_u32 v12, s40, v211
    s_mul_i32 s40, s38, 512
    s_add_u32 s40, s40, 133120
    v_lshl_add_u32 v13, v208, 6, s40
    s_mov_b32 s47, s40
    s_lshl_b32 s40, s42, 8
    s_add_u32 s40, s40, 135168
    v_lshl_add_u32 v244, v208, 5, s40
    v_and_b32 v211, 3, v0
    v_lshl_add_u32 v211, v210, 3, v211
    v_lshl_add_u32 v246, v211, 2, s40
    s_lshl_b32 s40, s43, 8
    s_add_u32 s40, s40, 136192
    v_lshl_add_u32 v245, v209, 2, s40
    v_lshl_add_u32 v247, v208, 4, s40
    s_add_u32 s20, s10, 0x600000
    s_addc_u32 s21, s11, 0
    s_and_b32 s21, s21, 0xffff
    s_mov_b32 s22, 524288
    s_mov_b32 s23, 0x20000
    s_lshl_b32 s40, s13, 5
    s_lshl_b32 s41, s12, 1
    s_add_u32 s40, s40, s41
    s_add_u32 s40, s40, s42
    s_lshl_b32 s40, s40, 14
    s_lshl_b32 s41, s43, 12
    s_add_u32 s40, s40, s41
    s_add_u32 s40, s40, 0x2000000
    s_add_u32 s24, s10, s40
    s_addc_u32 s25, s11, 0
    s_and_b32 s25, s25, 0xffff
    s_mov_b32 s26, 16384
    s_mov_b32 s27, 0x20000
    s_mul_i32 s40, s12, 56
    s_lshl_b32 s41, s13, 2
    s_add_u32 s40, s40, s41
    s_lshl_b32 s41, s43, 1
    s_add_u32 s40, s40, s41
    s_lshl_b32 s40, s40, 13
    s_lshl_b32 s41, s42, 12
    s_add_u32 s40, s40, s41
    s_add_u32 s40, s40, 0x3000000
    s_add_u32 s28, s10, s40
    s_addc_u32 s29, s11, 0
    s_and_b32 s29, s29, 0xffff
    s_mov_b32 s30, 16384
    s_mov_b32 s31, 0x20000
    s_mov_b32 s48, 4096
    s_mov_b32 s49, 8192
    s_mov_b32 s50, 12288
    s_load_dwordx2 s[54:55], s[0:1], 80
    s_cmp_lt_u32 s38, 2
    s_cbranch_scc1 mega_kernel_tz
    s_lshl_b32 s40, s12, 19
    s_add_u32 s32, s6, s40
    s_addc_u32 s33, s7, 0
    s_and_b32 s33, s33, 0xffff
    s_mov_b32 s34, 524288
    s_mov_b32 s35, 0x20000
    s_mov_b64 s[56:57], s[32:33]
    s_mov_b32 s58, 524288
    s_mov_b32 s59, 0x20000
    s_and_b32 s40, s38, 1
    s_lshl_b32 s40, s40, 18
    v_lshl_add_u32 v250, v0, 12, s40
    v_mov_b32 v251, v250
    s_lshl_b32 s39, s13, 7
    s_add_u32 s44, s39, 1792
    s_mov_b64 s[36:37], 0
    s_add_u32 s40, s13, 0
    s_add_u32 s40, s13, 32
    s_bitset1_b64 s[36:37], s40
    s_cmp_lt_u32 s13, 4
    s_cbranch_scc0 mega_kernel_td
    s_add_u32 s40, s13, 43
    s_bitset1_b64 s[36:37], s40
    s_branch mega_kernel_td
mega_kernel_tz:
    s_mov_b32 s32, s4
    s_and_b32 s33, s5, 0xffff
    s_mov_b32 s34, 7340032
    s_mov_b32 s35, 0x20000
    s_lshl_b32 s40, s38, 5
    s_lshl_b32 s41, s12, 6
    s_add_u32 s40, s40, s41
    v_lshrrev_b32 v250, 1, v0
    v_add_u32 v250, s40, v250
    v_mul_u32_u24 v250, 7168, v250
    v_and_b32 v251, 1, v0
    v_lshl_add_u32 v250, v251, 7, v250
    v_lshlrev_b32 v251, 7, v0
    s_lshl_b32 s39, s13, 8
    s_lshl_b32 s44, s2, 14
    s_lshl_b32 s41, s38, 13
    s_add_u32 s44, s44, s41
    s_mov_b64 s[36:37], 0
    s_lshr_b32 s40, s12, 0
    s_add_i32 s40, s40, 0
    s_max_i32 s40, s40, 0
    s_lshr_b32 s40, s2, 3
    s_and_b32 s40, s40, 15
    s_add_u32 s40, s40, 0
    s_waitcnt lgkmcnt(0)
    s_mov_b32 s56, s54
    s_and_b32 s57, s55, 0xffff
    s_mov_b32 s58, 3670016
    s_mov_b32 s59, 0x20000
mega_kernel_td:
    v_mov_b32 v16, 0
    v_mov_b32 v17, 0
    v_mov_b32 v18, 0
    v_mov_b32 v19, 0
    v_mov_b32 v20, 0
    v_mov_b32 v21, 0
    v_mov_b32 v22, 0
    v_mov_b32 v23, 0
    v_mov_b32 v24, 0
    v_mov_b32 v25, 0
    v_mov_b32 v26, 0
    v_mov_b32 v27, 0
    v_mov_b32 v28, 0
    v_mov_b32 v29, 0
    v_mov_b32 v30, 0
    v_mov_b32 v31, 0
    v_mov_b32 v32, 0
    v_mov_b32 v33, 0
    v_mov_b32 v34, 0
    v_mov_b32 v35, 0
    v_mov_b32 v36, 0
    v_mov_b32 v37, 0
    v_mov_b32 v38, 0
    v_mov_b32 v39, 0
    v_mov_b32 v40, 0
    v_mov_b32 v41, 0
    v_mov_b32 v42, 0
    v_mov_b32 v43, 0
    v_mov_b32 v44, 0
    v_mov_b32 v45, 0
    v_mov_b32 v46, 0
    v_mov_b32 v47, 0
    v_mov_b32 v48, 0
    v_mov_b32 v49, 0
    v_mov_b32 v50, 0
    v_mov_b32 v51, 0
    v_mov_b32 v52, 0
    v_mov_b32 v53, 0
    v_mov_b32 v54, 0
    v_mov_b32 v55, 0
    v_mov_b32 v56, 0
    v_mov_b32 v57, 0
    v_mov_b32 v58, 0
    v_mov_b32 v59, 0
    v_mov_b32 v60, 0
    v_mov_b32 v61, 0
    v_mov_b32 v62, 0
    v_mov_b32 v63, 0
    v_mov_b32 v64, 0
    v_mov_b32 v65, 0
    v_mov_b32 v66, 0
    v_mov_b32 v67, 0
    v_mov_b32 v68, 0
    v_mov_b32 v69, 0
    v_mov_b32 v70, 0
    v_mov_b32 v71, 0
    v_mov_b32 v72, 0
    v_mov_b32 v73, 0
    v_mov_b32 v74, 0
    v_mov_b32 v75, 0
    v_mov_b32 v76, 0
    v_mov_b32 v77, 0
    v_mov_b32 v78, 0
    v_mov_b32 v79, 0
    s_waitcnt vmcnt(0)
    v_lshlrev_b32 v252, 16, v252
    v_lshlrev_b32 v253, 16, v253
    v_lshlrev_b32 v254, 16, v254
    v_lshlrev_b32 v255, 16, v255
    s_barrier
    ds_read_b64_tr_b16 v[176:177], v4 offset:0
    ds_read_b64_tr_b16 v[178:179], v4 offset:1024
    ds_read_b128 v[144:147], v2 offset:0
    ds_read_b128 v[148:151], v3 offset:512
    ds_read_b128 v[152:155], v2 offset:1024
    ds_read_b128 v[156:159], v3 offset:1536
    ds_read_b64_tr_b16 v[180:181], v5 offset:0
    ds_read_b64_tr_b16 v[182:183], v5 offset:1024
    ds_read_b64_tr_b16 v[184:185], v6 offset:0
    ds_read_b64_tr_b16 v[186:187], v6 offset:1024
    ds_read_b64_tr_b16 v[188:189], v7 offset:0
    ds_read_b64_tr_b16 v[190:191], v7 offset:1024
    s_mov_b32 s51, 3
mega_kernel_A:
    s_waitcnt lgkmcnt(0)
    v_mfma_f32_16x16x32_bf16 v[16:19], v[144:147], v[176:179], v[16:19]
    ds_read_b64_tr_b16 v[192:193], v4 offset:2048
    v_mfma_f32_16x16x32_bf16 v[20:23], v[148:151], v[176:179], v[20:23]
    ds_read_b64_tr_b16 v[194:195], v4 offset:3072
    v_mfma_f32_16x16x32_bf16 v[24:27], v[152:155], v[176:179], v[24:27]
    ds_read_b128 v[160:163], v3 offset:0
    v_mfma_f32_16x16x32_bf16 v[28:31], v[156:159], v[176:179], v[28:31]
    ds_read_b128 v[164:167], v2 offset:512
    v_mfma_f32_16x16x32_bf16 v[32:35], v[144:147], v[180:183], v[32:35]
    ds_read_b128 v[168:171], v3 offset:1024
    v_mfma_f32_16x16x32_bf16 v[36:39], v[148:151], v[180:183], v[36:39]
    ds_read_b128 v[172:175], v2 offset:1536
    v_mfma_f32_16x16x32_bf16 v[40:43], v[152:155], v[180:183], v[40:43]
    ds_read_b64_tr_b16 v[196:197], v5 offset:2048
    v_mfma_f32_16x16x32_bf16 v[44:47], v[156:159], v[180:183], v[44:47]
    ds_read_b64_tr_b16 v[198:199], v5 offset:3072
    v_mfma_f32_16x16x32_bf16 v[48:51], v[144:147], v[184:187], v[48:51]
    ds_read_b64_tr_b16 v[200:201], v6 offset:2048
    v_mfma_f32_16x16x32_bf16 v[52:55], v[148:151], v[184:187], v[52:55]
    ds_read_b64_tr_b16 v[202:203], v6 offset:3072
    v_mfma_f32_16x16x32_bf16 v[56:59], v[152:155], v[184:187], v[56:59]
    ds_read_b64_tr_b16 v[204:205], v7 offset:2048
    v_mfma_f32_16x16x32_bf16 v[60:63], v[156:159], v[184:187], v[60:63]
    ds_read_b64_tr_b16 v[206:207], v7 offset:3072
    v_mfma_f32_16x16x32_bf16 v[64:67], v[144:147], v[188:191], v[64:67]
    v_mfma_f32_16x16x32_bf16 v[68:71], v[148:151], v[188:191], v[68:71]
    v_mfma_f32_16x16x32_bf16 v[72:75], v[152:155], v[188:191], v[72:75]
    v_mfma_f32_16x16x32_bf16 v[76:79], v[156:159], v[188:191], v[76:79]
    s_waitcnt lgkmcnt(0)
    s_barrier
    v_mfma_f32_16x16x32_bf16 v[16:19], v[160:163], v[192:195], v[16:19]
    ds_read_b64_tr_b16 v[176:177], v4 offset:4096
    v_mfma_f32_16x16x32_bf16 v[20:23], v[164:167], v[192:195], v[20:23]
    ds_read_b64_tr_b16 v[178:179], v4 offset:5120
    v_mfma_f32_16x16x32_bf16 v[24:27], v[168:171], v[192:195], v[24:27]
    ds_read_b128 v[144:147], v2 offset:4096
    v_mfma_f32_16x16x32_bf16 v[28:31], v[172:175], v[192:195], v[28:31]
    ds_read_b128 v[148:151], v3 offset:4608
    v_mfma_f32_16x16x32_bf16 v[32:35], v[160:163], v[196:199], v[32:35]
    ds_read_b128 v[152:155], v2 offset:5120
    v_mfma_f32_16x16x32_bf16 v[36:39], v[164:167], v[196:199], v[36:39]
    ds_read_b128 v[156:159], v3 offset:5632
    v_mfma_f32_16x16x32_bf16 v[40:43], v[168:171], v[196:199], v[40:43]
    ds_read_b64_tr_b16 v[180:181], v5 offset:4096
    v_mfma_f32_16x16x32_bf16 v[44:47], v[172:175], v[196:199], v[44:47]
    ds_read_b64_tr_b16 v[182:183], v5 offset:5120
    v_mfma_f32_16x16x32_bf16 v[48:51], v[160:163], v[200:203], v[48:51]
    ds_read_b64_tr_b16 v[184:185], v6 offset:4096
    v_mfma_f32_16x16x32_bf16 v[52:55], v[164:167], v[200:203], v[52:55]
    ds_read_b64_tr_b16 v[186:187], v6 offset:5120
    v_mfma_f32_16x16x32_bf16 v[56:59], v[168:171], v[200:203], v[56:59]
    ds_read_b64_tr_b16 v[188:189], v7 offset:4096
    v_mfma_f32_16x16x32_bf16 v[60:63], v[172:175], v[200:203], v[60:63]
    ds_read_b64_tr_b16 v[190:191], v7 offset:5120
    v_mfma_f32_16x16x32_bf16 v[64:67], v[160:163], v[204:207], v[64:67]
    v_mfma_f32_16x16x32_bf16 v[68:71], v[164:167], v[204:207], v[68:71]
    v_mfma_f32_16x16x32_bf16 v[72:75], v[168:171], v[204:207], v[72:75]
    v_mfma_f32_16x16x32_bf16 v[76:79], v[172:175], v[204:207], v[76:79]
    s_waitcnt lgkmcnt(0)
    v_mfma_f32_16x16x32_bf16 v[16:19], v[144:147], v[176:179], v[16:19]
    ds_read_b64_tr_b16 v[192:193], v4 offset:6144
    v_mfma_f32_16x16x32_bf16 v[20:23], v[148:151], v[176:179], v[20:23]
    ds_read_b64_tr_b16 v[194:195], v4 offset:7168
    v_mfma_f32_16x16x32_bf16 v[24:27], v[152:155], v[176:179], v[24:27]
    ds_read_b128 v[160:163], v3 offset:4096
    v_mfma_f32_16x16x32_bf16 v[28:31], v[156:159], v[176:179], v[28:31]
    ds_read_b128 v[164:167], v2 offset:4608
    v_mfma_f32_16x16x32_bf16 v[32:35], v[144:147], v[180:183], v[32:35]
    ds_read_b128 v[168:171], v3 offset:5120
    v_mfma_f32_16x16x32_bf16 v[36:39], v[148:151], v[180:183], v[36:39]
    ds_read_b128 v[172:175], v2 offset:5632
    v_mfma_f32_16x16x32_bf16 v[40:43], v[152:155], v[180:183], v[40:43]
    ds_read_b64_tr_b16 v[196:197], v5 offset:6144
    v_mfma_f32_16x16x32_bf16 v[44:47], v[156:159], v[180:183], v[44:47]
    ds_read_b64_tr_b16 v[198:199], v5 offset:7168
    v_mfma_f32_16x16x32_bf16 v[48:51], v[144:147], v[184:187], v[48:51]
    ds_read_b64_tr_b16 v[200:201], v6 offset:6144
    v_mfma_f32_16x16x32_bf16 v[52:55], v[148:151], v[184:187], v[52:55]
    ds_read_b64_tr_b16 v[202:203], v6 offset:7168
    v_mfma_f32_16x16x32_bf16 v[56:59], v[152:155], v[184:187], v[56:59]
    ds_read_b64_tr_b16 v[204:205], v7 offset:6144
    v_mfma_f32_16x16x32_bf16 v[60:63], v[156:159], v[184:187], v[60:63]
    ds_read_b64_tr_b16 v[206:207], v7 offset:7168
    v_mfma_f32_16x16x32_bf16 v[64:67], v[144:147], v[188:191], v[64:67]
    v_mfma_f32_16x16x32_bf16 v[68:71], v[148:151], v[188:191], v[68:71]
    v_mfma_f32_16x16x32_bf16 v[72:75], v[152:155], v[188:191], v[72:75]
    v_mfma_f32_16x16x32_bf16 v[76:79], v[156:159], v[188:191], v[76:79]
    s_waitcnt lgkmcnt(0)
    s_barrier
    v_mfma_f32_16x16x32_bf16 v[16:19], v[160:163], v[192:195], v[16:19]
    ds_read_b64_tr_b16 v[176:177], v4 offset:8192
    v_mfma_f32_16x16x32_bf16 v[20:23], v[164:167], v[192:195], v[20:23]
    ds_read_b64_tr_b16 v[178:179], v4 offset:9216
    v_mfma_f32_16x16x32_bf16 v[24:27], v[168:171], v[192:195], v[24:27]
    ds_read_b128 v[144:147], v2 offset:8192
    v_mfma_f32_16x16x32_bf16 v[28:31], v[172:175], v[192:195], v[28:31]
    ds_read_b128 v[148:151], v3 offset:8704
    v_mfma_f32_16x16x32_bf16 v[32:35], v[160:163], v[196:199], v[32:35]
    ds_read_b128 v[152:155], v2 offset:9216
    v_mfma_f32_16x16x32_bf16 v[36:39], v[164:167], v[196:199], v[36:39]
    ds_read_b128 v[156:159], v3 offset:9728
    v_mfma_f32_16x16x32_bf16 v[40:43], v[168:171], v[196:199], v[40:43]
    ds_read_b64_tr_b16 v[180:181], v5 offset:8192
    v_mfma_f32_16x16x32_bf16 v[44:47], v[172:175], v[196:199], v[44:47]
    ds_read_b64_tr_b16 v[182:183], v5 offset:9216
    v_mfma_f32_16x16x32_bf16 v[48:51], v[160:163], v[200:203], v[48:51]
    ds_read_b64_tr_b16 v[184:185], v6 offset:8192
    v_mfma_f32_16x16x32_bf16 v[52:55], v[164:167], v[200:203], v[52:55]
    ds_read_b64_tr_b16 v[186:187], v6 offset:9216
    v_mfma_f32_16x16x32_bf16 v[56:59], v[168:171], v[200:203], v[56:59]
    ds_read_b64_tr_b16 v[188:189], v7 offset:8192
    v_mfma_f32_16x16x32_bf16 v[60:63], v[172:175], v[200:203], v[60:63]
    ds_read_b64_tr_b16 v[190:191], v7 offset:9216
    v_mfma_f32_16x16x32_bf16 v[64:67], v[160:163], v[204:207], v[64:67]
    v_mfma_f32_16x16x32_bf16 v[68:71], v[164:167], v[204:207], v[68:71]
    v_mfma_f32_16x16x32_bf16 v[72:75], v[168:171], v[204:207], v[72:75]
    v_mfma_f32_16x16x32_bf16 v[76:79], v[172:175], v[204:207], v[76:79]
    s_waitcnt lgkmcnt(0)
    v_mfma_f32_16x16x32_bf16 v[16:19], v[144:147], v[176:179], v[16:19]
    ds_read_b64_tr_b16 v[192:193], v4 offset:10240
    v_mfma_f32_16x16x32_bf16 v[20:23], v[148:151], v[176:179], v[20:23]
    ds_read_b64_tr_b16 v[194:195], v4 offset:11264
    v_mfma_f32_16x16x32_bf16 v[24:27], v[152:155], v[176:179], v[24:27]
    ds_read_b128 v[160:163], v3 offset:8192
    v_mfma_f32_16x16x32_bf16 v[28:31], v[156:159], v[176:179], v[28:31]
    ds_read_b128 v[164:167], v2 offset:8704
    v_mfma_f32_16x16x32_bf16 v[32:35], v[144:147], v[180:183], v[32:35]
    ds_read_b128 v[168:171], v3 offset:9216
    v_mfma_f32_16x16x32_bf16 v[36:39], v[148:151], v[180:183], v[36:39]
    ds_read_b128 v[172:175], v2 offset:9728
    v_mfma_f32_16x16x32_bf16 v[40:43], v[152:155], v[180:183], v[40:43]
    ds_read_b64_tr_b16 v[196:197], v5 offset:10240
    v_mfma_f32_16x16x32_bf16 v[44:47], v[156:159], v[180:183], v[44:47]
    ds_read_b64_tr_b16 v[198:199], v5 offset:11264
    v_mfma_f32_16x16x32_bf16 v[48:51], v[144:147], v[184:187], v[48:51]
    ds_read_b64_tr_b16 v[200:201], v6 offset:10240
    v_mfma_f32_16x16x32_bf16 v[52:55], v[148:151], v[184:187], v[52:55]
    ds_read_b64_tr_b16 v[202:203], v6 offset:11264
    v_mfma_f32_16x16x32_bf16 v[56:59], v[152:155], v[184:187], v[56:59]
    ds_read_b64_tr_b16 v[204:205], v7 offset:10240
    v_mfma_f32_16x16x32_bf16 v[60:63], v[156:159], v[184:187], v[60:63]
    ds_read_b64_tr_b16 v[206:207], v7 offset:11264
    v_mfma_f32_16x16x32_bf16 v[64:67], v[144:147], v[188:191], v[64:67]
    v_mfma_f32_16x16x32_bf16 v[68:71], v[148:151], v[188:191], v[68:71]
    v_mfma_f32_16x16x32_bf16 v[72:75], v[152:155], v[188:191], v[72:75]
    v_mfma_f32_16x16x32_bf16 v[76:79], v[156:159], v[188:191], v[76:79]
    s_waitcnt lgkmcnt(0)
    s_barrier
    v_mfma_f32_16x16x32_bf16 v[16:19], v[160:163], v[192:195], v[16:19]
    ds_read_b64_tr_b16 v[176:177], v4 offset:12288
    v_mfma_f32_16x16x32_bf16 v[20:23], v[164:167], v[192:195], v[20:23]
    ds_read_b64_tr_b16 v[178:179], v4 offset:13312
    v_mfma_f32_16x16x32_bf16 v[24:27], v[168:171], v[192:195], v[24:27]
    ds_read_b128 v[144:147], v2 offset:12288
    v_mfma_f32_16x16x32_bf16 v[28:31], v[172:175], v[192:195], v[28:31]
    ds_read_b128 v[148:151], v3 offset:12800
    v_mfma_f32_16x16x32_bf16 v[32:35], v[160:163], v[196:199], v[32:35]
    ds_read_b128 v[152:155], v2 offset:13312
    v_mfma_f32_16x16x32_bf16 v[36:39], v[164:167], v[196:199], v[36:39]
    ds_read_b128 v[156:159], v3 offset:13824
    v_mfma_f32_16x16x32_bf16 v[40:43], v[168:171], v[196:199], v[40:43]
    ds_read_b64_tr_b16 v[180:181], v5 offset:12288
    v_mfma_f32_16x16x32_bf16 v[44:47], v[172:175], v[196:199], v[44:47]
    ds_read_b64_tr_b16 v[182:183], v5 offset:13312
    v_mfma_f32_16x16x32_bf16 v[48:51], v[160:163], v[200:203], v[48:51]
    ds_read_b64_tr_b16 v[184:185], v6 offset:12288
    v_mfma_f32_16x16x32_bf16 v[52:55], v[164:167], v[200:203], v[52:55]
    ds_read_b64_tr_b16 v[186:187], v6 offset:13312
    v_mfma_f32_16x16x32_bf16 v[56:59], v[168:171], v[200:203], v[56:59]
    ds_read_b64_tr_b16 v[188:189], v7 offset:12288
    v_mfma_f32_16x16x32_bf16 v[60:63], v[172:175], v[200:203], v[60:63]
    ds_read_b64_tr_b16 v[190:191], v7 offset:13312
    v_mfma_f32_16x16x32_bf16 v[64:67], v[160:163], v[204:207], v[64:67]
    v_mfma_f32_16x16x32_bf16 v[68:71], v[164:167], v[204:207], v[68:71]
    v_mfma_f32_16x16x32_bf16 v[72:75], v[168:171], v[204:207], v[72:75]
    v_mfma_f32_16x16x32_bf16 v[76:79], v[172:175], v[204:207], v[76:79]
    s_waitcnt lgkmcnt(0)
    v_mfma_f32_16x16x32_bf16 v[16:19], v[144:147], v[176:179], v[16:19]
    ds_read_b64_tr_b16 v[192:193], v4 offset:14336
    v_mfma_f32_16x16x32_bf16 v[20:23], v[148:151], v[176:179], v[20:23]
    ds_read_b64_tr_b16 v[194:195], v4 offset:15360
    v_mfma_f32_16x16x32_bf16 v[24:27], v[152:155], v[176:179], v[24:27]
    ds_read_b128 v[160:163], v3 offset:12288
    v_mfma_f32_16x16x32_bf16 v[28:31], v[156:159], v[176:179], v[28:31]
    ds_read_b128 v[164:167], v2 offset:12800
    v_mfma_f32_16x16x32_bf16 v[32:35], v[144:147], v[180:183], v[32:35]
    ds_read_b128 v[168:171], v3 offset:13312
    v_mfma_f32_16x16x32_bf16 v[36:39], v[148:151], v[180:183], v[36:39]
    ds_read_b128 v[172:175], v2 offset:13824
    v_mfma_f32_16x16x32_bf16 v[40:43], v[152:155], v[180:183], v[40:43]
    ds_read_b64_tr_b16 v[196:197], v5 offset:14336
    v_mfma_f32_16x16x32_bf16 v[44:47], v[156:159], v[180:183], v[44:47]
    ds_read_b64_tr_b16 v[198:199], v5 offset:15360
    v_mfma_f32_16x16x32_bf16 v[48:51], v[144:147], v[184:187], v[48:51]
    ds_read_b64_tr_b16 v[200:201], v6 offset:14336
    v_mfma_f32_16x16x32_bf16 v[52:55], v[148:151], v[184:187], v[52:55]
    ds_read_b64_tr_b16 v[202:203], v6 offset:15360
    v_mfma_f32_16x16x32_bf16 v[56:59], v[152:155], v[184:187], v[56:59]
    ds_read_b64_tr_b16 v[204:205], v7 offset:14336
    v_mfma_f32_16x16x32_bf16 v[60:63], v[156:159], v[184:187], v[60:63]
    ds_read_b64_tr_b16 v[206:207], v7 offset:15360
    v_mfma_f32_16x16x32_bf16 v[64:67], v[144:147], v[188:191], v[64:67]
    v_mfma_f32_16x16x32_bf16 v[68:71], v[148:151], v[188:191], v[68:71]
    v_mfma_f32_16x16x32_bf16 v[72:75], v[152:155], v[188:191], v[72:75]
    v_mfma_f32_16x16x32_bf16 v[76:79], v[156:159], v[188:191], v[76:79]
    s_waitcnt lgkmcnt(0)
    s_barrier
    v_mfma_f32_16x16x32_bf16 v[16:19], v[160:163], v[192:195], v[16:19]
    ds_read_b64_tr_b16 v[176:177], v4 offset:0
    v_mfma_f32_16x16x32_bf16 v[20:23], v[164:167], v[192:195], v[20:23]
    ds_read_b64_tr_b16 v[178:179], v4 offset:1024
    v_mfma_f32_16x16x32_bf16 v[24:27], v[168:171], v[192:195], v[24:27]
    ds_read_b128 v[144:147], v2 offset:0
    v_mfma_f32_16x16x32_bf16 v[28:31], v[172:175], v[192:195], v[28:31]
    ds_read_b128 v[148:151], v3 offset:512
    v_mfma_f32_16x16x32_bf16 v[32:35], v[160:163], v[196:199], v[32:35]
    ds_read_b128 v[152:155], v2 offset:1024
    v_mfma_f32_16x16x32_bf16 v[36:39], v[164:167], v[196:199], v[36:39]
    ds_read_b128 v[156:159], v3 offset:1536
    v_mfma_f32_16x16x32_bf16 v[40:43], v[168:171], v[196:199], v[40:43]
    ds_read_b64_tr_b16 v[180:181], v5 offset:0
    v_mfma_f32_16x16x32_bf16 v[44:47], v[172:175], v[196:199], v[44:47]
    ds_read_b64_tr_b16 v[182:183], v5 offset:1024
    v_mfma_f32_16x16x32_bf16 v[48:51], v[160:163], v[200:203], v[48:51]
    ds_read_b64_tr_b16 v[184:185], v6 offset:0
    v_mfma_f32_16x16x32_bf16 v[52:55], v[164:167], v[200:203], v[52:55]
    ds_read_b64_tr_b16 v[186:187], v6 offset:1024
    v_mfma_f32_16x16x32_bf16 v[56:59], v[168:171], v[200:203], v[56:59]
    ds_read_b64_tr_b16 v[188:189], v7 offset:0
    v_mfma_f32_16x16x32_bf16 v[60:63], v[172:175], v[200:203], v[60:63]
    ds_read_b64_tr_b16 v[190:191], v7 offset:1024
    v_mfma_f32_16x16x32_bf16 v[64:67], v[160:163], v[204:207], v[64:67]
    v_mfma_f32_16x16x32_bf16 v[68:71], v[164:167], v[204:207], v[68:71]
    v_mfma_f32_16x16x32_bf16 v[72:75], v[168:171], v[204:207], v[72:75]
    v_mfma_f32_16x16x32_bf16 v[76:79], v[172:175], v[204:207], v[76:79]
    s_lshr_b32 s36, s36, 4
    s_sub_u32 s51, s51, 1
    s_cmp_lg_u32 s51, 0
    s_cbranch_scc1 mega_kernel_A
    s_waitcnt lgkmcnt(0)
    v_mfma_f32_16x16x32_bf16 v[16:19], v[144:147], v[176:179], v[16:19]
    ds_read_b64_tr_b16 v[192:193], v4 offset:2048
    v_mfma_f32_16x16x32_bf16 v[20:23], v[148:151], v[176:179], v[20:23]
    ds_read_b64_tr_b16 v[194:195], v4 offset:3072
    v_mfma_f32_16x16x32_bf16 v[24:27], v[152:155], v[176:179], v[24:27]
    ds_read_b128 v[160:163], v3 offset:0
    v_mfma_f32_16x16x32_bf16 v[28:31], v[156:159], v[176:179], v[28:31]
    ds_read_b128 v[164:167], v2 offset:512
    v_mfma_f32_16x16x32_bf16 v[32:35], v[144:147], v[180:183], v[32:35]
    ds_read_b128 v[168:171], v3 offset:1024
    v_mfma_f32_16x16x32_bf16 v[36:39], v[148:151], v[180:183], v[36:39]
    ds_read_b128 v[172:175], v2 offset:1536
    v_mfma_f32_16x16x32_bf16 v[40:43], v[152:155], v[180:183], v[40:43]
    ds_read_b64_tr_b16 v[196:197], v5 offset:2048
    v_mfma_f32_16x16x32_bf16 v[44:47], v[156:159], v[180:183], v[44:47]
    ds_read_b64_tr_b16 v[198:199], v5 offset:3072
    v_mfma_f32_16x16x32_bf16 v[48:51], v[144:147], v[184:187], v[48:51]
    ds_read_b64_tr_b16 v[200:201], v6 offset:2048
    v_mfma_f32_16x16x32_bf16 v[52:55], v[148:151], v[184:187], v[52:55]
    ds_read_b64_tr_b16 v[202:203], v6 offset:3072
    v_mfma_f32_16x16x32_bf16 v[56:59], v[152:155], v[184:187], v[56:59]
    ds_read_b64_tr_b16 v[204:205], v7 offset:2048
    v_mfma_f32_16x16x32_bf16 v[60:63], v[156:159], v[184:187], v[60:63]
    ds_read_b64_tr_b16 v[206:207], v7 offset:3072
    v_mfma_f32_16x16x32_bf16 v[64:67], v[144:147], v[188:191], v[64:67]
    v_mfma_f32_16x16x32_bf16 v[68:71], v[148:151], v[188:191], v[68:71]
    v_mfma_f32_16x16x32_bf16 v[72:75], v[152:155], v[188:191], v[72:75]
    v_mfma_f32_16x16x32_bf16 v[76:79], v[156:159], v[188:191], v[76:79]
    s_waitcnt lgkmcnt(0)
    s_barrier
    v_mfma_f32_16x16x32_bf16 v[16:19], v[160:163], v[192:195], v[16:19]
    ds_read_b64_tr_b16 v[176:177], v4 offset:4096
    v_mfma_f32_16x16x32_bf16 v[20:23], v[164:167], v[192:195], v[20:23]
    ds_read_b64_tr_b16 v[178:179], v4 offset:5120
    v_mfma_f32_16x16x32_bf16 v[24:27], v[168:171], v[192:195], v[24:27]
    ds_read_b128 v[144:147], v2 offset:4096
    v_mfma_f32_16x16x32_bf16 v[28:31], v[172:175], v[192:195], v[28:31]
    ds_read_b128 v[148:151], v3 offset:4608
    v_mfma_f32_16x16x32_bf16 v[32:35], v[160:163], v[196:199], v[32:35]
    ds_read_b128 v[152:155], v2 offset:5120
    v_mfma_f32_16x16x32_bf16 v[36:39], v[164:167], v[196:199], v[36:39]
    ds_read_b128 v[156:159], v3 offset:5632
    v_mfma_f32_16x16x32_bf16 v[40:43], v[168:171], v[196:199], v[40:43]
    ds_read_b64_tr_b16 v[180:181], v5 offset:4096
    v_mfma_f32_16x16x32_bf16 v[44:47], v[172:175], v[196:199], v[44:47]
    ds_read_b64_tr_b16 v[182:183], v5 offset:5120
    v_mfma_f32_16x16x32_bf16 v[48:51], v[160:163], v[200:203], v[48:51]
    ds_read_b64_tr_b16 v[184:185], v6 offset:4096
    v_mfma_f32_16x16x32_bf16 v[52:55], v[164:167], v[200:203], v[52:55]
    ds_read_b64_tr_b16 v[186:187], v6 offset:5120
    v_mfma_f32_16x16x32_bf16 v[56:59], v[168:171], v[200:203], v[56:59]
    ds_read_b64_tr_b16 v[188:189], v7 offset:4096
    v_mfma_f32_16x16x32_bf16 v[60:63], v[172:175], v[200:203], v[60:63]
    ds_read_b64_tr_b16 v[190:191], v7 offset:5120
    v_mfma_f32_16x16x32_bf16 v[64:67], v[160:163], v[204:207], v[64:67]
    v_mfma_f32_16x16x32_bf16 v[68:71], v[164:167], v[204:207], v[68:71]
    v_mfma_f32_16x16x32_bf16 v[72:75], v[168:171], v[204:207], v[72:75]
    v_mfma_f32_16x16x32_bf16 v[76:79], v[172:175], v[204:207], v[76:79]
    s_waitcnt lgkmcnt(0)
    v_mfma_f32_16x16x32_bf16 v[16:19], v[144:147], v[176:179], v[16:19]
    ds_read_b64_tr_b16 v[192:193], v4 offset:6144
    v_mfma_f32_16x16x32_bf16 v[20:23], v[148:151], v[176:179], v[20:23]
    ds_read_b64_tr_b16 v[194:195], v4 offset:7168
    v_mfma_f32_16x16x32_bf16 v[24:27], v[152:155], v[176:179], v[24:27]
    ds_read_b128 v[160:163], v3 offset:4096
    v_mfma_f32_16x16x32_bf16 v[28:31], v[156:159], v[176:179], v[28:31]
    ds_read_b128 v[164:167], v2 offset:4608
    v_mfma_f32_16x16x32_bf16 v[32:35], v[144:147], v[180:183], v[32:35]
    ds_read_b128 v[168:171], v3 offset:5120
    v_mfma_f32_16x16x32_bf16 v[36:39], v[148:151], v[180:183], v[36:39]
    ds_read_b128 v[172:175], v2 offset:5632
    v_mfma_f32_16x16x32_bf16 v[40:43], v[152:155], v[180:183], v[40:43]
    ds_read_b64_tr_b16 v[196:197], v5 offset:6144
    v_mfma_f32_16x16x32_bf16 v[44:47], v[156:159], v[180:183], v[44:47]
    ds_read_b64_tr_b16 v[198:199], v5 offset:7168
    v_mfma_f32_16x16x32_bf16 v[48:51], v[144:147], v[184:187], v[48:51]
    ds_read_b64_tr_b16 v[200:201], v6 offset:6144
    v_mfma_f32_16x16x32_bf16 v[52:55], v[148:151], v[184:187], v[52:55]
    ds_read_b64_tr_b16 v[202:203], v6 offset:7168
    v_mfma_f32_16x16x32_bf16 v[56:59], v[152:155], v[184:187], v[56:59]
    ds_read_b64_tr_b16 v[204:205], v7 offset:6144
    v_mfma_f32_16x16x32_bf16 v[60:63], v[156:159], v[184:187], v[60:63]
    ds_read_b64_tr_b16 v[206:207], v7 offset:7168
    v_mfma_f32_16x16x32_bf16 v[64:67], v[144:147], v[188:191], v[64:67]
    v_mfma_f32_16x16x32_bf16 v[68:71], v[148:151], v[188:191], v[68:71]
    v_mfma_f32_16x16x32_bf16 v[72:75], v[152:155], v[188:191], v[72:75]
    v_mfma_f32_16x16x32_bf16 v[76:79], v[156:159], v[188:191], v[76:79]
    s_waitcnt lgkmcnt(0)
    s_barrier
    v_mfma_f32_16x16x32_bf16 v[16:19], v[160:163], v[192:195], v[16:19]
    ds_read_b64_tr_b16 v[176:177], v4 offset:8192
    v_mfma_f32_16x16x32_bf16 v[20:23], v[164:167], v[192:195], v[20:23]
    ds_read_b64_tr_b16 v[178:179], v4 offset:9216
    v_mfma_f32_16x16x32_bf16 v[24:27], v[168:171], v[192:195], v[24:27]
    ds_read_b128 v[144:147], v2 offset:8192
    v_mfma_f32_16x16x32_bf16 v[28:31], v[172:175], v[192:195], v[28:31]
    ds_read_b128 v[148:151], v3 offset:8704
    v_mfma_f32_16x16x32_bf16 v[32:35], v[160:163], v[196:199], v[32:35]
    ds_read_b128 v[152:155], v2 offset:9216
    v_mfma_f32_16x16x32_bf16 v[36:39], v[164:167], v[196:199], v[36:39]
    ds_read_b128 v[156:159], v3 offset:9728
    v_mfma_f32_16x16x32_bf16 v[40:43], v[168:171], v[196:199], v[40:43]
    ds_read_b64_tr_b16 v[180:181], v5 offset:8192
    v_mfma_f32_16x16x32_bf16 v[44:47], v[172:175], v[196:199], v[44:47]
    ds_read_b64_tr_b16 v[182:183], v5 offset:9216
    v_mfma_f32_16x16x32_bf16 v[48:51], v[160:163], v[200:203], v[48:51]
    ds_read_b64_tr_b16 v[184:185], v6 offset:8192
    v_mfma_f32_16x16x32_bf16 v[52:55], v[164:167], v[200:203], v[52:55]
    ds_read_b64_tr_b16 v[186:187], v6 offset:9216
    v_mfma_f32_16x16x32_bf16 v[56:59], v[168:171], v[200:203], v[56:59]
    ds_read_b64_tr_b16 v[188:189], v7 offset:8192
    v_mfma_f32_16x16x32_bf16 v[60:63], v[172:175], v[200:203], v[60:63]
    ds_read_b64_tr_b16 v[190:191], v7 offset:9216
    v_mfma_f32_16x16x32_bf16 v[64:67], v[160:163], v[204:207], v[64:67]
    v_mfma_f32_16x16x32_bf16 v[68:71], v[164:167], v[204:207], v[68:71]
    v_mfma_f32_16x16x32_bf16 v[72:75], v[168:171], v[204:207], v[72:75]
    v_mfma_f32_16x16x32_bf16 v[76:79], v[172:175], v[204:207], v[76:79]
    s_waitcnt lgkmcnt(0)
    v_mfma_f32_16x16x32_bf16 v[16:19], v[144:147], v[176:179], v[16:19]
    ds_read_b64_tr_b16 v[192:193], v4 offset:10240
    v_mfma_f32_16x16x32_bf16 v[20:23], v[148:151], v[176:179], v[20:23]
    ds_read_b64_tr_b16 v[194:195], v4 offset:11264
    v_mfma_f32_16x16x32_bf16 v[24:27], v[152:155], v[176:179], v[24:27]
    ds_read_b128 v[160:163], v3 offset:8192
    v_mfma_f32_16x16x32_bf16 v[28:31], v[156:159], v[176:179], v[28:31]
    ds_read_b128 v[164:167], v2 offset:8704
    v_mfma_f32_16x16x32_bf16 v[32:35], v[144:147], v[180:183], v[32:35]
    ds_read_b128 v[168:171], v3 offset:9216
    v_mfma_f32_16x16x32_bf16 v[36:39], v[148:151], v[180:183], v[36:39]
    ds_read_b128 v[172:175], v2 offset:9728
    v_mfma_f32_16x16x32_bf16 v[40:43], v[152:155], v[180:183], v[40:43]
    ds_read_b64_tr_b16 v[196:197], v5 offset:10240
    v_mfma_f32_16x16x32_bf16 v[44:47], v[156:159], v[180:183], v[44:47]
    ds_read_b64_tr_b16 v[198:199], v5 offset:11264
    v_mfma_f32_16x16x32_bf16 v[48:51], v[144:147], v[184:187], v[48:51]
    ds_read_b64_tr_b16 v[200:201], v6 offset:10240
    v_mfma_f32_16x16x32_bf16 v[52:55], v[148:151], v[184:187], v[52:55]
    ds_read_b64_tr_b16 v[202:203], v6 offset:11264
    v_mfma_f32_16x16x32_bf16 v[56:59], v[152:155], v[184:187], v[56:59]
    ds_read_b64_tr_b16 v[204:205], v7 offset:10240
    v_mfma_f32_16x16x32_bf16 v[60:63], v[156:159], v[184:187], v[60:63]
    ds_read_b64_tr_b16 v[206:207], v7 offset:11264
    v_mfma_f32_16x16x32_bf16 v[64:67], v[144:147], v[188:191], v[64:67]
    v_mfma_f32_16x16x32_bf16 v[68:71], v[148:151], v[188:191], v[68:71]
    v_mfma_f32_16x16x32_bf16 v[72:75], v[152:155], v[188:191], v[72:75]
    v_mfma_f32_16x16x32_bf16 v[76:79], v[156:159], v[188:191], v[76:79]
    s_waitcnt lgkmcnt(0)
    s_barrier
    v_mfma_f32_16x16x32_bf16 v[16:19], v[160:163], v[192:195], v[16:19]
    ds_read_b64_tr_b16 v[176:177], v4 offset:12288
    v_mfma_f32_16x16x32_bf16 v[20:23], v[164:167], v[192:195], v[20:23]
    ds_read_b64_tr_b16 v[178:179], v4 offset:13312
    v_mfma_f32_16x16x32_bf16 v[24:27], v[168:171], v[192:195], v[24:27]
    ds_read_b128 v[144:147], v2 offset:12288
    v_mfma_f32_16x16x32_bf16 v[28:31], v[172:175], v[192:195], v[28:31]
    ds_read_b128 v[148:151], v3 offset:12800
    v_mfma_f32_16x16x32_bf16 v[32:35], v[160:163], v[196:199], v[32:35]
    ds_read_b128 v[152:155], v2 offset:13312
    v_mfma_f32_16x16x32_bf16 v[36:39], v[164:167], v[196:199], v[36:39]
    ds_read_b128 v[156:159], v3 offset:13824
    v_mfma_f32_16x16x32_bf16 v[40:43], v[168:171], v[196:199], v[40:43]
    ds_read_b64_tr_b16 v[180:181], v5 offset:12288
    v_mfma_f32_16x16x32_bf16 v[44:47], v[172:175], v[196:199], v[44:47]
    ds_read_b64_tr_b16 v[182:183], v5 offset:13312
    v_mfma_f32_16x16x32_bf16 v[48:51], v[160:163], v[200:203], v[48:51]
    ds_read_b64_tr_b16 v[184:185], v6 offset:12288
    v_mfma_f32_16x16x32_bf16 v[52:55], v[164:167], v[200:203], v[52:55]
    ds_read_b64_tr_b16 v[186:187], v6 offset:13312
    v_mfma_f32_16x16x32_bf16 v[56:59], v[168:171], v[200:203], v[56:59]
    ds_read_b64_tr_b16 v[188:189], v7 offset:12288
    v_mfma_f32_16x16x32_bf16 v[60:63], v[172:175], v[200:203], v[60:63]
    ds_read_b64_tr_b16 v[190:191], v7 offset:13312
    v_mfma_f32_16x16x32_bf16 v[64:67], v[160:163], v[204:207], v[64:67]
    v_mfma_f32_16x16x32_bf16 v[68:71], v[164:167], v[204:207], v[68:71]
    v_mfma_f32_16x16x32_bf16 v[72:75], v[168:171], v[204:207], v[72:75]
    v_mfma_f32_16x16x32_bf16 v[76:79], v[172:175], v[204:207], v[76:79]
    s_waitcnt lgkmcnt(0)
    v_mfma_f32_16x16x32_bf16 v[16:19], v[144:147], v[176:179], v[16:19]
    ds_read_b64_tr_b16 v[192:193], v4 offset:14336
    ds_read_b128 v[96:99], v244 offset:512
    v_mfma_f32_16x16x32_bf16 v[20:23], v[148:151], v[176:179], v[20:23]
    ds_read_b64_tr_b16 v[194:195], v4 offset:15360
    ds_read_b128 v[100:103], v244 offset:528
    v_mfma_f32_16x16x32_bf16 v[24:27], v[152:155], v[176:179], v[24:27]
    ds_read_b128 v[160:163], v3 offset:12288
    ds_read_b128 v[104:107], v244 offset:640
    v_mfma_f32_16x16x32_bf16 v[28:31], v[156:159], v[176:179], v[28:31]
    ds_read_b128 v[164:167], v2 offset:12800
    ds_read_b128 v[108:111], v244 offset:656
    v_mfma_f32_16x16x32_bf16 v[32:35], v[144:147], v[180:183], v[32:35]
    ds_read_b128 v[168:171], v3 offset:13312
    ds_read_b128 v[80:83], v244 offset:0
    v_mfma_f32_16x16x32_bf16 v[36:39], v[148:151], v[180:183], v[36:39]
    ds_read_b128 v[172:175], v2 offset:13824
    ds_read_b128 v[84:87], v244 offset:16
    v_mfma_f32_16x16x32_bf16 v[40:43], v[152:155], v[180:183], v[40:43]
    ds_read_b64_tr_b16 v[196:197], v5 offset:14336
    ds_read_b128 v[88:91], v244 offset:128
    v_mfma_f32_16x16x32_bf16 v[44:47], v[156:159], v[180:183], v[44:47]
    ds_read_b64_tr_b16 v[198:199], v5 offset:15360
    ds_read_b128 v[92:95], v244 offset:144
    v_mfma_f32_16x16x32_bf16 v[48:51], v[144:147], v[184:187], v[48:51]
    ds_read_b64_tr_b16 v[200:201], v6 offset:14336
    v_mfma_f32_16x16x32_bf16 v[52:55], v[148:151], v[184:187], v[52:55]
    ds_read_b64_tr_b16 v[202:203], v6 offset:15360
    v_mfma_f32_16x16x32_bf16 v[56:59], v[152:155], v[184:187], v[56:59]
    ds_read_b64_tr_b16 v[204:205], v7 offset:14336
    v_mfma_f32_16x16x32_bf16 v[60:63], v[156:159], v[184:187], v[60:63]
    ds_read_b64_tr_b16 v[206:207], v7 offset:15360
    v_mfma_f32_16x16x32_bf16 v[64:67], v[144:147], v[188:191], v[64:67]
    v_mfma_f32_16x16x32_bf16 v[68:71], v[148:151], v[188:191], v[68:71]
    v_mfma_f32_16x16x32_bf16 v[72:75], v[152:155], v[188:191], v[72:75]
    v_mfma_f32_16x16x32_bf16 v[76:79], v[156:159], v[188:191], v[76:79]
    s_waitcnt lgkmcnt(0)
    s_barrier
    v_mfma_f32_16x16x32_bf16 v[16:19], v[160:163], v[192:195], v[16:19]
    ds_read_b64_tr_b16 v[176:177], v4 offset:0
    ds_read_b32 v112, v245 offset:0
    v_mfma_f32_16x16x32_bf16 v[20:23], v[164:167], v[192:195], v[20:23]
    ds_read_b64_tr_b16 v[178:179], v4 offset:1024
    ds_read_b32 v114, v245 offset:64
    v_mfma_f32_16x16x32_bf16 v[24:27], v[168:171], v[192:195], v[24:27]
    ds_read_b128 v[144:147], v2 offset:0
    ds_read_b32 v116, v245 offset:128
    v_mfma_f32_16x16x32_bf16 v[28:31], v[172:175], v[192:195], v[28:31]
    ds_read_b128 v[148:151], v3 offset:512
    ds_read_b32 v118, v245 offset:192
    v_mfma_f32_16x16x32_bf16 v[32:35], v[160:163], v[196:199], v[32:35]
    ds_read_b128 v[152:155], v2 offset:1024
    v_mfma_f32_16x16x32_bf16 v[36:39], v[164:167], v[196:199], v[36:39]
    ds_read_b128 v[156:159], v3 offset:1536
    v_mfma_f32_16x16x32_bf16 v[40:43], v[168:171], v[196:199], v[40:43]
    ds_read_b64_tr_b16 v[180:181], v5 offset:0
    v_mfma_f32_16x16x32_bf16 v[44:47], v[172:175], v[196:199], v[44:47]
    ds_read_b64_tr_b16 v[182:183], v5 offset:1024
    v_mfma_f32_16x16x32_bf16 v[48:51], v[160:163], v[200:203], v[48:51]
    ds_read_b64_tr_b16 v[184:185], v6 offset:0
    v_mfma_f32_16x16x32_bf16 v[52:55], v[164:167], v[200:203], v[52:55]
    ds_read_b64_tr_b16 v[186:187], v6 offset:1024
    v_mfma_f32_16x16x32_bf16 v[56:59], v[168:171], v[200:203], v[56:59]
    ds_read_b64_tr_b16 v[188:189], v7 offset:0
    v_mfma_f32_16x16x32_bf16 v[60:63], v[172:175], v[200:203], v[60:63]
    ds_read_b64_tr_b16 v[190:191], v7 offset:1024
    v_mfma_f32_16x16x32_bf16 v[64:67], v[160:163], v[204:207], v[64:67]
    v_mfma_f32_16x16x32_bf16 v[68:71], v[164:167], v[204:207], v[68:71]
    v_mfma_f32_16x16x32_bf16 v[72:75], v[168:171], v[204:207], v[72:75]
    v_mfma_f32_16x16x32_bf16 v[76:79], v[172:175], v[204:207], v[76:79]
    s_lshr_b32 s36, s36, 4
    s_waitcnt lgkmcnt(0)
    v_mov_b32 v192, 0xc0135761
    v_mov_b32 v193, 0xc0135761
    v_mov_b32 v194, 0xbdd2d3e8
    v_mov_b32 v195, 0xbdd2d3e8
    v_mov_b32 v196, 1.0
    v_mov_b32 v197, 1.0
    s_nop 3
    v_pk_mul_f32 v[160:161], v[96:97], v[112:113] op_sel_hi:[1,0]
    v_pk_mul_f32 v[162:163], v[98:99], v[112:113] op_sel_hi:[1,0]
    v_pk_mul_f32 v[164:165], v[100:101], v[112:113] op_sel_hi:[1,0]
    v_pk_mul_f32 v[166:167], v[102:103], v[112:113] op_sel_hi:[1,0]
    v_pk_mul_f32 v[168:169], v[104:105], v[112:113] op_sel_hi:[1,0]
    v_pk_mul_f32 v[170:171], v[106:107], v[112:113] op_sel_hi:[1,0]
    v_pk_mul_f32 v[172:173], v[108:109], v[112:113] op_sel_hi:[1,0]
    v_pk_mul_f32 v[174:175], v[110:111], v[112:113] op_sel_hi:[1,0]
    v_pk_fma_f32 v[16:17], v[16:17], v[80:81], v[160:161]
    v_pk_fma_f32 v[18:19], v[18:19], v[82:83], v[162:163]
    v_pk_fma_f32 v[20:21], v[20:21], v[84:85], v[164:165]
    v_pk_fma_f32 v[22:23], v[22:23], v[86:87], v[166:167]
    v_pk_fma_f32 v[24:25], v[24:25], v[88:89], v[168:169]
    v_pk_fma_f32 v[26:27], v[26:27], v[90:91], v[170:171]
    v_pk_fma_f32 v[28:29], v[28:29], v[92:93], v[172:173]
    v_pk_fma_f32 v[30:31], v[30:31], v[94:95], v[174:175]
    v_pk_mul_f32 v[160:161], v[16:17], v[16:17]
    v_pk_mul_f32 v[162:163], v[18:19], v[18:19]
    v_pk_mul_f32 v[164:165], v[20:21], v[20:21]
    v_pk_mul_f32 v[166:167], v[22:23], v[22:23]
    v_pk_mul_f32 v[168:169], v[24:25], v[24:25]
    v_pk_mul_f32 v[170:171], v[26:27], v[26:27]
    v_pk_mul_f32 v[172:173], v[28:29], v[28:29]
    v_pk_mul_f32 v[174:175], v[30:31], v[30:31]
    v_pk_fma_f32 v[160:161], v[160:161], v[194:195], v[192:193]
    v_pk_fma_f32 v[162:163], v[162:163], v[194:195], v[192:193]
    v_pk_fma_f32 v[164:165], v[164:165], v[194:195], v[192:193]
    v_pk_fma_f32 v[166:167], v[166:167], v[194:195], v[192:193]
    v_pk_fma_f32 v[168:169], v[168:169], v[194:195], v[192:193]
    v_pk_fma_f32 v[170:171], v[170:171], v[194:195], v[192:193]
    v_pk_fma_f32 v[172:173], v[172:173], v[194:195], v[192:193]
    v_pk_fma_f32 v[174:175], v[174:175], v[194:195], v[192:193]
    v_pk_mul_f32 v[160:161], v[160:161], v[16:17]
    v_pk_mul_f32 v[162:163], v[162:163], v[18:19]
    v_pk_mul_f32 v[164:165], v[164:165], v[20:21]
    v_pk_mul_f32 v[166:167], v[166:167], v[22:23]
    v_pk_mul_f32 v[168:169], v[168:169], v[24:25]
    v_pk_mul_f32 v[170:171], v[170:171], v[26:27]
    v_pk_mul_f32 v[172:173], v[172:173], v[28:29]
    v_pk_mul_f32 v[174:175], v[174:175], v[30:31]
    v_exp_f32 v160, v160
    v_exp_f32 v161, v161
    v_exp_f32 v162, v162
    v_exp_f32 v163, v163
    v_exp_f32 v164, v164
    v_exp_f32 v165, v165
    v_exp_f32 v166, v166
    v_exp_f32 v167, v167
    v_exp_f32 v168, v168
    v_exp_f32 v169, v169
    v_exp_f32 v170, v170
    v_exp_f32 v171, v171
    v_exp_f32 v172, v172
    v_exp_f32 v173, v173
    v_exp_f32 v174, v174
    v_exp_f32 v175, v175
    v_pk_add_f32 v[160:161], v[160:161], v[196:197]
    v_pk_add_f32 v[162:163], v[162:163], v[196:197]
    v_pk_add_f32 v[164:165], v[164:165], v[196:197]
    v_pk_add_f32 v[166:167], v[166:167], v[196:197]
    v_pk_add_f32 v[168:169], v[168:169], v[196:197]
    v_pk_add_f32 v[170:171], v[170:171], v[196:197]
    v_pk_add_f32 v[172:173], v[172:173], v[196:197]
    v_pk_add_f32 v[174:175], v[174:175], v[196:197]
    v_rcp_f32 v160, v160
    v_rcp_f32 v161, v161
    v_rcp_f32 v162, v162
    v_rcp_f32 v163, v163
    v_rcp_f32 v164, v164
    v_rcp_f32 v165, v165
    v_rcp_f32 v166, v166
    v_rcp_f32 v167, v167
    v_rcp_f32 v168, v168
    v_rcp_f32 v169, v169
    v_rcp_f32 v170, v170
    v_rcp_f32 v171, v171
    v_rcp_f32 v172, v172
    v_rcp_f32 v173, v173
    v_rcp_f32 v174, v174
    v_rcp_f32 v175, v175
    v_pk_mul_f32 v[16:17], v[16:17], v[160:161]
    v_pk_mul_f32 v[18:19], v[18:19], v[162:163]
    v_pk_mul_f32 v[20:21], v[20:21], v[164:165]
    v_pk_mul_f32 v[22:23], v[22:23], v[166:167]
    v_pk_mul_f32 v[24:25], v[24:25], v[168:169]
    v_pk_mul_f32 v[26:27], v[26:27], v[170:171]
    v_pk_mul_f32 v[28:29], v[28:29], v[172:173]
    v_pk_mul_f32 v[30:31], v[30:31], v[174:175]
    v_pk_mul_f32 v[224:225], v[16:17], v[16:17]
    v_pk_mul_f32 v[226:227], v[18:19], v[18:19]
    v_pk_mul_f32 v[228:229], v[20:21], v[20:21]
    v_pk_mul_f32 v[230:231], v[22:23], v[22:23]
    v_pk_mul_f32 v[232:233], v[24:25], v[24:25]
    v_pk_mul_f32 v[234:235], v[26:27], v[26:27]
    v_pk_mul_f32 v[236:237], v[28:29], v[28:29]
    v_pk_mul_f32 v[238:239], v[30:31], v[30:31]
    v_pk_mul_f32 v[160:161], v[96:97], v[114:115] op_sel_hi:[1,0]
    v_pk_mul_f32 v[162:163], v[98:99], v[114:115] op_sel_hi:[1,0]
    v_pk_mul_f32 v[164:165], v[100:101], v[114:115] op_sel_hi:[1,0]
    v_pk_mul_f32 v[166:167], v[102:103], v[114:115] op_sel_hi:[1,0]
    v_pk_mul_f32 v[168:169], v[104:105], v[114:115] op_sel_hi:[1,0]
    v_pk_mul_f32 v[170:171], v[106:107], v[114:115] op_sel_hi:[1,0]
    v_pk_mul_f32 v[172:173], v[108:109], v[114:115] op_sel_hi:[1,0]
    v_pk_mul_f32 v[174:175], v[110:111], v[114:115] op_sel_hi:[1,0]
    v_pk_fma_f32 v[32:33], v[32:33], v[80:81], v[160:161]
    v_pk_fma_f32 v[34:35], v[34:35], v[82:83], v[162:163]
    v_pk_fma_f32 v[36:37], v[36:37], v[84:85], v[164:165]
    v_pk_fma_f32 v[38:39], v[38:39], v[86:87], v[166:167]
    v_pk_fma_f32 v[40:41], v[40:41], v[88:89], v[168:169]
    v_pk_fma_f32 v[42:43], v[42:43], v[90:91], v[170:171]
    v_pk_fma_f32 v[44:45], v[44:45], v[92:93], v[172:173]
    v_pk_fma_f32 v[46:47], v[46:47], v[94:95], v[174:175]
    v_pk_mul_f32 v[160:161], v[32:33], v[32:33]
    v_pk_mul_f32 v[162:163], v[34:35], v[34:35]
    v_pk_mul_f32 v[164:165], v[36:37], v[36:37]
    v_pk_mul_f32 v[166:167], v[38:39], v[38:39]
    v_pk_mul_f32 v[168:169], v[40:41], v[40:41]
    v_pk_mul_f32 v[170:171], v[42:43], v[42:43]
    v_pk_mul_f32 v[172:173], v[44:45], v[44:45]
    v_pk_mul_f32 v[174:175], v[46:47], v[46:47]
    v_pk_fma_f32 v[160:161], v[160:161], v[194:195], v[192:193]
    v_pk_fma_f32 v[162:163], v[162:163], v[194:195], v[192:193]
    v_pk_fma_f32 v[164:165], v[164:165], v[194:195], v[192:193]
    v_pk_fma_f32 v[166:167], v[166:167], v[194:195], v[192:193]
    v_pk_fma_f32 v[168:169], v[168:169], v[194:195], v[192:193]
    v_pk_fma_f32 v[170:171], v[170:171], v[194:195], v[192:193]
    v_pk_fma_f32 v[172:173], v[172:173], v[194:195], v[192:193]
    v_pk_fma_f32 v[174:175], v[174:175], v[194:195], v[192:193]
    v_pk_mul_f32 v[160:161], v[160:161], v[32:33]
    v_pk_mul_f32 v[162:163], v[162:163], v[34:35]
    v_pk_mul_f32 v[164:165], v[164:165], v[36:37]
    v_pk_mul_f32 v[166:167], v[166:167], v[38:39]
    v_pk_mul_f32 v[168:169], v[168:169], v[40:41]
    v_pk_mul_f32 v[170:171], v[170:171], v[42:43]
    v_pk_mul_f32 v[172:173], v[172:173], v[44:45]
    v_pk_mul_f32 v[174:175], v[174:175], v[46:47]
    v_exp_f32 v160, v160
    v_exp_f32 v161, v161
    v_exp_f32 v162, v162
    v_exp_f32 v163, v163
    v_exp_f32 v164, v164
    v_exp_f32 v165, v165
    v_exp_f32 v166, v166
    v_exp_f32 v167, v167
    v_exp_f32 v168, v168
    v_exp_f32 v169, v169
    v_exp_f32 v170, v170
    v_exp_f32 v171, v171
    v_exp_f32 v172, v172
    v_exp_f32 v173, v173
    v_exp_f32 v174, v174
    v_exp_f32 v175, v175
    v_pk_add_f32 v[160:161], v[160:161], v[196:197]
    v_pk_add_f32 v[162:163], v[162:163], v[196:197]
    v_pk_add_f32 v[164:165], v[164:165], v[196:197]
    v_pk_add_f32 v[166:167], v[166:167], v[196:197]
    v_pk_add_f32 v[168:169], v[168:169], v[196:197]
    v_pk_add_f32 v[170:171], v[170:171], v[196:197]
    v_pk_add_f32 v[172:173], v[172:173], v[196:197]
    v_pk_add_f32 v[174:175], v[174:175], v[196:197]
    v_rcp_f32 v160, v160
    v_rcp_f32 v161, v161
    v_rcp_f32 v162, v162
    v_rcp_f32 v163, v163
    v_rcp_f32 v164, v164
    v_rcp_f32 v165, v165
    v_rcp_f32 v166, v166
    v_rcp_f32 v167, v167
    v_rcp_f32 v168, v168
    v_rcp_f32 v169, v169
    v_rcp_f32 v170, v170
    v_rcp_f32 v171, v171
    v_rcp_f32 v172, v172
    v_rcp_f32 v173, v173
    v_rcp_f32 v174, v174
    v_rcp_f32 v175, v175
    v_pk_mul_f32 v[32:33], v[32:33], v[160:161]
    v_pk_mul_f32 v[34:35], v[34:35], v[162:163]
    v_pk_mul_f32 v[36:37], v[36:37], v[164:165]
    v_pk_mul_f32 v[38:39], v[38:39], v[166:167]
    v_pk_mul_f32 v[40:41], v[40:41], v[168:169]
    v_pk_mul_f32 v[42:43], v[42:43], v[170:171]
    v_pk_mul_f32 v[44:45], v[44:45], v[172:173]
    v_pk_mul_f32 v[46:47], v[46:47], v[174:175]
    v_pk_fma_f32 v[224:225], v[32:33], v[32:33], v[224:225]
    v_pk_fma_f32 v[226:227], v[34:35], v[34:35], v[226:227]
    v_pk_fma_f32 v[228:229], v[36:37], v[36:37], v[228:229]
    v_pk_fma_f32 v[230:231], v[38:39], v[38:39], v[230:231]
    v_pk_fma_f32 v[232:233], v[40:41], v[40:41], v[232:233]
    v_pk_fma_f32 v[234:235], v[42:43], v[42:43], v[234:235]
    v_pk_fma_f32 v[236:237], v[44:45], v[44:45], v[236:237]
    v_pk_fma_f32 v[238:239], v[46:47], v[46:47], v[238:239]
    v_pk_add_f32 v[208:209], v[16:17], v[32:33]
    v_pk_add_f32 v[210:211], v[18:19], v[34:35]
    v_pk_add_f32 v[212:213], v[20:21], v[36:37]
    v_pk_add_f32 v[214:215], v[22:23], v[38:39]
    v_pk_add_f32 v[216:217], v[24:25], v[40:41]
    v_pk_add_f32 v[218:219], v[26:27], v[42:43]
    v_pk_add_f32 v[220:221], v[28:29], v[44:45]
    v_pk_add_f32 v[222:223], v[30:31], v[46:47]
    v_pk_mul_f32 v[160:161], v[96:97], v[116:117] op_sel_hi:[1,0]
    v_pk_mul_f32 v[162:163], v[98:99], v[116:117] op_sel_hi:[1,0]
    v_pk_mul_f32 v[164:165], v[100:101], v[116:117] op_sel_hi:[1,0]
    v_pk_mul_f32 v[166:167], v[102:103], v[116:117] op_sel_hi:[1,0]
    v_pk_mul_f32 v[168:169], v[104:105], v[116:117] op_sel_hi:[1,0]
    v_pk_mul_f32 v[170:171], v[106:107], v[116:117] op_sel_hi:[1,0]
    v_pk_mul_f32 v[172:173], v[108:109], v[116:117] op_sel_hi:[1,0]
    v_pk_mul_f32 v[174:175], v[110:111], v[116:117] op_sel_hi:[1,0]
    v_pk_fma_f32 v[48:49], v[48:49], v[80:81], v[160:161]
    v_pk_fma_f32 v[50:51], v[50:51], v[82:83], v[162:163]
    v_pk_fma_f32 v[52:53], v[52:53], v[84:85], v[164:165]
    v_pk_fma_f32 v[54:55], v[54:55], v[86:87], v[166:167]
    v_pk_fma_f32 v[56:57], v[56:57], v[88:89], v[168:169]
    v_pk_fma_f32 v[58:59], v[58:59], v[90:91], v[170:171]
    v_pk_fma_f32 v[60:61], v[60:61], v[92:93], v[172:173]
    v_pk_fma_f32 v[62:63], v[62:63], v[94:95], v[174:175]
    v_pk_mul_f32 v[160:161], v[48:49], v[48:49]
    v_pk_mul_f32 v[162:163], v[50:51], v[50:51]
    v_pk_mul_f32 v[164:165], v[52:53], v[52:53]
    v_pk_mul_f32 v[166:167], v[54:55], v[54:55]
    v_pk_mul_f32 v[168:169], v[56:57], v[56:57]
    v_pk_mul_f32 v[170:171], v[58:59], v[58:59]
    v_pk_mul_f32 v[172:173], v[60:61], v[60:61]
    v_pk_mul_f32 v[174:175], v[62:63], v[62:63]
    v_pk_fma_f32 v[160:161], v[160:161], v[194:195], v[192:193]
    v_pk_fma_f32 v[162:163], v[162:163], v[194:195], v[192:193]
    v_pk_fma_f32 v[164:165], v[164:165], v[194:195], v[192:193]
    v_pk_fma_f32 v[166:167], v[166:167], v[194:195], v[192:193]
    v_pk_fma_f32 v[168:169], v[168:169], v[194:195], v[192:193]
    v_pk_fma_f32 v[170:171], v[170:171], v[194:195], v[192:193]
    v_pk_fma_f32 v[172:173], v[172:173], v[194:195], v[192:193]
    v_pk_fma_f32 v[174:175], v[174:175], v[194:195], v[192:193]
    v_pk_mul_f32 v[160:161], v[160:161], v[48:49]
    v_pk_mul_f32 v[162:163], v[162:163], v[50:51]
    v_pk_mul_f32 v[164:165], v[164:165], v[52:53]
    v_pk_mul_f32 v[166:167], v[166:167], v[54:55]
    v_pk_mul_f32 v[168:169], v[168:169], v[56:57]
    v_pk_mul_f32 v[170:171], v[170:171], v[58:59]
    v_pk_mul_f32 v[172:173], v[172:173], v[60:61]
    v_pk_mul_f32 v[174:175], v[174:175], v[62:63]
    v_exp_f32 v160, v160
    v_exp_f32 v161, v161
    v_exp_f32 v162, v162
    v_exp_f32 v163, v163
    v_exp_f32 v164, v164
    v_exp_f32 v165, v165
    v_exp_f32 v166, v166
    v_exp_f32 v167, v167
    v_exp_f32 v168, v168
    v_exp_f32 v169, v169
    v_exp_f32 v170, v170
    v_exp_f32 v171, v171
    v_exp_f32 v172, v172
    v_exp_f32 v173, v173
    v_exp_f32 v174, v174
    v_exp_f32 v175, v175
    v_pk_add_f32 v[160:161], v[160:161], v[196:197]
    v_pk_add_f32 v[162:163], v[162:163], v[196:197]
    v_pk_add_f32 v[164:165], v[164:165], v[196:197]
    v_pk_add_f32 v[166:167], v[166:167], v[196:197]
    v_pk_add_f32 v[168:169], v[168:169], v[196:197]
    v_pk_add_f32 v[170:171], v[170:171], v[196:197]
    v_pk_add_f32 v[172:173], v[172:173], v[196:197]
    v_pk_add_f32 v[174:175], v[174:175], v[196:197]
    v_rcp_f32 v160, v160
    v_rcp_f32 v161, v161
    v_rcp_f32 v162, v162
    v_rcp_f32 v163, v163
    v_rcp_f32 v164, v164
    v_rcp_f32 v165, v165
    v_rcp_f32 v166, v166
    v_rcp_f32 v167, v167
    v_rcp_f32 v168, v168
    v_rcp_f32 v169, v169
    v_rcp_f32 v170, v170
    v_rcp_f32 v171, v171
    v_rcp_f32 v172, v172
    v_rcp_f32 v173, v173
    v_rcp_f32 v174, v174
    v_rcp_f32 v175, v175
    v_pk_mul_f32 v[48:49], v[48:49], v[160:161]
    v_pk_mul_f32 v[50:51], v[50:51], v[162:163]
    v_pk_mul_f32 v[52:53], v[52:53], v[164:165]
    v_pk_mul_f32 v[54:55], v[54:55], v[166:167]
    v_pk_mul_f32 v[56:57], v[56:57], v[168:169]
    v_pk_mul_f32 v[58:59], v[58:59], v[170:171]
    v_pk_mul_f32 v[60:61], v[60:61], v[172:173]
    v_pk_mul_f32 v[62:63], v[62:63], v[174:175]
    v_pk_fma_f32 v[224:225], v[48:49], v[48:49], v[224:225]
    v_pk_fma_f32 v[226:227], v[50:51], v[50:51], v[226:227]
    v_pk_fma_f32 v[228:229], v[52:53], v[52:53], v[228:229]
    v_pk_fma_f32 v[230:231], v[54:55], v[54:55], v[230:231]
    v_pk_fma_f32 v[232:233], v[56:57], v[56:57], v[232:233]
    v_pk_fma_f32 v[234:235], v[58:59], v[58:59], v[234:235]
    v_pk_fma_f32 v[236:237], v[60:61], v[60:61], v[236:237]
    v_pk_fma_f32 v[238:239], v[62:63], v[62:63], v[238:239]
    v_pk_add_f32 v[208:209], v[208:209], v[48:49]
    v_pk_add_f32 v[210:211], v[210:211], v[50:51]
    v_pk_add_f32 v[212:213], v[212:213], v[52:53]
    v_pk_add_f32 v[214:215], v[214:215], v[54:55]
    v_pk_add_f32 v[216:217], v[216:217], v[56:57]
    v_pk_add_f32 v[218:219], v[218:219], v[58:59]
    v_pk_add_f32 v[220:221], v[220:221], v[60:61]
    v_pk_add_f32 v[222:223], v[222:223], v[62:63]
    s_cmp_lt_u32 s38, 2
    s_cbranch_scc1 mega_kernel_tg4
    buffer_load_dword v249, v250, s[32:35], s39 offen
mega_kernel_tg4:
    v_pk_mul_f32 v[160:161], v[96:97], v[118:119] op_sel_hi:[1,0]
    v_pk_mul_f32 v[162:163], v[98:99], v[118:119] op_sel_hi:[1,0]
    v_pk_mul_f32 v[164:165], v[100:101], v[118:119] op_sel_hi:[1,0]
    v_pk_mul_f32 v[166:167], v[102:103], v[118:119] op_sel_hi:[1,0]
    v_pk_mul_f32 v[168:169], v[104:105], v[118:119] op_sel_hi:[1,0]
    v_pk_mul_f32 v[170:171], v[106:107], v[118:119] op_sel_hi:[1,0]
    v_pk_mul_f32 v[172:173], v[108:109], v[118:119] op_sel_hi:[1,0]
    v_pk_mul_f32 v[174:175], v[110:111], v[118:119] op_sel_hi:[1,0]
    v_pk_fma_f32 v[64:65], v[64:65], v[80:81], v[160:161]
    v_pk_fma_f32 v[66:67], v[66:67], v[82:83], v[162:163]
    v_pk_fma_f32 v[68:69], v[68:69], v[84:85], v[164:165]
    v_pk_fma_f32 v[70:71], v[70:71], v[86:87], v[166:167]
    v_pk_fma_f32 v[72:73], v[72:73], v[88:89], v[168:169]
    v_pk_fma_f32 v[74:75], v[74:75], v[90:91], v[170:171]
    v_pk_fma_f32 v[76:77], v[76:77], v[92:93], v[172:173]
    v_pk_fma_f32 v[78:79], v[78:79], v[94:95], v[174:175]
    v_pk_mul_f32 v[160:161], v[64:65], v[64:65]
    v_pk_mul_f32 v[162:163], v[66:67], v[66:67]
    v_pk_mul_f32 v[164:165], v[68:69], v[68:69]
    v_pk_mul_f32 v[166:167], v[70:71], v[70:71]
    v_pk_mul_f32 v[168:169], v[72:73], v[72:73]
    v_pk_mul_f32 v[170:171], v[74:75], v[74:75]
    v_pk_mul_f32 v[172:173], v[76:77], v[76:77]
    v_pk_mul_f32 v[174:175], v[78:79], v[78:79]
    v_pk_fma_f32 v[160:161], v[160:161], v[194:195], v[192:193]
    v_pk_fma_f32 v[162:163], v[162:163], v[194:195], v[192:193]
    v_pk_fma_f32 v[164:165], v[164:165], v[194:195], v[192:193]
    v_pk_fma_f32 v[166:167], v[166:167], v[194:195], v[192:193]
    v_pk_fma_f32 v[168:169], v[168:169], v[194:195], v[192:193]
    v_pk_fma_f32 v[170:171], v[170:171], v[194:195], v[192:193]
    v_pk_fma_f32 v[172:173], v[172:173], v[194:195], v[192:193]
    v_pk_fma_f32 v[174:175], v[174:175], v[194:195], v[192:193]
    v_pk_mul_f32 v[160:161], v[160:161], v[64:65]
    v_pk_mul_f32 v[162:163], v[162:163], v[66:67]
    v_pk_mul_f32 v[164:165], v[164:165], v[68:69]
    v_pk_mul_f32 v[166:167], v[166:167], v[70:71]
    v_pk_mul_f32 v[168:169], v[168:169], v[72:73]
    v_pk_mul_f32 v[170:171], v[170:171], v[74:75]
    v_pk_mul_f32 v[172:173], v[172:173], v[76:77]
    v_pk_mul_f32 v[174:175], v[174:175], v[78:79]
    v_exp_f32 v160, v160
    v_exp_f32 v161, v161
    v_exp_f32 v162, v162
    v_exp_f32 v163, v163
    v_exp_f32 v164, v164
    v_exp_f32 v165, v165
    v_exp_f32 v166, v166
    v_exp_f32 v167, v167
    v_exp_f32 v168, v168
    v_exp_f32 v169, v169
    v_exp_f32 v170, v170
    v_exp_f32 v171, v171
    v_exp_f32 v172, v172
    v_exp_f32 v173, v173
    v_exp_f32 v174, v174
    v_exp_f32 v175, v175
    v_pk_add_f32 v[160:161], v[160:161], v[196:197]
    v_pk_add_f32 v[162:163], v[162:163], v[196:197]
    v_pk_add_f32 v[164:165], v[164:165], v[196:197]
    v_pk_add_f32 v[166:167], v[166:167], v[196:197]
    v_pk_add_f32 v[168:169], v[168:169], v[196:197]
    v_pk_add_f32 v[170:171], v[170:171], v[196:197]
    v_pk_add_f32 v[172:173], v[172:173], v[196:197]
    v_pk_add_f32 v[174:175], v[174:175], v[196:197]
    v_rcp_f32 v160, v160
    v_rcp_f32 v161, v161
    v_rcp_f32 v162, v162
    v_rcp_f32 v163, v163
    v_rcp_f32 v164, v164
    v_rcp_f32 v165, v165
    v_rcp_f32 v166, v166
    v_rcp_f32 v167, v167
    v_rcp_f32 v168, v168
    v_rcp_f32 v169, v169
    v_rcp_f32 v170, v170
    v_rcp_f32 v171, v171
    v_rcp_f32 v172, v172
    v_rcp_f32 v173, v173
    v_rcp_f32 v174, v174
    v_rcp_f32 v175, v175
    v_pk_mul_f32 v[64:65], v[64:65], v[160:161]
    v_pk_mul_f32 v[66:67], v[66:67], v[162:163]
    v_pk_mul_f32 v[68:69], v[68:69], v[164:165]
    v_pk_mul_f32 v[70:71], v[70:71], v[166:167]
    v_pk_mul_f32 v[72:73], v[72:73], v[168:169]
    v_pk_mul_f32 v[74:75], v[74:75], v[170:171]
    v_pk_mul_f32 v[76:77], v[76:77], v[172:173]
    v_pk_mul_f32 v[78:79], v[78:79], v[174:175]
    v_pk_fma_f32 v[224:225], v[64:65], v[64:65], v[224:225]
    v_pk_fma_f32 v[226:227], v[66:67], v[66:67], v[226:227]
    v_pk_fma_f32 v[228:229], v[68:69], v[68:69], v[228:229]
    v_pk_fma_f32 v[230:231], v[70:71], v[70:71], v[230:231]
    v_pk_fma_f32 v[232:233], v[72:73], v[72:73], v[232:233]
    v_pk_fma_f32 v[234:235], v[74:75], v[74:75], v[234:235]
    v_pk_fma_f32 v[236:237], v[76:77], v[76:77], v[236:237]
    v_pk_fma_f32 v[238:239], v[78:79], v[78:79], v[238:239]
    v_pk_add_f32 v[208:209], v[208:209], v[64:65]
    v_pk_add_f32 v[210:211], v[210:211], v[66:67]
    v_pk_add_f32 v[212:213], v[212:213], v[68:69]
    v_pk_add_f32 v[214:215], v[214:215], v[70:71]
    v_pk_add_f32 v[216:217], v[216:217], v[72:73]
    v_pk_add_f32 v[218:219], v[218:219], v[74:75]
    v_pk_add_f32 v[220:221], v[220:221], v[76:77]
    v_pk_add_f32 v[222:223], v[222:223], v[78:79]
    s_nop 0
    v_add_f32_dpp v224, v224, v224 row_ror:8 row_mask:0xf bank_mask:0x3
    v_add_f32_dpp v225, v225, v225 row_ror:8 row_mask:0xf bank_mask:0x3
    v_add_f32_dpp v226, v226, v226 row_ror:8 row_mask:0xf bank_mask:0x3
    v_add_f32_dpp v227, v227, v227 row_ror:8 row_mask:0xf bank_mask:0x3
    v_add_f32_dpp v228, v228, v228 row_ror:8 row_mask:0xf bank_mask:0x3
    v_add_f32_dpp v229, v229, v229 row_ror:8 row_mask:0xf bank_mask:0x3
    v_add_f32_dpp v230, v230, v230 row_ror:8 row_mask:0xf bank_mask:0x3
    v_add_f32_dpp v231, v231, v231 row_ror:8 row_mask:0xf bank_mask:0x3
    v_add_f32_dpp v224, v232, v232 row_ror:8 row_mask:0xf bank_mask:0xc
    v_add_f32_dpp v225, v233, v233 row_ror:8 row_mask:0xf bank_mask:0xc
    v_add_f32_dpp v226, v234, v234 row_ror:8 row_mask:0xf bank_mask:0xc
    v_add_f32_dpp v227, v235, v235 row_ror:8 row_mask:0xf bank_mask:0xc
    v_add_f32_dpp v228, v236, v236 row_ror:8 row_mask:0xf bank_mask:0xc
    v_add_f32_dpp v229, v237, v237 row_ror:8 row_mask:0xf bank_mask:0xc
    v_add_f32_dpp v230, v238, v238 row_ror:8 row_mask:0xf bank_mask:0xc
    v_add_f32_dpp v231, v239, v239 row_ror:8 row_mask:0xf bank_mask:0xc
    v_add_f32_dpp v208, v208, v208 row_ror:8 row_mask:0xf bank_mask:0x3
    v_add_f32_dpp v209, v209, v209 row_ror:8 row_mask:0xf bank_mask:0x3
    v_add_f32_dpp v210, v210, v210 row_ror:8 row_mask:0xf bank_mask:0x3
    v_add_f32_dpp v211, v211, v211 row_ror:8 row_mask:0xf bank_mask:0x3
    v_add_f32_dpp v212, v212, v212 row_ror:8 row_mask:0xf bank_mask:0x3
    v_add_f32_dpp v213, v213, v213 row_ror:8 row_mask:0xf bank_mask:0x3
    v_add_f32_dpp v214, v214, v214 row_ror:8 row_mask:0xf bank_mask:0x3
    v_add_f32_dpp v215, v215, v215 row_ror:8 row_mask:0xf bank_mask:0x3
    v_add_f32_dpp v208, v216, v216 row_ror:8 row_mask:0xf bank_mask:0xc
    v_add_f32_dpp v209, v217, v217 row_ror:8 row_mask:0xf bank_mask:0xc
    v_add_f32_dpp v210, v218, v218 row_ror:8 row_mask:0xf bank_mask:0xc
    v_add_f32_dpp v211, v219, v219 row_ror:8 row_mask:0xf bank_mask:0xc
    v_add_f32_dpp v212, v220, v220 row_ror:8 row_mask:0xf bank_mask:0xc
    v_add_f32_dpp v213, v221, v221 row_ror:8 row_mask:0xf bank_mask:0xc
    v_add_f32_dpp v214, v222, v222 row_ror:8 row_mask:0xf bank_mask:0xc
    v_add_f32_dpp v215, v223, v223 row_ror:8 row_mask:0xf bank_mask:0xc
    v_add_f32_dpp v161, v224, v224 row_half_mirror row_mask:0xf bank_mask:0x5
    v_add_f32_dpp v163, v225, v225 row_half_mirror row_mask:0xf bank_mask:0x5
    v_add_f32_dpp v165, v226, v226 row_half_mirror row_mask:0xf bank_mask:0x5
    v_add_f32_dpp v167, v227, v227 row_half_mirror row_mask:0xf bank_mask:0x5
    v_add_f32_dpp v161, v228, v228 row_half_mirror row_mask:0xf bank_mask:0xa
    v_add_f32_dpp v163, v229, v229 row_half_mirror row_mask:0xf bank_mask:0xa
    v_add_f32_dpp v165, v230, v230 row_half_mirror row_mask:0xf bank_mask:0xa
    v_add_f32_dpp v167, v231, v231 row_half_mirror row_mask:0xf bank_mask:0xa
    v_add_f32_dpp v160, v208, v208 row_half_mirror row_mask:0xf bank_mask:0x5
    v_add_f32_dpp v162, v209, v209 row_half_mirror row_mask:0xf bank_mask:0x5
    v_add_f32_dpp v164, v210, v210 row_half_mirror row_mask:0xf bank_mask:0x5
    v_add_f32_dpp v166, v211, v211 row_half_mirror row_mask:0xf bank_mask:0x5
    v_add_f32_dpp v160, v212, v212 row_half_mirror row_mask:0xf bank_mask:0xa
    v_add_f32_dpp v162, v213, v213 row_half_mirror row_mask:0xf bank_mask:0xa
    v_add_f32_dpp v164, v214, v214 row_half_mirror row_mask:0xf bank_mask:0xa
    v_add_f32_dpp v166, v215, v215 row_half_mirror row_mask:0xf bank_mask:0xa
    v_add_f32_dpp v161, v161, v161 quad_perm:[1,0,3,2] row_mask:0xf bank_mask:0xf
    v_add_f32_dpp v163, v163, v163 quad_perm:[1,0,3,2] row_mask:0xf bank_mask:0xf
    v_add_f32_dpp v165, v165, v165 quad_perm:[1,0,3,2] row_mask:0xf bank_mask:0xf
    v_add_f32_dpp v167, v167, v167 quad_perm:[1,0,3,2] row_mask:0xf bank_mask:0xf
    v_add_f32_dpp v160, v160, v160 quad_perm:[1,0,3,2] row_mask:0xf bank_mask:0xf
    v_add_f32_dpp v162, v162, v162 quad_perm:[1,0,3,2] row_mask:0xf bank_mask:0xf
    v_add_f32_dpp v164, v164, v164 quad_perm:[1,0,3,2] row_mask:0xf bank_mask:0xf
    v_add_f32_dpp v166, v166, v166 quad_perm:[1,0,3,2] row_mask:0xf bank_mask:0xf
    v_add_f32_dpp v161, v161, v161 quad_perm:[2,3,0,1] row_mask:0xf bank_mask:0xf
    v_add_f32_dpp v163, v163, v163 quad_perm:[2,3,0,1] row_mask:0xf bank_mask:0xf
    v_add_f32_dpp v165, v165, v165 quad_perm:[2,3,0,1] row_mask:0xf bank_mask:0xf
    v_add_f32_dpp v167, v167, v167 quad_perm:[2,3,0,1] row_mask:0xf bank_mask:0xf
    v_add_f32_dpp v160, v160, v160 quad_perm:[2,3,0,1] row_mask:0xf bank_mask:0xf
    v_add_f32_dpp v162, v162, v162 quad_perm:[2,3,0,1] row_mask:0xf bank_mask:0xf
    v_add_f32_dpp v164, v164, v164 quad_perm:[2,3,0,1] row_mask:0xf bank_mask:0xf
    v_add_f32_dpp v166, v166, v166 quad_perm:[2,3,0,1] row_mask:0xf bank_mask:0xf
    s_mov_b32 exec_lo, 0x11111111
    s_mov_b32 exec_hi, 0x11111111
    ds_write_b128 v12, v[160:163]
    ds_write_b128 v12, v[164:167] offset:16
    s_mov_b64 exec, -1
    s_lshl_b32 s40, s38, 8
    s_add_u32 s40, s40, 131072
    v_add_u32 v216, s40, v9
    s_waitcnt lgkmcnt(0)
    s_barrier
    s_waitcnt lgkmcnt(0)
    v_mfma_f32_16x16x32_bf16 v[80:83], v[176:179], v[144:147], 0
    ds_read_b64_tr_b16 v[192:193], v4 offset:2048
    v_mfma_f32_16x16x32_bf16 v[84:87], v[176:179], v[148:151], 0
    ds_read_b64_tr_b16 v[194:195], v4 offset:3072
    v_mfma_f32_16x16x32_bf16 v[88:91], v[176:179], v[152:155], 0
    ds_read_b128 v[160:163], v3 offset:0
    v_mfma_f32_16x16x32_bf16 v[92:95], v[176:179], v[156:159], 0
    ds_read_b128 v[164:167], v2 offset:512
    v_mfma_f32_16x16x32_bf16 v[96:99], v[180:183], v[144:147], 0
    ds_read_b128 v[168:171], v3 offset:1024
    v_mfma_f32_16x16x32_bf16 v[100:103], v[180:183], v[148:151], 0
    ds_read_b128 v[172:175], v2 offset:1536
    v_mfma_f32_16x16x32_bf16 v[104:107], v[180:183], v[152:155], 0
    ds_read_b64_tr_b16 v[196:197], v5 offset:2048
    v_mfma_f32_16x16x32_bf16 v[108:111], v[180:183], v[156:159], 0
    ds_read_b64_tr_b16 v[198:199], v5 offset:3072
    v_mfma_f32_16x16x32_bf16 v[112:115], v[184:187], v[144:147], 0
    ds_read_b64_tr_b16 v[200:201], v6 offset:2048
    v_mfma_f32_16x16x32_bf16 v[116:119], v[184:187], v[148:151], 0
    ds_read_b64_tr_b16 v[202:203], v6 offset:3072
    v_mfma_f32_16x16x32_bf16 v[120:123], v[184:187], v[152:155], 0
    ds_read_b64_tr_b16 v[204:205], v7 offset:2048
    v_mfma_f32_16x16x32_bf16 v[124:127], v[184:187], v[156:159], 0
    ds_read_b64_tr_b16 v[206:207], v7 offset:3072
    v_mfma_f32_16x16x32_bf16 v[128:131], v[188:191], v[144:147], 0
    v_mfma_f32_16x16x32_bf16 v[132:135], v[188:191], v[148:151], 0
    v_mfma_f32_16x16x32_bf16 v[136:139], v[188:191], v[152:155], 0
    v_mfma_f32_16x16x32_bf16 v[140:143], v[188:191], v[156:159], 0
    s_waitcnt lgkmcnt(0)
    s_barrier
    v_mfma_f32_16x16x32_bf16 v[80:83], v[192:195], v[160:163], v[80:83]
    ds_read_b64_tr_b16 v[176:177], v4 offset:4096
    v_mfma_f32_16x16x32_bf16 v[84:87], v[192:195], v[164:167], v[84:87]
    ds_read_b64_tr_b16 v[178:179], v4 offset:5120
    v_mfma_f32_16x16x32_bf16 v[88:91], v[192:195], v[168:171], v[88:91]
    ds_read_b128 v[144:147], v2 offset:4096
    v_mfma_f32_16x16x32_bf16 v[92:95], v[192:195], v[172:175], v[92:95]
    ds_read_b128 v[148:151], v3 offset:4608
    v_mfma_f32_16x16x32_bf16 v[96:99], v[196:199], v[160:163], v[96:99]
    ds_read_b128 v[152:155], v2 offset:5120
    v_mfma_f32_16x16x32_bf16 v[100:103], v[196:199], v[164:167], v[100:103]
    ds_read_b128 v[156:159], v3 offset:5632
    v_mfma_f32_16x16x32_bf16 v[104:107], v[196:199], v[168:171], v[104:107]
    ds_read_b64_tr_b16 v[180:181], v5 offset:4096
    v_mfma_f32_16x16x32_bf16 v[108:111], v[196:199], v[172:175], v[108:111]
    ds_read_b64_tr_b16 v[182:183], v5 offset:5120
    v_mfma_f32_16x16x32_bf16 v[112:115], v[200:203], v[160:163], v[112:115]
    ds_read_b64_tr_b16 v[184:185], v6 offset:4096
    v_mfma_f32_16x16x32_bf16 v[116:119], v[200:203], v[164:167], v[116:119]
    ds_read_b64_tr_b16 v[186:187], v6 offset:5120
    v_mfma_f32_16x16x32_bf16 v[120:123], v[200:203], v[168:171], v[120:123]
    ds_read_b64_tr_b16 v[188:189], v7 offset:4096
    v_mfma_f32_16x16x32_bf16 v[124:127], v[200:203], v[172:175], v[124:127]
    ds_read_b64_tr_b16 v[190:191], v7 offset:5120
    v_mfma_f32_16x16x32_bf16 v[128:131], v[204:207], v[160:163], v[128:131]
    v_mfma_f32_16x16x32_bf16 v[132:135], v[204:207], v[164:167], v[132:135]
    v_mfma_f32_16x16x32_bf16 v[136:139], v[204:207], v[168:171], v[136:139]
    v_mfma_f32_16x16x32_bf16 v[140:143], v[204:207], v[172:175], v[140:143]
    s_waitcnt lgkmcnt(0)
    v_mfma_f32_16x16x32_bf16 v[80:83], v[176:179], v[144:147], v[80:83]
    ds_read_b64_tr_b16 v[192:193], v4 offset:6144
    v_mfma_f32_16x16x32_bf16 v[84:87], v[176:179], v[148:151], v[84:87]
    ds_read_b64_tr_b16 v[194:195], v4 offset:7168
    v_mfma_f32_16x16x32_bf16 v[88:91], v[176:179], v[152:155], v[88:91]
    ds_read_b128 v[160:163], v3 offset:4096
    v_mfma_f32_16x16x32_bf16 v[92:95], v[176:179], v[156:159], v[92:95]
    ds_read_b128 v[164:167], v2 offset:4608
    v_mfma_f32_16x16x32_bf16 v[96:99], v[180:183], v[144:147], v[96:99]
    ds_read_b128 v[168:171], v3 offset:5120
    v_mfma_f32_16x16x32_bf16 v[100:103], v[180:183], v[148:151], v[100:103]
    ds_read_b128 v[172:175], v2 offset:5632
    v_mfma_f32_16x16x32_bf16 v[104:107], v[180:183], v[152:155], v[104:107]
    ds_read_b64_tr_b16 v[196:197], v5 offset:6144
    v_mfma_f32_16x16x32_bf16 v[108:111], v[180:183], v[156:159], v[108:111]
    ds_read_b64_tr_b16 v[198:199], v5 offset:7168
    v_mfma_f32_16x16x32_bf16 v[112:115], v[184:187], v[144:147], v[112:115]
    ds_read_b64_tr_b16 v[200:201], v6 offset:6144
    v_mfma_f32_16x16x32_bf16 v[116:119], v[184:187], v[148:151], v[116:119]
    ds_read_b64_tr_b16 v[202:203], v6 offset:7168
    v_mfma_f32_16x16x32_bf16 v[120:123], v[184:187], v[152:155], v[120:123]
    ds_read_b64_tr_b16 v[204:205], v7 offset:6144
    v_mfma_f32_16x16x32_bf16 v[124:127], v[184:187], v[156:159], v[124:127]
    ds_read_b64_tr_b16 v[206:207], v7 offset:7168
    v_mfma_f32_16x16x32_bf16 v[128:131], v[188:191], v[144:147], v[128:131]
    v_mfma_f32_16x16x32_bf16 v[132:135], v[188:191], v[148:151], v[132:135]
    v_mfma_f32_16x16x32_bf16 v[136:139], v[188:191], v[152:155], v[136:139]
    v_mfma_f32_16x16x32_bf16 v[140:143], v[188:191], v[156:159], v[140:143]
    s_waitcnt lgkmcnt(0)
    s_barrier
    v_mfma_f32_16x16x32_bf16 v[80:83], v[192:195], v[160:163], v[80:83]
    ds_read_b64_tr_b16 v[176:177], v4 offset:8192
    v_mfma_f32_16x16x32_bf16 v[84:87], v[192:195], v[164:167], v[84:87]
    ds_read_b64_tr_b16 v[178:179], v4 offset:9216
    v_mfma_f32_16x16x32_bf16 v[88:91], v[192:195], v[168:171], v[88:91]
    ds_read_b128 v[144:147], v2 offset:8192
    v_mfma_f32_16x16x32_bf16 v[92:95], v[192:195], v[172:175], v[92:95]
    ds_read_b128 v[148:151], v3 offset:8704
    v_mfma_f32_16x16x32_bf16 v[96:99], v[196:199], v[160:163], v[96:99]
    ds_read_b128 v[152:155], v2 offset:9216
    v_mfma_f32_16x16x32_bf16 v[100:103], v[196:199], v[164:167], v[100:103]
    ds_read_b128 v[156:159], v3 offset:9728
    v_mfma_f32_16x16x32_bf16 v[104:107], v[196:199], v[168:171], v[104:107]
    ds_read_b64_tr_b16 v[180:181], v5 offset:8192
    v_mfma_f32_16x16x32_bf16 v[108:111], v[196:199], v[172:175], v[108:111]
    ds_read_b64_tr_b16 v[182:183], v5 offset:9216
    v_mfma_f32_16x16x32_bf16 v[112:115], v[200:203], v[160:163], v[112:115]
    ds_read_b64_tr_b16 v[184:185], v6 offset:8192
    v_mfma_f32_16x16x32_bf16 v[116:119], v[200:203], v[164:167], v[116:119]
    ds_read_b64_tr_b16 v[186:187], v6 offset:9216
    v_mfma_f32_16x16x32_bf16 v[120:123], v[200:203], v[168:171], v[120:123]
    ds_read_b64_tr_b16 v[188:189], v7 offset:8192
    v_mfma_f32_16x16x32_bf16 v[124:127], v[200:203], v[172:175], v[124:127]
    ds_read_b64_tr_b16 v[190:191], v7 offset:9216
    v_mfma_f32_16x16x32_bf16 v[128:131], v[204:207], v[160:163], v[128:131]
    v_mfma_f32_16x16x32_bf16 v[132:135], v[204:207], v[164:167], v[132:135]
    v_mfma_f32_16x16x32_bf16 v[136:139], v[204:207], v[168:171], v[136:139]
    v_mfma_f32_16x16x32_bf16 v[140:143], v[204:207], v[172:175], v[140:143]
    s_waitcnt lgkmcnt(0)
    v_mfma_f32_16x16x32_bf16 v[80:83], v[176:179], v[144:147], v[80:83]
    ds_read_b64_tr_b16 v[192:193], v4 offset:10240
    v_mfma_f32_16x16x32_bf16 v[84:87], v[176:179], v[148:151], v[84:87]
    ds_read_b64_tr_b16 v[194:195], v4 offset:11264
    v_mfma_f32_16x16x32_bf16 v[88:91], v[176:179], v[152:155], v[88:91]
    ds_read_b128 v[160:163], v3 offset:8192
    v_mfma_f32_16x16x32_bf16 v[92:95], v[176:179], v[156:159], v[92:95]
    ds_read_b128 v[164:167], v2 offset:8704
    v_mfma_f32_16x16x32_bf16 v[96:99], v[180:183], v[144:147], v[96:99]
    ds_read_b128 v[168:171], v3 offset:9216
    v_mfma_f32_16x16x32_bf16 v[100:103], v[180:183], v[148:151], v[100:103]
    ds_read_b128 v[172:175], v2 offset:9728
    v_mfma_f32_16x16x32_bf16 v[104:107], v[180:183], v[152:155], v[104:107]
    ds_read_b64_tr_b16 v[196:197], v5 offset:10240
    v_mfma_f32_16x16x32_bf16 v[108:111], v[180:183], v[156:159], v[108:111]
    ds_read_b64_tr_b16 v[198:199], v5 offset:11264
    v_mfma_f32_16x16x32_bf16 v[112:115], v[184:187], v[144:147], v[112:115]
    ds_read_b64_tr_b16 v[200:201], v6 offset:10240
    v_mfma_f32_16x16x32_bf16 v[116:119], v[184:187], v[148:151], v[116:119]
    ds_read_b64_tr_b16 v[202:203], v6 offset:11264
    v_mfma_f32_16x16x32_bf16 v[120:123], v[184:187], v[152:155], v[120:123]
    ds_read_b64_tr_b16 v[204:205], v7 offset:10240
    v_mfma_f32_16x16x32_bf16 v[124:127], v[184:187], v[156:159], v[124:127]
    ds_read_b64_tr_b16 v[206:207], v7 offset:11264
    v_mfma_f32_16x16x32_bf16 v[128:131], v[188:191], v[144:147], v[128:131]
    v_mfma_f32_16x16x32_bf16 v[132:135], v[188:191], v[148:151], v[132:135]
    v_mfma_f32_16x16x32_bf16 v[136:139], v[188:191], v[152:155], v[136:139]
    v_mfma_f32_16x16x32_bf16 v[140:143], v[188:191], v[156:159], v[140:143]
    s_waitcnt lgkmcnt(0)
    s_barrier
    v_mfma_f32_16x16x32_bf16 v[80:83], v[192:195], v[160:163], v[80:83]
    ds_read_b64_tr_b16 v[176:177], v4 offset:12288
    v_mfma_f32_16x16x32_bf16 v[84:87], v[192:195], v[164:167], v[84:87]
    ds_read_b64_tr_b16 v[178:179], v4 offset:13312
    v_mfma_f32_16x16x32_bf16 v[88:91], v[192:195], v[168:171], v[88:91]
    ds_read_b128 v[144:147], v2 offset:12288
    v_mfma_f32_16x16x32_bf16 v[92:95], v[192:195], v[172:175], v[92:95]
    ds_read_b128 v[148:151], v3 offset:12800
    v_mfma_f32_16x16x32_bf16 v[96:99], v[196:199], v[160:163], v[96:99]
    ds_read_b128 v[152:155], v2 offset:13312
    v_mfma_f32_16x16x32_bf16 v[100:103], v[196:199], v[164:167], v[100:103]
    ds_read_b128 v[156:159], v3 offset:13824
    v_mfma_f32_16x16x32_bf16 v[104:107], v[196:199], v[168:171], v[104:107]
    ds_read_b64_tr_b16 v[180:181], v5 offset:12288
    v_mfma_f32_16x16x32_bf16 v[108:111], v[196:199], v[172:175], v[108:111]
    ds_read_b64_tr_b16 v[182:183], v5 offset:13312
    v_mfma_f32_16x16x32_bf16 v[112:115], v[200:203], v[160:163], v[112:115]
    ds_read_b64_tr_b16 v[184:185], v6 offset:12288
    v_mfma_f32_16x16x32_bf16 v[116:119], v[200:203], v[164:167], v[116:119]
    ds_read_b64_tr_b16 v[186:187], v6 offset:13312
    v_mfma_f32_16x16x32_bf16 v[120:123], v[200:203], v[168:171], v[120:123]
    ds_read_b64_tr_b16 v[188:189], v7 offset:12288
    v_mfma_f32_16x16x32_bf16 v[124:127], v[200:203], v[172:175], v[124:127]
    ds_read_b64_tr_b16 v[190:191], v7 offset:13312
    v_mfma_f32_16x16x32_bf16 v[128:131], v[204:207], v[160:163], v[128:131]
    v_mfma_f32_16x16x32_bf16 v[132:135], v[204:207], v[164:167], v[132:135]
    v_mfma_f32_16x16x32_bf16 v[136:139], v[204:207], v[168:171], v[136:139]
    v_mfma_f32_16x16x32_bf16 v[140:143], v[204:207], v[172:175], v[140:143]
    s_waitcnt lgkmcnt(0)
    v_mfma_f32_16x16x32_bf16 v[80:83], v[176:179], v[144:147], v[80:83]
    ds_read_b64_tr_b16 v[192:193], v4 offset:14336
    v_mfma_f32_16x16x32_bf16 v[84:87], v[176:179], v[148:151], v[84:87]
    ds_read_b64_tr_b16 v[194:195], v4 offset:15360
    v_mfma_f32_16x16x32_bf16 v[88:91], v[176:179], v[152:155], v[88:91]
    ds_read_b128 v[160:163], v3 offset:12288
    v_mfma_f32_16x16x32_bf16 v[92:95], v[176:179], v[156:159], v[92:95]
    ds_read_b128 v[164:167], v2 offset:12800
    v_mfma_f32_16x16x32_bf16 v[96:99], v[180:183], v[144:147], v[96:99]
    ds_read_b128 v[168:171], v3 offset:13312
    v_mfma_f32_16x16x32_bf16 v[100:103], v[180:183], v[148:151], v[100:103]
    ds_read_b128 v[172:175], v2 offset:13824
    v_mfma_f32_16x16x32_bf16 v[104:107], v[180:183], v[152:155], v[104:107]
    ds_read_b64_tr_b16 v[196:197], v5 offset:14336
    v_mfma_f32_16x16x32_bf16 v[108:111], v[180:183], v[156:159], v[108:111]
    ds_read_b64_tr_b16 v[198:199], v5 offset:15360
    v_mfma_f32_16x16x32_bf16 v[112:115], v[184:187], v[144:147], v[112:115]
    ds_read_b64_tr_b16 v[200:201], v6 offset:14336
    v_mfma_f32_16x16x32_bf16 v[116:119], v[184:187], v[148:151], v[116:119]
    ds_read_b64_tr_b16 v[202:203], v6 offset:15360
    v_mfma_f32_16x16x32_bf16 v[120:123], v[184:187], v[152:155], v[120:123]
    ds_read_b64_tr_b16 v[204:205], v7 offset:14336
    v_mfma_f32_16x16x32_bf16 v[124:127], v[184:187], v[156:159], v[124:127]
    ds_read_b64_tr_b16 v[206:207], v7 offset:15360
    v_mfma_f32_16x16x32_bf16 v[128:131], v[188:191], v[144:147], v[128:131]
    v_mfma_f32_16x16x32_bf16 v[132:135], v[188:191], v[148:151], v[132:135]
    v_mfma_f32_16x16x32_bf16 v[136:139], v[188:191], v[152:155], v[136:139]
    v_mfma_f32_16x16x32_bf16 v[140:143], v[188:191], v[156:159], v[140:143]
    s_waitcnt lgkmcnt(0)
    s_barrier
    v_mfma_f32_16x16x32_bf16 v[80:83], v[192:195], v[160:163], v[80:83]
    ds_read_b64_tr_b16 v[176:177], v4 offset:0
    v_mfma_f32_16x16x32_bf16 v[84:87], v[192:195], v[164:167], v[84:87]
    ds_read_b64_tr_b16 v[178:179], v4 offset:1024
    v_mfma_f32_16x16x32_bf16 v[88:91], v[192:195], v[168:171], v[88:91]
    ds_read_b128 v[144:147], v2 offset:0
    v_mfma_f32_16x16x32_bf16 v[92:95], v[192:195], v[172:175], v[92:95]
    ds_read_b128 v[148:151], v3 offset:512
    v_mfma_f32_16x16x32_bf16 v[96:99], v[196:199], v[160:163], v[96:99]
    ds_read_b128 v[152:155], v2 offset:1024
    v_mfma_f32_16x16x32_bf16 v[100:103], v[196:199], v[164:167], v[100:103]
    ds_read_b128 v[156:159], v3 offset:1536
    v_mfma_f32_16x16x32_bf16 v[104:107], v[196:199], v[168:171], v[104:107]
    ds_read_b64_tr_b16 v[180:181], v5 offset:0
    v_mfma_f32_16x16x32_bf16 v[108:111], v[196:199], v[172:175], v[108:111]
    ds_read_b64_tr_b16 v[182:183], v5 offset:1024
    v_mfma_f32_16x16x32_bf16 v[112:115], v[200:203], v[160:163], v[112:115]
    ds_read_b64_tr_b16 v[184:185], v6 offset:0
    v_mfma_f32_16x16x32_bf16 v[116:119], v[200:203], v[164:167], v[116:119]
    ds_read_b64_tr_b16 v[186:187], v6 offset:1024
    v_mfma_f32_16x16x32_bf16 v[120:123], v[200:203], v[168:171], v[120:123]
    ds_read_b64_tr_b16 v[188:189], v7 offset:0
    v_mfma_f32_16x16x32_bf16 v[124:127], v[200:203], v[172:175], v[124:127]
    ds_read_b64_tr_b16 v[190:191], v7 offset:1024
    v_mfma_f32_16x16x32_bf16 v[128:131], v[204:207], v[160:163], v[128:131]
    v_mfma_f32_16x16x32_bf16 v[132:135], v[204:207], v[164:167], v[132:135]
    v_mfma_f32_16x16x32_bf16 v[136:139], v[204:207], v[168:171], v[136:139]
    v_mfma_f32_16x16x32_bf16 v[140:143], v[204:207], v[172:175], v[140:143]
    s_waitcnt lgkmcnt(0)
    v_mfma_f32_16x16x32_bf16 v[80:83], v[176:179], v[144:147], v[80:83]
    ds_read_b64_tr_b16 v[192:193], v4 offset:2048
    v_mfma_f32_16x16x32_bf16 v[84:87], v[176:179], v[148:151], v[84:87]
    ds_read_b64_tr_b16 v[194:195], v4 offset:3072
    v_mfma_f32_16x16x32_bf16 v[88:91], v[176:179], v[152:155], v[88:91]
    ds_read_b128 v[160:163], v3 offset:0
    v_mfma_f32_16x16x32_bf16 v[92:95], v[176:179], v[156:159], v[92:95]
    ds_read_b128 v[164:167], v2 offset:512
    v_mfma_f32_16x16x32_bf16 v[96:99], v[180:183], v[144:147], v[96:99]
    ds_read_b128 v[168:171], v3 offset:1024
    v_mfma_f32_16x16x32_bf16 v[100:103], v[180:183], v[148:151], v[100:103]
    ds_read_b128 v[172:175], v2 offset:1536
    v_mfma_f32_16x16x32_bf16 v[104:107], v[180:183], v[152:155], v[104:107]
    ds_read_b64_tr_b16 v[196:197], v5 offset:2048
    v_mfma_f32_16x16x32_bf16 v[108:111], v[180:183], v[156:159], v[108:111]
    ds_read_b64_tr_b16 v[198:199], v5 offset:3072
    v_mfma_f32_16x16x32_bf16 v[112:115], v[184:187], v[144:147], v[112:115]
    ds_read_b64_tr_b16 v[200:201], v6 offset:2048
    v_mfma_f32_16x16x32_bf16 v[116:119], v[184:187], v[148:151], v[116:119]
    ds_read_b64_tr_b16 v[202:203], v6 offset:3072
    v_mfma_f32_16x16x32_bf16 v[120:123], v[184:187], v[152:155], v[120:123]
    ds_read_b64_tr_b16 v[204:205], v7 offset:2048
    v_mfma_f32_16x16x32_bf16 v[124:127], v[184:187], v[156:159], v[124:127]
    ds_read_b64_tr_b16 v[206:207], v7 offset:3072
    v_mfma_f32_16x16x32_bf16 v[128:131], v[188:191], v[144:147], v[128:131]
    v_mfma_f32_16x16x32_bf16 v[132:135], v[188:191], v[148:151], v[132:135]
    v_mfma_f32_16x16x32_bf16 v[136:139], v[188:191], v[152:155], v[136:139]
    v_mfma_f32_16x16x32_bf16 v[140:143], v[188:191], v[156:159], v[140:143]
    s_waitcnt lgkmcnt(0)
    s_barrier
    v_mfma_f32_16x16x32_bf16 v[80:83], v[192:195], v[160:163], v[80:83]
    ds_read_b64_tr_b16 v[176:177], v4 offset:4096
    v_mfma_f32_16x16x32_bf16 v[84:87], v[192:195], v[164:167], v[84:87]
    ds_read_b64_tr_b16 v[178:179], v4 offset:5120
    v_mfma_f32_16x16x32_bf16 v[88:91], v[192:195], v[168:171], v[88:91]
    ds_read_b128 v[144:147], v2 offset:4096
    v_mfma_f32_16x16x32_bf16 v[92:95], v[192:195], v[172:175], v[92:95]
    ds_read_b128 v[148:151], v3 offset:4608
    v_mfma_f32_16x16x32_bf16 v[96:99], v[196:199], v[160:163], v[96:99]
    ds_read_b128 v[152:155], v2 offset:5120
    v_mfma_f32_16x16x32_bf16 v[100:103], v[196:199], v[164:167], v[100:103]
    ds_read_b128 v[156:159], v3 offset:5632
    v_mfma_f32_16x16x32_bf16 v[104:107], v[196:199], v[168:171], v[104:107]
    ds_read_b64_tr_b16 v[180:181], v5 offset:4096
    v_mfma_f32_16x16x32_bf16 v[108:111], v[196:199], v[172:175], v[108:111]
    ds_read_b64_tr_b16 v[182:183], v5 offset:5120
    v_mfma_f32_16x16x32_bf16 v[112:115], v[200:203], v[160:163], v[112:115]
    ds_read_b64_tr_b16 v[184:185], v6 offset:4096
    v_mfma_f32_16x16x32_bf16 v[116:119], v[200:203], v[164:167], v[116:119]
    ds_read_b64_tr_b16 v[186:187], v6 offset:5120
    v_mfma_f32_16x16x32_bf16 v[120:123], v[200:203], v[168:171], v[120:123]
    ds_read_b64_tr_b16 v[188:189], v7 offset:4096
    v_mfma_f32_16x16x32_bf16 v[124:127], v[200:203], v[172:175], v[124:127]
    ds_read_b64_tr_b16 v[190:191], v7 offset:5120
    v_mfma_f32_16x16x32_bf16 v[128:131], v[204:207], v[160:163], v[128:131]
    v_mfma_f32_16x16x32_bf16 v[132:135], v[204:207], v[164:167], v[132:135]
    v_mfma_f32_16x16x32_bf16 v[136:139], v[204:207], v[168:171], v[136:139]
    v_mfma_f32_16x16x32_bf16 v[140:143], v[204:207], v[172:175], v[140:143]
    s_waitcnt lgkmcnt(0)
    v_mfma_f32_16x16x32_bf16 v[80:83], v[176:179], v[144:147], v[80:83]
    ds_read_b64_tr_b16 v[192:193], v4 offset:6144
    v_mfma_f32_16x16x32_bf16 v[84:87], v[176:179], v[148:151], v[84:87]
    ds_read_b64_tr_b16 v[194:195], v4 offset:7168
    v_mfma_f32_16x16x32_bf16 v[88:91], v[176:179], v[152:155], v[88:91]
    ds_read_b128 v[160:163], v3 offset:4096
    v_mfma_f32_16x16x32_bf16 v[92:95], v[176:179], v[156:159], v[92:95]
    ds_read_b128 v[164:167], v2 offset:4608
    v_mfma_f32_16x16x32_bf16 v[96:99], v[180:183], v[144:147], v[96:99]
    ds_read_b128 v[168:171], v3 offset:5120
    v_mfma_f32_16x16x32_bf16 v[100:103], v[180:183], v[148:151], v[100:103]
    ds_read_b128 v[172:175], v2 offset:5632
    v_mfma_f32_16x16x32_bf16 v[104:107], v[180:183], v[152:155], v[104:107]
    ds_read_b64_tr_b16 v[196:197], v5 offset:6144
    v_mfma_f32_16x16x32_bf16 v[108:111], v[180:183], v[156:159], v[108:111]
    ds_read_b64_tr_b16 v[198:199], v5 offset:7168
    v_mfma_f32_16x16x32_bf16 v[112:115], v[184:187], v[144:147], v[112:115]
    ds_read_b64_tr_b16 v[200:201], v6 offset:6144
    v_mfma_f32_16x16x32_bf16 v[116:119], v[184:187], v[148:151], v[116:119]
    ds_read_b64_tr_b16 v[202:203], v6 offset:7168
    v_mfma_f32_16x16x32_bf16 v[120:123], v[184:187], v[152:155], v[120:123]
    ds_read_b64_tr_b16 v[204:205], v7 offset:6144
    v_mfma_f32_16x16x32_bf16 v[124:127], v[184:187], v[156:159], v[124:127]
    ds_read_b64_tr_b16 v[206:207], v7 offset:7168
    v_mfma_f32_16x16x32_bf16 v[128:131], v[188:191], v[144:147], v[128:131]
    v_mfma_f32_16x16x32_bf16 v[132:135], v[188:191], v[148:151], v[132:135]
    v_mfma_f32_16x16x32_bf16 v[136:139], v[188:191], v[152:155], v[136:139]
    v_mfma_f32_16x16x32_bf16 v[140:143], v[188:191], v[156:159], v[140:143]
    s_waitcnt lgkmcnt(0)
    s_barrier
    ds_read_b128 v[208:211], v244 offset:2048
    ds_read_b128 v[224:227], v244 offset:2560
    ds_read_b128 v[212:215], v244 offset:2064
    ds_read_b128 v[228:231], v244 offset:2576
    ds_read_b128 v[216:219], v244 offset:2176
    ds_read_b128 v[232:235], v244 offset:2688
    ds_read_b128 v[220:223], v244 offset:2192
    ds_read_b128 v[236:239], v244 offset:2704
    v_mfma_f32_16x16x32_bf16 v[80:83], v[192:195], v[160:163], v[80:83]
    ds_read_b64_tr_b16 v[176:177], v4 offset:8192
    v_mfma_f32_16x16x32_bf16 v[84:87], v[192:195], v[164:167], v[84:87]
    ds_read_b64_tr_b16 v[178:179], v4 offset:9216
    v_mfma_f32_16x16x32_bf16 v[88:91], v[192:195], v[168:171], v[88:91]
    ds_read_b128 v[144:147], v2 offset:8192
    s_waitcnt lgkmcnt(3)
    v_fma_f32 v16, v16, v208, v224
    v_fma_f32 v17, v17, v209, v225
    v_fma_f32 v18, v18, v210, v226
    v_fma_f32 v19, v19, v211, v227
    v_fma_f32 v20, v20, v212, v228
    v_fma_f32 v21, v21, v213, v229
    v_fma_f32 v22, v22, v214, v230
    v_fma_f32 v23, v23, v215, v231
    v_cvt_pk_bf16_f32 v16, v16, v17
    v_cvt_pk_bf16_f32 v17, v18, v19
    v_mfma_f32_16x16x32_bf16 v[92:95], v[192:195], v[172:175], v[92:95]
    ds_read_b128 v[148:151], v3 offset:8704
    v_cvt_pk_bf16_f32 v18, v20, v21
    v_cvt_pk_bf16_f32 v19, v22, v23
    buffer_store_dwordx4 v[16:19], v9, s[24:27], 0 offen offset:0 sc1
    v_fma_f32 v32, v32, v208, v224
    v_fma_f32 v33, v33, v209, v225
    v_fma_f32 v34, v34, v210, v226
    v_fma_f32 v35, v35, v211, v227
    v_fma_f32 v36, v36, v212, v228
    v_fma_f32 v37, v37, v213, v229
    v_mfma_f32_16x16x32_bf16 v[96:99], v[196:199], v[160:163], v[96:99]
    ds_read_b128 v[152:155], v2 offset:9216
    v_fma_f32 v38, v38, v214, v230
    v_fma_f32 v39, v39, v215, v231
    v_cvt_pk_bf16_f32 v32, v32, v33
    v_cvt_pk_bf16_f32 v33, v34, v35
    v_cvt_pk_bf16_f32 v34, v36, v37
    v_cvt_pk_bf16_f32 v35, v38, v39
    buffer_store_dwordx4 v[32:35], v9, s[24:27], 0 offen offset:1024 sc1
    v_fma_f32 v48, v48, v208, v224
    v_fma_f32 v49, v49, v209, v225
    v_mfma_f32_16x16x32_bf16 v[100:103], v[196:199], v[164:167], v[100:103]
    ds_read_b128 v[156:159], v3 offset:9728
    v_fma_f32 v50, v50, v210, v226
    v_fma_f32 v51, v51, v211, v227
    v_fma_f32 v52, v52, v212, v228
    v_fma_f32 v53, v53, v213, v229
    v_fma_f32 v54, v54, v214, v230
    v_fma_f32 v55, v55, v215, v231
    v_cvt_pk_bf16_f32 v48, v48, v49
    v_cvt_pk_bf16_f32 v49, v50, v51
    v_cvt_pk_bf16_f32 v50, v52, v53
    v_mfma_f32_16x16x32_bf16 v[104:107], v[196:199], v[168:171], v[104:107]
    ds_read_b64_tr_b16 v[180:181], v5 offset:8192
    v_cvt_pk_bf16_f32 v51, v54, v55
    buffer_store_dwordx4 v[48:51], v9, s[24:27], 0 offen offset:2048 sc1
    v_fma_f32 v64, v64, v208, v224
    v_fma_f32 v65, v65, v209, v225
    v_fma_f32 v66, v66, v210, v226
    v_fma_f32 v67, v67, v211, v227
    v_fma_f32 v68, v68, v212, v228
    v_fma_f32 v69, v69, v213, v229
    v_fma_f32 v70, v70, v214, v230
    v_mfma_f32_16x16x32_bf16 v[108:111], v[196:199], v[172:175], v[108:111]
    ds_read_b64_tr_b16 v[182:183], v5 offset:9216
    v_fma_f32 v71, v71, v215, v231
    v_cvt_pk_bf16_f32 v64, v64, v65
    v_cvt_pk_bf16_f32 v65, v66, v67
    v_cvt_pk_bf16_f32 v66, v68, v69
    v_cvt_pk_bf16_f32 v67, v70, v71
    buffer_store_dwordx4 v[64:67], v9, s[24:27], 0 offen offset:3072 sc1
    v_fma_f32 v24, v24, v216, v232
    v_fma_f32 v25, v25, v217, v233
    v_fma_f32 v26, v26, v218, v234
    v_mfma_f32_16x16x32_bf16 v[112:115], v[200:203], v[160:163], v[112:115]
    ds_read_b64_tr_b16 v[184:185], v6 offset:8192
    v_fma_f32 v27, v27, v219, v235
    v_fma_f32 v28, v28, v220, v236
    v_fma_f32 v29, v29, v221, v237
    v_fma_f32 v30, v30, v222, v238
    v_fma_f32 v31, v31, v223, v239
    v_cvt_pk_bf16_f32 v24, v24, v25
    v_cvt_pk_bf16_f32 v25, v26, v27
    v_cvt_pk_bf16_f32 v26, v28, v29
    v_cvt_pk_bf16_f32 v27, v30, v31
    v_mfma_f32_16x16x32_bf16 v[116:119], v[200:203], v[164:167], v[116:119]
    ds_read_b64_tr_b16 v[186:187], v6 offset:9216
    buffer_store_dwordx4 v[24:27], v9, s[24:27], s49 offen offset:0 sc1
    v_fma_f32 v40, v40, v216, v232
    v_fma_f32 v41, v41, v217, v233
    v_fma_f32 v42, v42, v218, v234
    v_fma_f32 v43, v43, v219, v235
    v_fma_f32 v44, v44, v220, v236
    v_fma_f32 v45, v45, v221, v237
    v_fma_f32 v46, v46, v222, v238
    v_fma_f32 v47, v47, v223, v239
    v_mfma_f32_16x16x32_bf16 v[120:123], v[200:203], v[168:171], v[120:123]
    ds_read_b64_tr_b16 v[188:189], v7 offset:8192
    v_cvt_pk_bf16_f32 v40, v40, v41
    v_cvt_pk_bf16_f32 v41, v42, v43
    v_cvt_pk_bf16_f32 v42, v44, v45
    v_cvt_pk_bf16_f32 v43, v46, v47
    buffer_store_dwordx4 v[40:43], v9, s[24:27], s49 offen offset:1024 sc1
    v_fma_f32 v56, v56, v216, v232
    v_fma_f32 v57, v57, v217, v233
    v_fma_f32 v58, v58, v218, v234
    v_fma_f32 v59, v59, v219, v235
    v_mfma_f32_16x16x32_bf16 v[124:127], v[200:203], v[172:175], v[124:127]
    ds_read_b64_tr_b16 v[190:191], v7 offset:9216
    v_fma_f32 v60, v60, v220, v236
    v_fma_f32 v61, v61, v221, v237
    v_fma_f32 v62, v62, v222, v238
    v_fma_f32 v63, v63, v223, v239
    v_cvt_pk_bf16_f32 v56, v56, v57
    v_cvt_pk_bf16_f32 v57, v58, v59
    v_cvt_pk_bf16_f32 v58, v60, v61
    v_cvt_pk_bf16_f32 v59, v62, v63
    buffer_store_dwordx4 v[56:59], v9, s[24:27], s49 offen offset:2048 sc1
    v_mfma_f32_16x16x32_bf16 v[128:131], v[204:207], v[160:163], v[128:131]
    v_fma_f32 v72, v72, v216, v232
    v_fma_f32 v73, v73, v217, v233
    v_fma_f32 v74, v74, v218, v234
    v_fma_f32 v75, v75, v219, v235
    v_fma_f32 v76, v76, v220, v236
    v_fma_f32 v77, v77, v221, v237
    v_fma_f32 v78, v78, v222, v238
    v_fma_f32 v79, v79, v223, v239
    v_cvt_pk_bf16_f32 v72, v72, v73
    v_cvt_pk_bf16_f32 v73, v74, v75
    v_mfma_f32_16x16x32_bf16 v[132:135], v[204:207], v[164:167], v[132:135]
    v_cvt_pk_bf16_f32 v74, v76, v77
    v_cvt_pk_bf16_f32 v75, v78, v79
    buffer_store_dwordx4 v[72:75], v9, s[24:27], s49 offen offset:3072 sc1
    v_mfma_f32_16x16x32_bf16 v[136:139], v[204:207], v[168:171], v[136:139]
    v_mfma_f32_16x16x32_bf16 v[140:143], v[204:207], v[172:175], v[140:143]
    s_waitcnt lgkmcnt(0)
    v_mfma_f32_16x16x32_bf16 v[80:83], v[176:179], v[144:147], v[80:83]
    ds_read_b64_tr_b16 v[192:193], v4 offset:10240
    v_mfma_f32_16x16x32_bf16 v[84:87], v[176:179], v[148:151], v[84:87]
    ds_read_b64_tr_b16 v[194:195], v4 offset:11264
    v_mfma_f32_16x16x32_bf16 v[88:91], v[176:179], v[152:155], v[88:91]
    ds_read_b128 v[160:163], v3 offset:8192
    v_mfma_f32_16x16x32_bf16 v[92:95], v[176:179], v[156:159], v[92:95]
    ds_read_b128 v[164:167], v2 offset:8704
    v_mfma_f32_16x16x32_bf16 v[96:99], v[180:183], v[144:147], v[96:99]
    ds_read_b128 v[168:171], v3 offset:9216
    v_mfma_f32_16x16x32_bf16 v[100:103], v[180:183], v[148:151], v[100:103]
    ds_read_b128 v[172:175], v2 offset:9728
    v_mfma_f32_16x16x32_bf16 v[104:107], v[180:183], v[152:155], v[104:107]
    ds_read_b64_tr_b16 v[196:197], v5 offset:10240
    v_mfma_f32_16x16x32_bf16 v[108:111], v[180:183], v[156:159], v[108:111]
    ds_read_b64_tr_b16 v[198:199], v5 offset:11264
    v_mfma_f32_16x16x32_bf16 v[112:115], v[184:187], v[144:147], v[112:115]
    ds_read_b64_tr_b16 v[200:201], v6 offset:10240
    v_mfma_f32_16x16x32_bf16 v[116:119], v[184:187], v[148:151], v[116:119]
    ds_read_b64_tr_b16 v[202:203], v6 offset:11264
    v_mfma_f32_16x16x32_bf16 v[120:123], v[184:187], v[152:155], v[120:123]
    ds_read_b64_tr_b16 v[204:205], v7 offset:10240
    v_mfma_f32_16x16x32_bf16 v[124:127], v[184:187], v[156:159], v[124:127]
    ds_read_b64_tr_b16 v[206:207], v7 offset:11264
    v_mfma_f32_16x16x32_bf16 v[128:131], v[188:191], v[144:147], v[128:131]
    v_mfma_f32_16x16x32_bf16 v[132:135], v[188:191], v[148:151], v[132:135]
    v_mfma_f32_16x16x32_bf16 v[136:139], v[188:191], v[152:155], v[136:139]
    v_mfma_f32_16x16x32_bf16 v[140:143], v[188:191], v[156:159], v[140:143]
    s_waitcnt lgkmcnt(0)
    s_barrier
    v_mfma_f32_16x16x32_bf16 v[80:83], v[192:195], v[160:163], v[80:83]
    ds_read_b64_tr_b16 v[176:177], v4 offset:12288
    v_mfma_f32_16x16x32_bf16 v[84:87], v[192:195], v[164:167], v[84:87]
    ds_read_b64_tr_b16 v[178:179], v4 offset:13312
    v_mfma_f32_16x16x32_bf16 v[88:91], v[192:195], v[168:171], v[88:91]
    ds_read_b128 v[144:147], v2 offset:12288
    v_mfma_f32_16x16x32_bf16 v[92:95], v[192:195], v[172:175], v[92:95]
    ds_read_b128 v[148:151], v3 offset:12800
    v_mfma_f32_16x16x32_bf16 v[96:99], v[196:199], v[160:163], v[96:99]
    ds_read_b128 v[152:155], v2 offset:13312
    v_mfma_f32_16x16x32_bf16 v[100:103], v[196:199], v[164:167], v[100:103]
    ds_read_b128 v[156:159], v3 offset:13824
    v_mfma_f32_16x16x32_bf16 v[104:107], v[196:199], v[168:171], v[104:107]
    ds_read_b64_tr_b16 v[180:181], v5 offset:12288
    v_mfma_f32_16x16x32_bf16 v[108:111], v[196:199], v[172:175], v[108:111]
    ds_read_b64_tr_b16 v[182:183], v5 offset:13312
    v_mfma_f32_16x16x32_bf16 v[112:115], v[200:203], v[160:163], v[112:115]
    ds_read_b64_tr_b16 v[184:185], v6 offset:12288
    v_mfma_f32_16x16x32_bf16 v[116:119], v[200:203], v[164:167], v[116:119]
    ds_read_b64_tr_b16 v[186:187], v6 offset:13312
    v_mfma_f32_16x16x32_bf16 v[120:123], v[200:203], v[168:171], v[120:123]
    ds_read_b64_tr_b16 v[188:189], v7 offset:12288
    v_mfma_f32_16x16x32_bf16 v[124:127], v[200:203], v[172:175], v[124:127]
    ds_read_b64_tr_b16 v[190:191], v7 offset:13312
    v_mfma_f32_16x16x32_bf16 v[128:131], v[204:207], v[160:163], v[128:131]
    v_mfma_f32_16x16x32_bf16 v[132:135], v[204:207], v[164:167], v[132:135]
    v_mfma_f32_16x16x32_bf16 v[136:139], v[204:207], v[168:171], v[136:139]
    v_mfma_f32_16x16x32_bf16 v[140:143], v[204:207], v[172:175], v[140:143]
    s_waitcnt lgkmcnt(0)
    v_mfma_f32_16x16x32_bf16 v[80:83], v[176:179], v[144:147], v[80:83]
    ds_read_b64_tr_b16 v[192:193], v4 offset:14336
    v_mfma_f32_16x16x32_bf16 v[84:87], v[176:179], v[148:151], v[84:87]
    ds_read_b64_tr_b16 v[194:195], v4 offset:15360
    v_mfma_f32_16x16x32_bf16 v[88:91], v[176:179], v[152:155], v[88:91]
    ds_read_b128 v[160:163], v3 offset:12288
    v_mfma_f32_16x16x32_bf16 v[92:95], v[176:179], v[156:159], v[92:95]
    ds_read_b128 v[164:167], v2 offset:12800
    v_mfma_f32_16x16x32_bf16 v[96:99], v[180:183], v[144:147], v[96:99]
    ds_read_b128 v[168:171], v3 offset:13312
    v_mfma_f32_16x16x32_bf16 v[100:103], v[180:183], v[148:151], v[100:103]
    ds_read_b128 v[172:175], v2 offset:13824
    v_mfma_f32_16x16x32_bf16 v[104:107], v[180:183], v[152:155], v[104:107]
    ds_read_b64_tr_b16 v[196:197], v5 offset:14336
    v_mfma_f32_16x16x32_bf16 v[108:111], v[180:183], v[156:159], v[108:111]
    ds_read_b64_tr_b16 v[198:199], v5 offset:15360
    v_mfma_f32_16x16x32_bf16 v[112:115], v[184:187], v[144:147], v[112:115]
    ds_read_b64_tr_b16 v[200:201], v6 offset:14336
    v_mfma_f32_16x16x32_bf16 v[116:119], v[184:187], v[148:151], v[116:119]
    ds_read_b64_tr_b16 v[202:203], v6 offset:15360
    v_mfma_f32_16x16x32_bf16 v[120:123], v[184:187], v[152:155], v[120:123]
    ds_read_b64_tr_b16 v[204:205], v7 offset:14336
    v_mfma_f32_16x16x32_bf16 v[124:127], v[184:187], v[156:159], v[124:127]
    ds_read_b64_tr_b16 v[206:207], v7 offset:15360
    v_mfma_f32_16x16x32_bf16 v[128:131], v[188:191], v[144:147], v[128:131]
    v_mfma_f32_16x16x32_bf16 v[132:135], v[188:191], v[148:151], v[132:135]
    v_mfma_f32_16x16x32_bf16 v[136:139], v[188:191], v[152:155], v[136:139]
    v_mfma_f32_16x16x32_bf16 v[140:143], v[188:191], v[156:159], v[140:143]
    s_waitcnt lgkmcnt(0)
    s_waitcnt vmcnt(0)
    buffer_store_dword v15, v14, s[20:23], s46 offen sc1
    s_barrier
    v_mfma_f32_16x16x32_bf16 v[80:83], v[192:195], v[160:163], v[80:83]
    ds_read_b64_tr_b16 v[176:177], v4 offset:0
    v_mfma_f32_16x16x32_bf16 v[84:87], v[192:195], v[164:167], v[84:87]
    ds_read_b64_tr_b16 v[178:179], v4 offset:1024
    v_mfma_f32_16x16x32_bf16 v[88:91], v[192:195], v[168:171], v[88:91]
    ds_read_b128 v[144:147], v2 offset:0
    v_mfma_f32_16x16x32_bf16 v[92:95], v[192:195], v[172:175], v[92:95]
    ds_read_b128 v[148:151], v3 offset:512
    v_mfma_f32_16x16x32_bf16 v[96:99], v[196:199], v[160:163], v[96:99]
    ds_read_b128 v[152:155], v2 offset:1024
    v_mfma_f32_16x16x32_bf16 v[100:103], v[196:199], v[164:167], v[100:103]
    ds_read_b128 v[156:159], v3 offset:1536
    v_mfma_f32_16x16x32_bf16 v[104:107], v[196:199], v[168:171], v[104:107]
    ds_read_b64_tr_b16 v[180:181], v5 offset:0
    v_mfma_f32_16x16x32_bf16 v[108:111], v[196:199], v[172:175], v[108:111]
    ds_read_b64_tr_b16 v[182:183], v5 offset:1024
    v_mfma_f32_16x16x32_bf16 v[112:115], v[200:203], v[160:163], v[112:115]
    ds_read_b64_tr_b16 v[184:185], v6 offset:0
    v_mfma_f32_16x16x32_bf16 v[116:119], v[200:203], v[164:167], v[116:119]
    ds_read_b64_tr_b16 v[186:187], v6 offset:1024
    v_mfma_f32_16x16x32_bf16 v[120:123], v[200:203], v[168:171], v[120:123]
    ds_read_b64_tr_b16 v[188:189], v7 offset:0
    v_mfma_f32_16x16x32_bf16 v[124:127], v[200:203], v[172:175], v[124:127]
    ds_read_b64_tr_b16 v[190:191], v7 offset:1024
    v_mfma_f32_16x16x32_bf16 v[128:131], v[204:207], v[160:163], v[128:131]
    v_mfma_f32_16x16x32_bf16 v[132:135], v[204:207], v[164:167], v[132:135]
    v_mfma_f32_16x16x32_bf16 v[136:139], v[204:207], v[168:171], v[136:139]
    v_mfma_f32_16x16x32_bf16 v[140:143], v[204:207], v[172:175], v[140:143]
    s_waitcnt lgkmcnt(0)
    v_mfma_f32_16x16x32_bf16 v[80:83], v[176:179], v[144:147], v[80:83]
    ds_read_b64_tr_b16 v[192:193], v4 offset:2048
    v_mfma_f32_16x16x32_bf16 v[84:87], v[176:179], v[148:151], v[84:87]
    ds_read_b64_tr_b16 v[194:195], v4 offset:3072
    v_mfma_f32_16x16x32_bf16 v[88:91], v[176:179], v[152:155], v[88:91]
    ds_read_b128 v[160:163], v3 offset:0
    v_mfma_f32_16x16x32_bf16 v[92:95], v[176:179], v[156:159], v[92:95]
    ds_read_b128 v[164:167], v2 offset:512
    v_mfma_f32_16x16x32_bf16 v[96:99], v[180:183], v[144:147], v[96:99]
    ds_read_b128 v[168:171], v3 offset:1024
    v_mfma_f32_16x16x32_bf16 v[100:103], v[180:183], v[148:151], v[100:103]
    ds_read_b128 v[172:175], v2 offset:1536
    v_mfma_f32_16x16x32_bf16 v[104:107], v[180:183], v[152:155], v[104:107]
    ds_read_b64_tr_b16 v[196:197], v5 offset:2048
    v_mfma_f32_16x16x32_bf16 v[108:111], v[180:183], v[156:159], v[108:111]
    ds_read_b64_tr_b16 v[198:199], v5 offset:3072
    v_mfma_f32_16x16x32_bf16 v[112:115], v[184:187], v[144:147], v[112:115]
    ds_read_b64_tr_b16 v[200:201], v6 offset:2048
    v_mfma_f32_16x16x32_bf16 v[116:119], v[184:187], v[148:151], v[116:119]
    ds_read_b64_tr_b16 v[202:203], v6 offset:3072
    v_mfma_f32_16x16x32_bf16 v[120:123], v[184:187], v[152:155], v[120:123]
    ds_read_b64_tr_b16 v[204:205], v7 offset:2048
    v_mfma_f32_16x16x32_bf16 v[124:127], v[184:187], v[156:159], v[124:127]
    ds_read_b64_tr_b16 v[206:207], v7 offset:3072
    v_mfma_f32_16x16x32_bf16 v[128:131], v[188:191], v[144:147], v[128:131]
    v_mfma_f32_16x16x32_bf16 v[132:135], v[188:191], v[148:151], v[132:135]
    v_mfma_f32_16x16x32_bf16 v[136:139], v[188:191], v[152:155], v[136:139]
    v_mfma_f32_16x16x32_bf16 v[140:143], v[188:191], v[156:159], v[140:143]
    s_waitcnt lgkmcnt(0)
    s_barrier
    v_mfma_f32_16x16x32_bf16 v[80:83], v[192:195], v[160:163], v[80:83]
    ds_read_b64_tr_b16 v[176:177], v4 offset:4096
    v_mfma_f32_16x16x32_bf16 v[84:87], v[192:195], v[164:167], v[84:87]
    ds_read_b64_tr_b16 v[178:179], v4 offset:5120
    v_mfma_f32_16x16x32_bf16 v[88:91], v[192:195], v[168:171], v[88:91]
    ds_read_b128 v[144:147], v2 offset:4096
    v_mfma_f32_16x16x32_bf16 v[92:95], v[192:195], v[172:175], v[92:95]
    ds_read_b128 v[148:151], v3 offset:4608
    v_mfma_f32_16x16x32_bf16 v[96:99], v[196:199], v[160:163], v[96:99]
    ds_read_b128 v[152:155], v2 offset:5120
    v_mfma_f32_16x16x32_bf16 v[100:103], v[196:199], v[164:167], v[100:103]
    ds_read_b128 v[156:159], v3 offset:5632
    v_mfma_f32_16x16x32_bf16 v[104:107], v[196:199], v[168:171], v[104:107]
    ds_read_b64_tr_b16 v[180:181], v5 offset:4096
    v_mfma_f32_16x16x32_bf16 v[108:111], v[196:199], v[172:175], v[108:111]
    ds_read_b64_tr_b16 v[182:183], v5 offset:5120
    v_mfma_f32_16x16x32_bf16 v[112:115], v[200:203], v[160:163], v[112:115]
    ds_read_b64_tr_b16 v[184:185], v6 offset:4096
    v_mfma_f32_16x16x32_bf16 v[116:119], v[200:203], v[164:167], v[116:119]
    ds_read_b64_tr_b16 v[186:187], v6 offset:5120
    v_mfma_f32_16x16x32_bf16 v[120:123], v[200:203], v[168:171], v[120:123]
    ds_read_b64_tr_b16 v[188:189], v7 offset:4096
    v_mfma_f32_16x16x32_bf16 v[124:127], v[200:203], v[172:175], v[124:127]
    ds_read_b64_tr_b16 v[190:191], v7 offset:5120
    v_mfma_f32_16x16x32_bf16 v[128:131], v[204:207], v[160:163], v[128:131]
    v_mfma_f32_16x16x32_bf16 v[132:135], v[204:207], v[164:167], v[132:135]
    v_mfma_f32_16x16x32_bf16 v[136:139], v[204:207], v[168:171], v[136:139]
    v_mfma_f32_16x16x32_bf16 v[140:143], v[204:207], v[172:175], v[140:143]
    s_waitcnt lgkmcnt(0)
    v_mfma_f32_16x16x32_bf16 v[80:83], v[176:179], v[144:147], v[80:83]
    ds_read_b64_tr_b16 v[192:193], v4 offset:6144
    v_mfma_f32_16x16x32_bf16 v[84:87], v[176:179], v[148:151], v[84:87]
    ds_read_b64_tr_b16 v[194:195], v4 offset:7168
    v_mfma_f32_16x16x32_bf16 v[88:91], v[176:179], v[152:155], v[88:91]
    ds_read_b128 v[160:163], v3 offset:4096
    v_mfma_f32_16x16x32_bf16 v[92:95], v[176:179], v[156:159], v[92:95]
    ds_read_b128 v[164:167], v2 offset:4608
    v_mfma_f32_16x16x32_bf16 v[96:99], v[180:183], v[144:147], v[96:99]
    ds_read_b128 v[168:171], v3 offset:5120
    v_mfma_f32_16x16x32_bf16 v[100:103], v[180:183], v[148:151], v[100:103]
    ds_read_b128 v[172:175], v2 offset:5632
    v_mfma_f32_16x16x32_bf16 v[104:107], v[180:183], v[152:155], v[104:107]
    ds_read_b64_tr_b16 v[196:197], v5 offset:6144
    v_mfma_f32_16x16x32_bf16 v[108:111], v[180:183], v[156:159], v[108:111]
    ds_read_b64_tr_b16 v[198:199], v5 offset:7168
    v_mfma_f32_16x16x32_bf16 v[112:115], v[184:187], v[144:147], v[112:115]
    ds_read_b64_tr_b16 v[200:201], v6 offset:6144
    v_mfma_f32_16x16x32_bf16 v[116:119], v[184:187], v[148:151], v[116:119]
    ds_read_b64_tr_b16 v[202:203], v6 offset:7168
    v_mfma_f32_16x16x32_bf16 v[120:123], v[184:187], v[152:155], v[120:123]
    ds_read_b64_tr_b16 v[204:205], v7 offset:6144
    v_mfma_f32_16x16x32_bf16 v[124:127], v[184:187], v[156:159], v[124:127]
    ds_read_b64_tr_b16 v[206:207], v7 offset:7168
    v_mfma_f32_16x16x32_bf16 v[128:131], v[188:191], v[144:147], v[128:131]
    v_mfma_f32_16x16x32_bf16 v[132:135], v[188:191], v[148:151], v[132:135]
    v_mfma_f32_16x16x32_bf16 v[136:139], v[188:191], v[152:155], v[136:139]
    v_mfma_f32_16x16x32_bf16 v[140:143], v[188:191], v[156:159], v[140:143]
    s_waitcnt lgkmcnt(0)
    s_barrier
    v_mfma_f32_16x16x32_bf16 v[80:83], v[192:195], v[160:163], v[80:83]
    ds_read_b64_tr_b16 v[176:177], v4 offset:8192
    v_mfma_f32_16x16x32_bf16 v[84:87], v[192:195], v[164:167], v[84:87]
    ds_read_b64_tr_b16 v[178:179], v4 offset:9216
    v_mfma_f32_16x16x32_bf16 v[88:91], v[192:195], v[168:171], v[88:91]
    ds_read_b128 v[144:147], v2 offset:8192
    v_mfma_f32_16x16x32_bf16 v[92:95], v[192:195], v[172:175], v[92:95]
    ds_read_b128 v[148:151], v3 offset:8704
    v_mfma_f32_16x16x32_bf16 v[96:99], v[196:199], v[160:163], v[96:99]
    ds_read_b128 v[152:155], v2 offset:9216
    v_mfma_f32_16x16x32_bf16 v[100:103], v[196:199], v[164:167], v[100:103]
    ds_read_b128 v[156:159], v3 offset:9728
    v_mfma_f32_16x16x32_bf16 v[104:107], v[196:199], v[168:171], v[104:107]
    ds_read_b64_tr_b16 v[180:181], v5 offset:8192
    v_mfma_f32_16x16x32_bf16 v[108:111], v[196:199], v[172:175], v[108:111]
    ds_read_b64_tr_b16 v[182:183], v5 offset:9216
    v_mfma_f32_16x16x32_bf16 v[112:115], v[200:203], v[160:163], v[112:115]
    ds_read_b64_tr_b16 v[184:185], v6 offset:8192
    v_mfma_f32_16x16x32_bf16 v[116:119], v[200:203], v[164:167], v[116:119]
    ds_read_b64_tr_b16 v[186:187], v6 offset:9216
    v_mfma_f32_16x16x32_bf16 v[120:123], v[200:203], v[168:171], v[120:123]
    ds_read_b64_tr_b16 v[188:189], v7 offset:8192
    v_mfma_f32_16x16x32_bf16 v[124:127], v[200:203], v[172:175], v[124:127]
    ds_read_b64_tr_b16 v[190:191], v7 offset:9216
    v_mfma_f32_16x16x32_bf16 v[128:131], v[204:207], v[160:163], v[128:131]
    v_mfma_f32_16x16x32_bf16 v[132:135], v[204:207], v[164:167], v[132:135]
    v_mfma_f32_16x16x32_bf16 v[136:139], v[204:207], v[168:171], v[136:139]
    v_mfma_f32_16x16x32_bf16 v[140:143], v[204:207], v[172:175], v[140:143]
    s_waitcnt lgkmcnt(0)
    v_mfma_f32_16x16x32_bf16 v[80:83], v[176:179], v[144:147], v[80:83]
    ds_read_b64_tr_b16 v[192:193], v4 offset:10240
    v_mfma_f32_16x16x32_bf16 v[84:87], v[176:179], v[148:151], v[84:87]
    ds_read_b64_tr_b16 v[194:195], v4 offset:11264
    v_mfma_f32_16x16x32_bf16 v[88:91], v[176:179], v[152:155], v[88:91]
    ds_read_b128 v[160:163], v3 offset:8192
    v_mfma_f32_16x16x32_bf16 v[92:95], v[176:179], v[156:159], v[92:95]
    ds_read_b128 v[164:167], v2 offset:8704
    v_mfma_f32_16x16x32_bf16 v[96:99], v[180:183], v[144:147], v[96:99]
    ds_read_b128 v[168:171], v3 offset:9216
    v_mfma_f32_16x16x32_bf16 v[100:103], v[180:183], v[148:151], v[100:103]
    ds_read_b128 v[172:175], v2 offset:9728
    v_mfma_f32_16x16x32_bf16 v[104:107], v[180:183], v[152:155], v[104:107]
    ds_read_b64_tr_b16 v[196:197], v5 offset:10240
    v_mfma_f32_16x16x32_bf16 v[108:111], v[180:183], v[156:159], v[108:111]
    ds_read_b64_tr_b16 v[198:199], v5 offset:11264
    v_mfma_f32_16x16x32_bf16 v[112:115], v[184:187], v[144:147], v[112:115]
    ds_read_b64_tr_b16 v[200:201], v6 offset:10240
    v_mfma_f32_16x16x32_bf16 v[116:119], v[184:187], v[148:151], v[116:119]
    ds_read_b64_tr_b16 v[202:203], v6 offset:11264
    v_mfma_f32_16x16x32_bf16 v[120:123], v[184:187], v[152:155], v[120:123]
    ds_read_b64_tr_b16 v[204:205], v7 offset:10240
    v_mfma_f32_16x16x32_bf16 v[124:127], v[184:187], v[156:159], v[124:127]
    ds_read_b64_tr_b16 v[206:207], v7 offset:11264
    v_mfma_f32_16x16x32_bf16 v[128:131], v[188:191], v[144:147], v[128:131]
    v_mfma_f32_16x16x32_bf16 v[132:135], v[188:191], v[148:151], v[132:135]
    v_mfma_f32_16x16x32_bf16 v[136:139], v[188:191], v[152:155], v[136:139]
    v_mfma_f32_16x16x32_bf16 v[140:143], v[188:191], v[156:159], v[140:143]
    s_waitcnt lgkmcnt(0)
    s_barrier
    v_mfma_f32_16x16x32_bf16 v[80:83], v[192:195], v[160:163], v[80:83]
    ds_read_b64_tr_b16 v[176:177], v4 offset:12288
    v_mfma_f32_16x16x32_bf16 v[84:87], v[192:195], v[164:167], v[84:87]
    ds_read_b64_tr_b16 v[178:179], v4 offset:13312
    v_mfma_f32_16x16x32_bf16 v[88:91], v[192:195], v[168:171], v[88:91]
    ds_read_b128 v[144:147], v2 offset:12288
    v_mfma_f32_16x16x32_bf16 v[92:95], v[192:195], v[172:175], v[92:95]
    ds_read_b128 v[148:151], v3 offset:12800
    v_mfma_f32_16x16x32_bf16 v[96:99], v[196:199], v[160:163], v[96:99]
    ds_read_b128 v[152:155], v2 offset:13312
    v_mfma_f32_16x16x32_bf16 v[100:103], v[196:199], v[164:167], v[100:103]
    ds_read_b128 v[156:159], v3 offset:13824
    v_mfma_f32_16x16x32_bf16 v[104:107], v[196:199], v[168:171], v[104:107]
    ds_read_b64_tr_b16 v[180:181], v5 offset:12288
    v_mfma_f32_16x16x32_bf16 v[108:111], v[196:199], v[172:175], v[108:111]
    ds_read_b64_tr_b16 v[182:183], v5 offset:13312
    v_mfma_f32_16x16x32_bf16 v[112:115], v[200:203], v[160:163], v[112:115]
    ds_read_b64_tr_b16 v[184:185], v6 offset:12288
    v_mfma_f32_16x16x32_bf16 v[116:119], v[200:203], v[164:167], v[116:119]
    ds_read_b64_tr_b16 v[186:187], v6 offset:13312
    v_mfma_f32_16x16x32_bf16 v[120:123], v[200:203], v[168:171], v[120:123]
    ds_read_b64_tr_b16 v[188:189], v7 offset:12288
    v_mfma_f32_16x16x32_bf16 v[124:127], v[200:203], v[172:175], v[124:127]
    ds_read_b64_tr_b16 v[190:191], v7 offset:13312
    v_mfma_f32_16x16x32_bf16 v[128:131], v[204:207], v[160:163], v[128:131]
    v_mfma_f32_16x16x32_bf16 v[132:135], v[204:207], v[164:167], v[132:135]
    v_mfma_f32_16x16x32_bf16 v[136:139], v[204:207], v[168:171], v[136:139]
    v_mfma_f32_16x16x32_bf16 v[140:143], v[204:207], v[172:175], v[140:143]
    s_waitcnt lgkmcnt(0)
    v_mfma_f32_16x16x32_bf16 v[80:83], v[176:179], v[144:147], v[80:83]
    ds_read_b64_tr_b16 v[192:193], v4 offset:14336
    v_mfma_f32_16x16x32_bf16 v[84:87], v[176:179], v[148:151], v[84:87]
    ds_read_b64_tr_b16 v[194:195], v4 offset:15360
    v_mfma_f32_16x16x32_bf16 v[88:91], v[176:179], v[152:155], v[88:91]
    ds_read_b128 v[160:163], v3 offset:12288
    v_mfma_f32_16x16x32_bf16 v[92:95], v[176:179], v[156:159], v[92:95]
    ds_read_b128 v[164:167], v2 offset:12800
    v_mfma_f32_16x16x32_bf16 v[96:99], v[180:183], v[144:147], v[96:99]
    ds_read_b128 v[168:171], v3 offset:13312
    v_mfma_f32_16x16x32_bf16 v[100:103], v[180:183], v[148:151], v[100:103]
    ds_read_b128 v[172:175], v2 offset:13824
    v_mfma_f32_16x16x32_bf16 v[104:107], v[180:183], v[152:155], v[104:107]
    ds_read_b64_tr_b16 v[196:197], v5 offset:14336
    v_mfma_f32_16x16x32_bf16 v[108:111], v[180:183], v[156:159], v[108:111]
    ds_read_b64_tr_b16 v[198:199], v5 offset:15360
    v_mfma_f32_16x16x32_bf16 v[112:115], v[184:187], v[144:147], v[112:115]
    ds_read_b64_tr_b16 v[200:201], v6 offset:14336
    v_mfma_f32_16x16x32_bf16 v[116:119], v[184:187], v[148:151], v[116:119]
    ds_read_b64_tr_b16 v[202:203], v6 offset:15360
    v_mfma_f32_16x16x32_bf16 v[120:123], v[184:187], v[152:155], v[120:123]
    ds_read_b64_tr_b16 v[204:205], v7 offset:14336
    v_mfma_f32_16x16x32_bf16 v[124:127], v[184:187], v[156:159], v[124:127]
    ds_read_b64_tr_b16 v[206:207], v7 offset:15360
    v_mfma_f32_16x16x32_bf16 v[128:131], v[188:191], v[144:147], v[128:131]
    v_mfma_f32_16x16x32_bf16 v[132:135], v[188:191], v[148:151], v[132:135]
    v_mfma_f32_16x16x32_bf16 v[136:139], v[188:191], v[152:155], v[136:139]
    v_mfma_f32_16x16x32_bf16 v[140:143], v[188:191], v[156:159], v[140:143]
    s_waitcnt lgkmcnt(0)
    s_barrier
    v_mfma_f32_16x16x32_bf16 v[80:83], v[192:195], v[160:163], v[80:83]
    ds_read_b64_tr_b16 v[176:177], v4 offset:0
    v_mfma_f32_16x16x32_bf16 v[84:87], v[192:195], v[164:167], v[84:87]
    ds_read_b64_tr_b16 v[178:179], v4 offset:1024
    v_mfma_f32_16x16x32_bf16 v[88:91], v[192:195], v[168:171], v[88:91]
    ds_read_b128 v[144:147], v2 offset:0
    v_mfma_f32_16x16x32_bf16 v[92:95], v[192:195], v[172:175], v[92:95]
    ds_read_b128 v[148:151], v3 offset:512
    v_mfma_f32_16x16x32_bf16 v[96:99], v[196:199], v[160:163], v[96:99]
    ds_read_b128 v[152:155], v2 offset:1024
    v_mfma_f32_16x16x32_bf16 v[100:103], v[196:199], v[164:167], v[100:103]
    ds_read_b128 v[156:159], v3 offset:1536
    v_mfma_f32_16x16x32_bf16 v[104:107], v[196:199], v[168:171], v[104:107]
    ds_read_b64_tr_b16 v[180:181], v5 offset:0
    v_mfma_f32_16x16x32_bf16 v[108:111], v[196:199], v[172:175], v[108:111]
    ds_read_b64_tr_b16 v[182:183], v5 offset:1024
    v_mfma_f32_16x16x32_bf16 v[112:115], v[200:203], v[160:163], v[112:115]
    ds_read_b64_tr_b16 v[184:185], v6 offset:0
    v_mfma_f32_16x16x32_bf16 v[116:119], v[200:203], v[164:167], v[116:119]
    ds_read_b64_tr_b16 v[186:187], v6 offset:1024
    v_mfma_f32_16x16x32_bf16 v[120:123], v[200:203], v[168:171], v[120:123]
    ds_read_b64_tr_b16 v[188:189], v7 offset:0
    v_mfma_f32_16x16x32_bf16 v[124:127], v[200:203], v[172:175], v[124:127]
    ds_read_b64_tr_b16 v[190:191], v7 offset:1024
    v_mfma_f32_16x16x32_bf16 v[128:131], v[204:207], v[160:163], v[128:131]
    v_mfma_f32_16x16x32_bf16 v[132:135], v[204:207], v[164:167], v[132:135]
    v_mfma_f32_16x16x32_bf16 v[136:139], v[204:207], v[168:171], v[136:139]
    v_mfma_f32_16x16x32_bf16 v[140:143], v[204:207], v[172:175], v[140:143]
    s_waitcnt lgkmcnt(0)
    v_mfma_f32_16x16x32_bf16 v[80:83], v[176:179], v[144:147], v[80:83]
    ds_read_b64_tr_b16 v[192:193], v4 offset:2048
    v_mfma_f32_16x16x32_bf16 v[84:87], v[176:179], v[148:151], v[84:87]
    ds_read_b64_tr_b16 v[194:195], v4 offset:3072
    v_mfma_f32_16x16x32_bf16 v[88:91], v[176:179], v[152:155], v[88:91]
    ds_read_b128 v[160:163], v3 offset:0
    v_mfma_f32_16x16x32_bf16 v[92:95], v[176:179], v[156:159], v[92:95]
    ds_read_b128 v[164:167], v2 offset:512
    v_mfma_f32_16x16x32_bf16 v[96:99], v[180:183], v[144:147], v[96:99]
    ds_read_b128 v[168:171], v3 offset:1024
    v_mfma_f32_16x16x32_bf16 v[100:103], v[180:183], v[148:151], v[100:103]
    ds_read_b128 v[172:175], v2 offset:1536
    v_mfma_f32_16x16x32_bf16 v[104:107], v[180:183], v[152:155], v[104:107]
    ds_read_b64_tr_b16 v[196:197], v5 offset:2048
    v_mfma_f32_16x16x32_bf16 v[108:111], v[180:183], v[156:159], v[108:111]
    ds_read_b64_tr_b16 v[198:199], v5 offset:3072
    v_mfma_f32_16x16x32_bf16 v[112:115], v[184:187], v[144:147], v[112:115]
    ds_read_b64_tr_b16 v[200:201], v6 offset:2048
    v_mfma_f32_16x16x32_bf16 v[116:119], v[184:187], v[148:151], v[116:119]
    ds_read_b64_tr_b16 v[202:203], v6 offset:3072
    v_mfma_f32_16x16x32_bf16 v[120:123], v[184:187], v[152:155], v[120:123]
    ds_read_b64_tr_b16 v[204:205], v7 offset:2048
    v_mfma_f32_16x16x32_bf16 v[124:127], v[184:187], v[156:159], v[124:127]
    ds_read_b64_tr_b16 v[206:207], v7 offset:3072
    v_mfma_f32_16x16x32_bf16 v[128:131], v[188:191], v[144:147], v[128:131]
    v_mfma_f32_16x16x32_bf16 v[132:135], v[188:191], v[148:151], v[132:135]
    v_mfma_f32_16x16x32_bf16 v[136:139], v[188:191], v[152:155], v[136:139]
    v_mfma_f32_16x16x32_bf16 v[140:143], v[188:191], v[156:159], v[140:143]
    s_waitcnt lgkmcnt(0)
    s_barrier
    v_mfma_f32_16x16x32_bf16 v[80:83], v[192:195], v[160:163], v[80:83]
    ds_read_b64_tr_b16 v[176:177], v4 offset:4096
    v_mfma_f32_16x16x32_bf16 v[84:87], v[192:195], v[164:167], v[84:87]
    ds_read_b64_tr_b16 v[178:179], v4 offset:5120
    v_mfma_f32_16x16x32_bf16 v[88:91], v[192:195], v[168:171], v[88:91]
    ds_read_b128 v[144:147], v2 offset:4096
    v_mfma_f32_16x16x32_bf16 v[92:95], v[192:195], v[172:175], v[92:95]
    ds_read_b128 v[148:151], v3 offset:4608
    v_mfma_f32_16x16x32_bf16 v[96:99], v[196:199], v[160:163], v[96:99]
    ds_read_b128 v[152:155], v2 offset:5120
    v_mfma_f32_16x16x32_bf16 v[100:103], v[196:199], v[164:167], v[100:103]
    ds_read_b128 v[156:159], v3 offset:5632
    v_mfma_f32_16x16x32_bf16 v[104:107], v[196:199], v[168:171], v[104:107]
    ds_read_b64_tr_b16 v[180:181], v5 offset:4096
    v_mfma_f32_16x16x32_bf16 v[108:111], v[196:199], v[172:175], v[108:111]
    ds_read_b64_tr_b16 v[182:183], v5 offset:5120
    v_mfma_f32_16x16x32_bf16 v[112:115], v[200:203], v[160:163], v[112:115]
    ds_read_b64_tr_b16 v[184:185], v6 offset:4096
    v_mfma_f32_16x16x32_bf16 v[116:119], v[200:203], v[164:167], v[116:119]
    ds_read_b64_tr_b16 v[186:187], v6 offset:5120
    v_mfma_f32_16x16x32_bf16 v[120:123], v[200:203], v[168:171], v[120:123]
    ds_read_b64_tr_b16 v[188:189], v7 offset:4096
    v_mfma_f32_16x16x32_bf16 v[124:127], v[200:203], v[172:175], v[124:127]
    ds_read_b64_tr_b16 v[190:191], v7 offset:5120
    v_mfma_f32_16x16x32_bf16 v[128:131], v[204:207], v[160:163], v[128:131]
    v_mfma_f32_16x16x32_bf16 v[132:135], v[204:207], v[164:167], v[132:135]
    v_mfma_f32_16x16x32_bf16 v[136:139], v[204:207], v[168:171], v[136:139]
    v_mfma_f32_16x16x32_bf16 v[140:143], v[204:207], v[172:175], v[140:143]
    s_waitcnt lgkmcnt(0)
    v_mfma_f32_16x16x32_bf16 v[80:83], v[176:179], v[144:147], v[80:83]
    ds_read_b64_tr_b16 v[192:193], v4 offset:6144
    v_mfma_f32_16x16x32_bf16 v[84:87], v[176:179], v[148:151], v[84:87]
    ds_read_b64_tr_b16 v[194:195], v4 offset:7168
    v_mfma_f32_16x16x32_bf16 v[88:91], v[176:179], v[152:155], v[88:91]
    ds_read_b128 v[160:163], v3 offset:4096
    v_mfma_f32_16x16x32_bf16 v[92:95], v[176:179], v[156:159], v[92:95]
    ds_read_b128 v[164:167], v2 offset:4608
    v_mfma_f32_16x16x32_bf16 v[96:99], v[180:183], v[144:147], v[96:99]
    ds_read_b128 v[168:171], v3 offset:5120
    v_mfma_f32_16x16x32_bf16 v[100:103], v[180:183], v[148:151], v[100:103]
    ds_read_b128 v[172:175], v2 offset:5632
    v_mfma_f32_16x16x32_bf16 v[104:107], v[180:183], v[152:155], v[104:107]
    ds_read_b64_tr_b16 v[196:197], v5 offset:6144
    v_mfma_f32_16x16x32_bf16 v[108:111], v[180:183], v[156:159], v[108:111]
    ds_read_b64_tr_b16 v[198:199], v5 offset:7168
    v_mfma_f32_16x16x32_bf16 v[112:115], v[184:187], v[144:147], v[112:115]
    ds_read_b64_tr_b16 v[200:201], v6 offset:6144
    v_mfma_f32_16x16x32_bf16 v[116:119], v[184:187], v[148:151], v[116:119]
    ds_read_b64_tr_b16 v[202:203], v6 offset:7168
    v_mfma_f32_16x16x32_bf16 v[120:123], v[184:187], v[152:155], v[120:123]
    ds_read_b64_tr_b16 v[204:205], v7 offset:6144
    v_mfma_f32_16x16x32_bf16 v[124:127], v[184:187], v[156:159], v[124:127]
    ds_read_b64_tr_b16 v[206:207], v7 offset:7168
    v_mfma_f32_16x16x32_bf16 v[128:131], v[188:191], v[144:147], v[128:131]
    v_mfma_f32_16x16x32_bf16 v[132:135], v[188:191], v[148:151], v[132:135]
    v_mfma_f32_16x16x32_bf16 v[136:139], v[188:191], v[152:155], v[136:139]
    v_mfma_f32_16x16x32_bf16 v[140:143], v[188:191], v[156:159], v[140:143]
    s_waitcnt lgkmcnt(0)
    s_barrier
    v_mfma_f32_16x16x32_bf16 v[80:83], v[192:195], v[160:163], v[80:83]
    ds_read_b64_tr_b16 v[176:177], v4 offset:8192
    v_mfma_f32_16x16x32_bf16 v[84:87], v[192:195], v[164:167], v[84:87]
    ds_read_b64_tr_b16 v[178:179], v4 offset:9216
    v_mfma_f32_16x16x32_bf16 v[88:91], v[192:195], v[168:171], v[88:91]
    ds_read_b128 v[144:147], v2 offset:8192
    v_mfma_f32_16x16x32_bf16 v[92:95], v[192:195], v[172:175], v[92:95]
    ds_read_b128 v[148:151], v3 offset:8704
    v_mfma_f32_16x16x32_bf16 v[96:99], v[196:199], v[160:163], v[96:99]
    ds_read_b128 v[152:155], v2 offset:9216
    v_mfma_f32_16x16x32_bf16 v[100:103], v[196:199], v[164:167], v[100:103]
    ds_read_b128 v[156:159], v3 offset:9728
    v_mfma_f32_16x16x32_bf16 v[104:107], v[196:199], v[168:171], v[104:107]
    ds_read_b64_tr_b16 v[180:181], v5 offset:8192
    v_mfma_f32_16x16x32_bf16 v[108:111], v[196:199], v[172:175], v[108:111]
    ds_read_b64_tr_b16 v[182:183], v5 offset:9216
    v_mfma_f32_16x16x32_bf16 v[112:115], v[200:203], v[160:163], v[112:115]
    ds_read_b64_tr_b16 v[184:185], v6 offset:8192
    v_mfma_f32_16x16x32_bf16 v[116:119], v[200:203], v[164:167], v[116:119]
    ds_read_b64_tr_b16 v[186:187], v6 offset:9216
    v_mfma_f32_16x16x32_bf16 v[120:123], v[200:203], v[168:171], v[120:123]
    ds_read_b64_tr_b16 v[188:189], v7 offset:8192
    v_mfma_f32_16x16x32_bf16 v[124:127], v[200:203], v[172:175], v[124:127]
    ds_read_b64_tr_b16 v[190:191], v7 offset:9216
    v_mfma_f32_16x16x32_bf16 v[128:131], v[204:207], v[160:163], v[128:131]
    v_mfma_f32_16x16x32_bf16 v[132:135], v[204:207], v[164:167], v[132:135]
    v_mfma_f32_16x16x32_bf16 v[136:139], v[204:207], v[168:171], v[136:139]
    v_mfma_f32_16x16x32_bf16 v[140:143], v[204:207], v[172:175], v[140:143]
    s_waitcnt lgkmcnt(0)
    v_mfma_f32_16x16x32_bf16 v[80:83], v[176:179], v[144:147], v[80:83]
    ds_read_b64_tr_b16 v[192:193], v4 offset:10240
    v_mov_b32 v16, v252
    v_mfma_f32_16x16x32_bf16 v[84:87], v[176:179], v[148:151], v[84:87]
    ds_read_b64_tr_b16 v[194:195], v4 offset:11264
    v_mov_b32 v17, v252
    v_mfma_f32_16x16x32_bf16 v[88:91], v[176:179], v[152:155], v[88:91]
    ds_read_b128 v[160:163], v3 offset:8192
    v_mov_b32 v18, v252
    v_mfma_f32_16x16x32_bf16 v[92:95], v[176:179], v[156:159], v[92:95]
    ds_read_b128 v[164:167], v2 offset:8704
    v_mov_b32 v19, v252
    v_mfma_f32_16x16x32_bf16 v[96:99], v[180:183], v[144:147], v[96:99]
    ds_read_b128 v[168:171], v3 offset:9216
    v_mov_b32 v20, v253
    v_mfma_f32_16x16x32_bf16 v[100:103], v[180:183], v[148:151], v[100:103]
    ds_read_b128 v[172:175], v2 offset:9728
    v_mov_b32 v21, v253
    v_mfma_f32_16x16x32_bf16 v[104:107], v[180:183], v[152:155], v[104:107]
    ds_read_b64_tr_b16 v[196:197], v5 offset:10240
    v_mov_b32 v22, v253
    v_mfma_f32_16x16x32_bf16 v[108:111], v[180:183], v[156:159], v[108:111]
    ds_read_b64_tr_b16 v[198:199], v5 offset:11264
    v_mov_b32 v23, v253
    v_mfma_f32_16x16x32_bf16 v[112:115], v[184:187], v[144:147], v[112:115]
    ds_read_b64_tr_b16 v[200:201], v6 offset:10240
    v_mov_b32 v24, v254
    v_mfma_f32_16x16x32_bf16 v[116:119], v[184:187], v[148:151], v[116:119]
    ds_read_b64_tr_b16 v[202:203], v6 offset:11264
    v_mov_b32 v25, v254
    v_mfma_f32_16x16x32_bf16 v[120:123], v[184:187], v[152:155], v[120:123]
    ds_read_b64_tr_b16 v[204:205], v7 offset:10240
    v_mov_b32 v26, v254
    v_mfma_f32_16x16x32_bf16 v[124:127], v[184:187], v[156:159], v[124:127]
    ds_read_b64_tr_b16 v[206:207], v7 offset:11264
    v_mov_b32 v27, v254
    v_mfma_f32_16x16x32_bf16 v[128:131], v[188:191], v[144:147], v[128:131]
    v_mov_b32 v28, v255
    v_mov_b32 v29, v255
    v_mfma_f32_16x16x32_bf16 v[132:135], v[188:191], v[148:151], v[132:135]
    v_mov_b32 v30, v255
    v_mov_b32 v31, v255
    v_mfma_f32_16x16x32_bf16 v[136:139], v[188:191], v[152:155], v[136:139]
    v_mfma_f32_16x16x32_bf16 v[140:143], v[188:191], v[156:159], v[140:143]
    s_waitcnt lgkmcnt(0)
    s_barrier
    v_mfma_f32_16x16x32_bf16 v[80:83], v[192:195], v[160:163], v[80:83]
    ds_read_b64_tr_b16 v[176:177], v4 offset:12288
    v_mfma_f32_16x16x32_bf16 v[84:87], v[192:195], v[164:167], v[84:87]
    ds_read_b64_tr_b16 v[178:179], v4 offset:13312
    v_mfma_f32_16x16x32_bf16 v[88:91], v[192:195], v[168:171], v[88:91]
    ds_read_b128 v[144:147], v2 offset:12288
    v_mfma_f32_16x16x32_bf16 v[92:95], v[192:195], v[172:175], v[92:95]
    ds_read_b128 v[148:151], v3 offset:12800
    v_mfma_f32_16x16x32_bf16 v[96:99], v[196:199], v[160:163], v[96:99]
    ds_read_b128 v[152:155], v2 offset:13312
    v_mfma_f32_16x16x32_bf16 v[100:103], v[196:199], v[164:167], v[100:103]
    ds_read_b128 v[156:159], v3 offset:13824
    v_mfma_f32_16x16x32_bf16 v[104:107], v[196:199], v[168:171], v[104:107]
    ds_read_b64_tr_b16 v[180:181], v5 offset:12288
    v_mfma_f32_16x16x32_bf16 v[108:111], v[196:199], v[172:175], v[108:111]
    ds_read_b64_tr_b16 v[182:183], v5 offset:13312
    v_mfma_f32_16x16x32_bf16 v[112:115], v[200:203], v[160:163], v[112:115]
    ds_read_b64_tr_b16 v[184:185], v6 offset:12288
    v_mfma_f32_16x16x32_bf16 v[116:119], v[200:203], v[164:167], v[116:119]
    ds_read_b64_tr_b16 v[186:187], v6 offset:13312
    v_mfma_f32_16x16x32_bf16 v[120:123], v[200:203], v[168:171], v[120:123]
    ds_read_b64_tr_b16 v[188:189], v7 offset:12288
    v_mfma_f32_16x16x32_bf16 v[124:127], v[200:203], v[172:175], v[124:127]
    ds_read_b64_tr_b16 v[190:191], v7 offset:13312
    v_mfma_f32_16x16x32_bf16 v[128:131], v[204:207], v[160:163], v[128:131]
    v_mfma_f32_16x16x32_bf16 v[132:135], v[204:207], v[164:167], v[132:135]
    v_mfma_f32_16x16x32_bf16 v[136:139], v[204:207], v[168:171], v[136:139]
    v_mfma_f32_16x16x32_bf16 v[140:143], v[204:207], v[172:175], v[140:143]
    s_waitcnt lgkmcnt(0)
    v_mfma_f32_16x16x32_bf16 v[80:83], v[176:179], v[144:147], v[80:83]
    ds_read_b64_tr_b16 v[192:193], v4 offset:14336
    v_mfma_f32_16x16x32_bf16 v[84:87], v[176:179], v[148:151], v[84:87]
    ds_read_b64_tr_b16 v[194:195], v4 offset:15360
    v_mfma_f32_16x16x32_bf16 v[88:91], v[176:179], v[152:155], v[88:91]
    ds_read_b128 v[160:163], v3 offset:12288
    v_mfma_f32_16x16x32_bf16 v[92:95], v[176:179], v[156:159], v[92:95]
    ds_read_b128 v[164:167], v2 offset:12800
    v_mfma_f32_16x16x32_bf16 v[96:99], v[180:183], v[144:147], v[96:99]
    ds_read_b128 v[168:171], v3 offset:13312
    v_mfma_f32_16x16x32_bf16 v[100:103], v[180:183], v[148:151], v[100:103]
    ds_read_b128 v[172:175], v2 offset:13824
    v_mfma_f32_16x16x32_bf16 v[104:107], v[180:183], v[152:155], v[104:107]
    ds_read_b64_tr_b16 v[196:197], v5 offset:14336
    v_mfma_f32_16x16x32_bf16 v[108:111], v[180:183], v[156:159], v[108:111]
    ds_read_b64_tr_b16 v[198:199], v5 offset:15360
    v_mfma_f32_16x16x32_bf16 v[112:115], v[184:187], v[144:147], v[112:115]
    ds_read_b64_tr_b16 v[200:201], v6 offset:14336
    v_mfma_f32_16x16x32_bf16 v[116:119], v[184:187], v[148:151], v[116:119]
    ds_read_b64_tr_b16 v[202:203], v6 offset:15360
    v_mfma_f32_16x16x32_bf16 v[120:123], v[184:187], v[152:155], v[120:123]
    ds_read_b64_tr_b16 v[204:205], v7 offset:14336
    v_mfma_f32_16x16x32_bf16 v[124:127], v[184:187], v[156:159], v[124:127]
    ds_read_b64_tr_b16 v[206:207], v7 offset:15360
    v_mfma_f32_16x16x32_bf16 v[128:131], v[188:191], v[144:147], v[128:131]
    v_mfma_f32_16x16x32_bf16 v[132:135], v[188:191], v[148:151], v[132:135]
    v_mfma_f32_16x16x32_bf16 v[136:139], v[188:191], v[152:155], v[136:139]
    v_mfma_f32_16x16x32_bf16 v[140:143], v[188:191], v[156:159], v[140:143]
    s_waitcnt lgkmcnt(0)
    s_barrier
    v_mfma_f32_16x16x32_bf16 v[80:83], v[192:195], v[160:163], v[80:83]
    ds_read_b128 v[176:179], v8 offset:0
    ds_read2_b32 v[212:213], v246 offset0:0 offset1:128
    v_mfma_f32_16x16x32_bf16 v[84:87], v[192:195], v[164:167], v[84:87]
    ds_read_b128 v[144:147], v2 offset:0
    ds_read2_b32 v[214:215], v246 offset0:4 offset1:132
    v_mfma_f32_16x16x32_bf16 v[88:91], v[192:195], v[168:171], v[88:91]
    ds_read_b128 v[148:151], v3 offset:512
    ds_read2_b32 v[216:217], v246 offset0:32 offset1:160
    v_mfma_f32_16x16x32_bf16 v[92:95], v[192:195], v[172:175], v[92:95]
    ds_read_b128 v[152:155], v2 offset:1024
    ds_read2_b32 v[218:219], v246 offset0:36 offset1:164
    v_mfma_f32_16x16x32_bf16 v[96:99], v[196:199], v[160:163], v[96:99]
    ds_read_b128 v[156:159], v3 offset:1536
    ds_read_b128 v[220:223], v247 offset:512
    v_mfma_f32_16x16x32_bf16 v[100:103], v[196:199], v[164:167], v[100:103]
    ds_read_b128 v[180:183], v8 offset:1024
    ds_read_b128 v[224:227], v247 offset:576
    v_mfma_f32_16x16x32_bf16 v[104:107], v[196:199], v[168:171], v[104:107]
    ds_read_b128 v[184:187], v8 offset:2048
    ds_read_b128 v[228:231], v247 offset:640
    v_mfma_f32_16x16x32_bf16 v[108:111], v[196:199], v[172:175], v[108:111]
    ds_read_b128 v[188:191], v8 offset:3072
    ds_read_b128 v[232:235], v247 offset:704
    v_mfma_f32_16x16x32_bf16 v[112:115], v[200:203], v[160:163], v[112:115]
    v_mfma_f32_16x16x32_bf16 v[116:119], v[200:203], v[164:167], v[116:119]
    v_mfma_f32_16x16x32_bf16 v[120:123], v[200:203], v[168:171], v[120:123]
    v_mfma_f32_16x16x32_bf16 v[124:127], v[200:203], v[172:175], v[124:127]
    v_mfma_f32_16x16x32_bf16 v[128:131], v[204:207], v[160:163], v[128:131]
    v_mfma_f32_16x16x32_bf16 v[132:135], v[204:207], v[164:167], v[132:135]
    v_mfma_f32_16x16x32_bf16 v[136:139], v[204:207], v[168:171], v[136:139]
    v_mfma_f32_16x16x32_bf16 v[140:143], v[204:207], v[172:175], v[140:143]
    s_waitcnt lgkmcnt(0)
    v_mfma_f32_16x16x32_bf16 v[32:35], v[180:183], v[144:147], v[16:19]
    ds_read_b128 v[192:195], v8 offset:32768
    v_mul_f32 v208, v213, v220
    v_mfma_f32_16x16x32_bf16 v[36:39], v[180:183], v[148:151], v[20:23]
    ds_read_b128 v[160:163], v3 offset:0
    v_mul_f32 v209, v213, v221
    v_mfma_f32_16x16x32_bf16 v[40:43], v[180:183], v[152:155], v[24:27]
    ds_read_b128 v[164:167], v2 offset:512
    v_mul_f32 v210, v213, v222
    v_mfma_f32_16x16x32_bf16 v[44:47], v[180:183], v[156:159], v[28:31]
    ds_read_b128 v[168:171], v3 offset:1024
    v_mul_f32 v211, v213, v223
    v_mfma_f32_16x16x32_bf16 v[48:51], v[184:187], v[144:147], v[16:19]
    ds_read_b128 v[172:175], v2 offset:1536
    v_fma_f32 v80, v80, v212, v208
    v_mfma_f32_16x16x32_bf16 v[52:55], v[184:187], v[148:151], v[20:23]
    ds_read_b128 v[196:199], v8 offset:33792
    v_fma_f32 v81, v81, v212, v209
    v_mfma_f32_16x16x32_bf16 v[56:59], v[184:187], v[152:155], v[24:27]
    ds_read_b128 v[200:203], v8 offset:34816
    v_fma_f32 v82, v82, v212, v210
    v_mfma_f32_16x16x32_bf16 v[60:63], v[184:187], v[156:159], v[28:31]
    ds_read_b128 v[204:207], v8 offset:35840
    v_fma_f32 v83, v83, v212, v211
    v_mfma_f32_16x16x32_bf16 v[64:67], v[188:191], v[144:147], v[16:19]
    v_mul_f32 v208, v80, v80
    v_mul_f32 v209, v81, v81
    v_mfma_f32_16x16x32_bf16 v[68:71], v[188:191], v[148:151], v[20:23]
    v_mul_f32 v210, v82, v82
    v_mul_f32 v211, v83, v83
    v_mfma_f32_16x16x32_bf16 v[72:75], v[188:191], v[152:155], v[24:27]
    v_fmaak_f32 v208, v15, v208, 0xc0135761
    v_fmaak_f32 v209, v15, v209, 0xc0135761
    v_mfma_f32_16x16x32_bf16 v[76:79], v[188:191], v[156:159], v[28:31]
    v_fmaak_f32 v210, v15, v210, 0xc0135761
    v_fmaak_f32 v211, v15, v211, 0xc0135761
    v_mfma_f32_16x16x32_bf16 v[16:19], v[176:179], v[144:147], v[16:19]
    v_mul_f32 v208, v208, v80
    v_mul_f32 v209, v209, v81
    v_mfma_f32_16x16x32_bf16 v[20:23], v[176:179], v[148:151], v[20:23]
    v_exp_f32 v208, v208
    v_mfma_f32_16x16x32_bf16 v[24:27], v[176:179], v[152:155], v[24:27]
    v_exp_f32 v209, v209
    v_mfma_f32_16x16x32_bf16 v[28:31], v[176:179], v[156:159], v[28:31]
    s_waitcnt lgkmcnt(0)
    s_barrier
    v_mfma_f32_16x16x32_bf16 v[16:19], v[192:195], v[160:163], v[16:19]
    ds_read_b128 v[176:179], v8 offset:4096
    v_mul_f32 v210, v210, v82
    v_mfma_f32_16x16x32_bf16 v[20:23], v[192:195], v[164:167], v[20:23]
    ds_read_b128 v[144:147], v2 offset:4096
    v_mul_f32 v211, v211, v83
    v_mfma_f32_16x16x32_bf16 v[24:27], v[192:195], v[168:171], v[24:27]
    ds_read_b128 v[148:151], v3 offset:4608
    v_add_f32 v208, 1.0, v208
    v_mfma_f32_16x16x32_bf16 v[28:31], v[192:195], v[172:175], v[28:31]
    ds_read_b128 v[152:155], v2 offset:5120
    v_add_f32 v209, 1.0, v209
    v_mfma_f32_16x16x32_bf16 v[32:35], v[196:199], v[160:163], v[32:35]
    ds_read_b128 v[156:159], v3 offset:5632
    v_mul_f32 v236, v215, v220
    v_mfma_f32_16x16x32_bf16 v[36:39], v[196:199], v[164:167], v[36:39]
    ds_read_b128 v[180:183], v8 offset:5120
    v_mul_f32 v237, v215, v221
    v_mfma_f32_16x16x32_bf16 v[40:43], v[196:199], v[168:171], v[40:43]
    ds_read_b128 v[184:187], v8 offset:6144
    v_mul_f32 v238, v215, v222
    v_mfma_f32_16x16x32_bf16 v[44:47], v[196:199], v[172:175], v[44:47]
    ds_read_b128 v[188:191], v8 offset:7168
    v_mul_f32 v239, v215, v223
    v_mfma_f32_16x16x32_bf16 v[48:51], v[200:203], v[160:163], v[48:51]
    v_exp_f32 v210, v210
    v_mfma_f32_16x16x32_bf16 v[52:55], v[200:203], v[164:167], v[52:55]
    s_bitcmp1_b32 s37, 0
    s_cbranch_scc1 mega_kernel_pf0
mega_kernel_pb0:
    v_mfma_f32_16x16x32_bf16 v[56:59], v[200:203], v[168:171], v[56:59]
    v_exp_f32 v211, v211
    v_mfma_f32_16x16x32_bf16 v[60:63], v[200:203], v[172:175], v[60:63]
    v_rcp_f32 v208, v208
    v_mfma_f32_16x16x32_bf16 v[64:67], v[204:207], v[160:163], v[64:67]
    v_rcp_f32 v209, v209
    v_mfma_f32_16x16x32_bf16 v[68:71], v[204:207], v[164:167], v[68:71]
    v_add_f32 v210, 1.0, v210
    v_add_f32 v211, 1.0, v211
    v_mfma_f32_16x16x32_bf16 v[72:75], v[204:207], v[168:171], v[72:75]
    v_rcp_f32 v210, v210
    v_mfma_f32_16x16x32_bf16 v[76:79], v[204:207], v[172:175], v[76:79]
    v_mul_f32 v80, v80, v208
    s_waitcnt lgkmcnt(0)
    v_mfma_f32_16x16x32_bf16 v[16:19], v[176:179], v[144:147], v[16:19]
    ds_read_b128 v[192:195], v8 offset:36864
    v_mul_f32 v81, v81, v209
    v_mfma_f32_16x16x32_bf16 v[20:23], v[176:179], v[148:151], v[20:23]
    ds_read_b128 v[160:163], v3 offset:4096
    v_mul_f32 v82, v82, v210
    v_mfma_f32_16x16x32_bf16 v[24:27], v[176:179], v[152:155], v[24:27]
    ds_read_b128 v[164:167], v2 offset:4608
    v_fma_f32 v84, v84, v214, v236
    v_mfma_f32_16x16x32_bf16 v[28:31], v[176:179], v[156:159], v[28:31]
    ds_read_b128 v[168:171], v3 offset:5120
    v_fma_f32 v85, v85, v214, v237
    v_mfma_f32_16x16x32_bf16 v[32:35], v[180:183], v[144:147], v[32:35]
    ds_read_b128 v[172:175], v2 offset:5632
    v_fma_f32 v86, v86, v214, v238
    v_mfma_f32_16x16x32_bf16 v[36:39], v[180:183], v[148:151], v[36:39]
    ds_read_b128 v[196:199], v8 offset:37888
    v_fma_f32 v87, v87, v214, v239
    v_mfma_f32_16x16x32_bf16 v[40:43], v[180:183], v[152:155], v[40:43]
    ds_read_b128 v[200:203], v8 offset:38912
    v_mul_f32 v236, v84, v84
    v_mfma_f32_16x16x32_bf16 v[44:47], v[180:183], v[156:159], v[44:47]
    ds_read_b128 v[204:207], v8 offset:39936
    v_mul_f32 v237, v85, v85
    v_mfma_f32_16x16x32_bf16 v[48:51], v[184:187], v[144:147], v[48:51]
    v_rcp_f32 v211, v211
    v_mfma_f32_16x16x32_bf16 v[52:55], v[184:187], v[148:151], v[52:55]
    v_mul_f32 v238, v86, v86
    v_mul_f32 v239, v87, v87
    v_mfma_f32_16x16x32_bf16 v[56:59], v[184:187], v[152:155], v[56:59]
    v_mul_f32 v83, v83, v211
    v_fmaak_f32 v236, v15, v236, 0xc0135761
    v_mfma_f32_16x16x32_bf16 v[60:63], v[184:187], v[156:159], v[60:63]
    v_fmaak_f32 v237, v15, v237, 0xc0135761
    v_fmaak_f32 v238, v15, v238, 0xc0135761
    v_mfma_f32_16x16x32_bf16 v[64:67], v[188:191], v[144:147], v[64:67]
    v_fmaak_f32 v239, v15, v239, 0xc0135761
    v_mul_f32 v236, v236, v84
    v_mfma_f32_16x16x32_bf16 v[68:71], v[188:191], v[148:151], v[68:71]
    v_exp_f32 v236, v236
    v_mfma_f32_16x16x32_bf16 v[72:75], v[188:191], v[152:155], v[72:75]
    v_mul_f32 v237, v237, v85
    v_mul_f32 v238, v238, v86
    v_mfma_f32_16x16x32_bf16 v[76:79], v[188:191], v[156:159], v[76:79]
    s_waitcnt lgkmcnt(0)
    s_barrier
    v_mfma_f32_16x16x32_bf16 v[16:19], v[192:195], v[160:163], v[16:19]
    ds_read_b128 v[176:179], v8 offset:8192
    v_mul_f32 v239, v239, v87
    v_mfma_f32_16x16x32_bf16 v[20:23], v[192:195], v[164:167], v[20:23]
    ds_read_b128 v[144:147], v2 offset:8192
    v_add_f32 v236, 1.0, v236
    v_mfma_f32_16x16x32_bf16 v[24:27], v[192:195], v[168:171], v[24:27]
    ds_read_b128 v[148:151], v3 offset:8704
    v_mul_f32 v240, v217, v220
    v_mfma_f32_16x16x32_bf16 v[28:31], v[192:195], v[172:175], v[28:31]
    ds_read_b128 v[152:155], v2 offset:9216
    v_mul_f32 v241, v217, v221
    v_mfma_f32_16x16x32_bf16 v[32:35], v[196:199], v[160:163], v[32:35]
    ds_read_b128 v[156:159], v3 offset:9728
    v_mul_f32 v242, v217, v222
    v_mfma_f32_16x16x32_bf16 v[36:39], v[196:199], v[164:167], v[36:39]
    ds_read_b128 v[180:183], v8 offset:9216
    v_mul_f32 v243, v217, v223
    v_mfma_f32_16x16x32_bf16 v[40:43], v[196:199], v[168:171], v[40:43]
    ds_read_b128 v[184:187], v8 offset:10240
    v_fma_f32 v88, v88, v216, v240
    v_mfma_f32_16x16x32_bf16 v[44:47], v[196:199], v[172:175], v[44:47]
    ds_read_b128 v[188:191], v8 offset:11264
    v_fma_f32 v89, v89, v216, v241
    v_mfma_f32_16x16x32_bf16 v[48:51], v[200:203], v[160:163], v[48:51]
    v_exp_f32 v237, v237
    v_mfma_f32_16x16x32_bf16 v[52:55], v[200:203], v[164:167], v[52:55]
    s_bitcmp1_b32 s37, 1
    s_cbranch_scc1 mega_kernel_pf1
mega_kernel_pb1:
    v_mfma_f32_16x16x32_bf16 v[56:59], v[200:203], v[168:171], v[56:59]
    v_exp_f32 v238, v238
    v_mfma_f32_16x16x32_bf16 v[60:63], v[200:203], v[172:175], v[60:63]
    v_exp_f32 v239, v239
    v_mfma_f32_16x16x32_bf16 v[64:67], v[204:207], v[160:163], v[64:67]
    v_rcp_f32 v236, v236
    v_mfma_f32_16x16x32_bf16 v[68:71], v[204:207], v[164:167], v[68:71]
    v_add_f32 v237, 1.0, v237
    v_add_f32 v238, 1.0, v238
    v_mfma_f32_16x16x32_bf16 v[72:75], v[204:207], v[168:171], v[72:75]
    v_rcp_f32 v237, v237
    v_mfma_f32_16x16x32_bf16 v[76:79], v[204:207], v[172:175], v[76:79]
    v_add_f32 v239, 1.0, v239
    s_waitcnt lgkmcnt(0)
    v_mfma_f32_16x16x32_bf16 v[16:19], v[176:179], v[144:147], v[16:19]
    ds_read_b128 v[192:195], v8 offset:40960
    v_mul_f32 v84, v84, v236
    v_mfma_f32_16x16x32_bf16 v[20:23], v[176:179], v[148:151], v[20:23]
    ds_read_b128 v[160:163], v3 offset:8192
    v_mul_f32 v85, v85, v237
    v_mfma_f32_16x16x32_bf16 v[24:27], v[176:179], v[152:155], v[24:27]
    ds_read_b128 v[164:167], v2 offset:8704
    v_fma_f32 v90, v90, v216, v242
    v_mfma_f32_16x16x32_bf16 v[28:31], v[176:179], v[156:159], v[28:31]
    ds_read_b128 v[168:171], v3 offset:9216
    v_fma_f32 v91, v91, v216, v243
    v_mfma_f32_16x16x32_bf16 v[32:35], v[180:183], v[144:147], v[32:35]
    ds_read_b128 v[172:175], v2 offset:9728
    v_mul_f32 v240, v88, v88
    v_mfma_f32_16x16x32_bf16 v[36:39], v[180:183], v[148:151], v[36:39]
    ds_read_b128 v[196:199], v8 offset:41984
    v_mul_f32 v241, v89, v89
    v_mfma_f32_16x16x32_bf16 v[40:43], v[180:183], v[152:155], v[40:43]
    ds_read_b128 v[200:203], v8 offset:43008
    v_mul_f32 v242, v90, v90
    v_mfma_f32_16x16x32_bf16 v[44:47], v[180:183], v[156:159], v[44:47]
    ds_read_b128 v[204:207], v8 offset:44032
    v_mul_f32 v243, v91, v91
    v_mfma_f32_16x16x32_bf16 v[48:51], v[184:187], v[144:147], v[48:51]
    v_rcp_f32 v238, v238
    v_mfma_f32_16x16x32_bf16 v[52:55], v[184:187], v[148:151], v[52:55]
    v_rcp_f32 v239, v239
    v_mfma_f32_16x16x32_bf16 v[56:59], v[184:187], v[152:155], v[56:59]
    v_mul_f32 v86, v86, v238
    v_fmaak_f32 v240, v15, v240, 0xc0135761
    v_mfma_f32_16x16x32_bf16 v[60:63], v[184:187], v[156:159], v[60:63]
    v_mul_f32 v87, v87, v239
    v_fmaak_f32 v241, v15, v241, 0xc0135761
    v_mfma_f32_16x16x32_bf16 v[64:67], v[188:191], v[144:147], v[64:67]
    v_fmaak_f32 v242, v15, v242, 0xc0135761
    v_fmaak_f32 v243, v15, v243, 0xc0135761
    v_mfma_f32_16x16x32_bf16 v[68:71], v[188:191], v[148:151], v[68:71]
    v_mul_f32 v240, v240, v88
    v_mul_f32 v241, v241, v89
    v_mfma_f32_16x16x32_bf16 v[72:75], v[188:191], v[152:155], v[72:75]
    v_exp_f32 v240, v240
    v_mfma_f32_16x16x32_bf16 v[76:79], v[188:191], v[156:159], v[76:79]
    s_waitcnt lgkmcnt(0)
    s_barrier
    v_mfma_f32_16x16x32_bf16 v[16:19], v[192:195], v[160:163], v[16:19]
    ds_read_b128 v[176:179], v8 offset:12288
    v_mul_f32 v242, v242, v90
    v_mfma_f32_16x16x32_bf16 v[20:23], v[192:195], v[164:167], v[20:23]
    ds_read_b128 v[144:147], v2 offset:12288
    v_mul_f32 v243, v243, v91
    v_mfma_f32_16x16x32_bf16 v[24:27], v[192:195], v[168:171], v[24:27]
    ds_read_b128 v[148:151], v3 offset:12800
    v_add_f32 v240, 1.0, v240
    v_mfma_f32_16x16x32_bf16 v[28:31], v[192:195], v[172:175], v[28:31]
    ds_read_b128 v[152:155], v2 offset:13312
    v_mul_f32 v208, v219, v220
    v_mfma_f32_16x16x32_bf16 v[32:35], v[196:199], v[160:163], v[32:35]
    ds_read_b128 v[156:159], v3 offset:13824
    v_mul_f32 v209, v219, v221
    v_mfma_f32_16x16x32_bf16 v[36:39], v[196:199], v[164:167], v[36:39]
    ds_read_b128 v[180:183], v8 offset:13312
    v_mul_f32 v210, v219, v222
    v_mfma_f32_16x16x32_bf16 v[40:43], v[196:199], v[168:171], v[40:43]
    ds_read_b128 v[184:187], v8 offset:14336
    v_mul_f32 v211, v219, v223
    v_mfma_f32_16x16x32_bf16 v[44:47], v[196:199], v[172:175], v[44:47]
    ds_read_b128 v[188:191], v8 offset:15360
    v_fma_f32 v92, v92, v218, v208
    v_mfma_f32_16x16x32_bf16 v[48:51], v[200:203], v[160:163], v[48:51]
    v_exp_f32 v241, v241
    v_mfma_f32_16x16x32_bf16 v[52:55], v[200:203], v[164:167], v[52:55]
    s_bitcmp1_b32 s37, 2
    s_cbranch_scc1 mega_kernel_pf2
mega_kernel_pb2:
    v_mfma_f32_16x16x32_bf16 v[56:59], v[200:203], v[168:171], v[56:59]
    v_exp_f32 v242, v242
    v_mfma_f32_16x16x32_bf16 v[60:63], v[200:203], v[172:175], v[60:63]
    v_exp_f32 v243, v243
    v_mfma_f32_16x16x32_bf16 v[64:67], v[204:207], v[160:163], v[64:67]
    v_rcp_f32 v240, v240
    v_mfma_f32_16x16x32_bf16 v[68:71], v[204:207], v[164:167], v[68:71]
    v_add_f32 v241, 1.0, v241
    v_add_f32 v242, 1.0, v242
    v_mfma_f32_16x16x32_bf16 v[72:75], v[204:207], v[168:171], v[72:75]
    v_rcp_f32 v241, v241
    v_mfma_f32_16x16x32_bf16 v[76:79], v[204:207], v[172:175], v[76:79]
    v_add_f32 v243, 1.0, v243
    s_waitcnt lgkmcnt(0)
    v_mfma_f32_16x16x32_bf16 v[16:19], v[176:179], v[144:147], v[16:19]
    ds_read_b128 v[192:195], v8 offset:45056
    v_mul_f32 v88, v88, v240
    v_mfma_f32_16x16x32_bf16 v[20:23], v[176:179], v[148:151], v[20:23]
    ds_read_b128 v[160:163], v3 offset:12288
    v_mul_f32 v89, v89, v241
    v_mfma_f32_16x16x32_bf16 v[24:27], v[176:179], v[152:155], v[24:27]
    ds_read_b128 v[164:167], v2 offset:12800
    v_fma_f32 v93, v93, v218, v209
    v_mfma_f32_16x16x32_bf16 v[28:31], v[176:179], v[156:159], v[28:31]
    ds_read_b128 v[168:171], v3 offset:13312
    v_fma_f32 v94, v94, v218, v210
    v_mfma_f32_16x16x32_bf16 v[32:35], v[180:183], v[144:147], v[32:35]
    ds_read_b128 v[172:175], v2 offset:13824
    v_fma_f32 v95, v95, v218, v211
    v_mfma_f32_16x16x32_bf16 v[36:39], v[180:183], v[148:151], v[36:39]
    ds_read_b128 v[196:199], v8 offset:46080
    v_mul_f32 v208, v92, v92
    v_mfma_f32_16x16x32_bf16 v[40:43], v[180:183], v[152:155], v[40:43]
    ds_read_b128 v[200:203], v8 offset:47104
    v_mul_f32 v209, v93, v93
    v_mfma_f32_16x16x32_bf16 v[44:47], v[180:183], v[156:159], v[44:47]
    ds_read_b128 v[204:207], v8 offset:48128
    v_mul_f32 v210, v94, v94
    v_mfma_f32_16x16x32_bf16 v[48:51], v[184:187], v[144:147], v[48:51]
    v_rcp_f32 v242, v242
    v_mfma_f32_16x16x32_bf16 v[52:55], v[184:187], v[148:151], v[52:55]
    v_rcp_f32 v243, v243
    v_mfma_f32_16x16x32_bf16 v[56:59], v[184:187], v[152:155], v[56:59]
    v_mul_f32 v90, v90, v242
    v_mul_f32 v211, v95, v95
    v_mfma_f32_16x16x32_bf16 v[60:63], v[184:187], v[156:159], v[60:63]
    v_mul_f32 v91, v91, v243
    v_fmaak_f32 v208, v15, v208, 0xc0135761
    v_mfma_f32_16x16x32_bf16 v[64:67], v[188:191], v[144:147], v[64:67]
    v_fmaak_f32 v209, v15, v209, 0xc0135761
    v_fmaak_f32 v210, v15, v210, 0xc0135761
    v_mfma_f32_16x16x32_bf16 v[68:71], v[188:191], v[148:151], v[68:71]
    v_fmaak_f32 v211, v15, v211, 0xc0135761
    v_mul_f32 v208, v208, v92
    v_mfma_f32_16x16x32_bf16 v[72:75], v[188:191], v[152:155], v[72:75]
    v_exp_f32 v208, v208
    v_mfma_f32_16x16x32_bf16 v[76:79], v[188:191], v[156:159], v[76:79]
    s_waitcnt lgkmcnt(0)
    s_barrier
    v_mfma_f32_16x16x32_bf16 v[16:19], v[192:195], v[160:163], v[16:19]
    ds_read_b128 v[176:179], v8 offset:0
    v_mul_f32 v209, v209, v93
    v_mfma_f32_16x16x32_bf16 v[20:23], v[192:195], v[164:167], v[20:23]
    ds_read_b128 v[144:147], v2 offset:0
    v_mul_f32 v210, v210, v94
    v_mfma_f32_16x16x32_bf16 v[24:27], v[192:195], v[168:171], v[24:27]
    ds_read_b128 v[148:151], v3 offset:512
    v_mul_f32 v211, v211, v95
    v_mfma_f32_16x16x32_bf16 v[28:31], v[192:195], v[172:175], v[28:31]
    ds_read_b128 v[152:155], v2 offset:1024
    v_add_f32 v208, 1.0, v208
    v_mfma_f32_16x16x32_bf16 v[32:35], v[196:199], v[160:163], v[32:35]
    ds_read_b128 v[156:159], v3 offset:1536
    v_mul_f32 v236, v213, v224
    v_mfma_f32_16x16x32_bf16 v[36:39], v[196:199], v[164:167], v[36:39]
    ds_read_b128 v[180:183], v8 offset:1024
    v_mul_f32 v237, v213, v225
    v_mfma_f32_16x16x32_bf16 v[40:43], v[196:199], v[168:171], v[40:43]
    ds_read_b128 v[184:187], v8 offset:2048
    v_mul_f32 v238, v213, v226
    v_mfma_f32_16x16x32_bf16 v[44:47], v[196:199], v[172:175], v[44:47]
    ds_read_b128 v[188:191], v8 offset:3072
    v_mul_f32 v239, v213, v227
    v_mfma_f32_16x16x32_bf16 v[48:51], v[200:203], v[160:163], v[48:51]
    v_exp_f32 v209, v209
    v_mfma_f32_16x16x32_bf16 v[52:55], v[200:203], v[164:167], v[52:55]
    s_bitcmp1_b32 s37, 3
    s_cbranch_scc1 mega_kernel_pf3
mega_kernel_pb3:
    v_mfma_f32_16x16x32_bf16 v[56:59], v[200:203], v[168:171], v[56:59]
    v_exp_f32 v210, v210
    v_mfma_f32_16x16x32_bf16 v[60:63], v[200:203], v[172:175], v[60:63]
    v_exp_f32 v211, v211
    v_mfma_f32_16x16x32_bf16 v[64:67], v[204:207], v[160:163], v[64:67]
    v_rcp_f32 v208, v208
    v_mfma_f32_16x16x32_bf16 v[68:71], v[204:207], v[164:167], v[68:71]
    v_add_f32 v209, 1.0, v209
    v_add_f32 v210, 1.0, v210
    v_mfma_f32_16x16x32_bf16 v[72:75], v[204:207], v[168:171], v[72:75]
    v_rcp_f32 v209, v209
    v_mfma_f32_16x16x32_bf16 v[76:79], v[204:207], v[172:175], v[76:79]
    v_add_f32 v211, 1.0, v211
    s_waitcnt lgkmcnt(0)
    v_mfma_f32_16x16x32_bf16 v[16:19], v[176:179], v[144:147], v[16:19]
    ds_read_b128 v[192:195], v8 offset:32768
    v_mul_f32 v92, v92, v208
    v_mfma_f32_16x16x32_bf16 v[20:23], v[176:179], v[148:151], v[20:23]
    ds_read_b128 v[160:163], v3 offset:0
    v_mul_f32 v93, v93, v209
    v_mfma_f32_16x16x32_bf16 v[24:27], v[176:179], v[152:155], v[24:27]
    ds_read_b128 v[164:167], v2 offset:512
    v_fma_f32 v96, v96, v212, v236
    v_mfma_f32_16x16x32_bf16 v[28:31], v[176:179], v[156:159], v[28:31]
    ds_read_b128 v[168:171], v3 offset:1024
    v_fma_f32 v97, v97, v212, v237
    v_mfma_f32_16x16x32_bf16 v[32:35], v[180:183], v[144:147], v[32:35]
    ds_read_b128 v[172:175], v2 offset:1536
    v_fma_f32 v98, v98, v212, v238
    v_mfma_f32_16x16x32_bf16 v[36:39], v[180:183], v[148:151], v[36:39]
    ds_read_b128 v[196:199], v8 offset:33792
    v_fma_f32 v99, v99, v212, v239
    v_mfma_f32_16x16x32_bf16 v[40:43], v[180:183], v[152:155], v[40:43]
    ds_read_b128 v[200:203], v8 offset:34816
    v_mul_f32 v236, v96, v96
    v_mfma_f32_16x16x32_bf16 v[44:47], v[180:183], v[156:159], v[44:47]
    ds_read_b128 v[204:207], v8 offset:35840
    v_mul_f32 v237, v97, v97
    v_mfma_f32_16x16x32_bf16 v[48:51], v[184:187], v[144:147], v[48:51]
    v_rcp_f32 v210, v210
    v_mfma_f32_16x16x32_bf16 v[52:55], v[184:187], v[148:151], v[52:55]
    v_rcp_f32 v211, v211
    v_mfma_f32_16x16x32_bf16 v[56:59], v[184:187], v[152:155], v[56:59]
    v_mul_f32 v94, v94, v210
    v_mul_f32 v238, v98, v98
    v_mfma_f32_16x16x32_bf16 v[60:63], v[184:187], v[156:159], v[60:63]
    v_mul_f32 v95, v95, v211
    v_mul_f32 v239, v99, v99
    v_mfma_f32_16x16x32_bf16 v[64:67], v[188:191], v[144:147], v[64:67]
    v_fmaak_f32 v236, v15, v236, 0xc0135761
    v_fmaak_f32 v237, v15, v237, 0xc0135761
    v_mfma_f32_16x16x32_bf16 v[68:71], v[188:191], v[148:151], v[68:71]
    v_fmaak_f32 v238, v15, v238, 0xc0135761
    v_fmaak_f32 v239, v15, v239, 0xc0135761
    v_mfma_f32_16x16x32_bf16 v[72:75], v[188:191], v[152:155], v[72:75]
    v_mul_f32 v236, v236, v96
    v_mul_f32 v237, v237, v97
    v_mfma_f32_16x16x32_bf16 v[76:79], v[188:191], v[156:159], v[76:79]
    s_waitcnt lgkmcnt(0)
    s_barrier
    v_mfma_f32_16x16x32_bf16 v[16:19], v[192:195], v[160:163], v[16:19]
    ds_read_b128 v[176:179], v8 offset:4096
    v_mul_f32 v238, v238, v98
    v_mfma_f32_16x16x32_bf16 v[20:23], v[192:195], v[164:167], v[20:23]
    ds_read_b128 v[144:147], v2 offset:4096
    v_mul_f32 v239, v239, v99
    v_mfma_f32_16x16x32_bf16 v[24:27], v[192:195], v[168:171], v[24:27]
    ds_read_b128 v[148:151], v3 offset:4608
    v_mul_f32 v240, v215, v224
    v_mfma_f32_16x16x32_bf16 v[28:31], v[192:195], v[172:175], v[28:31]
    ds_read_b128 v[152:155], v2 offset:5120
    v_mul_f32 v241, v215, v225
    v_mfma_f32_16x16x32_bf16 v[32:35], v[196:199], v[160:163], v[32:35]
    ds_read_b128 v[156:159], v3 offset:5632
    v_mul_f32 v242, v215, v226
    v_mfma_f32_16x16x32_bf16 v[36:39], v[196:199], v[164:167], v[36:39]
    ds_read_b128 v[180:183], v8 offset:5120
    v_mul_f32 v243, v215, v227
    v_mfma_f32_16x16x32_bf16 v[40:43], v[196:199], v[168:171], v[40:43]
    ds_read_b128 v[184:187], v8 offset:6144
    v_fma_f32 v100, v100, v214, v240
    v_mfma_f32_16x16x32_bf16 v[44:47], v[196:199], v[172:175], v[44:47]
    ds_read_b128 v[188:191], v8 offset:7168
    v_fma_f32 v101, v101, v214, v241
    v_mfma_f32_16x16x32_bf16 v[48:51], v[200:203], v[160:163], v[48:51]
    v_exp_f32 v236, v236
    v_mfma_f32_16x16x32_bf16 v[52:55], v[200:203], v[164:167], v[52:55]
    s_bitcmp1_b32 s37, 4
    s_cbranch_scc1 mega_kernel_pf4
mega_kernel_pb4:
    v_mfma_f32_16x16x32_bf16 v[56:59], v[200:203], v[168:171], v[56:59]
    v_exp_f32 v237, v237
    v_mfma_f32_16x16x32_bf16 v[60:63], v[200:203], v[172:175], v[60:63]
    v_exp_f32 v238, v238
    v_mfma_f32_16x16x32_bf16 v[64:67], v[204:207], v[160:163], v[64:67]
    v_exp_f32 v239, v239
    v_mfma_f32_16x16x32_bf16 v[68:71], v[204:207], v[164:167], v[68:71]
    v_add_f32 v236, 1.0, v236
    v_add_f32 v237, 1.0, v237
    v_mfma_f32_16x16x32_bf16 v[72:75], v[204:207], v[168:171], v[72:75]
    v_rcp_f32 v236, v236
    v_mfma_f32_16x16x32_bf16 v[76:79], v[204:207], v[172:175], v[76:79]
    v_add_f32 v238, 1.0, v238
    s_waitcnt lgkmcnt(0)
    v_mfma_f32_16x16x32_bf16 v[16:19], v[176:179], v[144:147], v[16:19]
    ds_read_b128 v[192:195], v8 offset:36864
    v_add_f32 v239, 1.0, v239
    v_mfma_f32_16x16x32_bf16 v[20:23], v[176:179], v[148:151], v[20:23]
    ds_read_b128 v[160:163], v3 offset:4096
    v_mul_f32 v96, v96, v236
    v_mfma_f32_16x16x32_bf16 v[24:27], v[176:179], v[152:155], v[24:27]
    ds_read_b128 v[164:167], v2 offset:4608
    v_fma_f32 v102, v102, v214, v242
    v_mfma_f32_16x16x32_bf16 v[28:31], v[176:179], v[156:159], v[28:31]
    ds_read_b128 v[168:171], v3 offset:5120
    v_fma_f32 v103, v103, v214, v243
    v_mfma_f32_16x16x32_bf16 v[32:35], v[180:183], v[144:147], v[32:35]
    ds_read_b128 v[172:175], v2 offset:5632
    v_mul_f32 v240, v100, v100
    v_mfma_f32_16x16x32_bf16 v[36:39], v[180:183], v[148:151], v[36:39]
    ds_read_b128 v[196:199], v8 offset:37888
    v_mul_f32 v241, v101, v101
    v_mfma_f32_16x16x32_bf16 v[40:43], v[180:183], v[152:155], v[40:43]
    ds_read_b128 v[200:203], v8 offset:38912
    v_mul_f32 v242, v102, v102
    v_mfma_f32_16x16x32_bf16 v[44:47], v[180:183], v[156:159], v[44:47]
    ds_read_b128 v[204:207], v8 offset:39936
    v_mul_f32 v243, v103, v103
    v_mfma_f32_16x16x32_bf16 v[48:51], v[184:187], v[144:147], v[48:51]
    v_rcp_f32 v237, v237
    v_mfma_f32_16x16x32_bf16 v[52:55], v[184:187], v[148:151], v[52:55]
    v_rcp_f32 v238, v238
    v_mfma_f32_16x16x32_bf16 v[56:59], v[184:187], v[152:155], v[56:59]
    v_rcp_f32 v239, v239
    v_mfma_f32_16x16x32_bf16 v[60:63], v[184:187], v[156:159], v[60:63]
    v_mul_f32 v97, v97, v237
    v_mul_f32 v98, v98, v238
    v_mfma_f32_16x16x32_bf16 v[64:67], v[188:191], v[144:147], v[64:67]
    v_mul_f32 v99, v99, v239
    v_fmaak_f32 v240, v15, v240, 0xc0135761
    v_mfma_f32_16x16x32_bf16 v[68:71], v[188:191], v[148:151], v[68:71]
    v_fmaak_f32 v241, v15, v241, 0xc0135761
    v_fmaak_f32 v242, v15, v242, 0xc0135761
    v_mfma_f32_16x16x32_bf16 v[72:75], v[188:191], v[152:155], v[72:75]
    v_fmaak_f32 v243, v15, v243, 0xc0135761
    v_mul_f32 v240, v240, v100
    v_mfma_f32_16x16x32_bf16 v[76:79], v[188:191], v[156:159], v[76:79]
    s_waitcnt lgkmcnt(0)
    s_barrier
    v_mfma_f32_16x16x32_bf16 v[16:19], v[192:195], v[160:163], v[16:19]
    ds_read_b128 v[176:179], v8 offset:8192
    v_mul_f32 v241, v241, v101
    v_mfma_f32_16x16x32_bf16 v[20:23], v[192:195], v[164:167], v[20:23]
    ds_read_b128 v[144:147], v2 offset:8192
    v_mul_f32 v242, v242, v102
    v_mfma_f32_16x16x32_bf16 v[24:27], v[192:195], v[168:171], v[24:27]
    ds_read_b128 v[148:151], v3 offset:8704
    v_mul_f32 v243, v243, v103
    v_mfma_f32_16x16x32_bf16 v[28:31], v[192:195], v[172:175], v[28:31]
    ds_read_b128 v[152:155], v2 offset:9216
    v_mul_f32 v208, v217, v224
    v_mfma_f32_16x16x32_bf16 v[32:35], v[196:199], v[160:163], v[32:35]
    ds_read_b128 v[156:159], v3 offset:9728
    v_mul_f32 v209, v217, v225
    v_mfma_f32_16x16x32_bf16 v[36:39], v[196:199], v[164:167], v[36:39]
    ds_read_b128 v[180:183], v8 offset:9216
    v_mul_f32 v210, v217, v226
    v_mfma_f32_16x16x32_bf16 v[40:43], v[196:199], v[168:171], v[40:43]
    ds_read_b128 v[184:187], v8 offset:10240
    v_mul_f32 v211, v217, v227
    v_mfma_f32_16x16x32_bf16 v[44:47], v[196:199], v[172:175], v[44:47]
    ds_read_b128 v[188:191], v8 offset:11264
    v_fma_f32 v104, v104, v216, v208
    v_mfma_f32_16x16x32_bf16 v[48:51], v[200:203], v[160:163], v[48:51]
    v_exp_f32 v240, v240
    v_mfma_f32_16x16x32_bf16 v[52:55], v[200:203], v[164:167], v[52:55]
    s_bitcmp1_b32 s37, 5
    s_cbranch_scc1 mega_kernel_pf5
mega_kernel_pb5:
    v_mfma_f32_16x16x32_bf16 v[56:59], v[200:203], v[168:171], v[56:59]
    v_exp_f32 v241, v241
    v_mfma_f32_16x16x32_bf16 v[60:63], v[200:203], v[172:175], v[60:63]
    v_exp_f32 v242, v242
    v_mfma_f32_16x16x32_bf16 v[64:67], v[204:207], v[160:163], v[64:67]
    v_exp_f32 v243, v243
    v_mfma_f32_16x16x32_bf16 v[68:71], v[204:207], v[164:167], v[68:71]
    v_add_f32 v240, 1.0, v240
    v_add_f32 v241, 1.0, v241
    v_mfma_f32_16x16x32_bf16 v[72:75], v[204:207], v[168:171], v[72:75]
    v_rcp_f32 v240, v240
    v_mfma_f32_16x16x32_bf16 v[76:79], v[204:207], v[172:175], v[76:79]
    v_add_f32 v242, 1.0, v242
    s_waitcnt lgkmcnt(0)
    v_mfma_f32_16x16x32_bf16 v[16:19], v[176:179], v[144:147], v[16:19]
    ds_read_b128 v[192:195], v8 offset:40960
    v_add_f32 v243, 1.0, v243
    v_mfma_f32_16x16x32_bf16 v[20:23], v[176:179], v[148:151], v[20:23]
    ds_read_b128 v[160:163], v3 offset:8192
    v_mul_f32 v100, v100, v240
    v_mfma_f32_16x16x32_bf16 v[24:27], v[176:179], v[152:155], v[24:27]
    ds_read_b128 v[164:167], v2 offset:8704
    v_fma_f32 v105, v105, v216, v209
    v_mfma_f32_16x16x32_bf16 v[28:31], v[176:179], v[156:159], v[28:31]
    ds_read_b128 v[168:171], v3 offset:9216
    v_fma_f32 v106, v106, v216, v210
    v_mfma_f32_16x16x32_bf16 v[32:35], v[180:183], v[144:147], v[32:35]
    ds_read_b128 v[172:175], v2 offset:9728
    v_fma_f32 v107, v107, v216, v211
    v_mfma_f32_16x16x32_bf16 v[36:39], v[180:183], v[148:151], v[36:39]
    ds_read_b128 v[196:199], v8 offset:41984
    v_mul_f32 v208, v104, v104
    v_mfma_f32_16x16x32_bf16 v[40:43], v[180:183], v[152:155], v[40:43]
    ds_read_b128 v[200:203], v8 offset:43008
    v_mul_f32 v209, v105, v105
    v_mfma_f32_16x16x32_bf16 v[44:47], v[180:183], v[156:159], v[44:47]
    ds_read_b128 v[204:207], v8 offset:44032
    v_mul_f32 v210, v106, v106
    v_mfma_f32_16x16x32_bf16 v[48:51], v[184:187], v[144:147], v[48:51]
    v_rcp_f32 v241, v241
    v_mfma_f32_16x16x32_bf16 v[52:55], v[184:187], v[148:151], v[52:55]
    v_rcp_f32 v242, v242
    v_mfma_f32_16x16x32_bf16 v[56:59], v[184:187], v[152:155], v[56:59]
    v_rcp_f32 v243, v243
    v_mfma_f32_16x16x32_bf16 v[60:63], v[184:187], v[156:159], v[60:63]
    v_mul_f32 v101, v101, v241
    v_mul_f32 v102, v102, v242
    v_mfma_f32_16x16x32_bf16 v[64:67], v[188:191], v[144:147], v[64:67]
    v_mul_f32 v103, v103, v243
    v_mul_f32 v211, v107, v107
    v_mfma_f32_16x16x32_bf16 v[68:71], v[188:191], v[148:151], v[68:71]
    v_fmaak_f32 v208, v15, v208, 0xc0135761
    v_fmaak_f32 v209, v15, v209, 0xc0135761
    v_mfma_f32_16x16x32_bf16 v[72:75], v[188:191], v[152:155], v[72:75]
    v_fmaak_f32 v210, v15, v210, 0xc0135761
    v_fmaak_f32 v211, v15, v211, 0xc0135761
    v_mfma_f32_16x16x32_bf16 v[76:79], v[188:191], v[156:159], v[76:79]
    s_waitcnt lgkmcnt(0)
    s_barrier
    v_mfma_f32_16x16x32_bf16 v[16:19], v[192:195], v[160:163], v[16:19]
    ds_read_b128 v[176:179], v8 offset:12288
    v_mul_f32 v208, v208, v104
    v_mfma_f32_16x16x32_bf16 v[20:23], v[192:195], v[164:167], v[20:23]
    ds_read_b128 v[144:147], v2 offset:12288
    v_mul_f32 v209, v209, v105
    v_mfma_f32_16x16x32_bf16 v[24:27], v[192:195], v[168:171], v[24:27]
    ds_read_b128 v[148:151], v3 offset:12800
    v_mul_f32 v210, v210, v106
    v_mfma_f32_16x16x32_bf16 v[28:31], v[192:195], v[172:175], v[28:31]
    ds_read_b128 v[152:155], v2 offset:13312
    v_mul_f32 v211, v211, v107
    v_mfma_f32_16x16x32_bf16 v[32:35], v[196:199], v[160:163], v[32:35]
    ds_read_b128 v[156:159], v3 offset:13824
    v_mul_f32 v236, v219, v224
    v_mfma_f32_16x16x32_bf16 v[36:39], v[196:199], v[164:167], v[36:39]
    ds_read_b128 v[180:183], v8 offset:13312
    v_mul_f32 v237, v219, v225
    v_mfma_f32_16x16x32_bf16 v[40:43], v[196:199], v[168:171], v[40:43]
    ds_read_b128 v[184:187], v8 offset:14336
    v_mul_f32 v238, v219, v226
    v_mfma_f32_16x16x32_bf16 v[44:47], v[196:199], v[172:175], v[44:47]
    ds_read_b128 v[188:191], v8 offset:15360
    v_mul_f32 v239, v219, v227
    v_mfma_f32_16x16x32_bf16 v[48:51], v[200:203], v[160:163], v[48:51]
    v_exp_f32 v208, v208
    v_mfma_f32_16x16x32_bf16 v[52:55], v[200:203], v[164:167], v[52:55]
    s_bitcmp1_b32 s37, 6
    s_cbranch_scc1 mega_kernel_pf6
mega_kernel_pb6:
    v_mfma_f32_16x16x32_bf16 v[56:59], v[200:203], v[168:171], v[56:59]
    v_exp_f32 v209, v209
    v_mfma_f32_16x16x32_bf16 v[60:63], v[200:203], v[172:175], v[60:63]
    v_exp_f32 v210, v210
    v_mfma_f32_16x16x32_bf16 v[64:67], v[204:207], v[160:163], v[64:67]
    v_exp_f32 v211, v211
    v_mfma_f32_16x16x32_bf16 v[68:71], v[204:207], v[164:167], v[68:71]
    v_add_f32 v208, 1.0, v208
    v_add_f32 v209, 1.0, v209
    v_mfma_f32_16x16x32_bf16 v[72:75], v[204:207], v[168:171], v[72:75]
    v_rcp_f32 v208, v208
    v_mfma_f32_16x16x32_bf16 v[76:79], v[204:207], v[172:175], v[76:79]
    v_add_f32 v210, 1.0, v210
    s_waitcnt lgkmcnt(0)
    v_mfma_f32_16x16x32_bf16 v[16:19], v[176:179], v[144:147], v[16:19]
    ds_read_b128 v[192:195], v8 offset:45056
    v_add_f32 v211, 1.0, v211
    v_mfma_f32_16x16x32_bf16 v[20:23], v[176:179], v[148:151], v[20:23]
    ds_read_b128 v[160:163], v3 offset:12288
    v_mul_f32 v104, v104, v208
    v_mfma_f32_16x16x32_bf16 v[24:27], v[176:179], v[152:155], v[24:27]
    ds_read_b128 v[164:167], v2 offset:12800
    v_fma_f32 v108, v108, v218, v236
    v_mfma_f32_16x16x32_bf16 v[28:31], v[176:179], v[156:159], v[28:31]
    ds_read_b128 v[168:171], v3 offset:13312
    v_fma_f32 v109, v109, v218, v237
    v_mfma_f32_16x16x32_bf16 v[32:35], v[180:183], v[144:147], v[32:35]
    ds_read_b128 v[172:175], v2 offset:13824
    v_fma_f32 v110, v110, v218, v238
    v_mfma_f32_16x16x32_bf16 v[36:39], v[180:183], v[148:151], v[36:39]
    ds_read_b128 v[196:199], v8 offset:46080
    v_fma_f32 v111, v111, v218, v239
    v_mfma_f32_16x16x32_bf16 v[40:43], v[180:183], v[152:155], v[40:43]
    ds_read_b128 v[200:203], v8 offset:47104
    v_mul_f32 v236, v108, v108
    v_mfma_f32_16x16x32_bf16 v[44:47], v[180:183], v[156:159], v[44:47]
    ds_read_b128 v[204:207], v8 offset:48128
    v_mul_f32 v237, v109, v109
    v_mfma_f32_16x16x32_bf16 v[48:51], v[184:187], v[144:147], v[48:51]
    v_rcp_f32 v209, v209
    v_mfma_f32_16x16x32_bf16 v[52:55], v[184:187], v[148:151], v[52:55]
    v_rcp_f32 v210, v210
    v_mfma_f32_16x16x32_bf16 v[56:59], v[184:187], v[152:155], v[56:59]
    v_rcp_f32 v211, v211
    v_mfma_f32_16x16x32_bf16 v[60:63], v[184:187], v[156:159], v[60:63]
    v_mul_f32 v105, v105, v209
    v_mul_f32 v106, v106, v210
    v_mfma_f32_16x16x32_bf16 v[64:67], v[188:191], v[144:147], v[64:67]
    v_mul_f32 v107, v107, v211
    v_mul_f32 v238, v110, v110
    v_mfma_f32_16x16x32_bf16 v[68:71], v[188:191], v[148:151], v[68:71]
    v_mul_f32 v239, v111, v111
    v_fmaak_f32 v236, v15, v236, 0xc0135761
    v_mfma_f32_16x16x32_bf16 v[72:75], v[188:191], v[152:155], v[72:75]
    v_fmaak_f32 v237, v15, v237, 0xc0135761
    v_fmaak_f32 v238, v15, v238, 0xc0135761
    v_mfma_f32_16x16x32_bf16 v[76:79], v[188:191], v[156:159], v[76:79]
    s_waitcnt lgkmcnt(0)
    s_barrier
    v_mfma_f32_16x16x32_bf16 v[16:19], v[192:195], v[160:163], v[16:19]
    ds_read_b128 v[176:179], v8 offset:0
    v_fmaak_f32 v239, v15, v239, 0xc0135761
    v_mfma_f32_16x16x32_bf16 v[20:23], v[192:195], v[164:167], v[20:23]
    ds_read_b128 v[144:147], v2 offset:0
    v_mul_f32 v236, v236, v108
    v_mfma_f32_16x16x32_bf16 v[24:27], v[192:195], v[168:171], v[24:27]
    ds_read_b128 v[148:151], v3 offset:512
    v_mul_f32 v237, v237, v109
    v_mfma_f32_16x16x32_bf16 v[28:31], v[192:195], v[172:175], v[28:31]
    ds_read_b128 v[152:155], v2 offset:1024
    v_mul_f32 v238, v238, v110
    v_mfma_f32_16x16x32_bf16 v[32:35], v[196:199], v[160:163], v[32:35]
    ds_read_b128 v[156:159], v3 offset:1536
    v_mul_f32 v239, v239, v111
    v_mfma_f32_16x16x32_bf16 v[36:39], v[196:199], v[164:167], v[36:39]
    ds_read_b128 v[180:183], v8 offset:1024
    v_mul_f32 v240, v213, v228
    v_mfma_f32_16x16x32_bf16 v[40:43], v[196:199], v[168:171], v[40:43]
    ds_read_b128 v[184:187], v8 offset:2048
    v_mul_f32 v241, v213, v229
    v_mfma_f32_16x16x32_bf16 v[44:47], v[196:199], v[172:175], v[44:47]
    ds_read_b128 v[188:191], v8 offset:3072
    v_mul_f32 v242, v213, v230
    v_mfma_f32_16x16x32_bf16 v[48:51], v[200:203], v[160:163], v[48:51]
    v_exp_f32 v236, v236
    v_mfma_f32_16x16x32_bf16 v[52:55], v[200:203], v[164:167], v[52:55]
    s_bitcmp1_b32 s37, 7
    s_cbranch_scc1 mega_kernel_pf7
mega_kernel_pb7:
    v_mfma_f32_16x16x32_bf16 v[56:59], v[200:203], v[168:171], v[56:59]
    v_exp_f32 v237, v237
    v_mfma_f32_16x16x32_bf16 v[60:63], v[200:203], v[172:175], v[60:63]
    v_exp_f32 v238, v238
    v_mfma_f32_16x16x32_bf16 v[64:67], v[204:207], v[160:163], v[64:67]
    v_exp_f32 v239, v239
    v_mfma_f32_16x16x32_bf16 v[68:71], v[204:207], v[164:167], v[68:71]
    v_add_f32 v236, 1.0, v236
    v_add_f32 v237, 1.0, v237
    v_mfma_f32_16x16x32_bf16 v[72:75], v[204:207], v[168:171], v[72:75]
    v_rcp_f32 v236, v236
    v_mfma_f32_16x16x32_bf16 v[76:79], v[204:207], v[172:175], v[76:79]
    v_add_f32 v238, 1.0, v238
    s_waitcnt lgkmcnt(0)
    v_mfma_f32_16x16x32_bf16 v[16:19], v[176:179], v[144:147], v[16:19]
    ds_read_b128 v[192:195], v8 offset:32768
    v_add_f32 v239, 1.0, v239
    v_mfma_f32_16x16x32_bf16 v[20:23], v[176:179], v[148:151], v[20:23]
    ds_read_b128 v[160:163], v3 offset:0
    v_mul_f32 v108, v108, v236
    v_mfma_f32_16x16x32_bf16 v[24:27], v[176:179], v[152:155], v[24:27]
    ds_read_b128 v[164:167], v2 offset:512
    v_mul_f32 v243, v213, v231
    v_mfma_f32_16x16x32_bf16 v[28:31], v[176:179], v[156:159], v[28:31]
    ds_read_b128 v[168:171], v3 offset:1024
    v_fma_f32 v112, v112, v212, v240
    v_mfma_f32_16x16x32_bf16 v[32:35], v[180:183], v[144:147], v[32:35]
    ds_read_b128 v[172:175], v2 offset:1536
    v_fma_f32 v113, v113, v212, v241
    v_mfma_f32_16x16x32_bf16 v[36:39], v[180:183], v[148:151], v[36:39]
    ds_read_b128 v[196:199], v8 offset:33792
    v_fma_f32 v114, v114, v212, v242
    v_mfma_f32_16x16x32_bf16 v[40:43], v[180:183], v[152:155], v[40:43]
    ds_read_b128 v[200:203], v8 offset:34816
    v_fma_f32 v115, v115, v212, v243
    v_mfma_f32_16x16x32_bf16 v[44:47], v[180:183], v[156:159], v[44:47]
    ds_read_b128 v[204:207], v8 offset:35840
    v_mul_f32 v240, v112, v112
    v_mfma_f32_16x16x32_bf16 v[48:51], v[184:187], v[144:147], v[48:51]
    v_rcp_f32 v237, v237
    v_mfma_f32_16x16x32_bf16 v[52:55], v[184:187], v[148:151], v[52:55]
    v_rcp_f32 v238, v238
    v_mfma_f32_16x16x32_bf16 v[56:59], v[184:187], v[152:155], v[56:59]
    v_rcp_f32 v239, v239
    v_mfma_f32_16x16x32_bf16 v[60:63], v[184:187], v[156:159], v[60:63]
    v_mul_f32 v109, v109, v237
    v_mul_f32 v110, v110, v238
    v_mfma_f32_16x16x32_bf16 v[64:67], v[188:191], v[144:147], v[64:67]
    v_mul_f32 v111, v111, v239
    v_mul_f32 v241, v113, v113
    v_mfma_f32_16x16x32_bf16 v[68:71], v[188:191], v[148:151], v[68:71]
    v_mul_f32 v242, v114, v114
    v_mul_f32 v243, v115, v115
    v_mfma_f32_16x16x32_bf16 v[72:75], v[188:191], v[152:155], v[72:75]
    v_fmaak_f32 v240, v15, v240, 0xc0135761
    v_fmaak_f32 v241, v15, v241, 0xc0135761
    v_mfma_f32_16x16x32_bf16 v[76:79], v[188:191], v[156:159], v[76:79]
    s_waitcnt lgkmcnt(0)
    s_barrier
    v_mfma_f32_16x16x32_bf16 v[16:19], v[192:195], v[160:163], v[16:19]
    ds_read_b128 v[176:179], v8 offset:4096
    v_fmaak_f32 v242, v15, v242, 0xc0135761
    v_mfma_f32_16x16x32_bf16 v[20:23], v[192:195], v[164:167], v[20:23]
    ds_read_b128 v[144:147], v2 offset:4096
    v_fmaak_f32 v243, v15, v243, 0xc0135761
    v_mfma_f32_16x16x32_bf16 v[24:27], v[192:195], v[168:171], v[24:27]
    ds_read_b128 v[148:151], v3 offset:4608
    v_mul_f32 v240, v240, v112
    v_mfma_f32_16x16x32_bf16 v[28:31], v[192:195], v[172:175], v[28:31]
    ds_read_b128 v[152:155], v2 offset:5120
    v_mul_f32 v241, v241, v113
    v_mfma_f32_16x16x32_bf16 v[32:35], v[196:199], v[160:163], v[32:35]
    ds_read_b128 v[156:159], v3 offset:5632
    v_mul_f32 v242, v242, v114
    v_mfma_f32_16x16x32_bf16 v[36:39], v[196:199], v[164:167], v[36:39]
    ds_read_b128 v[180:183], v8 offset:5120
    v_mul_f32 v243, v243, v115
    v_mfma_f32_16x16x32_bf16 v[40:43], v[196:199], v[168:171], v[40:43]
    ds_read_b128 v[184:187], v8 offset:6144
    v_mul_f32 v208, v215, v228
    v_mfma_f32_16x16x32_bf16 v[44:47], v[196:199], v[172:175], v[44:47]
    ds_read_b128 v[188:191], v8 offset:7168
    v_mul_f32 v209, v215, v229
    v_mfma_f32_16x16x32_bf16 v[48:51], v[200:203], v[160:163], v[48:51]
    v_exp_f32 v240, v240
    v_mfma_f32_16x16x32_bf16 v[52:55], v[200:203], v[164:167], v[52:55]
    s_bitcmp1_b32 s37, 8
    s_cbranch_scc1 mega_kernel_pf8
mega_kernel_pb8:
    v_mfma_f32_16x16x32_bf16 v[56:59], v[200:203], v[168:171], v[56:59]
    v_exp_f32 v241, v241
    v_mfma_f32_16x16x32_bf16 v[60:63], v[200:203], v[172:175], v[60:63]
    v_exp_f32 v242, v242
    v_mfma_f32_16x16x32_bf16 v[64:67], v[204:207], v[160:163], v[64:67]
    v_exp_f32 v243, v243
    v_mfma_f32_16x16x32_bf16 v[68:71], v[204:207], v[164:167], v[68:71]
    v_add_f32 v240, 1.0, v240
    v_add_f32 v241, 1.0, v241
    v_mfma_f32_16x16x32_bf16 v[72:75], v[204:207], v[168:171], v[72:75]
    v_rcp_f32 v240, v240
    v_mfma_f32_16x16x32_bf16 v[76:79], v[204:207], v[172:175], v[76:79]
    v_add_f32 v242, 1.0, v242
    s_waitcnt lgkmcnt(0)
    v_mfma_f32_16x16x32_bf16 v[16:19], v[176:179], v[144:147], v[16:19]
    ds_read_b128 v[192:195], v8 offset:36864
    v_add_f32 v243, 1.0, v243
    v_mfma_f32_16x16x32_bf16 v[20:23], v[176:179], v[148:151], v[20:23]
    ds_read_b128 v[160:163], v3 offset:4096
    v_mul_f32 v112, v112, v240
    v_mfma_f32_16x16x32_bf16 v[24:27], v[176:179], v[152:155], v[24:27]
    ds_read_b128 v[164:167], v2 offset:4608
    v_mul_f32 v210, v215, v230
    v_mfma_f32_16x16x32_bf16 v[28:31], v[176:179], v[156:159], v[28:31]
    ds_read_b128 v[168:171], v3 offset:5120
    v_mul_f32 v211, v215, v231
    v_mfma_f32_16x16x32_bf16 v[32:35], v[180:183], v[144:147], v[32:35]
    ds_read_b128 v[172:175], v2 offset:5632
    v_fma_f32 v116, v116, v214, v208
    v_mfma_f32_16x16x32_bf16 v[36:39], v[180:183], v[148:151], v[36:39]
    ds_read_b128 v[196:199], v8 offset:37888
    v_fma_f32 v117, v117, v214, v209
    v_mfma_f32_16x16x32_bf16 v[40:43], v[180:183], v[152:155], v[40:43]
    ds_read_b128 v[200:203], v8 offset:38912
    v_fma_f32 v118, v118, v214, v210
    v_mfma_f32_16x16x32_bf16 v[44:47], v[180:183], v[156:159], v[44:47]
    ds_read_b128 v[204:207], v8 offset:39936
    v_fma_f32 v119, v119, v214, v211
    v_mfma_f32_16x16x32_bf16 v[48:51], v[184:187], v[144:147], v[48:51]
    v_rcp_f32 v241, v241
    v_mfma_f32_16x16x32_bf16 v[52:55], v[184:187], v[148:151], v[52:55]
    v_rcp_f32 v242, v242
    v_mfma_f32_16x16x32_bf16 v[56:59], v[184:187], v[152:155], v[56:59]
    v_rcp_f32 v243, v243
    v_mfma_f32_16x16x32_bf16 v[60:63], v[184:187], v[156:159], v[60:63]
    v_mul_f32 v113, v113, v241
    v_mul_f32 v114, v114, v242
    v_mfma_f32_16x16x32_bf16 v[64:67], v[188:191], v[144:147], v[64:67]
    v_mul_f32 v115, v115, v243
    v_mul_f32 v208, v116, v116
    v_mfma_f32_16x16x32_bf16 v[68:71], v[188:191], v[148:151], v[68:71]
    v_mul_f32 v209, v117, v117
    v_mul_f32 v210, v118, v118
    v_mfma_f32_16x16x32_bf16 v[72:75], v[188:191], v[152:155], v[72:75]
    v_mul_f32 v211, v119, v119
    v_fmaak_f32 v208, v15, v208, 0xc0135761
    v_mfma_f32_16x16x32_bf16 v[76:79], v[188:191], v[156:159], v[76:79]
    s_waitcnt lgkmcnt(0)
    s_barrier
    v_mfma_f32_16x16x32_bf16 v[16:19], v[192:195], v[160:163], v[16:19]
    ds_read_b128 v[176:179], v8 offset:8192
    v_fmaak_f32 v209, v15, v209, 0xc0135761
    v_mfma_f32_16x16x32_bf16 v[20:23], v[192:195], v[164:167], v[20:23]
    ds_read_b128 v[144:147], v2 offset:8192
    v_fmaak_f32 v210, v15, v210, 0xc0135761
    v_mfma_f32_16x16x32_bf16 v[24:27], v[192:195], v[168:171], v[24:27]
    ds_read_b128 v[148:151], v3 offset:8704
    v_fmaak_f32 v211, v15, v211, 0xc0135761
    v_mfma_f32_16x16x32_bf16 v[28:31], v[192:195], v[172:175], v[28:31]
    ds_read_b128 v[152:155], v2 offset:9216
    v_mul_f32 v208, v208, v116
    v_mfma_f32_16x16x32_bf16 v[32:35], v[196:199], v[160:163], v[32:35]
    ds_read_b128 v[156:159], v3 offset:9728
    v_mul_f32 v209, v209, v117
    v_mfma_f32_16x16x32_bf16 v[36:39], v[196:199], v[164:167], v[36:39]
    ds_read_b128 v[180:183], v8 offset:9216
    v_mul_f32 v210, v210, v118
    v_mfma_f32_16x16x32_bf16 v[40:43], v[196:199], v[168:171], v[40:43]
    ds_read_b128 v[184:187], v8 offset:10240
    v_mul_f32 v211, v211, v119
    v_mfma_f32_16x16x32_bf16 v[44:47], v[196:199], v[172:175], v[44:47]
    ds_read_b128 v[188:191], v8 offset:11264
    v_mul_f32 v236, v217, v228
    v_mfma_f32_16x16x32_bf16 v[48:51], v[200:203], v[160:163], v[48:51]
    v_exp_f32 v208, v208
    v_mfma_f32_16x16x32_bf16 v[52:55], v[200:203], v[164:167], v[52:55]
    s_bitcmp1_b32 s37, 9
    s_cbranch_scc1 mega_kernel_pf9
mega_kernel_pb9:
    v_mfma_f32_16x16x32_bf16 v[56:59], v[200:203], v[168:171], v[56:59]
    v_exp_f32 v209, v209
    v_mfma_f32_16x16x32_bf16 v[60:63], v[200:203], v[172:175], v[60:63]
    v_exp_f32 v210, v210
    v_mfma_f32_16x16x32_bf16 v[64:67], v[204:207], v[160:163], v[64:67]
    v_exp_f32 v211, v211
    v_mfma_f32_16x16x32_bf16 v[68:71], v[204:207], v[164:167], v[68:71]
    v_add_f32 v208, 1.0, v208
    v_add_f32 v209, 1.0, v209
    v_mfma_f32_16x16x32_bf16 v[72:75], v[204:207], v[168:171], v[72:75]
    v_rcp_f32 v208, v208
    v_mfma_f32_16x16x32_bf16 v[76:79], v[204:207], v[172:175], v[76:79]
    v_add_f32 v210, 1.0, v210
    s_waitcnt lgkmcnt(0)
    v_mfma_f32_16x16x32_bf16 v[16:19], v[176:179], v[144:147], v[16:19]
    ds_read_b128 v[192:195], v8 offset:40960
    v_add_f32 v211, 1.0, v211
    v_mfma_f32_16x16x32_bf16 v[20:23], v[176:179], v[148:151], v[20:23]
    ds_read_b128 v[160:163], v3 offset:8192
    v_mul_f32 v116, v116, v208
    v_mfma_f32_16x16x32_bf16 v[24:27], v[176:179], v[152:155], v[24:27]
    ds_read_b128 v[164:167], v2 offset:8704
    v_mul_f32 v237, v217, v229
    v_mfma_f32_16x16x32_bf16 v[28:31], v[176:179], v[156:159], v[28:31]
    ds_read_b128 v[168:171], v3 offset:9216
    v_mul_f32 v238, v217, v230
    v_mfma_f32_16x16x32_bf16 v[32:35], v[180:183], v[144:147], v[32:35]
    ds_read_b128 v[172:175], v2 offset:9728
    v_mul_f32 v239, v217, v231
    v_mfma_f32_16x16x32_bf16 v[36:39], v[180:183], v[148:151], v[36:39]
    ds_read_b128 v[196:199], v8 offset:41984
    v_fma_f32 v120, v120, v216, v236
    v_mfma_f32_16x16x32_bf16 v[40:43], v[180:183], v[152:155], v[40:43]
    ds_read_b128 v[200:203], v8 offset:43008
    v_fma_f32 v121, v121, v216, v237
    v_mfma_f32_16x16x32_bf16 v[44:47], v[180:183], v[156:159], v[44:47]
    ds_read_b128 v[204:207], v8 offset:44032
    v_fma_f32 v122, v122, v216, v238
    v_mfma_f32_16x16x32_bf16 v[48:51], v[184:187], v[144:147], v[48:51]
    v_rcp_f32 v209, v209
    v_mfma_f32_16x16x32_bf16 v[52:55], v[184:187], v[148:151], v[52:55]
    v_rcp_f32 v210, v210
    v_mfma_f32_16x16x32_bf16 v[56:59], v[184:187], v[152:155], v[56:59]
    v_rcp_f32 v211, v211
    v_mfma_f32_16x16x32_bf16 v[60:63], v[184:187], v[156:159], v[60:63]
    v_mul_f32 v117, v117, v209
    v_mul_f32 v118, v118, v210
    v_mfma_f32_16x16x32_bf16 v[64:67], v[188:191], v[144:147], v[64:67]
    v_mul_f32 v119, v119, v211
    v_fma_f32 v123, v123, v216, v239
    v_mfma_f32_16x16x32_bf16 v[68:71], v[188:191], v[148:151], v[68:71]
    v_mul_f32 v236, v120, v120
    v_mul_f32 v237, v121, v121
    v_mfma_f32_16x16x32_bf16 v[72:75], v[188:191], v[152:155], v[72:75]
    v_mul_f32 v238, v122, v122
    v_mul_f32 v239, v123, v123
    v_mfma_f32_16x16x32_bf16 v[76:79], v[188:191], v[156:159], v[76:79]
    s_waitcnt lgkmcnt(0)
    s_barrier
    v_mfma_f32_16x16x32_bf16 v[16:19], v[192:195], v[160:163], v[16:19]
    ds_read_b128 v[176:179], v8 offset:12288
    v_fmaak_f32 v236, v15, v236, 0xc0135761
    v_mfma_f32_16x16x32_bf16 v[20:23], v[192:195], v[164:167], v[20:23]
    ds_read_b128 v[144:147], v2 offset:12288
    v_fmaak_f32 v237, v15, v237, 0xc0135761
    v_mfma_f32_16x16x32_bf16 v[24:27], v[192:195], v[168:171], v[24:27]
    ds_read_b128 v[148:151], v3 offset:12800
    v_fmaak_f32 v238, v15, v238, 0xc0135761
    v_mfma_f32_16x16x32_bf16 v[28:31], v[192:195], v[172:175], v[28:31]
    ds_read_b128 v[152:155], v2 offset:13312
    v_fmaak_f32 v239, v15, v239, 0xc0135761
    v_mfma_f32_16x16x32_bf16 v[32:35], v[196:199], v[160:163], v[32:35]
    ds_read_b128 v[156:159], v3 offset:13824
    v_mul_f32 v236, v236, v120
    v_mfma_f32_16x16x32_bf16 v[36:39], v[196:199], v[164:167], v[36:39]
    ds_read_b128 v[180:183], v8 offset:13312
    v_mul_f32 v237, v237, v121
    v_mfma_f32_16x16x32_bf16 v[40:43], v[196:199], v[168:171], v[40:43]
    ds_read_b128 v[184:187], v8 offset:14336
    v_mul_f32 v238, v238, v122
    v_mfma_f32_16x16x32_bf16 v[44:47], v[196:199], v[172:175], v[44:47]
    ds_read_b128 v[188:191], v8 offset:15360
    v_mul_f32 v239, v239, v123
    v_mfma_f32_16x16x32_bf16 v[48:51], v[200:203], v[160:163], v[48:51]
    v_exp_f32 v236, v236
    v_mfma_f32_16x16x32_bf16 v[52:55], v[200:203], v[164:167], v[52:55]
    s_bitcmp1_b32 s37, 10
    s_cbranch_scc1 mega_kernel_pf10
mega_kernel_pb10:
    v_mfma_f32_16x16x32_bf16 v[56:59], v[200:203], v[168:171], v[56:59]
    v_exp_f32 v237, v237
    v_mfma_f32_16x16x32_bf16 v[60:63], v[200:203], v[172:175], v[60:63]
    v_exp_f32 v238, v238
    v_mfma_f32_16x16x32_bf16 v[64:67], v[204:207], v[160:163], v[64:67]
    v_exp_f32 v239, v239
    v_mfma_f32_16x16x32_bf16 v[68:71], v[204:207], v[164:167], v[68:71]
    v_add_f32 v236, 1.0, v236
    v_add_f32 v237, 1.0, v237
    v_mfma_f32_16x16x32_bf16 v[72:75], v[204:207], v[168:171], v[72:75]
    v_rcp_f32 v236, v236
    v_mfma_f32_16x16x32_bf16 v[76:79], v[204:207], v[172:175], v[76:79]
    v_add_f32 v238, 1.0, v238
    s_waitcnt lgkmcnt(0)
    v_mfma_f32_16x16x32_bf16 v[16:19], v[176:179], v[144:147], v[16:19]
    ds_read_b128 v[192:195], v8 offset:45056
    v_add_f32 v239, 1.0, v239
    v_mfma_f32_16x16x32_bf16 v[20:23], v[176:179], v[148:151], v[20:23]
    ds_read_b128 v[160:163], v3 offset:12288
    v_mul_f32 v120, v120, v236
    v_mfma_f32_16x16x32_bf16 v[24:27], v[176:179], v[152:155], v[24:27]
    ds_read_b128 v[164:167], v2 offset:12800
    v_mul_f32 v240, v219, v228
    v_mfma_f32_16x16x32_bf16 v[28:31], v[176:179], v[156:159], v[28:31]
    ds_read_b128 v[168:171], v3 offset:13312
    v_mul_f32 v241, v219, v229
    v_mfma_f32_16x16x32_bf16 v[32:35], v[180:183], v[144:147], v[32:35]
    ds_read_b128 v[172:175], v2 offset:13824
    v_mul_f32 v242, v219, v230
    v_mfma_f32_16x16x32_bf16 v[36:39], v[180:183], v[148:151], v[36:39]
    ds_read_b128 v[196:199], v8 offset:46080
    v_mul_f32 v243, v219, v231
    v_mfma_f32_16x16x32_bf16 v[40:43], v[180:183], v[152:155], v[40:43]
    ds_read_b128 v[200:203], v8 offset:47104
    v_fma_f32 v124, v124, v218, v240
    v_mfma_f32_16x16x32_bf16 v[44:47], v[180:183], v[156:159], v[44:47]
    ds_read_b128 v[204:207], v8 offset:48128
    v_fma_f32 v125, v125, v218, v241
    v_mfma_f32_16x16x32_bf16 v[48:51], v[184:187], v[144:147], v[48:51]
    v_rcp_f32 v237, v237
    v_mfma_f32_16x16x32_bf16 v[52:55], v[184:187], v[148:151], v[52:55]
    v_rcp_f32 v238, v238
    v_mfma_f32_16x16x32_bf16 v[56:59], v[184:187], v[152:155], v[56:59]
    v_rcp_f32 v239, v239
    v_mfma_f32_16x16x32_bf16 v[60:63], v[184:187], v[156:159], v[60:63]
    v_mul_f32 v121, v121, v237
    v_mul_f32 v122, v122, v238
    v_mfma_f32_16x16x32_bf16 v[64:67], v[188:191], v[144:147], v[64:67]
    v_mul_f32 v123, v123, v239
    v_fma_f32 v126, v126, v218, v242
    v_mfma_f32_16x16x32_bf16 v[68:71], v[188:191], v[148:151], v[68:71]
    v_fma_f32 v127, v127, v218, v243
    v_mul_f32 v240, v124, v124
    v_mfma_f32_16x16x32_bf16 v[72:75], v[188:191], v[152:155], v[72:75]
    v_mul_f32 v241, v125, v125
    v_mul_f32 v242, v126, v126
    v_mfma_f32_16x16x32_bf16 v[76:79], v[188:191], v[156:159], v[76:79]
    s_waitcnt lgkmcnt(0)
    s_barrier
    v_mfma_f32_16x16x32_bf16 v[16:19], v[192:195], v[160:163], v[16:19]
    ds_read_b128 v[176:179], v8 offset:0
    v_mul_f32 v243, v127, v127
    v_mfma_f32_16x16x32_bf16 v[20:23], v[192:195], v[164:167], v[20:23]
    ds_read_b128 v[144:147], v2 offset:0
    v_fmaak_f32 v240, v15, v240, 0xc0135761
    v_mfma_f32_16x16x32_bf16 v[24:27], v[192:195], v[168:171], v[24:27]
    ds_read_b128 v[148:151], v3 offset:512
    v_fmaak_f32 v241, v15, v241, 0xc0135761
    v_mfma_f32_16x16x32_bf16 v[28:31], v[192:195], v[172:175], v[28:31]
    ds_read_b128 v[152:155], v2 offset:1024
    v_fmaak_f32 v242, v15, v242, 0xc0135761
    v_mfma_f32_16x16x32_bf16 v[32:35], v[196:199], v[160:163], v[32:35]
    ds_read_b128 v[156:159], v3 offset:1536
    v_fmaak_f32 v243, v15, v243, 0xc0135761
    v_mfma_f32_16x16x32_bf16 v[36:39], v[196:199], v[164:167], v[36:39]
    ds_read_b128 v[180:183], v8 offset:1024
    v_mul_f32 v240, v240, v124
    v_mfma_f32_16x16x32_bf16 v[40:43], v[196:199], v[168:171], v[40:43]
    ds_read_b128 v[184:187], v8 offset:2048
    v_mul_f32 v241, v241, v125
    v_mfma_f32_16x16x32_bf16 v[44:47], v[196:199], v[172:175], v[44:47]
    ds_read_b128 v[188:191], v8 offset:3072
    v_mul_f32 v242, v242, v126
    v_mfma_f32_16x16x32_bf16 v[48:51], v[200:203], v[160:163], v[48:51]
    v_exp_f32 v240, v240
    v_mfma_f32_16x16x32_bf16 v[52:55], v[200:203], v[164:167], v[52:55]
    s_bitcmp1_b32 s37, 11
    s_cbranch_scc1 mega_kernel_pf11
mega_kernel_pb11:
    v_mfma_f32_16x16x32_bf16 v[56:59], v[200:203], v[168:171], v[56:59]
    v_exp_f32 v241, v241
    v_mfma_f32_16x16x32_bf16 v[60:63], v[200:203], v[172:175], v[60:63]
    v_exp_f32 v242, v242
    v_mfma_f32_16x16x32_bf16 v[64:67], v[204:207], v[160:163], v[64:67]
    v_mul_f32 v243, v243, v127
    v_add_f32 v240, 1.0, v240
    v_mfma_f32_16x16x32_bf16 v[68:71], v[204:207], v[164:167], v[68:71]
    v_exp_f32 v243, v243
    v_mfma_f32_16x16x32_bf16 v[72:75], v[204:207], v[168:171], v[72:75]
    v_rcp_f32 v240, v240
    v_mfma_f32_16x16x32_bf16 v[76:79], v[204:207], v[172:175], v[76:79]
    v_add_f32 v241, 1.0, v241
    s_waitcnt lgkmcnt(0)
    v_mfma_f32_16x16x32_bf16 v[16:19], v[176:179], v[144:147], v[16:19]
    ds_read_b128 v[192:195], v8 offset:32768
    v_add_f32 v242, 1.0, v242
    v_mfma_f32_16x16x32_bf16 v[20:23], v[176:179], v[148:151], v[20:23]
    ds_read_b128 v[160:163], v3 offset:0
    v_add_f32 v243, 1.0, v243
    v_mfma_f32_16x16x32_bf16 v[24:27], v[176:179], v[152:155], v[24:27]
    ds_read_b128 v[164:167], v2 offset:512
    v_mul_f32 v124, v124, v240
    v_mfma_f32_16x16x32_bf16 v[28:31], v[176:179], v[156:159], v[28:31]
    ds_read_b128 v[168:171], v3 offset:1024
    v_mul_f32 v208, v213, v232
    v_mfma_f32_16x16x32_bf16 v[32:35], v[180:183], v[144:147], v[32:35]
    ds_read_b128 v[172:175], v2 offset:1536
    v_mul_f32 v209, v213, v233
    v_mfma_f32_16x16x32_bf16 v[36:39], v[180:183], v[148:151], v[36:39]
    ds_read_b128 v[196:199], v8 offset:33792
    v_mul_f32 v210, v213, v234
    v_mfma_f32_16x16x32_bf16 v[40:43], v[180:183], v[152:155], v[40:43]
    ds_read_b128 v[200:203], v8 offset:34816
    v_mul_f32 v211, v213, v235
    v_mfma_f32_16x16x32_bf16 v[44:47], v[180:183], v[156:159], v[44:47]
    ds_read_b128 v[204:207], v8 offset:35840
    v_fma_f32 v128, v128, v212, v208
    v_mfma_f32_16x16x32_bf16 v[48:51], v[184:187], v[144:147], v[48:51]
    v_rcp_f32 v241, v241
    v_mfma_f32_16x16x32_bf16 v[52:55], v[184:187], v[148:151], v[52:55]
    v_rcp_f32 v242, v242
    v_mfma_f32_16x16x32_bf16 v[56:59], v[184:187], v[152:155], v[56:59]
    v_rcp_f32 v243, v243
    v_mfma_f32_16x16x32_bf16 v[60:63], v[184:187], v[156:159], v[60:63]
    v_mul_f32 v125, v125, v241
    v_mul_f32 v126, v126, v242
    v_mfma_f32_16x16x32_bf16 v[64:67], v[188:191], v[144:147], v[64:67]
    v_mul_f32 v127, v127, v243
    v_fma_f32 v129, v129, v212, v209
    v_mfma_f32_16x16x32_bf16 v[68:71], v[188:191], v[148:151], v[68:71]
    v_fma_f32 v130, v130, v212, v210
    v_fma_f32 v131, v131, v212, v211
    v_mfma_f32_16x16x32_bf16 v[72:75], v[188:191], v[152:155], v[72:75]
    v_mul_f32 v208, v128, v128
    v_mul_f32 v209, v129, v129
    v_mfma_f32_16x16x32_bf16 v[76:79], v[188:191], v[156:159], v[76:79]
    s_waitcnt lgkmcnt(0)
    s_barrier
    v_mfma_f32_16x16x32_bf16 v[16:19], v[192:195], v[160:163], v[16:19]
    ds_read_b128 v[176:179], v8 offset:4096
    v_mul_f32 v210, v130, v130
    v_mfma_f32_16x16x32_bf16 v[20:23], v[192:195], v[164:167], v[20:23]
    ds_read_b128 v[144:147], v2 offset:4096
    v_mul_f32 v211, v131, v131
    v_mfma_f32_16x16x32_bf16 v[24:27], v[192:195], v[168:171], v[24:27]
    ds_read_b128 v[148:151], v3 offset:4608
    v_fmaak_f32 v208, v15, v208, 0xc0135761
    v_mfma_f32_16x16x32_bf16 v[28:31], v[192:195], v[172:175], v[28:31]
    ds_read_b128 v[152:155], v2 offset:5120
    v_fmaak_f32 v209, v15, v209, 0xc0135761
    v_mfma_f32_16x16x32_bf16 v[32:35], v[196:199], v[160:163], v[32:35]
    ds_read_b128 v[156:159], v3 offset:5632
    v_fmaak_f32 v210, v15, v210, 0xc0135761
    v_mfma_f32_16x16x32_bf16 v[36:39], v[196:199], v[164:167], v[36:39]
    ds_read_b128 v[180:183], v8 offset:5120
    v_fmaak_f32 v211, v15, v211, 0xc0135761
    v_mfma_f32_16x16x32_bf16 v[40:43], v[196:199], v[168:171], v[40:43]
    ds_read_b128 v[184:187], v8 offset:6144
    v_mul_f32 v208, v208, v128
    v_mfma_f32_16x16x32_bf16 v[44:47], v[196:199], v[172:175], v[44:47]
    ds_read_b128 v[188:191], v8 offset:7168
    v_mul_f32 v209, v209, v129
    v_mfma_f32_16x16x32_bf16 v[48:51], v[200:203], v[160:163], v[48:51]
    v_exp_f32 v208, v208
    v_mfma_f32_16x16x32_bf16 v[52:55], v[200:203], v[164:167], v[52:55]
    s_bitcmp1_b32 s37, 12
    s_cbranch_scc1 mega_kernel_pf12
mega_kernel_pb12:
    v_mfma_f32_16x16x32_bf16 v[56:59], v[200:203], v[168:171], v[56:59]
    v_exp_f32 v209, v209
    v_mfma_f32_16x16x32_bf16 v[60:63], v[200:203], v[172:175], v[60:63]
    v_mul_f32 v210, v210, v130
    v_mul_f32 v211, v211, v131
    v_mfma_f32_16x16x32_bf16 v[64:67], v[204:207], v[160:163], v[64:67]
    v_exp_f32 v210, v210
    v_mfma_f32_16x16x32_bf16 v[68:71], v[204:207], v[164:167], v[68:71]
    v_exp_f32 v211, v211
    v_mfma_f32_16x16x32_bf16 v[72:75], v[204:207], v[168:171], v[72:75]
    v_add_f32 v208, 1.0, v208
    v_add_f32 v209, 1.0, v209
    v_mfma_f32_16x16x32_bf16 v[76:79], v[204:207], v[172:175], v[76:79]
    v_add_f32 v210, 1.0, v210
    s_waitcnt lgkmcnt(0)
    v_mfma_f32_16x16x32_bf16 v[16:19], v[176:179], v[144:147], v[16:19]
    ds_read_b128 v[192:195], v8 offset:36864
    v_add_f32 v211, 1.0, v211
    v_mfma_f32_16x16x32_bf16 v[20:23], v[176:179], v[148:151], v[20:23]
    ds_read_b128 v[160:163], v3 offset:4096
    v_mul_f32 v236, v215, v232
    v_mfma_f32_16x16x32_bf16 v[24:27], v[176:179], v[152:155], v[24:27]
    ds_read_b128 v[164:167], v2 offset:4608
    v_mul_f32 v237, v215, v233
    v_mfma_f32_16x16x32_bf16 v[28:31], v[176:179], v[156:159], v[28:31]
    ds_read_b128 v[168:171], v3 offset:5120
    v_mul_f32 v238, v215, v234
    v_mfma_f32_16x16x32_bf16 v[32:35], v[180:183], v[144:147], v[32:35]
    ds_read_b128 v[172:175], v2 offset:5632
    v_mul_f32 v239, v215, v235
    v_mfma_f32_16x16x32_bf16 v[36:39], v[180:183], v[148:151], v[36:39]
    ds_read_b128 v[196:199], v8 offset:37888
    v_fma_f32 v132, v132, v214, v236
    v_mfma_f32_16x16x32_bf16 v[40:43], v[180:183], v[152:155], v[40:43]
    ds_read_b128 v[200:203], v8 offset:38912
    v_fma_f32 v133, v133, v214, v237
    v_mfma_f32_16x16x32_bf16 v[44:47], v[180:183], v[156:159], v[44:47]
    ds_read_b128 v[204:207], v8 offset:39936
    v_fma_f32 v134, v134, v214, v238
    v_mfma_f32_16x16x32_bf16 v[48:51], v[184:187], v[144:147], v[48:51]
    v_rcp_f32 v208, v208
    v_mfma_f32_16x16x32_bf16 v[52:55], v[184:187], v[148:151], v[52:55]
    v_rcp_f32 v209, v209
    v_mfma_f32_16x16x32_bf16 v[56:59], v[184:187], v[152:155], v[56:59]
    v_rcp_f32 v210, v210
    v_mfma_f32_16x16x32_bf16 v[60:63], v[184:187], v[156:159], v[60:63]
    v_rcp_f32 v211, v211
    v_mfma_f32_16x16x32_bf16 v[64:67], v[188:191], v[144:147], v[64:67]
    v_mul_f32 v128, v128, v208
    v_mul_f32 v129, v129, v209
    v_mfma_f32_16x16x32_bf16 v[68:71], v[188:191], v[148:151], v[68:71]
    v_mul_f32 v130, v130, v210
    v_mul_f32 v131, v131, v211
    v_mfma_f32_16x16x32_bf16 v[72:75], v[188:191], v[152:155], v[72:75]
    v_fma_f32 v135, v135, v214, v239
    v_mul_f32 v236, v132, v132
    v_mfma_f32_16x16x32_bf16 v[76:79], v[188:191], v[156:159], v[76:79]
    s_waitcnt lgkmcnt(0)
    s_barrier
    v_mfma_f32_16x16x32_bf16 v[16:19], v[192:195], v[160:163], v[16:19]
    ds_read_b128 v[176:179], v8 offset:8192
    v_mul_f32 v237, v133, v133
    v_mfma_f32_16x16x32_bf16 v[20:23], v[192:195], v[164:167], v[20:23]
    ds_read_b128 v[144:147], v2 offset:8192
    v_mul_f32 v238, v134, v134
    v_mfma_f32_16x16x32_bf16 v[24:27], v[192:195], v[168:171], v[24:27]
    ds_read_b128 v[148:151], v3 offset:8704
    v_mul_f32 v239, v135, v135
    v_mfma_f32_16x16x32_bf16 v[28:31], v[192:195], v[172:175], v[28:31]
    ds_read_b128 v[152:155], v2 offset:9216
    v_fmaak_f32 v236, v15, v236, 0xc0135761
    v_mfma_f32_16x16x32_bf16 v[32:35], v[196:199], v[160:163], v[32:35]
    ds_read_b128 v[156:159], v3 offset:9728
    v_fmaak_f32 v237, v15, v237, 0xc0135761
    v_mfma_f32_16x16x32_bf16 v[36:39], v[196:199], v[164:167], v[36:39]
    ds_read_b128 v[180:183], v8 offset:9216
    v_fmaak_f32 v238, v15, v238, 0xc0135761
    v_mfma_f32_16x16x32_bf16 v[40:43], v[196:199], v[168:171], v[40:43]
    ds_read_b128 v[184:187], v8 offset:10240
    v_fmaak_f32 v239, v15, v239, 0xc0135761
    v_mfma_f32_16x16x32_bf16 v[44:47], v[196:199], v[172:175], v[44:47]
    ds_read_b128 v[188:191], v8 offset:11264
    v_mul_f32 v236, v236, v132
    v_mfma_f32_16x16x32_bf16 v[48:51], v[200:203], v[160:163], v[48:51]
    v_exp_f32 v236, v236
    v_mfma_f32_16x16x32_bf16 v[52:55], v[200:203], v[164:167], v[52:55]
    s_bitcmp1_b32 s37, 13
    s_cbranch_scc1 mega_kernel_pf13
mega_kernel_pb13:
    v_mfma_f32_16x16x32_bf16 v[56:59], v[200:203], v[168:171], v[56:59]
    v_mul_f32 v237, v237, v133
    v_mul_f32 v238, v238, v134
    v_mfma_f32_16x16x32_bf16 v[60:63], v[200:203], v[172:175], v[60:63]
    v_exp_f32 v237, v237
    v_mfma_f32_16x16x32_bf16 v[64:67], v[204:207], v[160:163], v[64:67]
    v_exp_f32 v238, v238
    v_mfma_f32_16x16x32_bf16 v[68:71], v[204:207], v[164:167], v[68:71]
    v_mul_f32 v239, v239, v135
    v_add_f32 v236, 1.0, v236
    v_mfma_f32_16x16x32_bf16 v[72:75], v[204:207], v[168:171], v[72:75]
    v_exp_f32 v239, v239
    v_mfma_f32_16x16x32_bf16 v[76:79], v[204:207], v[172:175], v[76:79]
    v_add_f32 v237, 1.0, v237
    s_waitcnt lgkmcnt(0)
    v_mfma_f32_16x16x32_bf16 v[16:19], v[176:179], v[144:147], v[16:19]
    ds_read_b128 v[192:195], v8 offset:40960
    v_add_f32 v238, 1.0, v238
    v_mfma_f32_16x16x32_bf16 v[20:23], v[176:179], v[148:151], v[20:23]
    ds_read_b128 v[160:163], v3 offset:8192
    v_add_f32 v239, 1.0, v239
    v_mfma_f32_16x16x32_bf16 v[24:27], v[176:179], v[152:155], v[24:27]
    ds_read_b128 v[164:167], v2 offset:8704
    v_mul_f32 v240, v217, v232
    v_mfma_f32_16x16x32_bf16 v[28:31], v[176:179], v[156:159], v[28:31]
    ds_read_b128 v[168:171], v3 offset:9216
    v_mul_f32 v241, v217, v233
    v_mfma_f32_16x16x32_bf16 v[32:35], v[180:183], v[144:147], v[32:35]
    ds_read_b128 v[172:175], v2 offset:9728
    v_mul_f32 v242, v217, v234
    v_mfma_f32_16x16x32_bf16 v[36:39], v[180:183], v[148:151], v[36:39]
    ds_read_b128 v[196:199], v8 offset:41984
    v_mul_f32 v243, v217, v235
    v_mfma_f32_16x16x32_bf16 v[40:43], v[180:183], v[152:155], v[40:43]
    ds_read_b128 v[200:203], v8 offset:43008
    v_fma_f32 v136, v136, v216, v240
    v_mfma_f32_16x16x32_bf16 v[44:47], v[180:183], v[156:159], v[44:47]
    ds_read_b128 v[204:207], v8 offset:44032
    v_fma_f32 v137, v137, v216, v241
    v_mfma_f32_16x16x32_bf16 v[48:51], v[184:187], v[144:147], v[48:51]
    v_rcp_f32 v236, v236
    v_mfma_f32_16x16x32_bf16 v[52:55], v[184:187], v[148:151], v[52:55]
    v_rcp_f32 v237, v237
    v_mfma_f32_16x16x32_bf16 v[56:59], v[184:187], v[152:155], v[56:59]
    v_rcp_f32 v238, v238
    v_mfma_f32_16x16x32_bf16 v[60:63], v[184:187], v[156:159], v[60:63]
    v_rcp_f32 v239, v239
    v_mfma_f32_16x16x32_bf16 v[64:67], v[188:191], v[144:147], v[64:67]
    v_mul_f32 v132, v132, v236
    v_mul_f32 v133, v133, v237
    v_mfma_f32_16x16x32_bf16 v[68:71], v[188:191], v[148:151], v[68:71]
    v_mul_f32 v134, v134, v238
    v_mul_f32 v135, v135, v239
    v_mfma_f32_16x16x32_bf16 v[72:75], v[188:191], v[152:155], v[72:75]
    v_fma_f32 v138, v138, v216, v242
    v_fma_f32 v139, v139, v216, v243
    v_mfma_f32_16x16x32_bf16 v[76:79], v[188:191], v[156:159], v[76:79]
    s_waitcnt lgkmcnt(0)
    s_barrier
    v_mfma_f32_16x16x32_bf16 v[16:19], v[192:195], v[160:163], v[16:19]
    ds_read_b128 v[176:179], v8 offset:12288
    v_mul_f32 v240, v136, v136
    v_mfma_f32_16x16x32_bf16 v[20:23], v[192:195], v[164:167], v[20:23]
    ds_read_b128 v[144:147], v2 offset:12288
    v_mul_f32 v241, v137, v137
    v_mfma_f32_16x16x32_bf16 v[24:27], v[192:195], v[168:171], v[24:27]
    ds_read_b128 v[148:151], v3 offset:12800
    v_mul_f32 v242, v138, v138
    v_mfma_f32_16x16x32_bf16 v[28:31], v[192:195], v[172:175], v[28:31]
    ds_read_b128 v[152:155], v2 offset:13312
    v_mul_f32 v243, v139, v139
    v_mfma_f32_16x16x32_bf16 v[32:35], v[196:199], v[160:163], v[32:35]
    ds_read_b128 v[156:159], v3 offset:13824
    v_fmaak_f32 v240, v15, v240, 0xc0135761
    v_mfma_f32_16x16x32_bf16 v[36:39], v[196:199], v[164:167], v[36:39]
    ds_read_b128 v[180:183], v8 offset:13312
    v_fmaak_f32 v241, v15, v241, 0xc0135761
    v_mfma_f32_16x16x32_bf16 v[40:43], v[196:199], v[168:171], v[40:43]
    ds_read_b128 v[184:187], v8 offset:14336
    v_fmaak_f32 v242, v15, v242, 0xc0135761
    v_mfma_f32_16x16x32_bf16 v[44:47], v[196:199], v[172:175], v[44:47]
    ds_read_b128 v[188:191], v8 offset:15360
    v_fmaak_f32 v243, v15, v243, 0xc0135761
    v_mfma_f32_16x16x32_bf16 v[48:51], v[200:203], v[160:163], v[48:51]
    v_mul_f32 v240, v240, v136
    v_mul_f32 v241, v241, v137
    v_mfma_f32_16x16x32_bf16 v[52:55], v[200:203], v[164:167], v[52:55]
    s_bitcmp1_b32 s37, 14
    s_cbranch_scc1 mega_kernel_pf14
mega_kernel_pb14:
    v_mfma_f32_16x16x32_bf16 v[56:59], v[200:203], v[168:171], v[56:59]
    v_exp_f32 v240, v240
    v_mfma_f32_16x16x32_bf16 v[60:63], v[200:203], v[172:175], v[60:63]
    v_exp_f32 v241, v241
    v_mfma_f32_16x16x32_bf16 v[64:67], v[204:207], v[160:163], v[64:67]
    v_mul_f32 v242, v242, v138
    v_mul_f32 v243, v243, v139
    v_mfma_f32_16x16x32_bf16 v[68:71], v[204:207], v[164:167], v[68:71]
    v_exp_f32 v242, v242
    v_mfma_f32_16x16x32_bf16 v[72:75], v[204:207], v[168:171], v[72:75]
    v_exp_f32 v243, v243
    v_mfma_f32_16x16x32_bf16 v[76:79], v[204:207], v[172:175], v[76:79]
    v_add_f32 v240, 1.0, v240
    s_waitcnt lgkmcnt(0)
    v_mfma_f32_16x16x32_bf16 v[16:19], v[176:179], v[144:147], v[16:19]
    ds_read_b128 v[192:195], v8 offset:45056
    v_add_f32 v241, 1.0, v241
    v_mfma_f32_16x16x32_bf16 v[20:23], v[176:179], v[148:151], v[20:23]
    ds_read_b128 v[160:163], v3 offset:12288
    v_add_f32 v242, 1.0, v242
    v_mfma_f32_16x16x32_bf16 v[24:27], v[176:179], v[152:155], v[24:27]
    ds_read_b128 v[164:167], v2 offset:12800
    v_add_f32 v243, 1.0, v243
    v_mfma_f32_16x16x32_bf16 v[28:31], v[176:179], v[156:159], v[28:31]
    ds_read_b128 v[168:171], v3 offset:13312
    v_mul_f32 v208, v219, v232
    v_mfma_f32_16x16x32_bf16 v[32:35], v[180:183], v[144:147], v[32:35]
    ds_read_b128 v[172:175], v2 offset:13824
    v_mul_f32 v209, v219, v233
    v_mfma_f32_16x16x32_bf16 v[36:39], v[180:183], v[148:151], v[36:39]
    ds_read_b128 v[196:199], v8 offset:46080
    v_mul_f32 v210, v219, v234
    v_mfma_f32_16x16x32_bf16 v[40:43], v[180:183], v[152:155], v[40:43]
    ds_read_b128 v[200:203], v8 offset:47104
    v_mul_f32 v211, v219, v235
    v_mfma_f32_16x16x32_bf16 v[44:47], v[180:183], v[156:159], v[44:47]
    ds_read_b128 v[204:207], v8 offset:48128
    v_fma_f32 v140, v140, v218, v208
    v_mfma_f32_16x16x32_bf16 v[48:51], v[184:187], v[144:147], v[48:51]
    v_rcp_f32 v240, v240
    v_mfma_f32_16x16x32_bf16 v[52:55], v[184:187], v[148:151], v[52:55]
    v_rcp_f32 v241, v241
    v_mfma_f32_16x16x32_bf16 v[56:59], v[184:187], v[152:155], v[56:59]
    v_rcp_f32 v242, v242
    v_mfma_f32_16x16x32_bf16 v[60:63], v[184:187], v[156:159], v[60:63]
    v_rcp_f32 v243, v243
    v_mfma_f32_16x16x32_bf16 v[64:67], v[188:191], v[144:147], v[64:67]
    v_mul_f32 v136, v136, v240
    v_mul_f32 v137, v137, v241
    v_mfma_f32_16x16x32_bf16 v[68:71], v[188:191], v[148:151], v[68:71]
    v_mul_f32 v138, v138, v242
    v_mul_f32 v139, v139, v243
    v_mfma_f32_16x16x32_bf16 v[72:75], v[188:191], v[152:155], v[72:75]
    v_fma_f32 v141, v141, v218, v209
    v_fma_f32 v142, v142, v218, v210
    v_mfma_f32_16x16x32_bf16 v[76:79], v[188:191], v[156:159], v[76:79]
    s_waitcnt lgkmcnt(0)
    s_barrier
    v_mfma_f32_16x16x32_bf16 v[16:19], v[192:195], v[160:163], v[16:19]
    ds_read_b128 v[176:179], v8 offset:0
    v_fma_f32 v143, v143, v218, v211
    v_mfma_f32_16x16x32_bf16 v[20:23], v[192:195], v[164:167], v[20:23]
    ds_read_b128 v[144:147], v2 offset:0
    v_mul_f32 v208, v140, v140
    v_mfma_f32_16x16x32_bf16 v[24:27], v[192:195], v[168:171], v[24:27]
    ds_read_b128 v[148:151], v3 offset:512
    v_mul_f32 v209, v141, v141
    v_mfma_f32_16x16x32_bf16 v[28:31], v[192:195], v[172:175], v[28:31]
    ds_read_b128 v[152:155], v2 offset:1024
    v_mul_f32 v210, v142, v142
    v_mfma_f32_16x16x32_bf16 v[32:35], v[196:199], v[160:163], v[32:35]
    ds_read_b128 v[156:159], v3 offset:1536
    v_mul_f32 v211, v143, v143
    v_mfma_f32_16x16x32_bf16 v[36:39], v[196:199], v[164:167], v[36:39]
    ds_read_b128 v[180:183], v8 offset:1024
    v_fmaak_f32 v208, v15, v208, 0xc0135761
    v_mfma_f32_16x16x32_bf16 v[40:43], v[196:199], v[168:171], v[40:43]
    ds_read_b128 v[184:187], v8 offset:2048
    v_fmaak_f32 v209, v15, v209, 0xc0135761
    v_mfma_f32_16x16x32_bf16 v[44:47], v[196:199], v[172:175], v[44:47]
    ds_read_b128 v[188:191], v8 offset:3072
    v_fmaak_f32 v210, v15, v210, 0xc0135761
    v_mfma_f32_16x16x32_bf16 v[48:51], v[200:203], v[160:163], v[48:51]
    v_fmaak_f32 v211, v15, v211, 0xc0135761
    v_mul_f32 v208, v208, v140
    v_mfma_f32_16x16x32_bf16 v[52:55], v[200:203], v[164:167], v[52:55]
    v_exp_f32 v208, v208
    v_mfma_f32_16x16x32_bf16 v[56:59], v[200:203], v[168:171], v[56:59]
    v_mul_f32 v209, v209, v141
    v_mul_f32 v210, v210, v142
    v_mfma_f32_16x16x32_bf16 v[60:63], v[200:203], v[172:175], v[60:63]
    v_exp_f32 v209, v209
    v_mfma_f32_16x16x32_bf16 v[64:67], v[204:207], v[160:163], v[64:67]
    v_exp_f32 v210, v210
    v_mfma_f32_16x16x32_bf16 v[68:71], v[204:207], v[164:167], v[68:71]
    v_mul_f32 v211, v211, v143
    v_add_f32 v208, 1.0, v208
    v_mfma_f32_16x16x32_bf16 v[72:75], v[204:207], v[168:171], v[72:75]
    v_exp_f32 v211, v211
    v_mfma_f32_16x16x32_bf16 v[76:79], v[204:207], v[172:175], v[76:79]
    v_add_f32 v209, 1.0, v209
    s_waitcnt lgkmcnt(0)
    v_mfma_f32_16x16x32_bf16 v[16:19], v[176:179], v[144:147], v[16:19]
    ds_read_b128 v[192:195], v8 offset:32768
    v_add_f32 v210, 1.0, v210
    v_mfma_f32_16x16x32_bf16 v[20:23], v[176:179], v[148:151], v[20:23]
    ds_read_b128 v[160:163], v3 offset:0
    v_add_f32 v211, 1.0, v211
    v_mfma_f32_16x16x32_bf16 v[24:27], v[176:179], v[152:155], v[24:27]
    ds_read_b128 v[164:167], v2 offset:512
    v_mfma_f32_16x16x32_bf16 v[28:31], v[176:179], v[156:159], v[28:31]
    ds_read_b128 v[168:171], v3 offset:1024
    v_mfma_f32_16x16x32_bf16 v[32:35], v[180:183], v[144:147], v[32:35]
    ds_read_b128 v[172:175], v2 offset:1536
    v_mfma_f32_16x16x32_bf16 v[36:39], v[180:183], v[148:151], v[36:39]
    ds_read_b128 v[196:199], v8 offset:33792
    v_mfma_f32_16x16x32_bf16 v[40:43], v[180:183], v[152:155], v[40:43]
    ds_read_b128 v[200:203], v8 offset:34816
    v_mfma_f32_16x16x32_bf16 v[44:47], v[180:183], v[156:159], v[44:47]
    ds_read_b128 v[204:207], v8 offset:35840
    v_mfma_f32_16x16x32_bf16 v[48:51], v[184:187], v[144:147], v[48:51]
    v_rcp_f32 v208, v208
    v_mfma_f32_16x16x32_bf16 v[52:55], v[184:187], v[148:151], v[52:55]
    v_rcp_f32 v209, v209
    v_mfma_f32_16x16x32_bf16 v[56:59], v[184:187], v[152:155], v[56:59]
    v_rcp_f32 v210, v210
    v_mfma_f32_16x16x32_bf16 v[60:63], v[184:187], v[156:159], v[60:63]
    v_rcp_f32 v211, v211
    v_mfma_f32_16x16x32_bf16 v[64:67], v[188:191], v[144:147], v[64:67]
    v_mul_f32 v140, v140, v208
    v_mul_f32 v141, v141, v209
    v_mfma_f32_16x16x32_bf16 v[68:71], v[188:191], v[148:151], v[68:71]
    v_mul_f32 v142, v142, v210
    v_mul_f32 v143, v143, v211
    v_mfma_f32_16x16x32_bf16 v[72:75], v[188:191], v[152:155], v[72:75]
    v_mfma_f32_16x16x32_bf16 v[76:79], v[188:191], v[156:159], v[76:79]
    s_waitcnt lgkmcnt(0)
    s_barrier
    v_mfma_f32_16x16x32_bf16 v[16:19], v[192:195], v[160:163], v[16:19]
    ds_read_b128 v[176:179], v8 offset:4096
    v_mfma_f32_16x16x32_bf16 v[20:23], v[192:195], v[164:167], v[20:23]
    ds_read_b128 v[144:147], v2 offset:4096
    v_mfma_f32_16x16x32_bf16 v[24:27], v[192:195], v[168:171], v[24:27]
    ds_read_b128 v[148:151], v3 offset:4608
    v_mfma_f32_16x16x32_bf16 v[28:31], v[192:195], v[172:175], v[28:31]
    ds_read_b128 v[152:155], v2 offset:5120
    v_mfma_f32_16x16x32_bf16 v[32:35], v[196:199], v[160:163], v[32:35]
    ds_read_b128 v[156:159], v3 offset:5632
    v_mfma_f32_16x16x32_bf16 v[36:39], v[196:199], v[164:167], v[36:39]
    ds_read_b128 v[180:183], v8 offset:5120
    v_mfma_f32_16x16x32_bf16 v[40:43], v[196:199], v[168:171], v[40:43]
    ds_read_b128 v[184:187], v8 offset:6144
    v_mfma_f32_16x16x32_bf16 v[44:47], v[196:199], v[172:175], v[44:47]
    ds_read_b128 v[188:191], v8 offset:7168
    v_mfma_f32_16x16x32_bf16 v[48:51], v[200:203], v[160:163], v[48:51]
    v_mfma_f32_16x16x32_bf16 v[52:55], v[200:203], v[164:167], v[52:55]
    v_mfma_f32_16x16x32_bf16 v[56:59], v[200:203], v[168:171], v[56:59]
    v_mfma_f32_16x16x32_bf16 v[60:63], v[200:203], v[172:175], v[60:63]
    v_mfma_f32_16x16x32_bf16 v[64:67], v[204:207], v[160:163], v[64:67]
    v_mfma_f32_16x16x32_bf16 v[68:71], v[204:207], v[164:167], v[68:71]
    v_mfma_f32_16x16x32_bf16 v[72:75], v[204:207], v[168:171], v[72:75]
    v_mfma_f32_16x16x32_bf16 v[76:79], v[204:207], v[172:175], v[76:79]
    s_waitcnt lgkmcnt(0)
    v_mfma_f32_16x16x32_bf16 v[16:19], v[176:179], v[144:147], v[16:19]
    ds_read_b128 v[192:195], v8 offset:36864
    v_mfma_f32_16x16x32_bf16 v[20:23], v[176:179], v[148:151], v[20:23]
    ds_read_b128 v[160:163], v3 offset:4096
    v_mfma_f32_16x16x32_bf16 v[24:27], v[176:179], v[152:155], v[24:27]
    ds_read_b128 v[164:167], v2 offset:4608
    v_mfma_f32_16x16x32_bf16 v[28:31], v[176:179], v[156:159], v[28:31]
    ds_read_b128 v[168:171], v3 offset:5120
    v_mfma_f32_16x16x32_bf16 v[32:35], v[180:183], v[144:147], v[32:35]
    ds_read_b128 v[172:175], v2 offset:5632
    v_mfma_f32_16x16x32_bf16 v[36:39], v[180:183], v[148:151], v[36:39]
    ds_read_b128 v[196:199], v8 offset:37888
    v_mfma_f32_16x16x32_bf16 v[40:43], v[180:183], v[152:155], v[40:43]
    ds_read_b128 v[200:203], v8 offset:38912
    v_mfma_f32_16x16x32_bf16 v[44:47], v[180:183], v[156:159], v[44:47]
    ds_read_b128 v[204:207], v8 offset:39936
    v_mfma_f32_16x16x32_bf16 v[48:51], v[184:187], v[144:147], v[48:51]
    v_mfma_f32_16x16x32_bf16 v[52:55], v[184:187], v[148:151], v[52:55]
    v_mfma_f32_16x16x32_bf16 v[56:59], v[184:187], v[152:155], v[56:59]
    v_mfma_f32_16x16x32_bf16 v[60:63], v[184:187], v[156:159], v[60:63]
    v_mfma_f32_16x16x32_bf16 v[64:67], v[188:191], v[144:147], v[64:67]
    v_mfma_f32_16x16x32_bf16 v[68:71], v[188:191], v[148:151], v[68:71]
    v_mfma_f32_16x16x32_bf16 v[72:75], v[188:191], v[152:155], v[72:75]
    v_mfma_f32_16x16x32_bf16 v[76:79], v[188:191], v[156:159], v[76:79]
    s_waitcnt lgkmcnt(0)
    s_barrier
    v_mfma_f32_16x16x32_bf16 v[16:19], v[192:195], v[160:163], v[16:19]
    ds_read_b128 v[176:179], v8 offset:8192
    v_mfma_f32_16x16x32_bf16 v[20:23], v[192:195], v[164:167], v[20:23]
    ds_read_b128 v[144:147], v2 offset:8192
    v_mfma_f32_16x16x32_bf16 v[24:27], v[192:195], v[168:171], v[24:27]
    ds_read_b128 v[148:151], v3 offset:8704
    v_mfma_f32_16x16x32_bf16 v[28:31], v[192:195], v[172:175], v[28:31]
    ds_read_b128 v[152:155], v2 offset:9216
    v_mfma_f32_16x16x32_bf16 v[32:35], v[196:199], v[160:163], v[32:35]
    ds_read_b128 v[156:159], v3 offset:9728
    v_mfma_f32_16x16x32_bf16 v[36:39], v[196:199], v[164:167], v[36:39]
    ds_read_b128 v[180:183], v8 offset:9216
    v_mfma_f32_16x16x32_bf16 v[40:43], v[196:199], v[168:171], v[40:43]
    ds_read_b128 v[184:187], v8 offset:10240
    v_mfma_f32_16x16x32_bf16 v[44:47], v[196:199], v[172:175], v[44:47]
    ds_read_b128 v[188:191], v8 offset:11264
    v_mfma_f32_16x16x32_bf16 v[48:51], v[200:203], v[160:163], v[48:51]
    v_mfma_f32_16x16x32_bf16 v[52:55], v[200:203], v[164:167], v[52:55]
    v_mfma_f32_16x16x32_bf16 v[56:59], v[200:203], v[168:171], v[56:59]
    v_mfma_f32_16x16x32_bf16 v[60:63], v[200:203], v[172:175], v[60:63]
    v_mfma_f32_16x16x32_bf16 v[64:67], v[204:207], v[160:163], v[64:67]
    v_mfma_f32_16x16x32_bf16 v[68:71], v[204:207], v[164:167], v[68:71]
    v_mfma_f32_16x16x32_bf16 v[72:75], v[204:207], v[168:171], v[72:75]
    v_mfma_f32_16x16x32_bf16 v[76:79], v[204:207], v[172:175], v[76:79]
    s_waitcnt lgkmcnt(0)
    v_mfma_f32_16x16x32_bf16 v[16:19], v[176:179], v[144:147], v[16:19]
    ds_read_b128 v[192:195], v8 offset:40960
    v_mfma_f32_16x16x32_bf16 v[20:23], v[176:179], v[148:151], v[20:23]
    ds_read_b128 v[160:163], v3 offset:8192
    v_mfma_f32_16x16x32_bf16 v[24:27], v[176:179], v[152:155], v[24:27]
    ds_read_b128 v[164:167], v2 offset:8704
    v_mfma_f32_16x16x32_bf16 v[28:31], v[176:179], v[156:159], v[28:31]
    ds_read_b128 v[168:171], v3 offset:9216
    v_mfma_f32_16x16x32_bf16 v[32:35], v[180:183], v[144:147], v[32:35]
    ds_read_b128 v[172:175], v2 offset:9728
    v_mfma_f32_16x16x32_bf16 v[36:39], v[180:183], v[148:151], v[36:39]
    ds_read_b128 v[196:199], v8 offset:41984
    v_mfma_f32_16x16x32_bf16 v[40:43], v[180:183], v[152:155], v[40:43]
    ds_read_b128 v[200:203], v8 offset:43008
    v_mfma_f32_16x16x32_bf16 v[44:47], v[180:183], v[156:159], v[44:47]
    ds_read_b128 v[204:207], v8 offset:44032
    v_mfma_f32_16x16x32_bf16 v[48:51], v[184:187], v[144:147], v[48:51]
    v_mfma_f32_16x16x32_bf16 v[52:55], v[184:187], v[148:151], v[52:55]
    v_mfma_f32_16x16x32_bf16 v[56:59], v[184:187], v[152:155], v[56:59]
    v_mfma_f32_16x16x32_bf16 v[60:63], v[184:187], v[156:159], v[60:63]
    v_mfma_f32_16x16x32_bf16 v[64:67], v[188:191], v[144:147], v[64:67]
    v_mfma_f32_16x16x32_bf16 v[68:71], v[188:191], v[148:151], v[68:71]
    v_mfma_f32_16x16x32_bf16 v[72:75], v[188:191], v[152:155], v[72:75]
    v_mfma_f32_16x16x32_bf16 v[76:79], v[188:191], v[156:159], v[76:79]
    s_waitcnt lgkmcnt(0)
    s_barrier
    v_mfma_f32_16x16x32_bf16 v[16:19], v[192:195], v[160:163], v[16:19]
    ds_read_b128 v[176:179], v8 offset:12288
    v_mfma_f32_16x16x32_bf16 v[20:23], v[192:195], v[164:167], v[20:23]
    ds_read_b128 v[144:147], v2 offset:12288
    v_mfma_f32_16x16x32_bf16 v[24:27], v[192:195], v[168:171], v[24:27]
    ds_read_b128 v[148:151], v3 offset:12800
    v_mfma_f32_16x16x32_bf16 v[28:31], v[192:195], v[172:175], v[28:31]
    ds_read_b128 v[152:155], v2 offset:13312
    v_mfma_f32_16x16x32_bf16 v[32:35], v[196:199], v[160:163], v[32:35]
    ds_read_b128 v[156:159], v3 offset:13824
    v_mfma_f32_16x16x32_bf16 v[36:39], v[196:199], v[164:167], v[36:39]
    ds_read_b128 v[180:183], v8 offset:13312
    v_mfma_f32_16x16x32_bf16 v[40:43], v[196:199], v[168:171], v[40:43]
    ds_read_b128 v[184:187], v8 offset:14336
    v_mfma_f32_16x16x32_bf16 v[44:47], v[196:199], v[172:175], v[44:47]
    ds_read_b128 v[188:191], v8 offset:15360
    v_mfma_f32_16x16x32_bf16 v[48:51], v[200:203], v[160:163], v[48:51]
    v_mfma_f32_16x16x32_bf16 v[52:55], v[200:203], v[164:167], v[52:55]
    v_mfma_f32_16x16x32_bf16 v[56:59], v[200:203], v[168:171], v[56:59]
    v_mfma_f32_16x16x32_bf16 v[60:63], v[200:203], v[172:175], v[60:63]
    v_mfma_f32_16x16x32_bf16 v[64:67], v[204:207], v[160:163], v[64:67]
    v_mfma_f32_16x16x32_bf16 v[68:71], v[204:207], v[164:167], v[68:71]
    v_mfma_f32_16x16x32_bf16 v[72:75], v[204:207], v[168:171], v[72:75]
    v_mfma_f32_16x16x32_bf16 v[76:79], v[204:207], v[172:175], v[76:79]
    s_waitcnt lgkmcnt(0)
    v_mfma_f32_16x16x32_bf16 v[16:19], v[176:179], v[144:147], v[16:19]
    ds_read_b128 v[192:195], v8 offset:45056
    v_mfma_f32_16x16x32_bf16 v[20:23], v[176:179], v[148:151], v[20:23]
    ds_read_b128 v[160:163], v3 offset:12288
    v_mfma_f32_16x16x32_bf16 v[24:27], v[176:179], v[152:155], v[24:27]
    ds_read_b128 v[164:167], v2 offset:12800
    v_mfma_f32_16x16x32_bf16 v[28:31], v[176:179], v[156:159], v[28:31]
    ds_read_b128 v[168:171], v3 offset:13312
    v_mfma_f32_16x16x32_bf16 v[32:35], v[180:183], v[144:147], v[32:35]
    ds_read_b128 v[172:175], v2 offset:13824
    v_mfma_f32_16x16x32_bf16 v[36:39], v[180:183], v[148:151], v[36:39]
    ds_read_b128 v[196:199], v8 offset:46080
    v_mfma_f32_16x16x32_bf16 v[40:43], v[180:183], v[152:155], v[40:43]
    ds_read_b128 v[200:203], v8 offset:47104
    v_mfma_f32_16x16x32_bf16 v[44:47], v[180:183], v[156:159], v[44:47]
    ds_read_b128 v[204:207], v8 offset:48128
    v_mfma_f32_16x16x32_bf16 v[48:51], v[184:187], v[144:147], v[48:51]
    v_mfma_f32_16x16x32_bf16 v[52:55], v[184:187], v[148:151], v[52:55]
    v_mfma_f32_16x16x32_bf16 v[56:59], v[184:187], v[152:155], v[56:59]
    v_mfma_f32_16x16x32_bf16 v[60:63], v[184:187], v[156:159], v[60:63]
    v_mfma_f32_16x16x32_bf16 v[64:67], v[188:191], v[144:147], v[64:67]
    v_mfma_f32_16x16x32_bf16 v[68:71], v[188:191], v[148:151], v[68:71]
    v_mfma_f32_16x16x32_bf16 v[72:75], v[188:191], v[152:155], v[72:75]
    v_mfma_f32_16x16x32_bf16 v[76:79], v[188:191], v[156:159], v[76:79]
    s_waitcnt lgkmcnt(0)
    s_barrier
    v_mfma_f32_16x16x32_bf16 v[16:19], v[192:195], v[160:163], v[16:19]
    ds_read_b128 v[176:179], v8 offset:0
    v_mfma_f32_16x16x32_bf16 v[20:23], v[192:195], v[164:167], v[20:23]
    ds_read_b128 v[144:147], v2 offset:0
    v_mfma_f32_16x16x32_bf16 v[24:27], v[192:195], v[168:171], v[24:27]
    ds_read_b128 v[148:151], v3 offset:512
    v_mfma_f32_16x16x32_bf16 v[28:31], v[192:195], v[172:175], v[28:31]
    ds_read_b128 v[152:155], v2 offset:1024
    v_mfma_f32_16x16x32_bf16 v[32:35], v[196:199], v[160:163], v[32:35]
    ds_read_b128 v[156:159], v3 offset:1536
    v_mfma_f32_16x16x32_bf16 v[36:39], v[196:199], v[164:167], v[36:39]
    ds_read_b128 v[180:183], v8 offset:1024
    v_mfma_f32_16x16x32_bf16 v[40:43], v[196:199], v[168:171], v[40:43]
    ds_read_b128 v[184:187], v8 offset:2048
    v_mfma_f32_16x16x32_bf16 v[44:47], v[196:199], v[172:175], v[44:47]
    ds_read_b128 v[188:191], v8 offset:3072
    v_mfma_f32_16x16x32_bf16 v[48:51], v[200:203], v[160:163], v[48:51]
    v_mfma_f32_16x16x32_bf16 v[52:55], v[200:203], v[164:167], v[52:55]
    v_mfma_f32_16x16x32_bf16 v[56:59], v[200:203], v[168:171], v[56:59]
    v_mfma_f32_16x16x32_bf16 v[60:63], v[200:203], v[172:175], v[60:63]
    v_mfma_f32_16x16x32_bf16 v[64:67], v[204:207], v[160:163], v[64:67]
    v_mfma_f32_16x16x32_bf16 v[68:71], v[204:207], v[164:167], v[68:71]
    v_mfma_f32_16x16x32_bf16 v[72:75], v[204:207], v[168:171], v[72:75]
    v_mfma_f32_16x16x32_bf16 v[76:79], v[204:207], v[172:175], v[76:79]
    s_lshr_b32 s37, s37, 20
    s_mov_b32 s51, 2
mega_kernel_G:
    s_waitcnt lgkmcnt(0)
    v_mfma_f32_16x16x32_bf16 v[16:19], v[176:179], v[144:147], v[16:19]
    ds_read_b128 v[192:195], v8 offset:32768
    v_mfma_f32_16x16x32_bf16 v[20:23], v[176:179], v[148:151], v[20:23]
    ds_read_b128 v[160:163], v3 offset:0
    v_mfma_f32_16x16x32_bf16 v[24:27], v[176:179], v[152:155], v[24:27]
    ds_read_b128 v[164:167], v2 offset:512
    v_mfma_f32_16x16x32_bf16 v[28:31], v[176:179], v[156:159], v[28:31]
    ds_read_b128 v[168:171], v3 offset:1024
    v_mfma_f32_16x16x32_bf16 v[32:35], v[180:183], v[144:147], v[32:35]
    ds_read_b128 v[172:175], v2 offset:1536
    v_mfma_f32_16x16x32_bf16 v[36:39], v[180:183], v[148:151], v[36:39]
    ds_read_b128 v[196:199], v8 offset:33792
    v_mfma_f32_16x16x32_bf16 v[40:43], v[180:183], v[152:155], v[40:43]
    ds_read_b128 v[200:203], v8 offset:34816
    v_mfma_f32_16x16x32_bf16 v[44:47], v[180:183], v[156:159], v[44:47]
    ds_read_b128 v[204:207], v8 offset:35840
    v_mfma_f32_16x16x32_bf16 v[48:51], v[184:187], v[144:147], v[48:51]
    v_mfma_f32_16x16x32_bf16 v[52:55], v[184:187], v[148:151], v[52:55]
    v_mfma_f32_16x16x32_bf16 v[56:59], v[184:187], v[152:155], v[56:59]
    v_mfma_f32_16x16x32_bf16 v[60:63], v[184:187], v[156:159], v[60:63]
    v_mfma_f32_16x16x32_bf16 v[64:67], v[188:191], v[144:147], v[64:67]
    v_mfma_f32_16x16x32_bf16 v[68:71], v[188:191], v[148:151], v[68:71]
    v_mfma_f32_16x16x32_bf16 v[72:75], v[188:191], v[152:155], v[72:75]
    v_mfma_f32_16x16x32_bf16 v[76:79], v[188:191], v[156:159], v[76:79]
    s_waitcnt lgkmcnt(0)
    s_barrier
    v_mfma_f32_16x16x32_bf16 v[16:19], v[192:195], v[160:163], v[16:19]
    ds_read_b128 v[176:179], v8 offset:4096
    v_mfma_f32_16x16x32_bf16 v[20:23], v[192:195], v[164:167], v[20:23]
    ds_read_b128 v[144:147], v2 offset:4096
    v_mfma_f32_16x16x32_bf16 v[24:27], v[192:195], v[168:171], v[24:27]
    ds_read_b128 v[148:151], v3 offset:4608
    v_mfma_f32_16x16x32_bf16 v[28:31], v[192:195], v[172:175], v[28:31]
    ds_read_b128 v[152:155], v2 offset:5120
    v_mfma_f32_16x16x32_bf16 v[32:35], v[196:199], v[160:163], v[32:35]
    ds_read_b128 v[156:159], v3 offset:5632
    v_mfma_f32_16x16x32_bf16 v[36:39], v[196:199], v[164:167], v[36:39]
    ds_read_b128 v[180:183], v8 offset:5120
    v_mfma_f32_16x16x32_bf16 v[40:43], v[196:199], v[168:171], v[40:43]
    ds_read_b128 v[184:187], v8 offset:6144
    v_mfma_f32_16x16x32_bf16 v[44:47], v[196:199], v[172:175], v[44:47]
    ds_read_b128 v[188:191], v8 offset:7168
    v_mfma_f32_16x16x32_bf16 v[48:51], v[200:203], v[160:163], v[48:51]
    v_mfma_f32_16x16x32_bf16 v[52:55], v[200:203], v[164:167], v[52:55]
    v_mfma_f32_16x16x32_bf16 v[56:59], v[200:203], v[168:171], v[56:59]
    v_mfma_f32_16x16x32_bf16 v[60:63], v[200:203], v[172:175], v[60:63]
    v_mfma_f32_16x16x32_bf16 v[64:67], v[204:207], v[160:163], v[64:67]
    v_mfma_f32_16x16x32_bf16 v[68:71], v[204:207], v[164:167], v[68:71]
    v_mfma_f32_16x16x32_bf16 v[72:75], v[204:207], v[168:171], v[72:75]
    v_mfma_f32_16x16x32_bf16 v[76:79], v[204:207], v[172:175], v[76:79]
    s_waitcnt lgkmcnt(0)
    v_mfma_f32_16x16x32_bf16 v[16:19], v[176:179], v[144:147], v[16:19]
    ds_read_b128 v[192:195], v8 offset:36864
    v_mfma_f32_16x16x32_bf16 v[20:23], v[176:179], v[148:151], v[20:23]
    ds_read_b128 v[160:163], v3 offset:4096
    v_mfma_f32_16x16x32_bf16 v[24:27], v[176:179], v[152:155], v[24:27]
    ds_read_b128 v[164:167], v2 offset:4608
    v_mfma_f32_16x16x32_bf16 v[28:31], v[176:179], v[156:159], v[28:31]
    ds_read_b128 v[168:171], v3 offset:5120
    v_mfma_f32_16x16x32_bf16 v[32:35], v[180:183], v[144:147], v[32:35]
    ds_read_b128 v[172:175], v2 offset:5632
    v_mfma_f32_16x16x32_bf16 v[36:39], v[180:183], v[148:151], v[36:39]
    ds_read_b128 v[196:199], v8 offset:37888
    v_mfma_f32_16x16x32_bf16 v[40:43], v[180:183], v[152:155], v[40:43]
    ds_read_b128 v[200:203], v8 offset:38912
    v_mfma_f32_16x16x32_bf16 v[44:47], v[180:183], v[156:159], v[44:47]
    ds_read_b128 v[204:207], v8 offset:39936
    v_mfma_f32_16x16x32_bf16 v[48:51], v[184:187], v[144:147], v[48:51]
    v_mfma_f32_16x16x32_bf16 v[52:55], v[184:187], v[148:151], v[52:55]
    v_mfma_f32_16x16x32_bf16 v[56:59], v[184:187], v[152:155], v[56:59]
    v_mfma_f32_16x16x32_bf16 v[60:63], v[184:187], v[156:159], v[60:63]
    v_mfma_f32_16x16x32_bf16 v[64:67], v[188:191], v[144:147], v[64:67]
    v_mfma_f32_16x16x32_bf16 v[68:71], v[188:191], v[148:151], v[68:71]
    v_mfma_f32_16x16x32_bf16 v[72:75], v[188:191], v[152:155], v[72:75]
    v_mfma_f32_16x16x32_bf16 v[76:79], v[188:191], v[156:159], v[76:79]
    s_waitcnt lgkmcnt(0)
    s_barrier
    v_mfma_f32_16x16x32_bf16 v[16:19], v[192:195], v[160:163], v[16:19]
    ds_read_b128 v[176:179], v8 offset:8192
    v_mfma_f32_16x16x32_bf16 v[20:23], v[192:195], v[164:167], v[20:23]
    ds_read_b128 v[144:147], v2 offset:8192
    v_mfma_f32_16x16x32_bf16 v[24:27], v[192:195], v[168:171], v[24:27]
    ds_read_b128 v[148:151], v3 offset:8704
    v_mfma_f32_16x16x32_bf16 v[28:31], v[192:195], v[172:175], v[28:31]
    ds_read_b128 v[152:155], v2 offset:9216
    v_mfma_f32_16x16x32_bf16 v[32:35], v[196:199], v[160:163], v[32:35]
    ds_read_b128 v[156:159], v3 offset:9728
    v_mfma_f32_16x16x32_bf16 v[36:39], v[196:199], v[164:167], v[36:39]
    ds_read_b128 v[180:183], v8 offset:9216
    v_mfma_f32_16x16x32_bf16 v[40:43], v[196:199], v[168:171], v[40:43]
    ds_read_b128 v[184:187], v8 offset:10240
    v_mfma_f32_16x16x32_bf16 v[44:47], v[196:199], v[172:175], v[44:47]
    ds_read_b128 v[188:191], v8 offset:11264
    v_mfma_f32_16x16x32_bf16 v[48:51], v[200:203], v[160:163], v[48:51]
    v_mfma_f32_16x16x32_bf16 v[52:55], v[200:203], v[164:167], v[52:55]
    v_mfma_f32_16x16x32_bf16 v[56:59], v[200:203], v[168:171], v[56:59]
    v_mfma_f32_16x16x32_bf16 v[60:63], v[200:203], v[172:175], v[60:63]
    v_mfma_f32_16x16x32_bf16 v[64:67], v[204:207], v[160:163], v[64:67]
    v_mfma_f32_16x16x32_bf16 v[68:71], v[204:207], v[164:167], v[68:71]
    v_mfma_f32_16x16x32_bf16 v[72:75], v[204:207], v[168:171], v[72:75]
    v_mfma_f32_16x16x32_bf16 v[76:79], v[204:207], v[172:175], v[76:79]
    s_waitcnt lgkmcnt(0)
    v_mfma_f32_16x16x32_bf16 v[16:19], v[176:179], v[144:147], v[16:19]
    ds_read_b128 v[192:195], v8 offset:40960
    v_mfma_f32_16x16x32_bf16 v[20:23], v[176:179], v[148:151], v[20:23]
    ds_read_b128 v[160:163], v3 offset:8192
    v_mfma_f32_16x16x32_bf16 v[24:27], v[176:179], v[152:155], v[24:27]
    ds_read_b128 v[164:167], v2 offset:8704
    v_mfma_f32_16x16x32_bf16 v[28:31], v[176:179], v[156:159], v[28:31]
    ds_read_b128 v[168:171], v3 offset:9216
    v_mfma_f32_16x16x32_bf16 v[32:35], v[180:183], v[144:147], v[32:35]
    ds_read_b128 v[172:175], v2 offset:9728
    v_mfma_f32_16x16x32_bf16 v[36:39], v[180:183], v[148:151], v[36:39]
    ds_read_b128 v[196:199], v8 offset:41984
    v_mfma_f32_16x16x32_bf16 v[40:43], v[180:183], v[152:155], v[40:43]
    ds_read_b128 v[200:203], v8 offset:43008
    v_mfma_f32_16x16x32_bf16 v[44:47], v[180:183], v[156:159], v[44:47]
    ds_read_b128 v[204:207], v8 offset:44032
    v_mfma_f32_16x16x32_bf16 v[48:51], v[184:187], v[144:147], v[48:51]
    v_mfma_f32_16x16x32_bf16 v[52:55], v[184:187], v[148:151], v[52:55]
    v_mfma_f32_16x16x32_bf16 v[56:59], v[184:187], v[152:155], v[56:59]
    v_mfma_f32_16x16x32_bf16 v[60:63], v[184:187], v[156:159], v[60:63]
    v_mfma_f32_16x16x32_bf16 v[64:67], v[188:191], v[144:147], v[64:67]
    v_mfma_f32_16x16x32_bf16 v[68:71], v[188:191], v[148:151], v[68:71]
    v_mfma_f32_16x16x32_bf16 v[72:75], v[188:191], v[152:155], v[72:75]
    v_mfma_f32_16x16x32_bf16 v[76:79], v[188:191], v[156:159], v[76:79]
    s_waitcnt lgkmcnt(0)
    s_barrier
    v_mfma_f32_16x16x32_bf16 v[16:19], v[192:195], v[160:163], v[16:19]
    ds_read_b128 v[176:179], v8 offset:12288
    v_mfma_f32_16x16x32_bf16 v[20:23], v[192:195], v[164:167], v[20:23]
    ds_read_b128 v[144:147], v2 offset:12288
    v_mfma_f32_16x16x32_bf16 v[24:27], v[192:195], v[168:171], v[24:27]
    ds_read_b128 v[148:151], v3 offset:12800
    v_mfma_f32_16x16x32_bf16 v[28:31], v[192:195], v[172:175], v[28:31]
    ds_read_b128 v[152:155], v2 offset:13312
    v_mfma_f32_16x16x32_bf16 v[32:35], v[196:199], v[160:163], v[32:35]
    ds_read_b128 v[156:159], v3 offset:13824
    v_mfma_f32_16x16x32_bf16 v[36:39], v[196:199], v[164:167], v[36:39]
    ds_read_b128 v[180:183], v8 offset:13312
    v_mfma_f32_16x16x32_bf16 v[40:43], v[196:199], v[168:171], v[40:43]
    ds_read_b128 v[184:187], v8 offset:14336
    v_mfma_f32_16x16x32_bf16 v[44:47], v[196:199], v[172:175], v[44:47]
    ds_read_b128 v[188:191], v8 offset:15360
    v_mfma_f32_16x16x32_bf16 v[48:51], v[200:203], v[160:163], v[48:51]
    v_mfma_f32_16x16x32_bf16 v[52:55], v[200:203], v[164:167], v[52:55]
    v_mfma_f32_16x16x32_bf16 v[56:59], v[200:203], v[168:171], v[56:59]
    v_mfma_f32_16x16x32_bf16 v[60:63], v[200:203], v[172:175], v[60:63]
    v_mfma_f32_16x16x32_bf16 v[64:67], v[204:207], v[160:163], v[64:67]
    v_mfma_f32_16x16x32_bf16 v[68:71], v[204:207], v[164:167], v[68:71]
    v_mfma_f32_16x16x32_bf16 v[72:75], v[204:207], v[168:171], v[72:75]
    v_mfma_f32_16x16x32_bf16 v[76:79], v[204:207], v[172:175], v[76:79]
    s_waitcnt lgkmcnt(0)
    v_mfma_f32_16x16x32_bf16 v[16:19], v[176:179], v[144:147], v[16:19]
    ds_read_b128 v[192:195], v8 offset:45056
    v_mfma_f32_16x16x32_bf16 v[20:23], v[176:179], v[148:151], v[20:23]
    ds_read_b128 v[160:163], v3 offset:12288
    v_mfma_f32_16x16x32_bf16 v[24:27], v[176:179], v[152:155], v[24:27]
    ds_read_b128 v[164:167], v2 offset:12800
    v_mfma_f32_16x16x32_bf16 v[28:31], v[176:179], v[156:159], v[28:31]
    ds_read_b128 v[168:171], v3 offset:13312
    v_mfma_f32_16x16x32_bf16 v[32:35], v[180:183], v[144:147], v[32:35]
    ds_read_b128 v[172:175], v2 offset:13824
    v_mfma_f32_16x16x32_bf16 v[36:39], v[180:183], v[148:151], v[36:39]
    ds_read_b128 v[196:199], v8 offset:46080
    v_mfma_f32_16x16x32_bf16 v[40:43], v[180:183], v[152:155], v[40:43]
    ds_read_b128 v[200:203], v8 offset:47104
    v_mfma_f32_16x16x32_bf16 v[44:47], v[180:183], v[156:159], v[44:47]
    ds_read_b128 v[204:207], v8 offset:48128
    v_mfma_f32_16x16x32_bf16 v[48:51], v[184:187], v[144:147], v[48:51]
    v_mfma_f32_16x16x32_bf16 v[52:55], v[184:187], v[148:151], v[52:55]
    v_mfma_f32_16x16x32_bf16 v[56:59], v[184:187], v[152:155], v[56:59]
    v_mfma_f32_16x16x32_bf16 v[60:63], v[184:187], v[156:159], v[60:63]
    v_mfma_f32_16x16x32_bf16 v[64:67], v[188:191], v[144:147], v[64:67]
    v_mfma_f32_16x16x32_bf16 v[68:71], v[188:191], v[148:151], v[68:71]
    v_mfma_f32_16x16x32_bf16 v[72:75], v[188:191], v[152:155], v[72:75]
    v_mfma_f32_16x16x32_bf16 v[76:79], v[188:191], v[156:159], v[76:79]
    s_waitcnt lgkmcnt(0)
    s_barrier
    v_mfma_f32_16x16x32_bf16 v[16:19], v[192:195], v[160:163], v[16:19]
    ds_read_b128 v[176:179], v8 offset:0
    v_mfma_f32_16x16x32_bf16 v[20:23], v[192:195], v[164:167], v[20:23]
    ds_read_b128 v[144:147], v2 offset:0
    v_mfma_f32_16x16x32_bf16 v[24:27], v[192:195], v[168:171], v[24:27]
    ds_read_b128 v[148:151], v3 offset:512
    v_mfma_f32_16x16x32_bf16 v[28:31], v[192:195], v[172:175], v[28:31]
    ds_read_b128 v[152:155], v2 offset:1024
    v_mfma_f32_16x16x32_bf16 v[32:35], v[196:199], v[160:163], v[32:35]
    ds_read_b128 v[156:159], v3 offset:1536
    v_mfma_f32_16x16x32_bf16 v[36:39], v[196:199], v[164:167], v[36:39]
    ds_read_b128 v[180:183], v8 offset:1024
    v_mfma_f32_16x16x32_bf16 v[40:43], v[196:199], v[168:171], v[40:43]
    ds_read_b128 v[184:187], v8 offset:2048
    v_mfma_f32_16x16x32_bf16 v[44:47], v[196:199], v[172:175], v[44:47]
    ds_read_b128 v[188:191], v8 offset:3072
    v_mfma_f32_16x16x32_bf16 v[48:51], v[200:203], v[160:163], v[48:51]
    v_mfma_f32_16x16x32_bf16 v[52:55], v[200:203], v[164:167], v[52:55]
    v_mfma_f32_16x16x32_bf16 v[56:59], v[200:203], v[168:171], v[56:59]
    v_mfma_f32_16x16x32_bf16 v[60:63], v[200:203], v[172:175], v[60:63]
    v_mfma_f32_16x16x32_bf16 v[64:67], v[204:207], v[160:163], v[64:67]
    v_mfma_f32_16x16x32_bf16 v[68:71], v[204:207], v[164:167], v[68:71]
    v_mfma_f32_16x16x32_bf16 v[72:75], v[204:207], v[168:171], v[72:75]
    v_mfma_f32_16x16x32_bf16 v[76:79], v[204:207], v[172:175], v[76:79]
    s_lshr_b32 s37, s37, 4
    s_sub_u32 s51, s51, 1
    s_cmp_lg_u32 s51, 0
    s_cbranch_scc1 mega_kernel_G
    s_waitcnt lgkmcnt(0)
    v_mfma_f32_16x16x32_bf16 v[16:19], v[176:179], v[144:147], v[16:19]
    ds_read_b128 v[192:195], v8 offset:32768
    v_mfma_f32_16x16x32_bf16 v[20:23], v[176:179], v[148:151], v[20:23]
    ds_read_b128 v[160:163], v3 offset:0
    s_lshl_b32 s40, s42, 13
    s_add_u32 s40, s40, 147456
    s_lshl_b32 s41, s43, 2
    v_bfe_u32 v5, v0, 2, 2
    v_mfma_f32_16x16x32_bf16 v[24:27], v[176:179], v[152:155], v[24:27]
    ds_read_b128 v[164:167], v2 offset:512
    v_and_b32 v6, 3, v0
    v_mfma_f32_16x16x32_bf16 v[28:31], v[176:179], v[156:159], v[28:31]
    ds_read_b128 v[168:171], v3 offset:1024
    v_lshl_add_u32 v5, v5, 3, v6
    v_mfma_f32_16x16x32_bf16 v[32:35], v[180:183], v[144:147], v[32:35]
    ds_read_b128 v[172:175], v2 offset:1536
    v_bfe_u32 v6, v0, 1, 3
    v_mfma_f32_16x16x32_bf16 v[36:39], v[180:183], v[148:151], v[36:39]
    ds_read_b128 v[196:199], v8 offset:33792
    v_lshrrev_b32 v7, 5, v0
    v_mfma_f32_16x16x32_bf16 v[40:43], v[180:183], v[152:155], v[40:43]
    ds_read_b128 v[200:203], v8 offset:34816
    v_xor_b32 v6, v6, v7
    v_mfma_f32_16x16x32_bf16 v[44:47], v[180:183], v[156:159], v[44:47]
    ds_read_b128 v[204:207], v8 offset:35840
    v_xor_b32 v6, s41, v6
    v_mfma_f32_16x16x32_bf16 v[48:51], v[184:187], v[144:147], v[48:51]
    v_lshlrev_b32 v6, 4, v6
    v_lshl_add_u32 v6, v5, 7, v6
    v_mfma_f32_16x16x32_bf16 v[52:55], v[184:187], v[148:151], v[52:55]
    v_bfe_u32 v7, v0, 4, 1
    v_lshl_add_u32 v6, v7, 3, v6
    v_mfma_f32_16x16x32_bf16 v[56:59], v[184:187], v[152:155], v[56:59]
    v_add_u32 v4, s40, v6
    v_xor_b32 v5, 32, v4
    v_mfma_f32_16x16x32_bf16 v[60:63], v[184:187], v[156:159], v[60:63]
    v_mfma_f32_16x16x32_bf16 v[64:67], v[188:191], v[144:147], v[64:67]
    v_mfma_f32_16x16x32_bf16 v[68:71], v[188:191], v[148:151], v[68:71]
    v_mfma_f32_16x16x32_bf16 v[72:75], v[188:191], v[152:155], v[72:75]
    v_mfma_f32_16x16x32_bf16 v[76:79], v[188:191], v[156:159], v[76:79]
    s_waitcnt lgkmcnt(0)
    s_barrier
    v_mfma_f32_16x16x32_bf16 v[16:19], v[192:195], v[160:163], v[16:19]
    ds_read_b128 v[176:179], v8 offset:4096
    v_mfma_f32_16x16x32_bf16 v[20:23], v[192:195], v[164:167], v[20:23]
    ds_read_b128 v[144:147], v2 offset:4096
    v_mfma_f32_16x16x32_bf16 v[24:27], v[192:195], v[168:171], v[24:27]
    ds_read_b128 v[148:151], v3 offset:4608
    v_mfma_f32_16x16x32_bf16 v[28:31], v[192:195], v[172:175], v[28:31]
    ds_read_b128 v[152:155], v2 offset:5120
    v_mfma_f32_16x16x32_bf16 v[32:35], v[196:199], v[160:163], v[32:35]
    ds_read_b128 v[156:159], v3 offset:5632
    v_mfma_f32_16x16x32_bf16 v[36:39], v[196:199], v[164:167], v[36:39]
    ds_read_b128 v[180:183], v8 offset:5120
    v_mfma_f32_16x16x32_bf16 v[40:43], v[196:199], v[168:171], v[40:43]
    ds_read_b128 v[184:187], v8 offset:6144
    v_mfma_f32_16x16x32_bf16 v[44:47], v[196:199], v[172:175], v[44:47]
    ds_read_b128 v[188:191], v8 offset:7168
    v_mfma_f32_16x16x32_bf16 v[48:51], v[200:203], v[160:163], v[48:51]
    v_mfma_f32_16x16x32_bf16 v[52:55], v[200:203], v[164:167], v[52:55]
    v_mfma_f32_16x16x32_bf16 v[56:59], v[200:203], v[168:171], v[56:59]
    v_mfma_f32_16x16x32_bf16 v[60:63], v[200:203], v[172:175], v[60:63]
    v_mfma_f32_16x16x32_bf16 v[64:67], v[204:207], v[160:163], v[64:67]
    v_mfma_f32_16x16x32_bf16 v[68:71], v[204:207], v[164:167], v[68:71]
    v_mfma_f32_16x16x32_bf16 v[72:75], v[204:207], v[168:171], v[72:75]
    v_mfma_f32_16x16x32_bf16 v[76:79], v[204:207], v[172:175], v[76:79]
    s_waitcnt lgkmcnt(0)
    v_mfma_f32_16x16x32_bf16 v[16:19], v[176:179], v[144:147], v[16:19]
    ds_read_b128 v[192:195], v8 offset:36864
    v_mfma_f32_16x16x32_bf16 v[20:23], v[176:179], v[148:151], v[20:23]
    ds_read_b128 v[160:163], v3 offset:4096
    v_mfma_f32_16x16x32_bf16 v[24:27], v[176:179], v[152:155], v[24:27]
    ds_read_b128 v[164:167], v2 offset:4608
    v_mfma_f32_16x16x32_bf16 v[28:31], v[176:179], v[156:159], v[28:31]
    ds_read_b128 v[168:171], v3 offset:5120
    v_mfma_f32_16x16x32_bf16 v[32:35], v[180:183], v[144:147], v[32:35]
    ds_read_b128 v[172:175], v2 offset:5632
    v_mfma_f32_16x16x32_bf16 v[36:39], v[180:183], v[148:151], v[36:39]
    ds_read_b128 v[196:199], v8 offset:37888
    v_mfma_f32_16x16x32_bf16 v[40:43], v[180:183], v[152:155], v[40:43]
    ds_read_b128 v[200:203], v8 offset:38912
    v_mfma_f32_16x16x32_bf16 v[44:47], v[180:183], v[156:159], v[44:47]
    ds_read_b128 v[204:207], v8 offset:39936
    v_mfma_f32_16x16x32_bf16 v[48:51], v[184:187], v[144:147], v[48:51]
    v_mfma_f32_16x16x32_bf16 v[52:55], v[184:187], v[148:151], v[52:55]
    v_mfma_f32_16x16x32_bf16 v[56:59], v[184:187], v[152:155], v[56:59]
    v_mfma_f32_16x16x32_bf16 v[60:63], v[184:187], v[156:159], v[60:63]
    v_mfma_f32_16x16x32_bf16 v[64:67], v[188:191], v[144:147], v[64:67]
    v_mfma_f32_16x16x32_bf16 v[68:71], v[188:191], v[148:151], v[68:71]
    v_mfma_f32_16x16x32_bf16 v[72:75], v[188:191], v[152:155], v[72:75]
    v_mfma_f32_16x16x32_bf16 v[76:79], v[188:191], v[156:159], v[76:79]
    s_waitcnt lgkmcnt(0)
    s_barrier
    v_mfma_f32_16x16x32_bf16 v[16:19], v[192:195], v[160:163], v[16:19]
    ds_read_b128 v[176:179], v8 offset:8192
    v_mfma_f32_16x16x32_bf16 v[20:23], v[192:195], v[164:167], v[20:23]
    ds_read_b128 v[144:147], v2 offset:8192
    v_mfma_f32_16x16x32_bf16 v[24:27], v[192:195], v[168:171], v[24:27]
    ds_read_b128 v[148:151], v3 offset:8704
    v_mfma_f32_16x16x32_bf16 v[28:31], v[192:195], v[172:175], v[28:31]
    ds_read_b128 v[152:155], v2 offset:9216
    v_mfma_f32_16x16x32_bf16 v[32:35], v[196:199], v[160:163], v[32:35]
    ds_read_b128 v[156:159], v3 offset:9728
    v_mfma_f32_16x16x32_bf16 v[36:39], v[196:199], v[164:167], v[36:39]
    ds_read_b128 v[180:183], v8 offset:9216
    v_mfma_f32_16x16x32_bf16 v[40:43], v[196:199], v[168:171], v[40:43]
    ds_read_b128 v[184:187], v8 offset:10240
    v_mfma_f32_16x16x32_bf16 v[44:47], v[196:199], v[172:175], v[44:47]
    ds_read_b128 v[188:191], v8 offset:11264
    v_mfma_f32_16x16x32_bf16 v[48:51], v[200:203], v[160:163], v[48:51]
    v_mfma_f32_16x16x32_bf16 v[52:55], v[200:203], v[164:167], v[52:55]
    v_mfma_f32_16x16x32_bf16 v[56:59], v[200:203], v[168:171], v[56:59]
    v_mfma_f32_16x16x32_bf16 v[60:63], v[200:203], v[172:175], v[60:63]
    v_mfma_f32_16x16x32_bf16 v[64:67], v[204:207], v[160:163], v[64:67]
    v_mfma_f32_16x16x32_bf16 v[68:71], v[204:207], v[164:167], v[68:71]
    v_mfma_f32_16x16x32_bf16 v[72:75], v[204:207], v[168:171], v[72:75]
    v_mfma_f32_16x16x32_bf16 v[76:79], v[204:207], v[172:175], v[76:79]
    s_waitcnt lgkmcnt(0)
    v_mfma_f32_16x16x32_bf16 v[16:19], v[176:179], v[144:147], v[16:19]
    ds_read_b128 v[192:195], v8 offset:40960
    v_mfma_f32_16x16x32_bf16 v[20:23], v[176:179], v[148:151], v[20:23]
    ds_read_b128 v[160:163], v3 offset:8192
    v_mfma_f32_16x16x32_bf16 v[24:27], v[176:179], v[152:155], v[24:27]
    ds_read_b128 v[164:167], v2 offset:8704
    v_mfma_f32_16x16x32_bf16 v[28:31], v[176:179], v[156:159], v[28:31]
    ds_read_b128 v[168:171], v3 offset:9216
    v_mfma_f32_16x16x32_bf16 v[32:35], v[180:183], v[144:147], v[32:35]
    ds_read_b128 v[172:175], v2 offset:9728
    v_mfma_f32_16x16x32_bf16 v[36:39], v[180:183], v[148:151], v[36:39]
    ds_read_b128 v[196:199], v8 offset:41984
    v_mfma_f32_16x16x32_bf16 v[40:43], v[180:183], v[152:155], v[40:43]
    ds_read_b128 v[200:203], v8 offset:43008
    v_mfma_f32_16x16x32_bf16 v[44:47], v[180:183], v[156:159], v[44:47]
    ds_read_b128 v[204:207], v8 offset:44032
    v_mfma_f32_16x16x32_bf16 v[48:51], v[184:187], v[144:147], v[48:51]
    v_mfma_f32_16x16x32_bf16 v[52:55], v[184:187], v[148:151], v[52:55]
    v_mfma_f32_16x16x32_bf16 v[56:59], v[184:187], v[152:155], v[56:59]
    v_mfma_f32_16x16x32_bf16 v[60:63], v[184:187], v[156:159], v[60:63]
    v_mfma_f32_16x16x32_bf16 v[64:67], v[188:191], v[144:147], v[64:67]
    v_mfma_f32_16x16x32_bf16 v[68:71], v[188:191], v[148:151], v[68:71]
    v_mfma_f32_16x16x32_bf16 v[72:75], v[188:191], v[152:155], v[72:75]
    v_mfma_f32_16x16x32_bf16 v[76:79], v[188:191], v[156:159], v[76:79]
    s_waitcnt lgkmcnt(0)
    s_barrier
    v_mfma_f32_16x16x32_bf16 v[16:19], v[192:195], v[160:163], v[16:19]
    ds_read_b128 v[176:179], v8 offset:12288
    v_mfma_f32_16x16x32_bf16 v[20:23], v[192:195], v[164:167], v[20:23]
    ds_read_b128 v[144:147], v2 offset:12288
    v_mfma_f32_16x16x32_bf16 v[24:27], v[192:195], v[168:171], v[24:27]
    ds_read_b128 v[148:151], v3 offset:12800
    v_mfma_f32_16x16x32_bf16 v[28:31], v[192:195], v[172:175], v[28:31]
    ds_read_b128 v[152:155], v2 offset:13312
    v_mfma_f32_16x16x32_bf16 v[32:35], v[196:199], v[160:163], v[32:35]
    ds_read_b128 v[156:159], v3 offset:13824
    v_mfma_f32_16x16x32_bf16 v[36:39], v[196:199], v[164:167], v[36:39]
    ds_read_b128 v[180:183], v8 offset:13312
    v_mfma_f32_16x16x32_bf16 v[40:43], v[196:199], v[168:171], v[40:43]
    ds_read_b128 v[184:187], v8 offset:14336
    v_mfma_f32_16x16x32_bf16 v[44:47], v[196:199], v[172:175], v[44:47]
    ds_read_b128 v[188:191], v8 offset:15360
    v_mfma_f32_16x16x32_bf16 v[48:51], v[200:203], v[160:163], v[48:51]
    v_mfma_f32_16x16x32_bf16 v[52:55], v[200:203], v[164:167], v[52:55]
    v_mfma_f32_16x16x32_bf16 v[56:59], v[200:203], v[168:171], v[56:59]
    v_mfma_f32_16x16x32_bf16 v[60:63], v[200:203], v[172:175], v[60:63]
    v_mfma_f32_16x16x32_bf16 v[64:67], v[204:207], v[160:163], v[64:67]
    v_mfma_f32_16x16x32_bf16 v[68:71], v[204:207], v[164:167], v[68:71]
    v_mfma_f32_16x16x32_bf16 v[72:75], v[204:207], v[168:171], v[72:75]
    v_mfma_f32_16x16x32_bf16 v[76:79], v[204:207], v[172:175], v[76:79]
    s_waitcnt lgkmcnt(0)
    v_mfma_f32_16x16x32_bf16 v[16:19], v[176:179], v[144:147], v[16:19]
    ds_read_b128 v[192:195], v8 offset:45056
    v_mfma_f32_16x16x32_bf16 v[20:23], v[176:179], v[148:151], v[20:23]
    ds_read_b128 v[160:163], v3 offset:12288
    v_mfma_f32_16x16x32_bf16 v[24:27], v[176:179], v[152:155], v[24:27]
    ds_read_b128 v[164:167], v2 offset:12800
    v_mfma_f32_16x16x32_bf16 v[28:31], v[176:179], v[156:159], v[28:31]
    ds_read_b128 v[168:171], v3 offset:13312
    v_mfma_f32_16x16x32_bf16 v[32:35], v[180:183], v[144:147], v[32:35]
    ds_read_b128 v[172:175], v2 offset:13824
    v_mfma_f32_16x16x32_bf16 v[36:39], v[180:183], v[148:151], v[36:39]
    ds_read_b128 v[196:199], v8 offset:46080
    v_mfma_f32_16x16x32_bf16 v[40:43], v[180:183], v[152:155], v[40:43]
    ds_read_b128 v[200:203], v8 offset:47104
    v_mfma_f32_16x16x32_bf16 v[44:47], v[180:183], v[156:159], v[44:47]
    ds_read_b128 v[204:207], v8 offset:48128
    v_mfma_f32_16x16x32_bf16 v[48:51], v[184:187], v[144:147], v[48:51]
    ds_read_b64 v[224:225], v4 offset:0
    v_mfma_f32_16x16x32_bf16 v[52:55], v[184:187], v[148:151], v[52:55]
    ds_read_b64 v[226:227], v4 offset:512
    v_mfma_f32_16x16x32_bf16 v[56:59], v[184:187], v[152:155], v[56:59]
    ds_read_b64 v[228:229], v4 offset:4096
    v_mfma_f32_16x16x32_bf16 v[60:63], v[184:187], v[156:159], v[60:63]
    ds_read_b64 v[230:231], v4 offset:4608
    v_mfma_f32_16x16x32_bf16 v[64:67], v[188:191], v[144:147], v[64:67]
    ds_read_b64 v[232:233], v5 offset:0
    v_mfma_f32_16x16x32_bf16 v[68:71], v[188:191], v[148:151], v[68:71]
    ds_read_b64 v[234:235], v5 offset:512
    v_mfma_f32_16x16x32_bf16 v[72:75], v[188:191], v[152:155], v[72:75]
    ds_read_b64 v[236:237], v5 offset:4096
    v_mfma_f32_16x16x32_bf16 v[76:79], v[188:191], v[156:159], v[76:79]
    ds_read_b64 v[238:239], v5 offset:4608
    s_waitcnt lgkmcnt(0)
    s_barrier
    v_mfma_f32_16x16x32_bf16 v[16:19], v[192:195], v[160:163], v[16:19]
    s_and_b32 s40, s38, 1
    s_lshl_b32 s40, s40, 14
    s_lshr_b32 s41, s38, 1
    s_lshl_b32 s41, s41, 12
    s_add_u32 s40, s40, s41
    v_add_u32 v1, s40, v9
    v_mfma_f32_16x16x32_bf16 v[20:23], v[192:195], v[164:167], v[20:23]
    v_mfma_f32_16x16x32_bf16 v[24:27], v[192:195], v[168:171], v[24:27]
    v_mfma_f32_16x16x32_bf16 v[28:31], v[192:195], v[172:175], v[28:31]
    v_mfma_f32_16x16x32_bf16 v[32:35], v[196:199], v[160:163], v[32:35]
    v_mfma_f32_16x16x32_bf16 v[36:39], v[196:199], v[164:167], v[36:39]
    v_mfma_f32_16x16x32_bf16 v[40:43], v[196:199], v[168:171], v[40:43]
    v_mfma_f32_16x16x32_bf16 v[44:47], v[196:199], v[172:175], v[44:47]
    v_mfma_f32_16x16x32_bf16 v[48:51], v[200:203], v[160:163], v[48:51]
    v_mfma_f32_16x16x32_bf16 v[52:55], v[200:203], v[164:167], v[52:55]
    v_mfma_f32_16x16x32_bf16 v[56:59], v[200:203], v[168:171], v[56:59]
    v_mfma_f32_16x16x32_bf16 v[60:63], v[200:203], v[172:175], v[60:63]
    v_mfma_f32_16x16x32_bf16 v[64:67], v[204:207], v[160:163], v[64:67]
    v_mfma_f32_16x16x32_bf16 v[68:71], v[204:207], v[164:167], v[68:71]
    v_mfma_f32_16x16x32_bf16 v[72:75], v[204:207], v[168:171], v[72:75]
    v_mfma_f32_16x16x32_bf16 v[76:79], v[204:207], v[172:175], v[76:79]
    v_pk_mul_f32 v[16:17], v[16:17], v[80:81]
    v_pk_mul_f32 v[18:19], v[18:19], v[82:83]
    v_pk_mul_f32 v[32:33], v[32:33], v[96:97]
    v_pk_mul_f32 v[34:35], v[34:35], v[98:99]
    v_cvt_pk_bf16_f32 v176, v16, v17
    v_cvt_pk_bf16_f32 v177, v18, v19
    v_cvt_pk_bf16_f32 v178, v32, v33
    v_cvt_pk_bf16_f32 v179, v34, v35
    buffer_store_dwordx4 v[176:179], v9, s[28:31], 0 offen offset:0 sc1
    v_pk_mul_f32 v[20:21], v[20:21], v[84:85]
    v_pk_mul_f32 v[22:23], v[22:23], v[86:87]
    v_pk_mul_f32 v[36:37], v[36:37], v[100:101]
    v_pk_mul_f32 v[38:39], v[38:39], v[102:103]
    v_cvt_pk_bf16_f32 v180, v20, v21
    v_cvt_pk_bf16_f32 v181, v22, v23
    v_cvt_pk_bf16_f32 v182, v36, v37
    v_cvt_pk_bf16_f32 v183, v38, v39
    buffer_store_dwordx4 v[180:183], v9, s[28:31], 0 offen offset:1024 sc1
    v_pk_mul_f32 v[24:25], v[24:25], v[88:89]
    v_pk_mul_f32 v[26:27], v[26:27], v[90:91]
    v_pk_mul_f32 v[40:41], v[40:41], v[104:105]
    v_pk_mul_f32 v[42:43], v[42:43], v[106:107]
    v_cvt_pk_bf16_f32 v184, v24, v25
    v_cvt_pk_bf16_f32 v185, v26, v27
    v_cvt_pk_bf16_f32 v186, v40, v41
    v_cvt_pk_bf16_f32 v187, v42, v43
    buffer_store_dwordx4 v[184:187], v9, s[28:31], 0 offen offset:2048 sc1
    v_pk_mul_f32 v[28:29], v[28:29], v[92:93]
    v_pk_mul_f32 v[30:31], v[30:31], v[94:95]
    v_pk_mul_f32 v[44:45], v[44:45], v[108:109]
    v_pk_mul_f32 v[46:47], v[46:47], v[110:111]
    v_cvt_pk_bf16_f32 v188, v28, v29
    v_cvt_pk_bf16_f32 v189, v30, v31
    v_cvt_pk_bf16_f32 v190, v44, v45
    v_cvt_pk_bf16_f32 v191, v46, v47
    buffer_store_dwordx4 v[188:191], v9, s[28:31], 0 offen offset:3072 sc1
    v_pk_mul_f32 v[48:49], v[48:49], v[112:113]
    v_pk_mul_f32 v[50:51], v[50:51], v[114:115]
    v_pk_mul_f32 v[64:65], v[64:65], v[128:129]
    v_pk_mul_f32 v[66:67], v[66:67], v[130:131]
    v_cvt_pk_bf16_f32 v192, v48, v49
    v_cvt_pk_bf16_f32 v193, v50, v51
    v_cvt_pk_bf16_f32 v194, v64, v65
    v_cvt_pk_bf16_f32 v195, v66, v67
    buffer_store_dwordx4 v[192:195], v9, s[28:31], s49 offen offset:0 sc1
    v_pk_mul_f32 v[52:53], v[52:53], v[116:117]
    v_pk_mul_f32 v[54:55], v[54:55], v[118:119]
    v_pk_mul_f32 v[68:69], v[68:69], v[132:133]
    v_pk_mul_f32 v[70:71], v[70:71], v[134:135]
    v_cvt_pk_bf16_f32 v196, v52, v53
    v_cvt_pk_bf16_f32 v197, v54, v55
    v_cvt_pk_bf16_f32 v198, v68, v69
    v_cvt_pk_bf16_f32 v199, v70, v71
    buffer_store_dwordx4 v[196:199], v9, s[28:31], s49 offen offset:1024 sc1
    v_pk_mul_f32 v[56:57], v[56:57], v[120:121]
    v_pk_mul_f32 v[58:59], v[58:59], v[122:123]
    v_pk_mul_f32 v[72:73], v[72:73], v[136:137]
    v_pk_mul_f32 v[74:75], v[74:75], v[138:139]
    v_cvt_pk_bf16_f32 v200, v56, v57
    v_cvt_pk_bf16_f32 v201, v58, v59
    v_cvt_pk_bf16_f32 v202, v72, v73
    v_cvt_pk_bf16_f32 v203, v74, v75
    buffer_store_dwordx4 v[200:203], v9, s[28:31], s49 offen offset:2048 sc1
    s_nop 2
    v_pk_mul_f32 v[60:61], v[60:61], v[124:125]
    v_pk_mul_f32 v[62:63], v[62:63], v[126:127]
    v_pk_mul_f32 v[76:77], v[76:77], v[140:141]
    v_pk_mul_f32 v[78:79], v[78:79], v[142:143]
    v_cvt_pk_bf16_f32 v204, v60, v61
    v_cvt_pk_bf16_f32 v205, v62, v63
    v_cvt_pk_bf16_f32 v206, v76, v77
    v_cvt_pk_bf16_f32 v207, v78, v79
    buffer_store_dwordx4 v[204:207], v9, s[28:31], s49 offen offset:3072 sc1
    ds_write_b128 v1, v[176:179] offset:0
    ds_write_b128 v1, v[180:183] offset:1024
    ds_write_b128 v1, v[184:187] offset:2048
    ds_write_b128 v1, v[188:191] offset:3072
    ds_write_b128 v1, v[192:195] offset:8192
    ds_write_b128 v1, v[196:199] offset:9216
    ds_write_b128 v1, v[200:203] offset:10240
    ds_write_b128 v1, v[204:207] offset:11264
    s_lshl_b32 s53, s12, 14
    s_lshl_b32 s40, s13, 7
    s_add_u32 s53, s53, s40
    s_add_u32 s53, s53, 0x3800
    s_load_dwordx2 s[4:5], s[0:1], 0
    s_load_dwordx4 s[56:59], s[0:1], 80
    s_and_b32 s38, s3, 3
    s_and_b32 s12, s2, 3
    s_lshl_b32 s12, s12, 2
    s_bfe_u32 s13, s2, 0x20003
    s_add_u32 s12, s12, s13
    s_and_b32 s13, s2, 4
    s_lshl_b32 s13, s13, 1
    s_lshr_b32 s40, s2, 5
    s_add_u32 s13, s13, s40
    v_lshrrev_b32 v6, 3, v0
    v_bfe_u32 v7, v0, 4, 1
    s_lshl_b32 s40, s38, 1
    v_or_b32 v7, s40, v7
    v_and_b32 v1, 7, v0
    v_xor_b32 v7, v7, v1
    v_lshlrev_b32 v7, 4, v7
    s_lshl_b32 s41, s38, 3
    v_add_u32 v1, s41, v6
    v_lshl_add_u32 v2, v1, 11, v7
    s_lshl_b32 s44, s12, 18
    s_cmp_ge_u32 s2, 96
    s_addc_u32 s45, s13, 0
    s_lshl_b32 s45, s45, 7
    s_add_u32 s44, s44, s45
    s_lshr_b32 s42, s38, 1
    s_and_b32 s43, s38, 1
    v_lshrrev_b32 v136, 4, v0
    v_and_b32 v137, 15, v0
    v_lshrrev_b32 v138, 2, v137
    v_and_b32 v139, 3, v0
    v_lshl_add_u32 v140, v138, 3, v139
    s_lshl_b32 s40, s42, 6
    v_add_u32 v140, s40, v140
    v_lshlrev_b32 v141, 3, v140
    s_lshl_b32 s40, s42, 12
    v_lshl_add_u32 v3, v0, 4, s40
    v_lshl_add_u32 v142, v136, 2, v138
    v_bfe_u32 v143, v142, 1, 2
    v_lshlrev_b32 v144, 7, v142
    v_lshl_add_u32 v144, v139, 3, v144
    v_add_u32 v144, 114688, v144
    s_lshl_b32 s40, s43, 1
    s_add_u32 s41, s40, 0
    v_xor_b32 v145, s41, v143
    v_lshl_add_u32 v4, v145, 5, v144
    s_add_u32 s41, s40, 1
    v_xor_b32 v145, s41, v143
    v_lshl_add_u32 v5, v145, 5, v144
    v_lshrrev_b32 v143, 1, v137
    v_lshrrev_b32 v144, 1, v136
    v_xor_b32 v143, v143, v144
    s_lshl_b32 s40, s43, 2
    v_xor_b32 v143, s40, v143
    v_lshlrev_b32 v143, 4, v143
    v_lshl_add_u32 v143, v140, 7, v143
    v_and_b32 v144, 1, v136
    v_lshl_add_u32 v143, v144, 3, v143
    v_add_u32 v6, 65536, v143
    v_xor_b32 v7, 32, v6
    v_lshlrev_b32 v143, 2, v138
    s_lshl_b32 s40, s42, 3
    v_xor_b32 v143, s40, v143
    v_or_b32 v143, v143, v139
    v_lshlrev_b32 v143, 4, v143
    v_lshl_add_u32 v143, v142, 8, v143
    s_lshl_b32 s40, s43, 13
    s_add_u32 s40, s40, 81920
    v_add_u32 v8, s40, v143
    v_xor_b32 v9, 64, v8
    s_mov_b32 s39, 0
    v_mov_b32 v1, 98308
    v_mov_b32 v14, 1
    s_mov_b64 exec, 1
    s_waitcnt vmcnt(0)
    ds_add_rtn_u32 v1, v1, v14
    v_mov_b32 v14, 0
    s_waitcnt lgkmcnt(0)
    v_cmp_eq_u32 vcc, 3, v1
    s_and_b64 exec, exec, vcc
    buffer_store_dword v15, v14, s[20:23], s53 offen sc1
    s_mov_b64 exec, -1
mega_kernel_ccj:
    s_bitcmp1_b32 s13, 2
    s_cbranch_scc1 mega_kernel_cc
    s_cmp_eq_u32 s43, 0
    s_cbranch_scc1 mega_kernel_cc0
    v_lshlrev_b32 v16, 16, v224
    v_and_b32 v17, 0xffff0000, v224
    v_lshlrev_b32 v18, 16, v225
    v_and_b32 v19, 0xffff0000, v225
    v_lshlrev_b32 v20, 16, v226
    v_and_b32 v21, 0xffff0000, v226
    v_lshlrev_b32 v22, 16, v227
    v_and_b32 v23, 0xffff0000, v227
    v_lshlrev_b32 v24, 16, v228
    v_and_b32 v25, 0xffff0000, v228
    v_lshlrev_b32 v26, 16, v229
    v_and_b32 v27, 0xffff0000, v229
    v_lshlrev_b32 v28, 16, v230
    v_and_b32 v29, 0xffff0000, v230
    v_lshlrev_b32 v30, 16, v231
    v_and_b32 v31, 0xffff0000, v231
    v_lshlrev_b32 v32, 16, v232
    v_and_b32 v33, 0xffff0000, v232
    v_lshlrev_b32 v34, 16, v233
    v_and_b32 v35, 0xffff0000, v233
    v_lshlrev_b32 v36, 16, v234
    v_and_b32 v37, 0xffff0000, v234
    v_lshlrev_b32 v38, 16, v235
    v_and_b32 v39, 0xffff0000, v235
    v_lshlrev_b32 v40, 16, v236
    v_and_b32 v41, 0xffff0000, v236
    v_lshlrev_b32 v42, 16, v237
    v_and_b32 v43, 0xffff0000, v237
    v_lshlrev_b32 v44, 16, v238
    v_and_b32 v45, 0xffff0000, v238
    v_lshlrev_b32 v46, 16, v239
    v_and_b32 v47, 0xffff0000, v239
    v_pk_fma_f32 v[220:221], v[16:17], v[212:213], v[212:213] op_sel:[0,0,1] op_sel_hi:[1,0,1]
    v_pk_fma_f32 v[222:223], v[18:19], v[212:213], v[212:213] op_sel:[0,0,1] op_sel_hi:[1,0,1]
    v_pk_fma_f32 v[224:225], v[20:21], v[214:215], v[214:215] op_sel:[0,0,1] op_sel_hi:[1,0,1]
    v_pk_fma_f32 v[226:227], v[22:23], v[214:215], v[214:215] op_sel:[0,0,1] op_sel_hi:[1,0,1]
    v_pk_fma_f32 v[228:229], v[24:25], v[216:217], v[216:217] op_sel:[0,0,1] op_sel_hi:[1,0,1]
    v_pk_fma_f32 v[230:231], v[26:27], v[216:217], v[216:217] op_sel:[0,0,1] op_sel_hi:[1,0,1]
    v_pk_fma_f32 v[232:233], v[28:29], v[218:219], v[218:219] op_sel:[0,0,1] op_sel_hi:[1,0,1]
    v_pk_fma_f32 v[234:235], v[30:31], v[218:219], v[218:219] op_sel:[0,0,1] op_sel_hi:[1,0,1]
    v_pk_fma_f32 v[236:237], v[32:33], v[212:213], v[212:213] op_sel:[0,0,1] op_sel_hi:[1,0,1]
    v_pk_fma_f32 v[238:239], v[34:35], v[212:213], v[212:213] op_sel:[0,0,1] op_sel_hi:[1,0,1]
    v_pk_fma_f32 v[240:241], v[36:37], v[214:215], v[214:215] op_sel:[0,0,1] op_sel_hi:[1,0,1]
    v_pk_fma_f32 v[242:243], v[38:39], v[214:215], v[214:215] op_sel:[0,0,1] op_sel_hi:[1,0,1]
    v_pk_fma_f32 v[244:245], v[40:41], v[216:217], v[216:217] op_sel:[0,0,1] op_sel_hi:[1,0,1]
    v_pk_fma_f32 v[246:247], v[42:43], v[216:217], v[216:217] op_sel:[0,0,1] op_sel_hi:[1,0,1]
    v_pk_fma_f32 v[248:249], v[44:45], v[218:219], v[218:219] op_sel:[0,0,1] op_sel_hi:[1,0,1]
    v_pk_fma_f32 v[250:251], v[46:47], v[218:219], v[218:219] op_sel:[0,0,1] op_sel_hi:[1,0,1]
    v_mov_b32 v172, 0
    v_mov_b32 v173, 0
    v_mov_b32 v174, 0
    v_mov_b32 v175, 0
    v_mov_b32 v176, 0
    v_mov_b32 v177, 0
    v_mov_b32 v178, 0
    v_mov_b32 v179, 0
    v_lshlrev_b32 v160, 5, v142
    v_lshl_add_u32 v160, v139, 3, v160
    v_add_u32 v160, 102400, v160
    v_lshlrev_b32 v161, 11, v140
    v_lshl_add_u32 v161, v136, 3, v161
    v_add_u32 v161, 65536, v161
    v_add_u32 v162, 8192, v9
    s_lshr_b32 s40, s13, 3
    s_lshl_b32 s40, s40, 10
    s_and_b32 s41, s13, 7
    s_lshl_b32 s41, s41, 5
    s_add_u32 s40, s40, s41
    s_lshl_b32 s46, s12, 18
    s_add_u32 s46, s46, s40
    s_add_u32 s46, s46, 384
    v_add_u32 v4, 16384, v4
    v_add_u32 v5, 16384, v5
    s_lshl_b32 s40, s12, 10
    s_add_u32 s40, s40, 0x678000
    s_mov_b32 s47, 16384
    s_mov_b32 s48, 8192
    s_mov_b32 s49, 2048
    s_waitcnt lgkmcnt(0)
    s_add_u32 s16, s10, s40
    s_addc_u32 s17, s11, 0
    s_and_b32 s17, s17, 0xffff
    s_mov_b32 s18, 1024
    s_mov_b32 s19, 0x20000
    s_add_u32 s24, s4, s46
    s_addc_u32 s25, s5, 0
    s_and_b32 s25, s25, 0xffff
    s_mov_b32 s26, 260128
    s_mov_b32 s27, 0x20000
    s_barrier
    ds_read_b64_tr_b16 v[80:81], v4 offset:0
    ds_read_b64_tr_b16 v[82:83], v4 offset:2048
    ds_read_b128 v[48:51], v3 offset:0
    ds_read_b128 v[52:55], v3 offset:1024
    ds_read_b128 v[56:59], v3 offset:2048
    ds_read_b128 v[60:63], v3 offset:3072
    ds_read_b64_tr_b16 v[84:85], v5 offset:0
    ds_read_b64_tr_b16 v[86:87], v5 offset:2048
    ds_read_b64_tr_b16 v[164:165], v160 offset:0
    ds_read_b64_tr_b16 v[166:167], v160 offset:512
    buffer_load_dwordx2 v[180:181], v161, s[24:27], 0 offen
    buffer_load_dwordx2 v[182:183], v161, s[24:27], s48 offen
    s_mov_b32 s45, 27
mega_kernel_x1_cm:
    s_add_u32 s39, s39, 1
    s_cmp_eq_u32 s39, 4
    s_cselect_b32 s41, 0xffff6000, s48
    s_cmp_eq_u32 s39, 6
    s_cselect_b32 s40, 0xfffec000, s47
    s_cselect_b32 s50, 0xffffd800, s49
    s_cselect_b32 s39, 0, s39
    s_waitcnt lgkmcnt(0)
    v_mfma_f32_16x16x32_bf16 v[16:19], v[80:83], v[48:51], v[16:19]
    ds_read_b64_tr_b16 v[88:89], v4 offset:4096
    ds_read_b64_tr_b16 v[90:91], v4 offset:6144
    v_mfma_f32_16x16x32_bf16 v[20:23], v[80:83], v[52:55], v[20:23]
    ds_read_b128 v[64:67], v3 offset:8192
    ds_read_b128 v[68:71], v3 offset:9216
    v_mfma_f32_16x16x32_bf16 v[24:27], v[80:83], v[56:59], v[24:27]
    ds_read_b128 v[72:75], v3 offset:10240
    ds_read_b128 v[76:79], v3 offset:11264
    v_mfma_f32_16x16x32_bf16 v[28:31], v[80:83], v[60:63], v[28:31]
    ds_read_b64_tr_b16 v[92:93], v5 offset:4096
    ds_read_b64_tr_b16 v[94:95], v5 offset:6144
    v_mfma_f32_16x16x32_bf16 v[32:35], v[84:87], v[48:51], v[32:35]
    ds_read_b64_tr_b16 v[168:169], v160 offset:1024
    ds_read_b64_tr_b16 v[170:171], v160 offset:1536
    v_mfma_f32_16x16x32_bf16 v[36:39], v[84:87], v[52:55], v[36:39]
    v_mfma_f32_16x16x32_bf16 v[40:43], v[84:87], v[56:59], v[40:43]
    v_mfma_f32_16x16x32_bf16 v[44:47], v[84:87], v[60:63], v[44:47]
    v_mfma_f32_16x16x32_bf16 v[172:175], v[164:167], v[56:59], v[172:175]
    v_mfma_f32_16x16x32_bf16 v[176:179], v[164:167], v[60:63], v[176:179]
    v_add_u32 v3, s40, v3
    v_add_u32 v4, s41, v4
    v_add_u32 v5, s41, v5
    v_add_u32 v160, s50, v160
    s_waitcnt lgkmcnt(0)
    s_barrier
    v_mfma_f32_16x16x32_bf16 v[16:19], v[88:91], v[64:67], v[16:19]
    ds_read_b64_tr_b16 v[80:81], v4 offset:0
    ds_read_b64_tr_b16 v[82:83], v4 offset:2048
    v_mfma_f32_16x16x32_bf16 v[20:23], v[88:91], v[68:71], v[20:23]
    ds_read_b128 v[48:51], v3 offset:0
    ds_read_b128 v[52:55], v3 offset:1024
    v_mfma_f32_16x16x32_bf16 v[24:27], v[88:91], v[72:75], v[24:27]
    ds_read_b128 v[56:59], v3 offset:2048
    ds_read_b128 v[60:63], v3 offset:3072
    v_mfma_f32_16x16x32_bf16 v[28:31], v[88:91], v[76:79], v[28:31]
    ds_read_b64_tr_b16 v[84:85], v5 offset:0
    ds_read_b64_tr_b16 v[86:87], v5 offset:2048
    v_mfma_f32_16x16x32_bf16 v[32:35], v[92:95], v[64:67], v[32:35]
    ds_read_b64_tr_b16 v[164:165], v160 offset:0
    ds_read_b64_tr_b16 v[166:167], v160 offset:512
    v_mfma_f32_16x16x32_bf16 v[36:39], v[92:95], v[68:71], v[36:39]
    v_mfma_f32_16x16x32_bf16 v[40:43], v[92:95], v[72:75], v[40:43]
    v_mfma_f32_16x16x32_bf16 v[44:47], v[92:95], v[76:79], v[44:47]
    v_mfma_f32_16x16x32_bf16 v[172:175], v[168:171], v[72:75], v[172:175]
    v_mfma_f32_16x16x32_bf16 v[176:179], v[168:171], v[76:79], v[176:179]
    s_sub_u32 s45, s45, 1
    s_cmp_lg_u32 s45, 0
    s_cbranch_scc1 mega_kernel_x1_cm
    s_waitcnt lgkmcnt(0)
    s_waitcnt vmcnt(0)
    v_mfma_f32_16x16x32_bf16 v[16:19], v[80:83], v[48:51], v[16:19]
    ds_read_b64_tr_b16 v[88:89], v4 offset:4096
    ds_read_b64_tr_b16 v[90:91], v4 offset:6144
    v_mfma_f32_16x16x32_bf16 v[20:23], v[80:83], v[52:55], v[20:23]
    ds_read_b128 v[64:67], v3 offset:8192
    ds_read_b128 v[68:71], v3 offset:9216
    v_mfma_f32_16x16x32_bf16 v[24:27], v[80:83], v[56:59], v[24:27]
    ds_read_b128 v[72:75], v3 offset:10240
    ds_read_b128 v[76:79], v3 offset:11264
    v_mfma_f32_16x16x32_bf16 v[28:31], v[80:83], v[60:63], v[28:31]
    ds_read_b64_tr_b16 v[92:93], v5 offset:4096
    ds_read_b64_tr_b16 v[94:95], v5 offset:6144
    v_mfma_f32_16x16x32_bf16 v[32:35], v[84:87], v[48:51], v[32:35]
    v_lshlrev_b32 v188, 16, v180
    ds_read_b64_tr_b16 v[168:169], v160 offset:1024
    ds_read_b64_tr_b16 v[170:171], v160 offset:1536
    v_mfma_f32_16x16x32_bf16 v[36:39], v[84:87], v[52:55], v[36:39]
    v_and_b32 v189, 0xffff0000, v180
    v_lshlrev_b32 v190, 16, v181
    v_and_b32 v191, 0xffff0000, v181
    v_mfma_f32_16x16x32_bf16 v[40:43], v[84:87], v[56:59], v[40:43]
    v_fma_f32 v196, v188, v216, v217
    v_fma_f32 v197, v189, v216, v217
    v_fma_f32 v198, v190, v216, v217
    v_mfma_f32_16x16x32_bf16 v[44:47], v[84:87], v[60:63], v[44:47]
    v_fma_f32 v199, v191, v216, v217
    v_lshlrev_b32 v200, 16, v182
    v_and_b32 v201, 0xffff0000, v182
    v_mfma_f32_16x16x32_bf16 v[172:175], v[164:167], v[56:59], v[172:175]
    v_lshlrev_b32 v202, 16, v183
    v_and_b32 v203, 0xffff0000, v183
    v_fma_f32 v208, v200, v218, v219
    v_mfma_f32_16x16x32_bf16 v[176:179], v[164:167], v[60:63], v[176:179]
    v_fma_f32 v209, v201, v218, v219
    v_fma_f32 v210, v202, v218, v219
    v_fma_f32 v211, v203, v218, v219
    s_waitcnt vmcnt(0) lgkmcnt(0)
    s_barrier
    v_mfma_f32_16x16x32_bf16 v[172:175], v[168:171], v[72:75], v[172:175]
    ds_read_b64_tr_b16 v[184:185], v162 offset:0
    ds_read_b64_tr_b16 v[186:187], v162 offset:8
    ds_read_b64_tr_b16 v[120:121], v8 offset:0
    v_mfma_f32_16x16x32_bf16 v[176:179], v[168:171], v[76:79], v[176:179]
    ds_read_b64_tr_b16 v[122:123], v8 offset:8
    ds_read_b64_tr_b16 v[124:125], v9 offset:0
    v_mfma_f32_16x16x32_bf16 v[16:19], v[88:91], v[64:67], v[16:19]
    ds_read_b64_tr_b16 v[126:127], v9 offset:8
    ds_read_b64_tr_b16 v[128:129], v8 offset:4096
    v_mfma_f32_16x16x32_bf16 v[20:23], v[88:91], v[68:71], v[20:23]
    ds_read_b64_tr_b16 v[130:131], v8 offset:4104
    ds_read_b64_tr_b16 v[132:133], v9 offset:4096
    v_mfma_f32_16x16x32_bf16 v[24:27], v[88:91], v[72:75], v[24:27]
    ds_read_b64_tr_b16 v[134:135], v9 offset:4104
    v_mfma_f32_16x16x32_bf16 v[28:31], v[88:91], v[76:79], v[28:31]
    v_mfma_f32_16x16x32_bf16 v[32:35], v[92:95], v[64:67], v[32:35]
    v_mfma_f32_16x16x32_bf16 v[36:39], v[92:95], v[68:71], v[36:39]
    v_mfma_f32_16x16x32_bf16 v[40:43], v[92:95], v[72:75], v[40:43]
    v_mfma_f32_16x16x32_bf16 v[44:47], v[92:95], v[76:79], v[44:47]
    s_add_u32 s24, s58, s46
    s_addc_u32 s25, s59, 0
    s_and_b32 s25, s25, 0xffff
    s_mov_b32 s26, 260128
    s_mov_b32 s27, 0x20000
    s_waitcnt lgkmcnt(8)
    v_lshlrev_b32 v192, 16, v184
    v_and_b32 v193, 0xffff0000, v184
    v_lshlrev_b32 v194, 16, v185
    v_and_b32 v195, 0xffff0000, v185
    v_lshlrev_b32 v204, 16, v186
    v_and_b32 v205, 0xffff0000, v186
    v_lshlrev_b32 v206, 16, v187
    v_and_b32 v207, 0xffff0000, v187
    v_pk_fma_f32 v[188:189], v[196:197], v[192:193], v[188:189]
    v_pk_fma_f32 v[190:191], v[198:199], v[194:195], v[190:191]
    v_pk_fma_f32 v[200:201], v[208:209], v[204:205], v[200:201]
    v_pk_fma_f32 v[202:203], v[210:211], v[206:207], v[202:203]
    v_pk_add_f32 v[172:173], v[172:173], v[188:189]
    v_pk_add_f32 v[174:175], v[174:175], v[190:191]
    v_cvt_pk_bf16_f32 v172, v172, v173
    v_cvt_pk_bf16_f32 v173, v174, v175
    buffer_store_dwordx2 v[172:173], v161, s[24:27], 0 offen
    v_pk_add_f32 v[176:177], v[176:177], v[200:201]
    v_pk_add_f32 v[178:179], v[178:179], v[202:203]
    v_cvt_pk_bf16_f32 v176, v176, v177
    v_cvt_pk_bf16_f32 v177, v178, v179
    buffer_store_dwordx2 v[176:177], v161, s[24:27], s48 offen
    s_waitcnt lgkmcnt(6)
    v_lshlrev_b32 v104, 16, v120
    v_and_b32 v105, 0xffff0000, v120
    v_lshlrev_b32 v106, 16, v121
    v_and_b32 v107, 0xffff0000, v121
    v_lshlrev_b32 v108, 16, v122
    v_and_b32 v109, 0xffff0000, v122
    v_lshlrev_b32 v110, 16, v123
    v_and_b32 v111, 0xffff0000, v123
    s_waitcnt lgkmcnt(5)
    v_lshlrev_b32 v112, 16, v124
    v_and_b32 v113, 0xffff0000, v124
    v_lshlrev_b32 v114, 16, v125
    v_and_b32 v115, 0xffff0000, v125
    v_pk_fma_f32 v[16:17], v[220:221], v[104:105], v[16:17]
    v_pk_fma_f32 v[18:19], v[222:223], v[106:107], v[18:19]
    v_cvt_pk_bf16_f32 v16, v16, v17
    v_cvt_pk_bf16_f32 v17, v18, v19
    ds_write_b64 v6, v[16:17] offset:0
    s_waitcnt lgkmcnt(5)
    v_lshlrev_b32 v116, 16, v126
    v_and_b32 v117, 0xffff0000, v126
    v_lshlrev_b32 v118, 16, v127
    v_and_b32 v119, 0xffff0000, v127
    v_pk_fma_f32 v[20:21], v[224:225], v[108:109], v[20:21]
    v_pk_fma_f32 v[22:23], v[226:227], v[110:111], v[22:23]
    v_cvt_pk_bf16_f32 v20, v20, v21
    v_cvt_pk_bf16_f32 v21, v22, v23
    ds_write_b64 v6, v[20:21] offset:512
    s_waitcnt lgkmcnt(5)
    v_lshlrev_b32 v104, 16, v128
    v_and_b32 v105, 0xffff0000, v128
    v_lshlrev_b32 v106, 16, v129
    v_and_b32 v107, 0xffff0000, v129
    v_pk_fma_f32 v[24:25], v[228:229], v[112:113], v[24:25]
    v_pk_fma_f32 v[26:27], v[230:231], v[114:115], v[26:27]
    v_cvt_pk_bf16_f32 v24, v24, v25
    v_cvt_pk_bf16_f32 v25, v26, v27
    ds_write_b64 v6, v[24:25] offset:4096
    s_waitcnt lgkmcnt(5)
    v_lshlrev_b32 v108, 16, v130
    v_and_b32 v109, 0xffff0000, v130
    v_lshlrev_b32 v110, 16, v131
    v_and_b32 v111, 0xffff0000, v131
    v_pk_fma_f32 v[28:29], v[232:233], v[116:117], v[28:29]
    v_pk_fma_f32 v[30:31], v[234:235], v[118:119], v[30:31]
    v_cvt_pk_bf16_f32 v28, v28, v29
    v_cvt_pk_bf16_f32 v29, v30, v31
    ds_write_b64 v6, v[28:29] offset:4608
    s_waitcnt lgkmcnt(5)
    v_lshlrev_b32 v112, 16, v132
    v_and_b32 v113, 0xffff0000, v132
    v_lshlrev_b32 v114, 16, v133
    v_and_b32 v115, 0xffff0000, v133
    v_pk_fma_f32 v[32:33], v[236:237], v[104:105], v[32:33]
    v_pk_fma_f32 v[34:35], v[238:239], v[106:107], v[34:35]
    v_cvt_pk_bf16_f32 v32, v32, v33
    v_cvt_pk_bf16_f32 v33, v34, v35
    ds_write_b64 v7, v[32:33] offset:0
    s_waitcnt lgkmcnt(5)
    v_lshlrev_b32 v116, 16, v134
    v_and_b32 v117, 0xffff0000, v134
    v_lshlrev_b32 v118, 16, v135
    v_and_b32 v119, 0xffff0000, v135
    v_pk_fma_f32 v[36:37], v[240:241], v[108:109], v[36:37]
    v_pk_fma_f32 v[38:39], v[242:243], v[110:111], v[38:39]
    v_cvt_pk_bf16_f32 v36, v36, v37
    v_cvt_pk_bf16_f32 v37, v38, v39
    ds_write_b64 v7, v[36:37] offset:512
    v_pk_fma_f32 v[40:41], v[244:245], v[112:113], v[40:41]
    v_pk_fma_f32 v[42:43], v[246:247], v[114:115], v[42:43]
    v_cvt_pk_bf16_f32 v40, v40, v41
    v_cvt_pk_bf16_f32 v41, v42, v43
    ds_write_b64 v7, v[40:41] offset:4096
    v_pk_fma_f32 v[44:45], v[248:249], v[116:117], v[44:45]
    v_pk_fma_f32 v[46:47], v[250:251], v[118:119], v[46:47]
    v_cvt_pk_bf16_f32 v44, v44, v45
    v_cvt_pk_bf16_f32 v45, v46, v47
    ds_write_b64 v7, v[44:45] offset:4608
    s_waitcnt lgkmcnt(0)
    s_branch mega_kernel_cfin
mega_kernel_cc0:
    v_lshlrev_b32 v16, 16, v224
    v_and_b32 v17, 0xffff0000, v224
    v_lshlrev_b32 v18, 16, v225
    v_and_b32 v19, 0xffff0000, v225
    v_lshlrev_b32 v20, 16, v226
    v_and_b32 v21, 0xffff0000, v226
    v_lshlrev_b32 v22, 16, v227
    v_and_b32 v23, 0xffff0000, v227
    v_lshlrev_b32 v24, 16, v228
    v_and_b32 v25, 0xffff0000, v228
    v_lshlrev_b32 v26, 16, v229
    v_and_b32 v27, 0xffff0000, v229
    v_lshlrev_b32 v28, 16, v230
    v_and_b32 v29, 0xffff0000, v230
    v_lshlrev_b32 v30, 16, v231
    v_and_b32 v31, 0xffff0000, v231
    v_lshlrev_b32 v32, 16, v232
    v_and_b32 v33, 0xffff0000, v232
    v_lshlrev_b32 v34, 16, v233
    v_and_b32 v35, 0xffff0000, v233
    v_lshlrev_b32 v36, 16, v234
    v_and_b32 v37, 0xffff0000, v234
    v_lshlrev_b32 v38, 16, v235
    v_and_b32 v39, 0xffff0000, v235
    v_lshlrev_b32 v40, 16, v236
    v_and_b32 v41, 0xffff0000, v236
    v_lshlrev_b32 v42, 16, v237
    v_and_b32 v43, 0xffff0000, v237
    v_lshlrev_b32 v44, 16, v238
    v_and_b32 v45, 0xffff0000, v238
    v_lshlrev_b32 v46, 16, v239
    v_and_b32 v47, 0xffff0000, v239
    v_pk_fma_f32 v[220:221], v[16:17], v[212:213], v[212:213] op_sel:[0,0,1] op_sel_hi:[1,0,1]
    v_pk_fma_f32 v[222:223], v[18:19], v[212:213], v[212:213] op_sel:[0,0,1] op_sel_hi:[1,0,1]
    v_pk_fma_f32 v[224:225], v[20:21], v[214:215], v[214:215] op_sel:[0,0,1] op_sel_hi:[1,0,1]
    v_pk_fma_f32 v[226:227], v[22:23], v[214:215], v[214:215] op_sel:[0,0,1] op_sel_hi:[1,0,1]
    v_pk_fma_f32 v[228:229], v[24:25], v[216:217], v[216:217] op_sel:[0,0,1] op_sel_hi:[1,0,1]
    v_pk_fma_f32 v[230:231], v[26:27], v[216:217], v[216:217] op_sel:[0,0,1] op_sel_hi:[1,0,1]
    v_pk_fma_f32 v[232:233], v[28:29], v[218:219], v[218:219] op_sel:[0,0,1] op_sel_hi:[1,0,1]
    v_pk_fma_f32 v[234:235], v[30:31], v[218:219], v[218:219] op_sel:[0,0,1] op_sel_hi:[1,0,1]
    v_pk_fma_f32 v[236:237], v[32:33], v[212:213], v[212:213] op_sel:[0,0,1] op_sel_hi:[1,0,1]
    v_pk_fma_f32 v[238:239], v[34:35], v[212:213], v[212:213] op_sel:[0,0,1] op_sel_hi:[1,0,1]
    v_pk_fma_f32 v[240:241], v[36:37], v[214:215], v[214:215] op_sel:[0,0,1] op_sel_hi:[1,0,1]
    v_pk_fma_f32 v[242:243], v[38:39], v[214:215], v[214:215] op_sel:[0,0,1] op_sel_hi:[1,0,1]
    v_pk_fma_f32 v[244:245], v[40:41], v[216:217], v[216:217] op_sel:[0,0,1] op_sel_hi:[1,0,1]
    v_pk_fma_f32 v[246:247], v[42:43], v[216:217], v[216:217] op_sel:[0,0,1] op_sel_hi:[1,0,1]
    v_pk_fma_f32 v[248:249], v[44:45], v[218:219], v[218:219] op_sel:[0,0,1] op_sel_hi:[1,0,1]
    v_pk_fma_f32 v[250:251], v[46:47], v[218:219], v[218:219] op_sel:[0,0,1] op_sel_hi:[1,0,1]
    v_mov_b32 v172, 0
    v_mov_b32 v173, 0
    v_mov_b32 v174, 0
    v_mov_b32 v175, 0
    v_mov_b32 v176, 0
    v_mov_b32 v177, 0
    v_mov_b32 v178, 0
    v_mov_b32 v179, 0
    v_lshlrev_b32 v160, 5, v142
    v_lshl_add_u32 v160, v139, 3, v160
    v_add_u32 v160, 102400, v160
    v_lshlrev_b32 v161, 11, v140
    v_lshl_add_u32 v161, v136, 3, v161
    v_add_u32 v161, 0, v161
    v_add_u32 v162, 16384, v8
    s_lshr_b32 s40, s13, 3
    s_lshl_b32 s40, s40, 10
    s_and_b32 s41, s13, 7
    s_lshl_b32 s41, s41, 5
    s_add_u32 s40, s40, s41
    s_lshl_b32 s46, s12, 18
    s_add_u32 s46, s46, s40
    s_add_u32 s46, s46, 384
    v_add_u32 v4, 16384, v4
    v_add_u32 v5, 16384, v5
    s_lshl_b32 s40, s12, 10
    s_add_u32 s40, s40, 0x678000
    s_mov_b32 s47, 16384
    s_mov_b32 s48, 8192
    s_mov_b32 s49, 2048
    s_waitcnt lgkmcnt(0)
    s_add_u32 s16, s10, s40
    s_addc_u32 s17, s11, 0
    s_and_b32 s17, s17, 0xffff
    s_mov_b32 s18, 1024
    s_mov_b32 s19, 0x20000
    s_add_u32 s24, s4, s46
    s_addc_u32 s25, s5, 0
    s_and_b32 s25, s25, 0xffff
    s_mov_b32 s26, 260128
    s_mov_b32 s27, 0x20000
    s_barrier
    ds_read_b64_tr_b16 v[80:81], v4 offset:0
    ds_read_b64_tr_b16 v[82:83], v4 offset:2048
    ds_read_b128 v[48:51], v3 offset:0
    ds_read_b128 v[52:55], v3 offset:1024
    ds_read_b128 v[56:59], v3 offset:2048
    ds_read_b128 v[60:63], v3 offset:3072
    ds_read_b64_tr_b16 v[84:85], v5 offset:0
    ds_read_b64_tr_b16 v[86:87], v5 offset:2048
    ds_read_b64_tr_b16 v[164:165], v160 offset:0
    ds_read_b64_tr_b16 v[166:167], v160 offset:512
    buffer_load_dwordx2 v[180:181], v161, s[24:27], 0 offen
    buffer_load_dwordx2 v[182:183], v161, s[24:27], s48 offen
    s_mov_b32 s45, 27
mega_kernel_x0_cm:
    s_add_u32 s39, s39, 1
    s_cmp_eq_u32 s39, 4
    s_cselect_b32 s41, 0xffff6000, s48
    s_cmp_eq_u32 s39, 6
    s_cselect_b32 s40, 0xfffec000, s47
    s_cselect_b32 s50, 0xffffd800, s49
    s_cselect_b32 s39, 0, s39
    s_waitcnt lgkmcnt(0)
    v_mfma_f32_16x16x32_bf16 v[16:19], v[80:83], v[48:51], v[16:19]
    ds_read_b64_tr_b16 v[88:89], v4 offset:4096
    ds_read_b64_tr_b16 v[90:91], v4 offset:6144
    v_mfma_f32_16x16x32_bf16 v[20:23], v[80:83], v[52:55], v[20:23]
    ds_read_b128 v[64:67], v3 offset:8192
    ds_read_b128 v[68:71], v3 offset:9216
    v_mfma_f32_16x16x32_bf16 v[24:27], v[80:83], v[56:59], v[24:27]
    ds_read_b128 v[72:75], v3 offset:10240
    ds_read_b128 v[76:79], v3 offset:11264
    v_mfma_f32_16x16x32_bf16 v[28:31], v[80:83], v[60:63], v[28:31]
    ds_read_b64_tr_b16 v[92:93], v5 offset:4096
    ds_read_b64_tr_b16 v[94:95], v5 offset:6144
    v_mfma_f32_16x16x32_bf16 v[32:35], v[84:87], v[48:51], v[32:35]
    ds_read_b64_tr_b16 v[168:169], v160 offset:1024
    ds_read_b64_tr_b16 v[170:171], v160 offset:1536
    v_mfma_f32_16x16x32_bf16 v[36:39], v[84:87], v[52:55], v[36:39]
    v_mfma_f32_16x16x32_bf16 v[40:43], v[84:87], v[56:59], v[40:43]
    v_mfma_f32_16x16x32_bf16 v[44:47], v[84:87], v[60:63], v[44:47]
    v_mfma_f32_16x16x32_bf16 v[172:175], v[164:167], v[48:51], v[172:175]
    v_mfma_f32_16x16x32_bf16 v[176:179], v[164:167], v[52:55], v[176:179]
    v_add_u32 v3, s40, v3
    v_add_u32 v4, s41, v4
    v_add_u32 v5, s41, v5
    v_add_u32 v160, s50, v160
    s_waitcnt lgkmcnt(0)
    s_barrier
    v_mfma_f32_16x16x32_bf16 v[16:19], v[88:91], v[64:67], v[16:19]
    ds_read_b64_tr_b16 v[80:81], v4 offset:0
    ds_read_b64_tr_b16 v[82:83], v4 offset:2048
    v_mfma_f32_16x16x32_bf16 v[20:23], v[88:91], v[68:71], v[20:23]
    ds_read_b128 v[48:51], v3 offset:0
    ds_read_b128 v[52:55], v3 offset:1024
    v_mfma_f32_16x16x32_bf16 v[24:27], v[88:91], v[72:75], v[24:27]
    ds_read_b128 v[56:59], v3 offset:2048
    ds_read_b128 v[60:63], v3 offset:3072
    v_mfma_f32_16x16x32_bf16 v[28:31], v[88:91], v[76:79], v[28:31]
    ds_read_b64_tr_b16 v[84:85], v5 offset:0
    ds_read_b64_tr_b16 v[86:87], v5 offset:2048
    v_mfma_f32_16x16x32_bf16 v[32:35], v[92:95], v[64:67], v[32:35]
    ds_read_b64_tr_b16 v[164:165], v160 offset:0
    ds_read_b64_tr_b16 v[166:167], v160 offset:512
    v_mfma_f32_16x16x32_bf16 v[36:39], v[92:95], v[68:71], v[36:39]
    v_mfma_f32_16x16x32_bf16 v[40:43], v[92:95], v[72:75], v[40:43]
    v_mfma_f32_16x16x32_bf16 v[44:47], v[92:95], v[76:79], v[44:47]
    v_mfma_f32_16x16x32_bf16 v[172:175], v[168:171], v[64:67], v[172:175]
    v_mfma_f32_16x16x32_bf16 v[176:179], v[168:171], v[68:71], v[176:179]
    s_sub_u32 s45, s45, 1
    s_cmp_lg_u32 s45, 0
    s_cbranch_scc1 mega_kernel_x0_cm
    s_waitcnt lgkmcnt(0)
    s_waitcnt vmcnt(0)
    v_mfma_f32_16x16x32_bf16 v[16:19], v[80:83], v[48:51], v[16:19]
    ds_read_b64_tr_b16 v[88:89], v4 offset:4096
    ds_read_b64_tr_b16 v[90:91], v4 offset:6144
    v_mfma_f32_16x16x32_bf16 v[20:23], v[80:83], v[52:55], v[20:23]
    ds_read_b128 v[64:67], v3 offset:8192
    ds_read_b128 v[68:71], v3 offset:9216
    v_mfma_f32_16x16x32_bf16 v[24:27], v[80:83], v[56:59], v[24:27]
    ds_read_b128 v[72:75], v3 offset:10240
    ds_read_b128 v[76:79], v3 offset:11264
    v_mfma_f32_16x16x32_bf16 v[28:31], v[80:83], v[60:63], v[28:31]
    ds_read_b64_tr_b16 v[92:93], v5 offset:4096
    ds_read_b64_tr_b16 v[94:95], v5 offset:6144
    v_mfma_f32_16x16x32_bf16 v[32:35], v[84:87], v[48:51], v[32:35]
    v_lshlrev_b32 v188, 16, v180
    ds_read_b64_tr_b16 v[168:169], v160 offset:1024
    ds_read_b64_tr_b16 v[170:171], v160 offset:1536
    v_mfma_f32_16x16x32_bf16 v[36:39], v[84:87], v[52:55], v[36:39]
    v_and_b32 v189, 0xffff0000, v180
    v_lshlrev_b32 v190, 16, v181
    v_and_b32 v191, 0xffff0000, v181
    v_mfma_f32_16x16x32_bf16 v[40:43], v[84:87], v[56:59], v[40:43]
    v_fma_f32 v196, v188, v212, v213
    v_fma_f32 v197, v189, v212, v213
    v_fma_f32 v198, v190, v212, v213
    v_mfma_f32_16x16x32_bf16 v[44:47], v[84:87], v[60:63], v[44:47]
    v_fma_f32 v199, v191, v212, v213
    v_lshlrev_b32 v200, 16, v182
    v_and_b32 v201, 0xffff0000, v182
    v_mfma_f32_16x16x32_bf16 v[172:175], v[164:167], v[48:51], v[172:175]
    v_lshlrev_b32 v202, 16, v183
    v_and_b32 v203, 0xffff0000, v183
    v_fma_f32 v208, v200, v214, v215
    v_mfma_f32_16x16x32_bf16 v[176:179], v[164:167], v[52:55], v[176:179]
    v_fma_f32 v209, v201, v214, v215
    v_fma_f32 v210, v202, v214, v215
    v_fma_f32 v211, v203, v214, v215
    s_waitcnt vmcnt(0) lgkmcnt(0)
    s_barrier
    v_mfma_f32_16x16x32_bf16 v[172:175], v[168:171], v[64:67], v[172:175]
    ds_read_b64_tr_b16 v[184:185], v162 offset:0
    ds_read_b64_tr_b16 v[186:187], v162 offset:8
    ds_read_b64_tr_b16 v[120:121], v8 offset:0
    v_mfma_f32_16x16x32_bf16 v[176:179], v[168:171], v[68:71], v[176:179]
    ds_read_b64_tr_b16 v[122:123], v8 offset:8
    ds_read_b64_tr_b16 v[124:125], v9 offset:0
    v_mfma_f32_16x16x32_bf16 v[16:19], v[88:91], v[64:67], v[16:19]
    ds_read_b64_tr_b16 v[126:127], v9 offset:8
    ds_read_b64_tr_b16 v[128:129], v8 offset:4096
    v_mfma_f32_16x16x32_bf16 v[20:23], v[88:91], v[68:71], v[20:23]
    ds_read_b64_tr_b16 v[130:131], v8 offset:4104
    ds_read_b64_tr_b16 v[132:133], v9 offset:4096
    v_mfma_f32_16x16x32_bf16 v[24:27], v[88:91], v[72:75], v[24:27]
    ds_read_b64_tr_b16 v[134:135], v9 offset:4104
    v_mfma_f32_16x16x32_bf16 v[28:31], v[88:91], v[76:79], v[28:31]
    v_mfma_f32_16x16x32_bf16 v[32:35], v[92:95], v[64:67], v[32:35]
    v_mfma_f32_16x16x32_bf16 v[36:39], v[92:95], v[68:71], v[36:39]
    v_mfma_f32_16x16x32_bf16 v[40:43], v[92:95], v[72:75], v[40:43]
    v_mfma_f32_16x16x32_bf16 v[44:47], v[92:95], v[76:79], v[44:47]
    s_add_u32 s24, s58, s46
    s_addc_u32 s25, s59, 0
    s_and_b32 s25, s25, 0xffff
    s_mov_b32 s26, 260128
    s_mov_b32 s27, 0x20000
    s_waitcnt lgkmcnt(8)
    v_lshlrev_b32 v192, 16, v184
    v_and_b32 v193, 0xffff0000, v184
    v_lshlrev_b32 v194, 16, v185
    v_and_b32 v195, 0xffff0000, v185
    v_lshlrev_b32 v204, 16, v186
    v_and_b32 v205, 0xffff0000, v186
    v_lshlrev_b32 v206, 16, v187
    v_and_b32 v207, 0xffff0000, v187
    v_pk_fma_f32 v[188:189], v[196:197], v[192:193], v[188:189]
    v_pk_fma_f32 v[190:191], v[198:199], v[194:195], v[190:191]
    v_pk_fma_f32 v[200:201], v[208:209], v[204:205], v[200:201]
    v_pk_fma_f32 v[202:203], v[210:211], v[206:207], v[202:203]
    v_pk_add_f32 v[172:173], v[172:173], v[188:189]
    v_pk_add_f32 v[174:175], v[174:175], v[190:191]
    v_cvt_pk_bf16_f32 v172, v172, v173
    v_cvt_pk_bf16_f32 v173, v174, v175
    buffer_store_dwordx2 v[172:173], v161, s[24:27], 0 offen
    v_pk_add_f32 v[176:177], v[176:177], v[200:201]
    v_pk_add_f32 v[178:179], v[178:179], v[202:203]
    v_cvt_pk_bf16_f32 v176, v176, v177
    v_cvt_pk_bf16_f32 v177, v178, v179
    buffer_store_dwordx2 v[176:177], v161, s[24:27], s48 offen
    s_waitcnt lgkmcnt(6)
    v_lshlrev_b32 v104, 16, v120
    v_and_b32 v105, 0xffff0000, v120
    v_lshlrev_b32 v106, 16, v121
    v_and_b32 v107, 0xffff0000, v121
    v_lshlrev_b32 v108, 16, v122
    v_and_b32 v109, 0xffff0000, v122
    v_lshlrev_b32 v110, 16, v123
    v_and_b32 v111, 0xffff0000, v123
    s_waitcnt lgkmcnt(5)
    v_lshlrev_b32 v112, 16, v124
    v_and_b32 v113, 0xffff0000, v124
    v_lshlrev_b32 v114, 16, v125
    v_and_b32 v115, 0xffff0000, v125
    v_pk_fma_f32 v[16:17], v[220:221], v[104:105], v[16:17]
    v_pk_fma_f32 v[18:19], v[222:223], v[106:107], v[18:19]
    v_cvt_pk_bf16_f32 v16, v16, v17
    v_cvt_pk_bf16_f32 v17, v18, v19
    ds_write_b64 v6, v[16:17] offset:0
    s_waitcnt lgkmcnt(5)
    v_lshlrev_b32 v116, 16, v126
    v_and_b32 v117, 0xffff0000, v126
    v_lshlrev_b32 v118, 16, v127
    v_and_b32 v119, 0xffff0000, v127
    v_pk_fma_f32 v[20:21], v[224:225], v[108:109], v[20:21]
    v_pk_fma_f32 v[22:23], v[226:227], v[110:111], v[22:23]
    v_cvt_pk_bf16_f32 v20, v20, v21
    v_cvt_pk_bf16_f32 v21, v22, v23
    ds_write_b64 v6, v[20:21] offset:512
    s_waitcnt lgkmcnt(5)
    v_lshlrev_b32 v104, 16, v128
    v_and_b32 v105, 0xffff0000, v128
    v_lshlrev_b32 v106, 16, v129
    v_and_b32 v107, 0xffff0000, v129
    v_pk_fma_f32 v[24:25], v[228:229], v[112:113], v[24:25]
    v_pk_fma_f32 v[26:27], v[230:231], v[114:115], v[26:27]
    v_cvt_pk_bf16_f32 v24, v24, v25
    v_cvt_pk_bf16_f32 v25, v26, v27
    ds_write_b64 v6, v[24:25] offset:4096
    s_waitcnt lgkmcnt(5)
    v_lshlrev_b32 v108, 16, v130
    v_and_b32 v109, 0xffff0000, v130
    v_lshlrev_b32 v110, 16, v131
    v_and_b32 v111, 0xffff0000, v131
    v_pk_fma_f32 v[28:29], v[232:233], v[116:117], v[28:29]
    v_pk_fma_f32 v[30:31], v[234:235], v[118:119], v[30:31]
    v_cvt_pk_bf16_f32 v28, v28, v29
    v_cvt_pk_bf16_f32 v29, v30, v31
    ds_write_b64 v6, v[28:29] offset:4608
    s_waitcnt lgkmcnt(5)
    v_lshlrev_b32 v112, 16, v132
    v_and_b32 v113, 0xffff0000, v132
    v_lshlrev_b32 v114, 16, v133
    v_and_b32 v115, 0xffff0000, v133
    v_pk_fma_f32 v[32:33], v[236:237], v[104:105], v[32:33]
    v_pk_fma_f32 v[34:35], v[238:239], v[106:107], v[34:35]
    v_cvt_pk_bf16_f32 v32, v32, v33
    v_cvt_pk_bf16_f32 v33, v34, v35
    ds_write_b64 v7, v[32:33] offset:0
    s_waitcnt lgkmcnt(5)
    v_lshlrev_b32 v116, 16, v134
    v_and_b32 v117, 0xffff0000, v134
    v_lshlrev_b32 v118, 16, v135
    v_and_b32 v119, 0xffff0000, v135
    v_pk_fma_f32 v[36:37], v[240:241], v[108:109], v[36:37]
    v_pk_fma_f32 v[38:39], v[242:243], v[110:111], v[38:39]
    v_cvt_pk_bf16_f32 v36, v36, v37
    v_cvt_pk_bf16_f32 v37, v38, v39
    ds_write_b64 v7, v[36:37] offset:512
    v_pk_fma_f32 v[40:41], v[244:245], v[112:113], v[40:41]
    v_pk_fma_f32 v[42:43], v[246:247], v[114:115], v[42:43]
    v_cvt_pk_bf16_f32 v40, v40, v41
    v_cvt_pk_bf16_f32 v41, v42, v43
    ds_write_b64 v7, v[40:41] offset:4096
    v_pk_fma_f32 v[44:45], v[248:249], v[116:117], v[44:45]
    v_pk_fma_f32 v[46:47], v[250:251], v[118:119], v[46:47]
    v_cvt_pk_bf16_f32 v44, v44, v45
    v_cvt_pk_bf16_f32 v45, v46, v47
    ds_write_b64 v7, v[44:45] offset:4608
    s_waitcnt lgkmcnt(0)
    s_branch mega_kernel_cfin
mega_kernel_cc:
    v_lshlrev_b32 v16, 16, v224
    v_and_b32 v17, 0xffff0000, v224
    v_lshlrev_b32 v18, 16, v225
    v_and_b32 v19, 0xffff0000, v225
    v_lshlrev_b32 v20, 16, v226
    v_and_b32 v21, 0xffff0000, v226
    v_lshlrev_b32 v22, 16, v227
    v_and_b32 v23, 0xffff0000, v227
    v_lshlrev_b32 v24, 16, v228
    v_and_b32 v25, 0xffff0000, v228
    v_lshlrev_b32 v26, 16, v229
    v_and_b32 v27, 0xffff0000, v229
    v_lshlrev_b32 v28, 16, v230
    v_and_b32 v29, 0xffff0000, v230
    v_lshlrev_b32 v30, 16, v231
    v_and_b32 v31, 0xffff0000, v231
    v_lshlrev_b32 v32, 16, v232
    v_and_b32 v33, 0xffff0000, v232
    v_lshlrev_b32 v34, 16, v233
    v_and_b32 v35, 0xffff0000, v233
    v_lshlrev_b32 v36, 16, v234
    v_and_b32 v37, 0xffff0000, v234
    v_lshlrev_b32 v38, 16, v235
    v_and_b32 v39, 0xffff0000, v235
    v_lshlrev_b32 v40, 16, v236
    v_and_b32 v41, 0xffff0000, v236
    v_lshlrev_b32 v42, 16, v237
    v_and_b32 v43, 0xffff0000, v237
    v_lshlrev_b32 v44, 16, v238
    v_and_b32 v45, 0xffff0000, v238
    v_lshlrev_b32 v46, 16, v239
    v_and_b32 v47, 0xffff0000, v239
    v_pk_fma_f32 v[220:221], v[16:17], v[212:213], v[212:213] op_sel:[0,0,1] op_sel_hi:[1,0,1]
    v_pk_fma_f32 v[222:223], v[18:19], v[212:213], v[212:213] op_sel:[0,0,1] op_sel_hi:[1,0,1]
    v_pk_fma_f32 v[224:225], v[20:21], v[214:215], v[214:215] op_sel:[0,0,1] op_sel_hi:[1,0,1]
    v_pk_fma_f32 v[226:227], v[22:23], v[214:215], v[214:215] op_sel:[0,0,1] op_sel_hi:[1,0,1]
    v_pk_fma_f32 v[228:229], v[24:25], v[216:217], v[216:217] op_sel:[0,0,1] op_sel_hi:[1,0,1]
    v_pk_fma_f32 v[230:231], v[26:27], v[216:217], v[216:217] op_sel:[0,0,1] op_sel_hi:[1,0,1]
    v_pk_fma_f32 v[232:233], v[28:29], v[218:219], v[218:219] op_sel:[0,0,1] op_sel_hi:[1,0,1]
    v_pk_fma_f32 v[234:235], v[30:31], v[218:219], v[218:219] op_sel:[0,0,1] op_sel_hi:[1,0,1]
    v_pk_fma_f32 v[236:237], v[32:33], v[212:213], v[212:213] op_sel:[0,0,1] op_sel_hi:[1,0,1]
    v_pk_fma_f32 v[238:239], v[34:35], v[212:213], v[212:213] op_sel:[0,0,1] op_sel_hi:[1,0,1]
    v_pk_fma_f32 v[240:241], v[36:37], v[214:215], v[214:215] op_sel:[0,0,1] op_sel_hi:[1,0,1]
    v_pk_fma_f32 v[242:243], v[38:39], v[214:215], v[214:215] op_sel:[0,0,1] op_sel_hi:[1,0,1]
    v_pk_fma_f32 v[244:245], v[40:41], v[216:217], v[216:217] op_sel:[0,0,1] op_sel_hi:[1,0,1]
    v_pk_fma_f32 v[246:247], v[42:43], v[216:217], v[216:217] op_sel:[0,0,1] op_sel_hi:[1,0,1]
    v_pk_fma_f32 v[248:249], v[44:45], v[218:219], v[218:219] op_sel:[0,0,1] op_sel_hi:[1,0,1]
    v_pk_fma_f32 v[250:251], v[46:47], v[218:219], v[218:219] op_sel:[0,0,1] op_sel_hi:[1,0,1]
    v_add_u32 v4, 16384, v4
    v_add_u32 v5, 16384, v5
    s_lshl_b32 s40, s12, 10
    s_add_u32 s40, s40, 0x678000
    s_mov_b32 s47, 16384
    s_mov_b32 s48, 8192
    s_mov_b32 s49, 2048
    s_waitcnt lgkmcnt(0)
    s_add_u32 s16, s10, s40
    s_addc_u32 s17, s11, 0
    s_and_b32 s17, s17, 0xffff
    s_mov_b32 s18, 1024
    s_mov_b32 s19, 0x20000
    s_barrier
    ds_read_b64_tr_b16 v[80:81], v4 offset:0
    ds_read_b64_tr_b16 v[82:83], v4 offset:2048
    ds_read_b128 v[48:51], v3 offset:0
    ds_read_b128 v[52:55], v3 offset:1024
    ds_read_b128 v[56:59], v3 offset:2048
    ds_read_b128 v[60:63], v3 offset:3072
    ds_read_b64_tr_b16 v[84:85], v5 offset:0
    ds_read_b64_tr_b16 v[86:87], v5 offset:2048
    s_mov_b32 s45, 27
mega_kernel_cm:
    s_add_u32 s39, s39, 1
    s_cmp_eq_u32 s39, 4
    s_cselect_b32 s41, 0xffff6000, s48
    s_cmp_eq_u32 s39, 6
    s_cselect_b32 s40, 0xfffec000, s47
    s_cselect_b32 s39, 0, s39
    s_waitcnt lgkmcnt(0)
    v_mfma_f32_16x16x32_bf16 v[16:19], v[80:83], v[48:51], v[16:19]
    ds_read_b64_tr_b16 v[88:89], v4 offset:4096
    ds_read_b64_tr_b16 v[90:91], v4 offset:6144
    v_mfma_f32_16x16x32_bf16 v[20:23], v[80:83], v[52:55], v[20:23]
    ds_read_b128 v[64:67], v3 offset:8192
    ds_read_b128 v[68:71], v3 offset:9216
    v_mfma_f32_16x16x32_bf16 v[24:27], v[80:83], v[56:59], v[24:27]
    ds_read_b128 v[72:75], v3 offset:10240
    ds_read_b128 v[76:79], v3 offset:11264
    v_mfma_f32_16x16x32_bf16 v[28:31], v[80:83], v[60:63], v[28:31]
    ds_read_b64_tr_b16 v[92:93], v5 offset:4096
    ds_read_b64_tr_b16 v[94:95], v5 offset:6144
    v_mfma_f32_16x16x32_bf16 v[32:35], v[84:87], v[48:51], v[32:35]
    v_mfma_f32_16x16x32_bf16 v[36:39], v[84:87], v[52:55], v[36:39]
    v_mfma_f32_16x16x32_bf16 v[40:43], v[84:87], v[56:59], v[40:43]
    v_mfma_f32_16x16x32_bf16 v[44:47], v[84:87], v[60:63], v[44:47]
    v_add_u32 v3, s40, v3
    v_add_u32 v4, s41, v4
    v_add_u32 v5, s41, v5
    s_waitcnt lgkmcnt(0)
    s_barrier
    v_mfma_f32_16x16x32_bf16 v[16:19], v[88:91], v[64:67], v[16:19]
    ds_read_b64_tr_b16 v[80:81], v4 offset:0
    ds_read_b64_tr_b16 v[82:83], v4 offset:2048
    v_mfma_f32_16x16x32_bf16 v[20:23], v[88:91], v[68:71], v[20:23]
    ds_read_b128 v[48:51], v3 offset:0
    ds_read_b128 v[52:55], v3 offset:1024
    v_mfma_f32_16x16x32_bf16 v[24:27], v[88:91], v[72:75], v[24:27]
    ds_read_b128 v[56:59], v3 offset:2048
    ds_read_b128 v[60:63], v3 offset:3072
    v_mfma_f32_16x16x32_bf16 v[28:31], v[88:91], v[76:79], v[28:31]
    ds_read_b64_tr_b16 v[84:85], v5 offset:0
    ds_read_b64_tr_b16 v[86:87], v5 offset:2048
    v_mfma_f32_16x16x32_bf16 v[32:35], v[92:95], v[64:67], v[32:35]
    v_mfma_f32_16x16x32_bf16 v[36:39], v[92:95], v[68:71], v[36:39]
    v_mfma_f32_16x16x32_bf16 v[40:43], v[92:95], v[72:75], v[40:43]
    v_mfma_f32_16x16x32_bf16 v[44:47], v[92:95], v[76:79], v[44:47]
    s_sub_u32 s45, s45, 1
    s_cmp_lg_u32 s45, 0
    s_cbranch_scc1 mega_kernel_cm
    s_waitcnt lgkmcnt(0)
    v_mfma_f32_16x16x32_bf16 v[16:19], v[80:83], v[48:51], v[16:19]
    ds_read_b64_tr_b16 v[88:89], v4 offset:4096
    ds_read_b64_tr_b16 v[90:91], v4 offset:6144
    v_mfma_f32_16x16x32_bf16 v[20:23], v[80:83], v[52:55], v[20:23]
    ds_read_b128 v[64:67], v3 offset:8192
    ds_read_b128 v[68:71], v3 offset:9216
    v_mfma_f32_16x16x32_bf16 v[24:27], v[80:83], v[56:59], v[24:27]
    ds_read_b128 v[72:75], v3 offset:10240
    ds_read_b128 v[76:79], v3 offset:11264
    v_mfma_f32_16x16x32_bf16 v[28:31], v[80:83], v[60:63], v[28:31]
    ds_read_b64_tr_b16 v[92:93], v5 offset:4096
    ds_read_b64_tr_b16 v[94:95], v5 offset:6144
    v_mfma_f32_16x16x32_bf16 v[32:35], v[84:87], v[48:51], v[32:35]
    v_mfma_f32_16x16x32_bf16 v[36:39], v[84:87], v[52:55], v[36:39]
    v_mfma_f32_16x16x32_bf16 v[40:43], v[84:87], v[56:59], v[40:43]
    v_mfma_f32_16x16x32_bf16 v[44:47], v[84:87], v[60:63], v[44:47]
    s_waitcnt vmcnt(0) lgkmcnt(0)
    s_barrier
    v_mfma_f32_16x16x32_bf16 v[16:19], v[88:91], v[64:67], v[16:19]
    ds_read_b64_tr_b16 v[120:121], v8 offset:0
    ds_read_b64_tr_b16 v[122:123], v8 offset:8
    v_mfma_f32_16x16x32_bf16 v[20:23], v[88:91], v[68:71], v[20:23]
    ds_read_b64_tr_b16 v[124:125], v9 offset:0
    ds_read_b64_tr_b16 v[126:127], v9 offset:8
    v_mfma_f32_16x16x32_bf16 v[24:27], v[88:91], v[72:75], v[24:27]
    ds_read_b64_tr_b16 v[128:129], v8 offset:4096
    ds_read_b64_tr_b16 v[130:131], v8 offset:4104
    v_mfma_f32_16x16x32_bf16 v[28:31], v[88:91], v[76:79], v[28:31]
    ds_read_b64_tr_b16 v[132:133], v9 offset:4096
    ds_read_b64_tr_b16 v[134:135], v9 offset:4104
    v_mfma_f32_16x16x32_bf16 v[32:35], v[92:95], v[64:67], v[32:35]
    v_mfma_f32_16x16x32_bf16 v[36:39], v[92:95], v[68:71], v[36:39]
    v_mfma_f32_16x16x32_bf16 v[40:43], v[92:95], v[72:75], v[40:43]
    v_mfma_f32_16x16x32_bf16 v[44:47], v[92:95], v[76:79], v[44:47]
    s_waitcnt lgkmcnt(6)
    v_lshlrev_b32 v104, 16, v120
    v_and_b32 v105, 0xffff0000, v120
    v_lshlrev_b32 v106, 16, v121
    v_and_b32 v107, 0xffff0000, v121
    v_lshlrev_b32 v108, 16, v122
    v_and_b32 v109, 0xffff0000, v122
    v_lshlrev_b32 v110, 16, v123
    v_and_b32 v111, 0xffff0000, v123
    s_waitcnt lgkmcnt(5)
    v_lshlrev_b32 v112, 16, v124
    v_and_b32 v113, 0xffff0000, v124
    v_lshlrev_b32 v114, 16, v125
    v_and_b32 v115, 0xffff0000, v125
    v_pk_fma_f32 v[16:17], v[220:221], v[104:105], v[16:17]
    v_pk_fma_f32 v[18:19], v[222:223], v[106:107], v[18:19]
    v_cvt_pk_bf16_f32 v16, v16, v17
    v_cvt_pk_bf16_f32 v17, v18, v19
    ds_write_b64 v6, v[16:17] offset:0
    s_waitcnt lgkmcnt(5)
    v_lshlrev_b32 v116, 16, v126
    v_and_b32 v117, 0xffff0000, v126
    v_lshlrev_b32 v118, 16, v127
    v_and_b32 v119, 0xffff0000, v127
    v_pk_fma_f32 v[20:21], v[224:225], v[108:109], v[20:21]
    v_pk_fma_f32 v[22:23], v[226:227], v[110:111], v[22:23]
    v_cvt_pk_bf16_f32 v20, v20, v21
    v_cvt_pk_bf16_f32 v21, v22, v23
    ds_write_b64 v6, v[20:21] offset:512
    s_waitcnt lgkmcnt(5)
    v_lshlrev_b32 v104, 16, v128
    v_and_b32 v105, 0xffff0000, v128
    v_lshlrev_b32 v106, 16, v129
    v_and_b32 v107, 0xffff0000, v129
    v_pk_fma_f32 v[24:25], v[228:229], v[112:113], v[24:25]
    v_pk_fma_f32 v[26:27], v[230:231], v[114:115], v[26:27]
    v_cvt_pk_bf16_f32 v24, v24, v25
    v_cvt_pk_bf16_f32 v25, v26, v27
    ds_write_b64 v6, v[24:25] offset:4096
    s_waitcnt lgkmcnt(5)
    v_lshlrev_b32 v108, 16, v130
    v_and_b32 v109, 0xffff0000, v130
    v_lshlrev_b32 v110, 16, v131
    v_and_b32 v111, 0xffff0000, v131
    v_pk_fma_f32 v[28:29], v[232:233], v[116:117], v[28:29]
    v_pk_fma_f32 v[30:31], v[234:235], v[118:119], v[30:31]
    v_cvt_pk_bf16_f32 v28, v28, v29
    v_cvt_pk_bf16_f32 v29, v30, v31
    ds_write_b64 v6, v[28:29] offset:4608
    s_waitcnt lgkmcnt(5)
    v_lshlrev_b32 v112, 16, v132
    v_and_b32 v113, 0xffff0000, v132
    v_lshlrev_b32 v114, 16, v133
    v_and_b32 v115, 0xffff0000, v133
    v_pk_fma_f32 v[32:33], v[236:237], v[104:105], v[32:33]
    v_pk_fma_f32 v[34:35], v[238:239], v[106:107], v[34:35]
    v_cvt_pk_bf16_f32 v32, v32, v33
    v_cvt_pk_bf16_f32 v33, v34, v35
    ds_write_b64 v7, v[32:33] offset:0
    s_waitcnt lgkmcnt(5)
    v_lshlrev_b32 v116, 16, v134
    v_and_b32 v117, 0xffff0000, v134
    v_lshlrev_b32 v118, 16, v135
    v_and_b32 v119, 0xffff0000, v135
    v_pk_fma_f32 v[36:37], v[240:241], v[108:109], v[36:37]
    v_pk_fma_f32 v[38:39], v[242:243], v[110:111], v[38:39]
    v_cvt_pk_bf16_f32 v36, v36, v37
    v_cvt_pk_bf16_f32 v37, v38, v39
    ds_write_b64 v7, v[36:37] offset:512
    v_pk_fma_f32 v[40:41], v[244:245], v[112:113], v[40:41]
    v_pk_fma_f32 v[42:43], v[246:247], v[114:115], v[42:43]
    v_cvt_pk_bf16_f32 v40, v40, v41
    v_cvt_pk_bf16_f32 v41, v42, v43
    ds_write_b64 v7, v[40:41] offset:4096
    v_pk_fma_f32 v[44:45], v[248:249], v[116:117], v[44:45]
    v_pk_fma_f32 v[46:47], v[250:251], v[118:119], v[46:47]
    v_cvt_pk_bf16_f32 v44, v44, v45
    v_cvt_pk_bf16_f32 v45, v46, v47
    ds_write_b64 v7, v[44:45] offset:4608
    s_waitcnt lgkmcnt(0)
mega_kernel_cfin:
    s_lshr_b32 s40, s3, 2
    s_lshl_b32 s41, s40, 13
    s_lshl_b32 s40, s40, 17
    s_lshl_b32 s42, s38, 10
    s_add_u32 s41, s41, s42
    s_add_u32 s41, s41, 65536
    v_lshl_add_u32 v3, v0, 4, s41
    s_add_u32 s41, s40, 65536
    s_add_u32 s16, s58, s44
    s_addc_u32 s17, s59, 0
    s_and_b32 s17, s17, 0xffff
    s_mov_b32 s18, 262144
    s_mov_b32 s19, 0x20000
    s_barrier
    ds_read_b128 v[8:11], v3
    ds_read_b128 v[12:15], v3 offset:4096
    s_waitcnt lgkmcnt(1)
    buffer_store_dwordx4 v[8:11], v2, s[16:19], s40 offen
    s_waitcnt lgkmcnt(0)
    buffer_store_dwordx4 v[12:15], v2, s[16:19], s41 offen
    s_endpgm
mega_kernel_s0_gt_s:
    s_mov_b32 s52, 0x80000
mega_kernel_s0_gt_a:
    s_sub_u32 s52, s52, 1
    s_cbranch_scc1 mega_kernel_s0_gt_k
    buffer_load_dword v19, v18, s[88:91], 0 offen sc1
    s_waitcnt vmcnt(0)
    v_cmp_eq_u32 vcc, 0, v19
    s_cbranch_vccnz mega_kernel_s0_gt_a
    s_branch mega_kernel_s0_gt_k
mega_kernel_s0_pl0_s:
    s_mov_b32 s52, 0x80000
mega_kernel_s0_pl0_a:
    s_sub_u32 s52, s52, 1
    s_cbranch_scc1 mega_kernel_s0_pl0_k
    s_add_u32 s99, s98, 4096
    buffer_load_dwordx4 v[128:131], v20, s[48:51], s98 offen offset:0 sc1
    buffer_load_dwordx4 v[132:135], v20, s[48:51], s98 offen offset:1024 sc1
    buffer_load_dwordx4 v[136:139], v20, s[48:51], s98 offen offset:2048 sc1
    buffer_load_dwordx4 v[140:143], v20, s[48:51], s98 offen offset:3072 sc1
    buffer_load_dwordx4 v[144:147], v20, s[48:51], s99 offen offset:0 sc1
    buffer_load_dwordx4 v[148:151], v20, s[48:51], s99 offen offset:1024 sc1
    buffer_load_dwordx4 v[152:155], v20, s[48:51], s99 offen offset:2048 sc1
    buffer_load_dwordx4 v[156:159], v20, s[48:51], s99 offen offset:3072 sc1
    buffer_load_dwordx4 v[160:163], v20, s[48:51], s97 offen sc1
    s_waitcnt vmcnt(0)
    v_max3_u32 v176, v128, v129, v130
    v_max3_u32 v176, v176, v131, v132
    v_max3_u32 v176, v176, v133, v134
    v_max3_u32 v176, v176, v135, v136
    v_max3_u32 v176, v176, v137, v138
    v_max3_u32 v176, v176, v139, v140
    v_max3_u32 v176, v176, v141, v142
    v_max3_u32 v176, v176, v143, v144
    v_max3_u32 v176, v176, v145, v146
    v_max3_u32 v176, v176, v147, v148
    v_max3_u32 v176, v176, v149, v150
    v_max3_u32 v176, v176, v151, v152
    v_max3_u32 v176, v176, v153, v154
    v_max3_u32 v176, v176, v155, v156
    v_max3_u32 v176, v176, v157, v158
    v_max3_u32 v176, v176, v159, v160
    v_max3_u32 v176, v176, v161, v162
    v_max_u32 v176, v176, v163
    v_cmp_eq_u32 vcc, -1, v176
    s_cbranch_vccnz mega_kernel_s0_pl0_a
    s_branch mega_kernel_s0_pl0_k
mega_kernel_s0_st_slow:
    s_mov_b32 s52, 0x80000
mega_kernel_s0_st_again:
    s_mov_b64 s[40:41], 0
    v_cmp_eq_u32 vcc, -1, v128
    s_or_b64 s[40:41], s[40:41], vcc
    v_cmp_eq_u32 vcc, -1, v129
    s_or_b64 s[40:41], s[40:41], vcc
    v_cmp_eq_u32 vcc, -1, v130
    s_or_b64 s[40:41], s[40:41], vcc
    v_cmp_eq_u32 vcc, -1, v131
    s_or_b64 s[40:41], s[40:41], vcc
    v_cmp_eq_u32 vcc, -1, v132
    s_or_b64 s[40:41], s[40:41], vcc
    v_cmp_eq_u32 vcc, -1, v133
    s_or_b64 s[40:41], s[40:41], vcc
    v_cmp_eq_u32 vcc, -1, v134
    s_or_b64 s[40:41], s[40:41], vcc
    v_cmp_eq_u32 vcc, -1, v135
    s_or_b64 s[40:41], s[40:41], vcc
    v_cmp_eq_u32 vcc, -1, v136
    s_or_b64 s[40:41], s[40:41], vcc
    v_cmp_eq_u32 vcc, -1, v137
    s_or_b64 s[40:41], s[40:41], vcc
    v_cmp_eq_u32 vcc, -1, v138
    s_or_b64 s[40:41], s[40:41], vcc
    v_cmp_eq_u32 vcc, -1, v139
    s_or_b64 s[40:41], s[40:41], vcc
    v_cmp_eq_u32 vcc, -1, v140
    s_or_b64 s[40:41], s[40:41], vcc
    v_cmp_eq_u32 vcc, -1, v141
    s_or_b64 s[40:41], s[40:41], vcc
    v_cmp_eq_u32 vcc, -1, v142
    s_or_b64 s[40:41], s[40:41], vcc
    v_cmp_eq_u32 vcc, -1, v143
    s_or_b64 s[40:41], s[40:41], vcc
    v_cmp_eq_u32 vcc, -1, v144
    s_or_b64 s[40:41], s[40:41], vcc
    v_cmp_eq_u32 vcc, -1, v145
    s_or_b64 s[40:41], s[40:41], vcc
    v_cmp_eq_u32 vcc, -1, v146
    s_or_b64 s[40:41], s[40:41], vcc
    v_cmp_eq_u32 vcc, -1, v147
    s_or_b64 s[40:41], s[40:41], vcc
    v_cmp_eq_u32 vcc, -1, v148
    s_or_b64 s[40:41], s[40:41], vcc
    v_cmp_eq_u32 vcc, -1, v149
    s_or_b64 s[40:41], s[40:41], vcc
    v_cmp_eq_u32 vcc, -1, v150
    s_or_b64 s[40:41], s[40:41], vcc
    v_cmp_eq_u32 vcc, -1, v151
    s_or_b64 s[40:41], s[40:41], vcc
    v_cmp_eq_u32 vcc, -1, v152
    s_or_b64 s[40:41], s[40:41], vcc
    v_cmp_eq_u32 vcc, -1, v153
    s_or_b64 s[40:41], s[40:41], vcc
    v_cmp_eq_u32 vcc, -1, v154
    s_or_b64 s[40:41], s[40:41], vcc
    v_cmp_eq_u32 vcc, -1, v155
    s_or_b64 s[40:41], s[40:41], vcc
    s_cmp_eq_u64 s[40:41], 0
    s_cbranch_scc1 mega_kernel_s0_st_done
    s_sub_u32 s52, s52, 1
    s_cmp_eq_u32 s52, 0
    s_cbranch_scc1 mega_kernel_s0_st_done
    buffer_load_dwordx4 v[128:131], v170, s[48:51], s29 offen offset:0 sc1
    buffer_load_dwordx4 v[132:135], v170, s[48:51], s29 offen offset:2048 sc1
    buffer_load_dwordx4 v[136:139], v170, s[48:51], s30 offen offset:0 sc1
    buffer_load_dwordx4 v[140:143], v170, s[48:51], s30 offen offset:2048 sc1
    buffer_load_dwordx4 v[144:147], v170, s[48:51], s31 offen offset:0 sc1
    buffer_load_dwordx4 v[148:151], v170, s[48:51], s31 offen offset:2048 sc1
    buffer_load_dwordx4 v[152:155], v170, s[48:51], s28 offen offset:0 sc1
    s_waitcnt vmcnt(0)
    s_branch mega_kernel_s0_st_again
mega_kernel_s0_st_done:
    v_add_f32 v156, v128, v132
    v_add_f32 v157, v129, v133
    v_add_f32 v158, v130, v134
    v_add_f32 v159, v131, v135
    v_add_f32 v156, v156, v136
    v_add_f32 v157, v157, v137
    v_add_f32 v158, v158, v138
    v_add_f32 v159, v159, v139
    v_add_f32 v156, v156, v140
    v_add_f32 v157, v157, v141
    v_add_f32 v158, v158, v142
    v_add_f32 v159, v159, v143
    v_add_f32 v156, v156, v144
    v_add_f32 v157, v157, v145
    v_add_f32 v158, v158, v146
    v_add_f32 v159, v159, v147
    v_add_f32 v156, v156, v148
    v_add_f32 v157, v157, v149
    v_add_f32 v158, v158, v150
    v_add_f32 v159, v159, v151
    v_add_f32 v156, v156, v152
    v_add_f32 v157, v157, v153
    v_add_f32 v158, v158, v154
    v_add_f32 v159, v159, v155
    s_nop 1
    v_permlane32_swap_b32 v156, v158
    v_permlane32_swap_b32 v157, v159
    s_nop 1
    v_add_f32 v156, v156, v158
    v_add_f32 v157, v157, v159
    s_branch mega_kernel_s0_st_ok
mega_kernel_s0_pl1_s:
    s_mov_b32 s52, 0x80000
mega_kernel_s0_pl1_a:
    s_sub_u32 s52, s52, 1
    s_cbranch_scc1 mega_kernel_s0_pl1_k
    s_add_u32 s99, s98, 4096
    buffer_load_dwordx4 v[128:131], v20, s[48:51], s98 offen offset:0 sc1
    buffer_load_dwordx4 v[132:135], v20, s[48:51], s98 offen offset:1024 sc1
    buffer_load_dwordx4 v[136:139], v20, s[48:51], s98 offen offset:2048 sc1
    buffer_load_dwordx4 v[140:143], v20, s[48:51], s98 offen offset:3072 sc1
    buffer_load_dwordx4 v[144:147], v20, s[48:51], s99 offen offset:0 sc1
    buffer_load_dwordx4 v[148:151], v20, s[48:51], s99 offen offset:1024 sc1
    buffer_load_dwordx4 v[152:155], v20, s[48:51], s99 offen offset:2048 sc1
    buffer_load_dwordx4 v[156:159], v20, s[48:51], s99 offen offset:3072 sc1
    s_waitcnt vmcnt(0)
    v_max3_u32 v176, v128, v129, v130
    v_max3_u32 v176, v176, v131, v132
    v_max3_u32 v176, v176, v133, v134
    v_max3_u32 v176, v176, v135, v136
    v_max3_u32 v176, v176, v137, v138
    v_max3_u32 v176, v176, v139, v140
    v_max3_u32 v176, v176, v141, v142
    v_max3_u32 v176, v176, v143, v144
    v_max3_u32 v176, v176, v145, v146
    v_max3_u32 v176, v176, v147, v148
    v_max3_u32 v176, v176, v149, v150
    v_max3_u32 v176, v176, v151, v152
    v_max3_u32 v176, v176, v153, v154
    v_max3_u32 v176, v176, v155, v156
    v_max3_u32 v176, v176, v157, v158
    v_max_u32 v176, v176, v159
    v_cmp_eq_u32 vcc, -1, v176
    s_cbranch_vccnz mega_kernel_s0_pl1_a
    s_branch mega_kernel_s0_pl1_k
mega_kernel_s0_zf_s:
    s_mov_b32 s52, 0x80000
mega_kernel_s0_zf_a:
    s_sub_u32 s52, s52, 1
    s_cbranch_scc1 mega_kernel_s0_zf_k
    buffer_load_dword v29, v28, s[48:51], s46 offen sc1
    s_waitcnt vmcnt(0)
    v_cmp_eq_u32 vcc, -1, v29
    s_cbranch_vccnz mega_kernel_s0_zf_a
    s_branch mega_kernel_s0_zf_k
mega_kernel_s1_st_slow:
    s_mov_b32 s52, 0x80000
mega_kernel_s1_st_again:
    s_mov_b64 s[40:41], 0
    v_cmp_eq_u32 vcc, -1, v128
    s_or_b64 s[40:41], s[40:41], vcc
    v_cmp_eq_u32 vcc, -1, v129
    s_or_b64 s[40:41], s[40:41], vcc
    v_cmp_eq_u32 vcc, -1, v130
    s_or_b64 s[40:41], s[40:41], vcc
    v_cmp_eq_u32 vcc, -1, v131
    s_or_b64 s[40:41], s[40:41], vcc
    v_cmp_eq_u32 vcc, -1, v132
    s_or_b64 s[40:41], s[40:41], vcc
    v_cmp_eq_u32 vcc, -1, v133
    s_or_b64 s[40:41], s[40:41], vcc
    v_cmp_eq_u32 vcc, -1, v134
    s_or_b64 s[40:41], s[40:41], vcc
    v_cmp_eq_u32 vcc, -1, v135
    s_or_b64 s[40:41], s[40:41], vcc
    v_cmp_eq_u32 vcc, -1, v136
    s_or_b64 s[40:41], s[40:41], vcc
    v_cmp_eq_u32 vcc, -1, v137
    s_or_b64 s[40:41], s[40:41], vcc
    v_cmp_eq_u32 vcc, -1, v138
    s_or_b64 s[40:41], s[40:41], vcc
    v_cmp_eq_u32 vcc, -1, v139
    s_or_b64 s[40:41], s[40:41], vcc
    v_cmp_eq_u32 vcc, -1, v140
    s_or_b64 s[40:41], s[40:41], vcc
    v_cmp_eq_u32 vcc, -1, v141
    s_or_b64 s[40:41], s[40:41], vcc
    v_cmp_eq_u32 vcc, -1, v142
    s_or_b64 s[40:41], s[40:41], vcc
    v_cmp_eq_u32 vcc, -1, v143
    s_or_b64 s[40:41], s[40:41], vcc
    v_cmp_eq_u32 vcc, -1, v144
    s_or_b64 s[40:41], s[40:41], vcc
    v_cmp_eq_u32 vcc, -1, v145
    s_or_b64 s[40:41], s[40:41], vcc
    v_cmp_eq_u32 vcc, -1, v146
    s_or_b64 s[40:41], s[40:41], vcc
    v_cmp_eq_u32 vcc, -1, v147
    s_or_b64 s[40:41], s[40:41], vcc
    v_cmp_eq_u32 vcc, -1, v148
    s_or_b64 s[40:41], s[40:41], vcc
    v_cmp_eq_u32 vcc, -1, v149
    s_or_b64 s[40:41], s[40:41], vcc
    v_cmp_eq_u32 vcc, -1, v150
    s_or_b64 s[40:41], s[40:41], vcc
    v_cmp_eq_u32 vcc, -1, v151
    s_or_b64 s[40:41], s[40:41], vcc
    v_cmp_eq_u32 vcc, -1, v152
    s_or_b64 s[40:41], s[40:41], vcc
    v_cmp_eq_u32 vcc, -1, v153
    s_or_b64 s[40:41], s[40:41], vcc
    v_cmp_eq_u32 vcc, -1, v154
    s_or_b64 s[40:41], s[40:41], vcc
    v_cmp_eq_u32 vcc, -1, v155
    s_or_b64 s[40:41], s[40:41], vcc
    s_cmp_eq_u64 s[40:41], 0
    s_cbranch_scc1 mega_kernel_s1_st_done
    s_sub_u32 s52, s52, 1
    s_cmp_eq_u32 s52, 0
    s_cbranch_scc1 mega_kernel_s1_st_done
    buffer_load_dwordx4 v[128:131], v170, s[48:51], s29 offen offset:0 sc1
    buffer_load_dwordx4 v[132:135], v170, s[48:51], s29 offen offset:2048 sc1
    buffer_load_dwordx4 v[136:139], v170, s[48:51], s30 offen offset:0 sc1
    buffer_load_dwordx4 v[140:143], v170, s[48:51], s30 offen offset:2048 sc1
    buffer_load_dwordx4 v[144:147], v170, s[48:51], s31 offen offset:0 sc1
    buffer_load_dwordx4 v[148:151], v170, s[48:51], s31 offen offset:2048 sc1
    buffer_load_dwordx4 v[152:155], v170, s[48:51], s28 offen offset:0 sc1
    s_waitcnt vmcnt(0)
    s_branch mega_kernel_s1_st_again
mega_kernel_s1_st_done:
    v_add_f32 v156, v128, v132
    v_add_f32 v157, v129, v133
    v_add_f32 v158, v130, v134
    v_add_f32 v159, v131, v135
    v_add_f32 v156, v156, v136
    v_add_f32 v157, v157, v137
    v_add_f32 v158, v158, v138
    v_add_f32 v159, v159, v139
    v_add_f32 v156, v156, v140
    v_add_f32 v157, v157, v141
    v_add_f32 v158, v158, v142
    v_add_f32 v159, v159, v143
    v_add_f32 v156, v156, v144
    v_add_f32 v157, v157, v145
    v_add_f32 v158, v158, v146
    v_add_f32 v159, v159, v147
    v_add_f32 v156, v156, v148
    v_add_f32 v157, v157, v149
    v_add_f32 v158, v158, v150
    v_add_f32 v159, v159, v151
    v_add_f32 v156, v156, v152
    v_add_f32 v157, v157, v153
    v_add_f32 v158, v158, v154
    v_add_f32 v159, v159, v155
    s_nop 1
    v_permlane32_swap_b32 v156, v158
    v_permlane32_swap_b32 v157, v159
    s_nop 1
    v_add_f32 v156, v156, v158
    v_add_f32 v157, v157, v159
    s_branch mega_kernel_s1_st_ok
mega_kernel_pf_s:
    s_mov_b32 s52, 0x80000
mega_kernel_pf_a:
    s_sub_u32 s52, s52, 1
    s_cbranch_scc1 mega_kernel_pf_k
    buffer_load_dword v10, v8, s[48:51], s46 offen sc1
    s_waitcnt vmcnt(0)
    v_cmp_ne_u32 vcc, -1, v10
    s_and_b32 s33, vcc_lo, 0x3fff
    s_cmp_lg_u32 s33, 0x3fff
    s_cbranch_scc1 mega_kernel_pf_a
    s_branch mega_kernel_pf_k
mega_kernel_yf_s:
    s_waitcnt vmcnt(15)
    s_barrier
    s_mov_b32 s55, 1
    s_waitcnt vmcnt(0)
    v_cmp_eq_u32 vcc, -1, v14
    s_cbranch_vccz mega_kernel_yf_k
    buffer_load_dword v10, v9, s[48:51], s47 offen sc1
    s_waitcnt vmcnt(8)
    s_barrier
    s_mov_b32 s55, 2
    s_mov_b32 s52, 0x80000
mega_kernel_yf_a:
    s_waitcnt vmcnt(0)
    v_cmp_eq_u32 vcc, -1, v10
    s_cbranch_vccz mega_kernel_yf_k
    s_sub_u32 s52, s52, 1
    s_cbranch_scc1 mega_kernel_yf_k
    buffer_load_dword v10, v9, s[48:51], s47 offen sc1
    s_branch mega_kernel_yf_a
mega_kernel_s0_cs0:
    ds_read_b64_tr_b16 v[76:77], v11 offset:0
    ds_read_b64_tr_b16 v[78:79], v11 offset:1024
    ds_read_b64_tr_b16 v[80:81], v12 offset:0
    ds_read_b64_tr_b16 v[82:83], v12 offset:1024
    ds_read_b64_tr_b16 v[84:85], v13 offset:0
    ds_read_b64_tr_b16 v[86:87], v13 offset:1024
    ds_read_b64_tr_b16 v[88:89], v14 offset:0
    ds_read_b64_tr_b16 v[90:91], v14 offset:1024
    s_waitcnt lgkmcnt(4)
    ds_read_b64_tr_b16 v[92:93], v11 offset:2048
    ds_read_b64_tr_b16 v[94:95], v11 offset:3072
    ds_read_b64_tr_b16 v[96:97], v12 offset:2048
    ds_read_b64_tr_b16 v[98:99], v12 offset:3072
    ds_read_b64_tr_b16 v[100:101], v13 offset:2048
    ds_read_b64_tr_b16 v[102:103], v13 offset:3072
    ds_read_b64_tr_b16 v[104:105], v14 offset:2048
    ds_read_b64_tr_b16 v[106:107], v14 offset:3072
    s_waitcnt lgkmcnt(8)
    v_mfma_f32_16x16x32_bf16 v[108:111], v[72:75], v[76:79], 0
    v_mfma_f32_16x16x32_bf16 v[112:115], v[72:75], v[80:83], 0
    v_mfma_f32_16x16x32_bf16 v[116:119], v[72:75], v[84:87], 0
    v_mfma_f32_16x16x32_bf16 v[120:123], v[72:75], v[88:91], 0
    s_waitcnt lgkmcnt(0)
    v_mfma_f32_16x16x32_bf16 v[108:111], v[72:75], v[92:95], v[108:111]
    v_mfma_f32_16x16x32_bf16 v[112:115], v[72:75], v[96:99], v[112:115]
    v_mfma_f32_16x16x32_bf16 v[116:119], v[72:75], v[100:103], v[116:119]
    v_mfma_f32_16x16x32_bf16 v[120:123], v[72:75], v[104:107], v[120:123]
    s_nop 7
    s_branch mega_kernel_s0_cs0_k
mega_kernel_s0_cs16:
    ds_read_b64_tr_b16 v[76:77], v11 offset:0
    ds_read_b64_tr_b16 v[78:79], v11 offset:1024
    ds_read_b64_tr_b16 v[80:81], v12 offset:0
    ds_read_b64_tr_b16 v[82:83], v12 offset:1024
    ds_read_b64_tr_b16 v[84:85], v13 offset:0
    ds_read_b64_tr_b16 v[86:87], v13 offset:1024
    ds_read_b64_tr_b16 v[88:89], v14 offset:0
    ds_read_b64_tr_b16 v[90:91], v14 offset:1024
    s_waitcnt lgkmcnt(4)
    ds_read_b64_tr_b16 v[92:93], v11 offset:2048
    ds_read_b64_tr_b16 v[94:95], v11 offset:3072
    ds_read_b64_tr_b16 v[96:97], v12 offset:2048
    ds_read_b64_tr_b16 v[98:99], v12 offset:3072
    ds_read_b64_tr_b16 v[100:101], v13 offset:2048
    ds_read_b64_tr_b16 v[102:103], v13 offset:3072
    ds_read_b64_tr_b16 v[104:105], v14 offset:2048
    ds_read_b64_tr_b16 v[106:107], v14 offset:3072
    s_waitcnt lgkmcnt(8)
    v_mfma_f32_16x16x32_bf16 v[108:111], v[72:75], v[76:79], 0
    v_mfma_f32_16x16x32_bf16 v[112:115], v[72:75], v[80:83], 0
    v_mfma_f32_16x16x32_bf16 v[116:119], v[72:75], v[84:87], 0
    v_mfma_f32_16x16x32_bf16 v[120:123], v[72:75], v[88:91], 0
    s_waitcnt lgkmcnt(0)
    v_mfma_f32_16x16x32_bf16 v[108:111], v[72:75], v[92:95], v[108:111]
    v_mfma_f32_16x16x32_bf16 v[112:115], v[72:75], v[96:99], v[112:115]
    v_mfma_f32_16x16x32_bf16 v[116:119], v[72:75], v[100:103], v[116:119]
    v_mfma_f32_16x16x32_bf16 v[120:123], v[72:75], v[104:107], v[120:123]
    s_nop 7
    s_branch mega_kernel_s0_cs16_k
mega_kernel_s1_cs0:
    ds_read_b64_tr_b16 v[76:77], v11 offset:0
    ds_read_b64_tr_b16 v[78:79], v11 offset:1024
    ds_read_b64_tr_b16 v[80:81], v12 offset:0
    ds_read_b64_tr_b16 v[82:83], v12 offset:1024
    ds_read_b64_tr_b16 v[84:85], v13 offset:0
    ds_read_b64_tr_b16 v[86:87], v13 offset:1024
    ds_read_b64_tr_b16 v[88:89], v14 offset:0
    ds_read_b64_tr_b16 v[90:91], v14 offset:1024
    s_waitcnt lgkmcnt(4)
    ds_read_b64_tr_b16 v[92:93], v11 offset:2048
    ds_read_b64_tr_b16 v[94:95], v11 offset:3072
    ds_read_b64_tr_b16 v[96:97], v12 offset:2048
    ds_read_b64_tr_b16 v[98:99], v12 offset:3072
    ds_read_b64_tr_b16 v[100:101], v13 offset:2048
    ds_read_b64_tr_b16 v[102:103], v13 offset:3072
    ds_read_b64_tr_b16 v[104:105], v14 offset:2048
    ds_read_b64_tr_b16 v[106:107], v14 offset:3072
    s_waitcnt lgkmcnt(8)
    v_mfma_f32_16x16x32_bf16 v[108:111], v[72:75], v[76:79], 0
    v_mfma_f32_16x16x32_bf16 v[112:115], v[72:75], v[80:83], 0
    v_mfma_f32_16x16x32_bf16 v[116:119], v[72:75], v[84:87], 0
    v_mfma_f32_16x16x32_bf16 v[120:123], v[72:75], v[88:91], 0
    s_waitcnt lgkmcnt(0)
    v_mfma_f32_16x16x32_bf16 v[108:111], v[72:75], v[92:95], v[108:111]
    v_mfma_f32_16x16x32_bf16 v[112:115], v[72:75], v[96:99], v[112:115]
    v_mfma_f32_16x16x32_bf16 v[116:119], v[72:75], v[100:103], v[116:119]
    v_mfma_f32_16x16x32_bf16 v[120:123], v[72:75], v[104:107], v[120:123]
    s_nop 7
    s_branch mega_kernel_s1_cs0_k
mega_kernel_s1_cs16:
    ds_read_b64_tr_b16 v[76:77], v11 offset:0
    ds_read_b64_tr_b16 v[78:79], v11 offset:1024
    ds_read_b64_tr_b16 v[80:81], v12 offset:0
    ds_read_b64_tr_b16 v[82:83], v12 offset:1024
    ds_read_b64_tr_b16 v[84:85], v13 offset:0
    ds_read_b64_tr_b16 v[86:87], v13 offset:1024
    ds_read_b64_tr_b16 v[88:89], v14 offset:0
    ds_read_b64_tr_b16 v[90:91], v14 offset:1024
    s_waitcnt lgkmcnt(4)
    ds_read_b64_tr_b16 v[92:93], v11 offset:2048
    ds_read_b64_tr_b16 v[94:95], v11 offset:3072
    ds_read_b64_tr_b16 v[96:97], v12 offset:2048
    ds_read_b64_tr_b16 v[98:99], v12 offset:3072
    ds_read_b64_tr_b16 v[100:101], v13 offset:2048
    ds_read_b64_tr_b16 v[102:103], v13 offset:3072
    ds_read_b64_tr_b16 v[104:105], v14 offset:2048
    ds_read_b64_tr_b16 v[106:107], v14 offset:3072
    s_waitcnt lgkmcnt(8)
    v_mfma_f32_16x16x32_bf16 v[108:111], v[72:75], v[76:79], 0
    v_mfma_f32_16x16x32_bf16 v[112:115], v[72:75], v[80:83], 0
    v_mfma_f32_16x16x32_bf16 v[116:119], v[72:75], v[84:87], 0
    v_mfma_f32_16x16x32_bf16 v[120:123], v[72:75], v[88:91], 0
    s_waitcnt lgkmcnt(0)
    v_mfma_f32_16x16x32_bf16 v[108:111], v[72:75], v[92:95], v[108:111]
    v_mfma_f32_16x16x32_bf16 v[112:115], v[72:75], v[96:99], v[112:115]
    v_mfma_f32_16x16x32_bf16 v[116:119], v[72:75], v[100:103], v[116:119]
    v_mfma_f32_16x16x32_bf16 v[120:123], v[72:75], v[104:107], v[120:123]
    s_nop 7
    s_branch mega_kernel_s1_cs16_k
mega_kernel_pf0:
    buffer_load_dword v249, v251, s[56:59], s44 offen
    s_add_u32 s44, s44, 1792
    s_branch mega_kernel_pb0
mega_kernel_pf1:
    buffer_load_dword v249, v251, s[56:59], s44 offen
    s_add_u32 s44, s44, 1792
    s_branch mega_kernel_pb1
mega_kernel_pf2:
    buffer_load_dword v249, v251, s[56:59], s44 offen
    s_add_u32 s44, s44, 1792
    s_branch mega_kernel_pb2
mega_kernel_pf3:
    buffer_load_dword v249, v251, s[56:59], s44 offen
    s_add_u32 s44, s44, 1792
    s_branch mega_kernel_pb3
mega_kernel_pf4:
    buffer_load_dword v249, v251, s[56:59], s44 offen
    s_add_u32 s44, s44, 1792
    s_branch mega_kernel_pb4
mega_kernel_pf5:
    buffer_load_dword v249, v251, s[56:59], s44 offen
    s_add_u32 s44, s44, 1792
    s_branch mega_kernel_pb5
mega_kernel_pf6:
    buffer_load_dword v249, v251, s[56:59], s44 offen
    s_add_u32 s44, s44, 1792
    s_branch mega_kernel_pb6
mega_kernel_pf7:
    buffer_load_dword v249, v251, s[56:59], s44 offen
    s_add_u32 s44, s44, 1792
    s_branch mega_kernel_pb7
mega_kernel_pf8:
    buffer_load_dword v249, v251, s[56:59], s44 offen
    s_add_u32 s44, s44, 1792
    s_branch mega_kernel_pb8
mega_kernel_pf9:
    buffer_load_dword v249, v251, s[56:59], s44 offen
    s_add_u32 s44, s44, 1792
    s_branch mega_kernel_pb9
mega_kernel_pf10:
    buffer_load_dword v249, v251, s[56:59], s44 offen
    s_add_u32 s44, s44, 1792
    s_branch mega_kernel_pb10
mega_kernel_pf11:
    buffer_load_dword v249, v251, s[56:59], s44 offen
    s_add_u32 s44, s44, 1792
    s_branch mega_kernel_pb11
mega_kernel_pf12:
    buffer_load_dword v249, v251, s[56:59], s44 offen
    s_add_u32 s44, s44, 1792
    s_branch mega_kernel_pb12
mega_kernel_pf13:
    buffer_load_dword v249, v251, s[56:59], s44 offen
    s_add_u32 s44, s44, 1792
    s_branch mega_kernel_pb13
mega_kernel_pf14:
    buffer_load_dword v249, v251, s[56:59], s44 offen
    s_add_u32 s44, s44, 1792
    s_branch mega_kernel_pb14
.p2align 7
mega_kernel_helper:
    s_load_dwordx2 s[12:13], s[0:1], 8
    s_load_dwordx4 s[40:43], s[0:1], 16
    s_load_dwordx4 s[28:31], s[0:1], 32
    s_and_b32 s38, s3, 3
    s_waitcnt lgkmcnt(0)
    s_mov_b32 s16, s12
    s_and_b32 s17, s13, 0xffff
    s_mov_b32 s18, 4194304
    s_mov_b32 s19, 0x20000
    s_add_u32 s20, s10, 0x800000
    s_addc_u32 s21, s11, 0
    s_and_b32 s21, s21, 0xffff
    s_mov_b32 s22, 4325376
    s_mov_b32 s23, 0x20000
    s_mov_b32 s24, s28
    s_and_b32 s25, s29, 0xffff
    s_mov_b32 s26, 4194304
    s_mov_b32 s27, 0x20000
    s_lshl_b32 s12, s14, 2
    s_add_u32 s12, s12, s15
    s_sub_u32 s12, s12, 28
    s_lshl_b32 s12, s12, 5
    s_mul_i32 s13, s38, 40960
    s_lshl_b32 s35, s38, 3
    s_add_u32 s35, s35, s12
    v_lshlrev_b32 v12, 4, v0
    s_cmp_lt_u32 s3, 4
    s_cbranch_scc1 mega_kernel_hk
    s_mov_b32 s36, s30
    s_and_b32 s37, s31, 0xffff
    s_mov_b32 s38, 2048
    s_mov_b32 s39, 0x20000
    v_and_b32 v6, 7, v0
    v_add_u32 v6, s35, v6
    v_lshlrev_b32 v7, 1, v6
    v_lshlrev_b32 v6, 12, v6
    buffer_load_ushort v13, v6, s[24:27], 0 offen
    buffer_load_ushort v14, v7, s[36:39], 0 offen
    s_lshl_b32 s33, s35, 12
    s_add_u32 m0, s13, 16384
    s_nop 0
    buffer_load_dwordx4 v12, s[24:27], s33 offen offset:0 nt lds
    buffer_load_dwordx4 v12, s[24:27], s33 offen offset:1024 nt lds
    buffer_load_dwordx4 v12, s[24:27], s33 offen offset:2048 nt lds
    buffer_load_dwordx4 v12, s[24:27], s33 offen offset:3072 nt lds
    s_add_u32 s33, s33, 4096
    s_add_u32 m0, s13, 36864
    s_nop 0
    buffer_load_dwordx4 v12, s[24:27], s33 offen offset:0 nt lds
    buffer_load_dwordx4 v12, s[24:27], s33 offen offset:1024 nt lds
    buffer_load_dwordx4 v12, s[24:27], s33 offen offset:2048 nt lds
    buffer_load_dwordx4 v12, s[24:27], s33 offen offset:3072 nt lds
    s_add_u32 s33, s33, 4096
mega_kernel_hk:
    s_load_dwordx2 s[94:95], s[0:1], 96
    s_and_b32 s38, s3, 3
    s_add_u32 s48, s10, 0x600000
    s_addc_u32 s49, s11, 0
    s_and_b32 s49, s49, 0xffff
    s_mov_b32 s50, 524288
    s_mov_b32 s51, 0x20000
    s_cmp_lt_u32 s3, 4
    s_cbranch_scc0 mega_kernel_he
    s_lshl_b32 s33, s12, 9
    s_lshl_b32 s34, s3, 12
    s_add_u32 s33, s33, s34
    v_mov_b32 v16, -1
    v_mov_b32 v20, 0
    v_mov_b32 v17, -1
    v_mov_b32 v21, 0
    v_mov_b32 v18, -1
    v_mov_b32 v22, 0
    v_mov_b32 v19, -1
    v_mov_b32 v23, 0
    buffer_store_dwordx4 v[16:19], v12, s[48:51], s33 offen offset:0 sc1
    buffer_store_dwordx4 v[16:19], v12, s[48:51], s33 offen offset:1024 sc1
    buffer_store_dwordx4 v[16:19], v12, s[48:51], s33 offen offset:2048 sc1
    buffer_store_dwordx4 v[16:19], v12, s[48:51], s33 offen offset:3072 sc1
mega_kernel_he:
    s_waitcnt lgkmcnt(0)
    s_mov_b32 s96, s94
    s_and_b32 s97, s95, 0xffff
    s_mov_b32 s98, 128
    s_mov_b32 s99, 0x20000
    s_lshl_b32 s92, s12, 2
    s_add_u32 s92, s92, 0x7f000
    s_cmp_eq_u32 s3, 4
    s_cselect_b32 s92, s92, 0x7fffffff
    v_lshlrev_b32 v15, 12, v0
    v_lshrrev_b32 v6, 3, v0
    s_lshl_b32 s34, s3, 3
    v_add_u32 v1, s34, v6
    v_mul_u32_u24 v1, 4224, v1
    v_and_b32 v7, 7, v0
    v_lshl_add_u32 v1, v7, 4, v1
    s_mul_i32 s33, s12, 4224
    s_add_u32 s33, s33, 4096
    s_cmp_lt_u32 s3, 4
    s_cselect_b32 s33, s33, 0x7fffffff
    v_mov_b32 v238, 0
    v_mov_b32 v239, 0
    v_mov_b32 v240, 0
    v_mov_b32 v241, 0
    buffer_store_dwordx4 v[238:241], v1, s[20:23], s33 offen sc1
    s_lshl_b32 s33, s12, 12
    s_lshl_b32 s34, s3, 8
    s_add_u32 s33, s33, s34
    v_lshlrev_b32 v2, 14, v6
    v_lshl_add_u32 v2, v7, 4, v2
    v_add_u32 v2, s33, v2
    s_sub_u32 s34, s33, 6144
    s_cmp_eq_u32 s12, 0
    s_cselect_b32 s34, 0x80000000, s34
    v_add_u32 v1, -2, v6
    v_cmp_gt_u32 vcc, 5, v1
    v_min_u32 v1, 2, v6
    v_lshlrev_b32 v1, 11, v1
    v_lshl_add_u32 v1, v7, 4, v1
    v_add_u32 v3, s34, v1
    v_mov_b32 v1, 0x80000000
    v_cndmask_b32 v3, v3, v1, vcc
    v_add_u32 v10, -8, v0
    v_and_b32 v10, 63, v10
    v_lshlrev_b32 v10, 2, v10
    s_lshl_b32 s34, s3, 10
    v_lshl_add_u32 v4, v7, 6, s34
    v_add_u32 v4, s34, v12
    s_mov_b32 s44, s40
    s_and_b32 s45, s41, 0xffff
    s_mov_b32 s46, 4194304
    s_mov_b32 s47, 0x20000
    s_mov_b32 s36, s42
    s_and_b32 s37, s43, 0xffff
    s_mov_b32 s38, 8192
    s_mov_b32 s39, 0x20000
    s_mov_b32 s56, 0
    s_mov_b32 s57, 4096
    s_mov_b32 s58, 8192
    s_mov_b32 s59, 12288
    s_cmp_lt_u32 s3, 4
    s_cbranch_scc0 mega_kernel_ge0
    buffer_load_dwordx4 v[168:171], v4, s[36:39], 0 offen offset:0
    buffer_load_dwordx4 v[16:19], v3, s[16:19], s56 offen offset:0 nt
    buffer_load_dwordx4 v[28:31], v2, s[16:19], s56 offen offset:0 nt
    buffer_load_dwordx4 v[32:35], v2, s[16:19], s56 offen offset:2048 nt
    buffer_load_dwordx4 v[36:39], v2, s[16:19], s57 offen offset:0 nt
    s_lshr_b32 s33, s12, 3
    s_cmp_eq_u32 s3, 0
    s_cselect_b32 s33, s33, 0x7fffffff
    v_mov_b32 v1, 1
    s_waitcnt vmcnt(6)
    s_barrier
    buffer_store_dword v1, v15, s[96:99], s33 offen sc1
    s_branch mega_kernel_ge1
mega_kernel_ge0:
    s_barrier
    buffer_load_dwordx4 v[168:171], v4, s[36:39], 0 offen offset:0
    buffer_load_dwordx4 v[16:19], v3, s[16:19], s56 offen offset:0 nt
    buffer_load_dwordx4 v[28:31], v2, s[16:19], s56 offen offset:0 nt
    buffer_load_dwordx4 v[32:35], v2, s[16:19], s56 offen offset:2048 nt
    buffer_load_dwordx4 v[36:39], v2, s[16:19], s57 offen offset:0 nt
mega_kernel_ge1:
    buffer_load_dwordx4 v[40:43], v2, s[16:19], s57 offen offset:2048 nt
    buffer_load_dwordx4 v[44:47], v2, s[16:19], s58 offen offset:0 nt
    buffer_load_dwordx4 v[48:51], v2, s[16:19], s58 offen offset:2048 nt
    buffer_load_dwordx4 v[52:55], v2, s[16:19], s59 offen offset:0 nt
    buffer_load_dwordx4 v[56:59], v2, s[16:19], s59 offen offset:2048 nt
    buffer_load_dwordx4 v[60:63], v2, s[44:47], s56 offen offset:0 nt
    buffer_load_dwordx4 v[64:67], v2, s[44:47], s56 offen offset:2048 nt
    buffer_load_dwordx4 v[68:71], v2, s[44:47], s57 offen offset:0 nt
    buffer_load_dwordx4 v[72:75], v2, s[44:47], s57 offen offset:2048 nt
    buffer_load_dwordx4 v[76:79], v2, s[44:47], s58 offen offset:0 nt
    buffer_load_dwordx4 v[80:83], v2, s[44:47], s58 offen offset:2048 nt
    buffer_load_dwordx4 v[84:87], v2, s[44:47], s59 offen offset:0 nt
    buffer_load_dwordx4 v[88:91], v2, s[44:47], s59 offen offset:2048 nt
    buffer_load_dwordx4 v[92:95], v3, s[16:19], s56 offen offset:128 nt
    buffer_load_dwordx4 v[104:107], v2, s[16:19], s56 offen offset:128 nt
    buffer_load_dwordx4 v[108:111], v2, s[16:19], s56 offen offset:2176 nt
    buffer_load_dwordx4 v[112:115], v2, s[16:19], s57 offen offset:128 nt
    buffer_load_dwordx4 v[116:119], v2, s[16:19], s57 offen offset:2176 nt
    buffer_load_dwordx4 v[120:123], v2, s[16:19], s58 offen offset:128 nt
    buffer_load_dwordx4 v[124:127], v2, s[16:19], s58 offen offset:2176 nt
    buffer_load_dwordx4 v[128:131], v2, s[16:19], s59 offen offset:128 nt
    buffer_load_dwordx4 v[132:135], v2, s[16:19], s59 offen offset:2176 nt
    buffer_load_dwordx4 v[136:139], v2, s[44:47], s56 offen offset:128 nt
    buffer_load_dwordx4 v[140:143], v2, s[44:47], s56 offen offset:2176 nt
    buffer_load_dwordx4 v[144:147], v2, s[44:47], s57 offen offset:128 nt
    buffer_load_dwordx4 v[148:151], v2, s[44:47], s57 offen offset:2176 nt
    buffer_load_dwordx4 v[152:155], v2, s[44:47], s58 offen offset:128 nt
    buffer_load_dwordx4 v[156:159], v2, s[44:47], s58 offen offset:2176 nt
    buffer_load_dwordx4 v[160:163], v2, s[44:47], s59 offen offset:128 nt
    buffer_load_dwordx4 v[164:167], v2, s[44:47], s59 offen offset:2176 nt
    s_and_b32 s33, s3, 3
    s_mul_i32 s33, s33, 40960
    s_lshr_b32 s34, s3, 2
    s_lshl_b32 s34, s34, 13
    s_add_u32 s33, s33, s34
    s_add_u32 s33, s33, 20480
    v_xor_b32 v1, v6, v7
    v_lshlrev_b32 v1, 4, v1
    v_mul_u32_u24 v5, 33792, v6
    v_lshl_add_u32 v5, v7, 4, v5
    v_lshl_add_u32 v6, v6, 7, v1
    v_xor_b32 v1, 0x70, v1
    v_lshl_add_u32 v1, v7, 7, v1
    v_lshl_add_u32 v11, v7, 6, s33
    v_add_u32 v7, s33, v6
    v_add_u32 v6, s33, v1
    v_add_u32 v1, s33, v12
    s_mul_i32 s33, s3, 540672
    s_lshl_b32 s34, s12, 2
    s_sub_u32 s33, s33, s34
    s_add_u32 s33, s33, 3968
    v_add_u32 v5, s33, v5
    s_waitcnt vmcnt(34)
    ds_write_b128 v1, v[168:171] offset:4096
    s_waitcnt lgkmcnt(0)
    ds_read_b128 v[168:171], v11 offset:4096
    ds_read_b128 v[172:175], v11 offset:4112
    ds_read_b128 v[176:179], v11 offset:4128
    ds_read_b128 v[180:183], v11 offset:4144
    ds_read_b128 v[184:187], v11 offset:4608
    ds_read_b128 v[188:191], v11 offset:4624
    ds_read_b128 v[192:195], v11 offset:4640
    ds_read_b128 v[196:199], v11 offset:4656
    s_waitcnt vmcnt(25)
    s_mov_b32 vcc_lo, 0
    s_mov_b32 vcc_hi, 0xff000000
    v_cndmask_b32 v238, v56, v16, vcc
    v_cndmask_b32 v239, v57, v17, vcc
    v_cndmask_b32 v240, v58, v18, vcc
    v_cndmask_b32 v241, v59, v19, vcc
    ds_bpermute_b32 v24, v10, v238
    ds_bpermute_b32 v20, v10, v52
    ds_bpermute_b32 v242, v10, v48
    ds_bpermute_b32 v25, v10, v239
    ds_bpermute_b32 v21, v10, v53
    ds_bpermute_b32 v243, v10, v49
    ds_bpermute_b32 v26, v10, v240
    ds_bpermute_b32 v22, v10, v54
    ds_bpermute_b32 v244, v10, v50
    ds_bpermute_b32 v27, v10, v241
    ds_bpermute_b32 v23, v10, v55
    ds_bpermute_b32 v245, v10, v51
    s_waitcnt lgkmcnt(12)
    v_lshlrev_b32 v200, 16, v168
    v_and_b32 v202, 0xffff0000, v168
    v_lshlrev_b32 v204, 16, v169
    v_and_b32 v206, 0xffff0000, v169
    v_lshlrev_b32 v201, 16, v170
    v_and_b32 v203, 0xffff0000, v170
    v_lshlrev_b32 v205, 16, v171
    v_and_b32 v207, 0xffff0000, v171
    v_lshlrev_b32 v222, 16, v28
    v_and_b32 v223, 0xffff0000, v28
    v_lshlrev_b32 v224, 16, v32
    v_and_b32 v225, 0xffff0000, v32
    v_lshlrev_b32 v226, 16, v36
    v_and_b32 v227, 0xffff0000, v36
    v_lshlrev_b32 v228, 16, v40
    v_and_b32 v229, 0xffff0000, v40
    v_lshlrev_b32 v230, 16, v44
    v_and_b32 v231, 0xffff0000, v44
    v_lshlrev_b32 v232, 16, v48
    v_and_b32 v233, 0xffff0000, v48
    v_lshlrev_b32 v234, 16, v52
    v_and_b32 v235, 0xffff0000, v52
    v_lshlrev_b32 v236, 16, v56
    v_and_b32 v237, 0xffff0000, v56
    s_waitcnt lgkmcnt(0)
    v_mov_b32_dpp v20, v16 row_shl:8 row_mask:0x1 bank_mask:0x3
    v_mov_b32_dpp v21, v17 row_shl:8 row_mask:0x1 bank_mask:0x3
    v_mov_b32_dpp v22, v18 row_shl:8 row_mask:0x1 bank_mask:0x3
    v_mov_b32_dpp v23, v19 row_shl:8 row_mask:0x1 bank_mask:0x3
    s_mov_b32 exec_lo, 0xffffff00
    v_mov_b32 v16, v242
    v_mov_b32 v17, v243
    v_mov_b32 v18, v244
    v_mov_b32 v19, v245
    s_mov_b32 exec_lo, -1
    v_lshlrev_b32 v216, 16, v16
    v_and_b32 v217, 0xffff0000, v16
    v_lshlrev_b32 v218, 16, v20
    v_and_b32 v219, 0xffff0000, v20
    v_lshlrev_b32 v220, 16, v24
    v_and_b32 v221, 0xffff0000, v24
    v_pk_mul_f32 v[238:239], v[222:223], v[200:201]
    v_pk_mul_f32 v[240:241], v[224:225], v[200:201]
    v_pk_mul_f32 v[242:243], v[226:227], v[200:201]
    v_pk_mul_f32 v[244:245], v[228:229], v[200:201]
    v_pk_mul_f32 v[246:247], v[230:231], v[200:201]
    v_pk_mul_f32 v[248:249], v[232:233], v[200:201]
    v_pk_mul_f32 v[250:251], v[234:235], v[200:201]
    v_pk_mul_f32 v[252:253], v[236:237], v[200:201]
    v_pk_fma_f32 v[238:239], v[220:221], v[202:203], v[238:239]
    v_pk_fma_f32 v[240:241], v[222:223], v[202:203], v[240:241]
    v_pk_fma_f32 v[242:243], v[224:225], v[202:203], v[242:243]
    v_pk_fma_f32 v[244:245], v[226:227], v[202:203], v[244:245]
    v_pk_fma_f32 v[246:247], v[228:229], v[202:203], v[246:247]
    v_pk_fma_f32 v[248:249], v[230:231], v[202:203], v[248:249]
    v_pk_fma_f32 v[250:251], v[232:233], v[202:203], v[250:251]
    v_pk_fma_f32 v[252:253], v[234:235], v[202:203], v[252:253]
    v_pk_fma_f32 v[238:239], v[218:219], v[204:205], v[238:239]
    v_pk_fma_f32 v[240:241], v[220:221], v[204:205], v[240:241]
    v_pk_fma_f32 v[242:243], v[222:223], v[204:205], v[242:243]
    v_pk_fma_f32 v[244:245], v[224:225], v[204:205], v[244:245]
    v_pk_fma_f32 v[246:247], v[226:227], v[204:205], v[246:247]
    v_pk_fma_f32 v[248:249], v[228:229], v[204:205], v[248:249]
    v_pk_fma_f32 v[250:251], v[230:231], v[204:205], v[250:251]
    v_pk_fma_f32 v[252:253], v[232:233], v[204:205], v[252:253]
    v_pk_fma_f32 v[238:239], v[216:217], v[206:207], v[238:239]
    v_pk_fma_f32 v[240:241], v[218:219], v[206:207], v[240:241]
    v_pk_fma_f32 v[242:243], v[220:221], v[206:207], v[242:243]
    v_pk_fma_f32 v[244:245], v[222:223], v[206:207], v[244:245]
    v_pk_fma_f32 v[246:247], v[224:225], v[206:207], v[246:247]
    v_pk_fma_f32 v[248:249], v[226:227], v[206:207], v[248:249]
    v_pk_fma_f32 v[250:251], v[228:229], v[206:207], v[250:251]
    v_pk_fma_f32 v[252:253], v[230:231], v[206:207], v[252:253]
    s_waitcnt vmcnt(17)
    v_lshlrev_b32 v216, 16, v60
    v_and_b32 v217, 0xffff0000, v60
    v_lshlrev_b32 v218, 16, v64
    v_and_b32 v219, 0xffff0000, v64
    v_lshlrev_b32 v220, 16, v68
    v_and_b32 v221, 0xffff0000, v68
    v_lshlrev_b32 v222, 16, v72
    v_and_b32 v223, 0xffff0000, v72
    v_lshlrev_b32 v224, 16, v76
    v_and_b32 v225, 0xffff0000, v76
    v_lshlrev_b32 v226, 16, v80
    v_and_b32 v227, 0xffff0000, v80
    v_lshlrev_b32 v228, 16, v84
    v_and_b32 v229, 0xffff0000, v84
    v_lshlrev_b32 v230, 16, v88
    v_and_b32 v231, 0xffff0000, v88
    v_pk_mul_f32 v[238:239], v[238:239], v[216:217]
    v_pk_mul_f32 v[240:241], v[240:241], v[218:219]
    v_pk_mul_f32 v[242:243], v[242:243], v[220:221]
    v_pk_mul_f32 v[244:245], v[244:245], v[222:223]
    v_pk_mul_f32 v[246:247], v[246:247], v[224:225]
    v_pk_mul_f32 v[248:249], v[248:249], v[226:227]
    v_pk_mul_f32 v[250:251], v[250:251], v[228:229]
    v_pk_mul_f32 v[252:253], v[252:253], v[230:231]
    v_cvt_pk_bf16_f32 v216, v252, v250
    v_cvt_pk_bf16_f32 v217, v248, v246
    v_cvt_pk_bf16_f32 v218, v244, v242
    v_cvt_pk_bf16_f32 v219, v240, v238
    ds_write_b128 v6, v[216:219] offset:0
    v_cvt_pk_bf16_f32 v220, v253, v251
    v_cvt_pk_bf16_f32 v221, v249, v247
    v_cvt_pk_bf16_f32 v222, v245, v243
    v_cvt_pk_bf16_f32 v223, v241, v239
    ds_write_b128 v6, v[220:223] offset:1024
    v_lshlrev_b32 v200, 16, v172
    v_and_b32 v202, 0xffff0000, v172
    v_lshlrev_b32 v204, 16, v173
    v_and_b32 v206, 0xffff0000, v173
    v_lshlrev_b32 v201, 16, v174
    v_and_b32 v203, 0xffff0000, v174
    v_lshlrev_b32 v205, 16, v175
    v_and_b32 v207, 0xffff0000, v175
    v_lshlrev_b32 v216, 16, v17
    v_and_b32 v217, 0xffff0000, v17
    v_lshlrev_b32 v218, 16, v21
    v_and_b32 v219, 0xffff0000, v21
    v_lshlrev_b32 v220, 16, v25
    v_and_b32 v221, 0xffff0000, v25
    v_lshlrev_b32 v222, 16, v29
    v_and_b32 v223, 0xffff0000, v29
    v_lshlrev_b32 v224, 16, v33
    v_and_b32 v225, 0xffff0000, v33
    v_lshlrev_b32 v226, 16, v37
    v_and_b32 v227, 0xffff0000, v37
    v_lshlrev_b32 v228, 16, v41
    v_and_b32 v229, 0xffff0000, v41
    v_lshlrev_b32 v230, 16, v45
    v_and_b32 v231, 0xffff0000, v45
    v_lshlrev_b32 v232, 16, v49
    v_and_b32 v233, 0xffff0000, v49
    v_lshlrev_b32 v234, 16, v53
    v_and_b32 v235, 0xffff0000, v53
    v_lshlrev_b32 v236, 16, v57
    v_and_b32 v237, 0xffff0000, v57
    s_waitcnt lgkmcnt(0)
    ds_read_b128 v[208:211], v7 offset:0
    ds_read_b128 v[212:215], v7 offset:1024
    v_pk_mul_f32 v[238:239], v[222:223], v[200:201]
    v_pk_mul_f32 v[240:241], v[224:225], v[200:201]
    v_pk_mul_f32 v[242:243], v[226:227], v[200:201]
    v_pk_mul_f32 v[244:245], v[228:229], v[200:201]
    v_pk_mul_f32 v[246:247], v[230:231], v[200:201]
    v_pk_mul_f32 v[248:249], v[232:233], v[200:201]
    v_pk_mul_f32 v[250:251], v[234:235], v[200:201]
    v_pk_mul_f32 v[252:253], v[236:237], v[200:201]
    v_pk_fma_f32 v[238:239], v[220:221], v[202:203], v[238:239]
    v_pk_fma_f32 v[240:241], v[222:223], v[202:203], v[240:241]
    v_pk_fma_f32 v[242:243], v[224:225], v[202:203], v[242:243]
    v_pk_fma_f32 v[244:245], v[226:227], v[202:203], v[244:245]
    v_pk_fma_f32 v[246:247], v[228:229], v[202:203], v[246:247]
    v_pk_fma_f32 v[248:249], v[230:231], v[202:203], v[248:249]
    v_pk_fma_f32 v[250:251], v[232:233], v[202:203], v[250:251]
    v_pk_fma_f32 v[252:253], v[234:235], v[202:203], v[252:253]
    v_pk_fma_f32 v[238:239], v[218:219], v[204:205], v[238:239]
    v_pk_fma_f32 v[240:241], v[220:221], v[204:205], v[240:241]
    v_pk_fma_f32 v[242:243], v[222:223], v[204:205], v[242:243]
    v_pk_fma_f32 v[244:245], v[224:225], v[204:205], v[244:245]
    v_pk_fma_f32 v[246:247], v[226:227], v[204:205], v[246:247]
    v_pk_fma_f32 v[248:249], v[228:229], v[204:205], v[248:249]
    v_pk_fma_f32 v[250:251], v[230:231], v[204:205], v[250:251]
    v_pk_fma_f32 v[252:253], v[232:233], v[204:205], v[252:253]
    v_pk_fma_f32 v[238:239], v[216:217], v[206:207], v[238:239]
    v_pk_fma_f32 v[240:241], v[218:219], v[206:207], v[240:241]
    v_pk_fma_f32 v[242:243], v[220:221], v[206:207], v[242:243]
    v_pk_fma_f32 v[244:245], v[222:223], v[206:207], v[244:245]
    v_pk_fma_f32 v[246:247], v[224:225], v[206:207], v[246:247]
    v_pk_fma_f32 v[248:249], v[226:227], v[206:207], v[248:249]
    v_pk_fma_f32 v[250:251], v[228:229], v[206:207], v[250:251]
    v_pk_fma_f32 v[252:253], v[230:231], v[206:207], v[252:253]
    s_waitcnt lgkmcnt(0)
    s_mov_b32 s33, 0
    buffer_store_dwordx4 v[208:211], v5, s[20:23], s33 offen sc1
    s_mov_b32 s33, 4224
    buffer_store_dwordx4 v[212:215], v5, s[20:23], s33 offen sc1
    v_lshlrev_b32 v216, 16, v61
    v_and_b32 v217, 0xffff0000, v61
    v_lshlrev_b32 v218, 16, v65
    v_and_b32 v219, 0xffff0000, v65
    v_lshlrev_b32 v220, 16, v69
    v_and_b32 v221, 0xffff0000, v69
    v_lshlrev_b32 v222, 16, v73
    v_and_b32 v223, 0xffff0000, v73
    v_lshlrev_b32 v224, 16, v77
    v_and_b32 v225, 0xffff0000, v77
    v_lshlrev_b32 v226, 16, v81
    v_and_b32 v227, 0xffff0000, v81
    v_lshlrev_b32 v228, 16, v85
    v_and_b32 v229, 0xffff0000, v85
    v_lshlrev_b32 v230, 16, v89
    v_and_b32 v231, 0xffff0000, v89
    v_pk_mul_f32 v[238:239], v[238:239], v[216:217]
    v_pk_mul_f32 v[240:241], v[240:241], v[218:219]
    v_pk_mul_f32 v[242:243], v[242:243], v[220:221]
    v_pk_mul_f32 v[244:245], v[244:245], v[222:223]
    v_pk_mul_f32 v[246:247], v[246:247], v[224:225]
    v_pk_mul_f32 v[248:249], v[248:249], v[226:227]
    v_pk_mul_f32 v[250:251], v[250:251], v[228:229]
    v_pk_mul_f32 v[252:253], v[252:253], v[230:231]
    v_cvt_pk_bf16_f32 v216, v252, v250
    v_cvt_pk_bf16_f32 v217, v248, v246
    v_cvt_pk_bf16_f32 v218, v244, v242
    v_cvt_pk_bf16_f32 v219, v240, v238
    ds_write_b128 v6, v[216:219] offset:2048
    v_cvt_pk_bf16_f32 v220, v253, v251
    v_cvt_pk_bf16_f32 v221, v249, v247
    v_cvt_pk_bf16_f32 v222, v245, v243
    v_cvt_pk_bf16_f32 v223, v241, v239
    ds_write_b128 v6, v[220:223] offset:3072
    v_lshlrev_b32 v200, 16, v176
    v_and_b32 v202, 0xffff0000, v176
    v_lshlrev_b32 v204, 16, v177
    v_and_b32 v206, 0xffff0000, v177
    v_lshlrev_b32 v201, 16, v178
    v_and_b32 v203, 0xffff0000, v178
    v_lshlrev_b32 v205, 16, v179
    v_and_b32 v207, 0xffff0000, v179
    v_lshlrev_b32 v216, 16, v18
    v_and_b32 v217, 0xffff0000, v18
    v_lshlrev_b32 v218, 16, v22
    v_and_b32 v219, 0xffff0000, v22
    v_lshlrev_b32 v220, 16, v26
    v_and_b32 v221, 0xffff0000, v26
    v_lshlrev_b32 v222, 16, v30
    v_and_b32 v223, 0xffff0000, v30
    v_lshlrev_b32 v224, 16, v34
    v_and_b32 v225, 0xffff0000, v34
    v_lshlrev_b32 v226, 16, v38
    v_and_b32 v227, 0xffff0000, v38
    v_lshlrev_b32 v228, 16, v42
    v_and_b32 v229, 0xffff0000, v42
    v_lshlrev_b32 v230, 16, v46
    v_and_b32 v231, 0xffff0000, v46
    v_lshlrev_b32 v232, 16, v50
    v_and_b32 v233, 0xffff0000, v50
    v_lshlrev_b32 v234, 16, v54
    v_and_b32 v235, 0xffff0000, v54
    v_lshlrev_b32 v236, 16, v58
    v_and_b32 v237, 0xffff0000, v58
    s_waitcnt lgkmcnt(0)
    ds_read_b128 v[208:211], v7 offset:2048
    ds_read_b128 v[212:215], v7 offset:3072
    v_pk_mul_f32 v[238:239], v[222:223], v[200:201]
    v_pk_mul_f32 v[240:241], v[224:225], v[200:201]
    v_pk_mul_f32 v[242:243], v[226:227], v[200:201]
    v_pk_mul_f32 v[244:245], v[228:229], v[200:201]
    v_pk_mul_f32 v[246:247], v[230:231], v[200:201]
    v_pk_mul_f32 v[248:249], v[232:233], v[200:201]
    v_pk_mul_f32 v[250:251], v[234:235], v[200:201]
    v_pk_mul_f32 v[252:253], v[236:237], v[200:201]
    v_pk_fma_f32 v[238:239], v[220:221], v[202:203], v[238:239]
    v_pk_fma_f32 v[240:241], v[222:223], v[202:203], v[240:241]
    v_pk_fma_f32 v[242:243], v[224:225], v[202:203], v[242:243]
    v_pk_fma_f32 v[244:245], v[226:227], v[202:203], v[244:245]
    v_pk_fma_f32 v[246:247], v[228:229], v[202:203], v[246:247]
    v_pk_fma_f32 v[248:249], v[230:231], v[202:203], v[248:249]
    v_pk_fma_f32 v[250:251], v[232:233], v[202:203], v[250:251]
    v_pk_fma_f32 v[252:253], v[234:235], v[202:203], v[252:253]
    v_pk_fma_f32 v[238:239], v[218:219], v[204:205], v[238:239]
    v_pk_fma_f32 v[240:241], v[220:221], v[204:205], v[240:241]
    v_pk_fma_f32 v[242:243], v[222:223], v[204:205], v[242:243]
    v_pk_fma_f32 v[244:245], v[224:225], v[204:205], v[244:245]
    v_pk_fma_f32 v[246:247], v[226:227], v[204:205], v[246:247]
    v_pk_fma_f32 v[248:249], v[228:229], v[204:205], v[248:249]
    v_pk_fma_f32 v[250:251], v[230:231], v[204:205], v[250:251]
    v_pk_fma_f32 v[252:253], v[232:233], v[204:205], v[252:253]
    v_pk_fma_f32 v[238:239], v[216:217], v[206:207], v[238:239]
    v_pk_fma_f32 v[240:241], v[218:219], v[206:207], v[240:241]
    v_pk_fma_f32 v[242:243], v[220:221], v[206:207], v[242:243]
    v_pk_fma_f32 v[244:245], v[222:223], v[206:207], v[244:245]
    v_pk_fma_f32 v[246:247], v[224:225], v[206:207], v[246:247]
    v_pk_fma_f32 v[248:249], v[226:227], v[206:207], v[248:249]
    v_pk_fma_f32 v[250:251], v[228:229], v[206:207], v[250:251]
    v_pk_fma_f32 v[252:253], v[230:231], v[206:207], v[252:253]
    s_waitcnt lgkmcnt(0)
    s_mov_b32 s33, 8448
    buffer_store_dwordx4 v[208:211], v5, s[20:23], s33 offen sc1
    s_mov_b32 s33, 12672
    buffer_store_dwordx4 v[212:215], v5, s[20:23], s33 offen sc1
    v_lshlrev_b32 v216, 16, v62
    v_and_b32 v217, 0xffff0000, v62
    v_lshlrev_b32 v218, 16, v66
    v_and_b32 v219, 0xffff0000, v66
    v_lshlrev_b32 v220, 16, v70
    v_and_b32 v221, 0xffff0000, v70
    v_lshlrev_b32 v222, 16, v74
    v_and_b32 v223, 0xffff0000, v74
    v_lshlrev_b32 v224, 16, v78
    v_and_b32 v225, 0xffff0000, v78
    v_lshlrev_b32 v226, 16, v82
    v_and_b32 v227, 0xffff0000, v82
    v_lshlrev_b32 v228, 16, v86
    v_and_b32 v229, 0xffff0000, v86
    v_lshlrev_b32 v230, 16, v90
    v_and_b32 v231, 0xffff0000, v90
    v_pk_mul_f32 v[238:239], v[238:239], v[216:217]
    v_pk_mul_f32 v[240:241], v[240:241], v[218:219]
    v_pk_mul_f32 v[242:243], v[242:243], v[220:221]
    v_pk_mul_f32 v[244:245], v[244:245], v[222:223]
    v_pk_mul_f32 v[246:247], v[246:247], v[224:225]
    v_pk_mul_f32 v[248:249], v[248:249], v[226:227]
    v_pk_mul_f32 v[250:251], v[250:251], v[228:229]
    v_pk_mul_f32 v[252:253], v[252:253], v[230:231]
    v_cvt_pk_bf16_f32 v216, v252, v250
    v_cvt_pk_bf16_f32 v217, v248, v246
    v_cvt_pk_bf16_f32 v218, v244, v242
    v_cvt_pk_bf16_f32 v219, v240, v238
    ds_write_b128 v6, v[216:219] offset:0
    v_cvt_pk_bf16_f32 v220, v253, v251
    v_cvt_pk_bf16_f32 v221, v249, v247
    v_cvt_pk_bf16_f32 v222, v245, v243
    v_cvt_pk_bf16_f32 v223, v241, v239
    ds_write_b128 v6, v[220:223] offset:1024
    v_lshlrev_b32 v200, 16, v180
    v_and_b32 v202, 0xffff0000, v180
    v_lshlrev_b32 v204, 16, v181
    v_and_b32 v206, 0xffff0000, v181
    v_lshlrev_b32 v201, 16, v182
    v_and_b32 v203, 0xffff0000, v182
    v_lshlrev_b32 v205, 16, v183
    v_and_b32 v207, 0xffff0000, v183
    v_lshlrev_b32 v216, 16, v19
    v_and_b32 v217, 0xffff0000, v19
    v_lshlrev_b32 v218, 16, v23
    v_and_b32 v219, 0xffff0000, v23
    v_lshlrev_b32 v220, 16, v27
    v_and_b32 v221, 0xffff0000, v27
    v_lshlrev_b32 v222, 16, v31
    v_and_b32 v223, 0xffff0000, v31
    v_lshlrev_b32 v224, 16, v35
    v_and_b32 v225, 0xffff0000, v35
    v_lshlrev_b32 v226, 16, v39
    v_and_b32 v227, 0xffff0000, v39
    v_lshlrev_b32 v228, 16, v43
    v_and_b32 v229, 0xffff0000, v43
    v_lshlrev_b32 v230, 16, v47
    v_and_b32 v231, 0xffff0000, v47
    v_lshlrev_b32 v232, 16, v51
    v_and_b32 v233, 0xffff0000, v51
    v_lshlrev_b32 v234, 16, v55
    v_and_b32 v235, 0xffff0000, v55
    v_lshlrev_b32 v236, 16, v59
    v_and_b32 v237, 0xffff0000, v59
    s_waitcnt lgkmcnt(0)
    ds_read_b128 v[208:211], v7 offset:0
    ds_read_b128 v[212:215], v7 offset:1024
    v_pk_mul_f32 v[238:239], v[222:223], v[200:201]
    v_pk_mul_f32 v[240:241], v[224:225], v[200:201]
    v_pk_mul_f32 v[242:243], v[226:227], v[200:201]
    v_pk_mul_f32 v[244:245], v[228:229], v[200:201]
    v_pk_mul_f32 v[246:247], v[230:231], v[200:201]
    v_pk_mul_f32 v[248:249], v[232:233], v[200:201]
    v_pk_mul_f32 v[250:251], v[234:235], v[200:201]
    v_pk_mul_f32 v[252:253], v[236:237], v[200:201]
    v_pk_fma_f32 v[238:239], v[220:221], v[202:203], v[238:239]
    v_pk_fma_f32 v[240:241], v[222:223], v[202:203], v[240:241]
    v_pk_fma_f32 v[242:243], v[224:225], v[202:203], v[242:243]
    v_pk_fma_f32 v[244:245], v[226:227], v[202:203], v[244:245]
    v_pk_fma_f32 v[246:247], v[228:229], v[202:203], v[246:247]
    v_pk_fma_f32 v[248:249], v[230:231], v[202:203], v[248:249]
    v_pk_fma_f32 v[250:251], v[232:233], v[202:203], v[250:251]
    v_pk_fma_f32 v[252:253], v[234:235], v[202:203], v[252:253]
    v_pk_fma_f32 v[238:239], v[218:219], v[204:205], v[238:239]
    v_pk_fma_f32 v[240:241], v[220:221], v[204:205], v[240:241]
    v_pk_fma_f32 v[242:243], v[222:223], v[204:205], v[242:243]
    v_pk_fma_f32 v[244:245], v[224:225], v[204:205], v[244:245]
    v_pk_fma_f32 v[246:247], v[226:227], v[204:205], v[246:247]
    v_pk_fma_f32 v[248:249], v[228:229], v[204:205], v[248:249]
    v_pk_fma_f32 v[250:251], v[230:231], v[204:205], v[250:251]
    v_pk_fma_f32 v[252:253], v[232:233], v[204:205], v[252:253]
    v_pk_fma_f32 v[238:239], v[216:217], v[206:207], v[238:239]
    v_pk_fma_f32 v[240:241], v[218:219], v[206:207], v[240:241]
    v_pk_fma_f32 v[242:243], v[220:221], v[206:207], v[242:243]
    v_pk_fma_f32 v[244:245], v[222:223], v[206:207], v[244:245]
    v_pk_fma_f32 v[246:247], v[224:225], v[206:207], v[246:247]
    v_pk_fma_f32 v[248:249], v[226:227], v[206:207], v[248:249]
    v_pk_fma_f32 v[250:251], v[228:229], v[206:207], v[250:251]
    v_pk_fma_f32 v[252:253], v[230:231], v[206:207], v[252:253]
    s_waitcnt lgkmcnt(0)
    s_mov_b32 s33, 16896
    buffer_store_dwordx4 v[208:211], v5, s[20:23], s33 offen sc1
    s_mov_b32 s33, 21120
    buffer_store_dwordx4 v[212:215], v5, s[20:23], s33 offen sc1
    v_lshlrev_b32 v216, 16, v63
    v_and_b32 v217, 0xffff0000, v63
    v_lshlrev_b32 v218, 16, v67
    v_and_b32 v219, 0xffff0000, v67
    v_lshlrev_b32 v220, 16, v71
    v_and_b32 v221, 0xffff0000, v71
    v_lshlrev_b32 v222, 16, v75
    v_and_b32 v223, 0xffff0000, v75
    v_lshlrev_b32 v224, 16, v79
    v_and_b32 v225, 0xffff0000, v79
    v_lshlrev_b32 v226, 16, v83
    v_and_b32 v227, 0xffff0000, v83
    v_lshlrev_b32 v228, 16, v87
    v_and_b32 v229, 0xffff0000, v87
    v_lshlrev_b32 v230, 16, v91
    v_and_b32 v231, 0xffff0000, v91
    v_pk_mul_f32 v[238:239], v[238:239], v[216:217]
    v_pk_mul_f32 v[240:241], v[240:241], v[218:219]
    v_pk_mul_f32 v[242:243], v[242:243], v[220:221]
    v_pk_mul_f32 v[244:245], v[244:245], v[222:223]
    v_pk_mul_f32 v[246:247], v[246:247], v[224:225]
    v_pk_mul_f32 v[248:249], v[248:249], v[226:227]
    v_pk_mul_f32 v[250:251], v[250:251], v[228:229]
    v_pk_mul_f32 v[252:253], v[252:253], v[230:231]
    v_cvt_pk_bf16_f32 v216, v252, v250
    v_cvt_pk_bf16_f32 v217, v248, v246
    v_cvt_pk_bf16_f32 v218, v244, v242
    v_cvt_pk_bf16_f32 v219, v240, v238
    ds_write_b128 v6, v[216:219] offset:2048
    v_cvt_pk_bf16_f32 v220, v253, v251
    v_cvt_pk_bf16_f32 v221, v249, v247
    v_cvt_pk_bf16_f32 v222, v245, v243
    v_cvt_pk_bf16_f32 v223, v241, v239
    ds_write_b128 v6, v[220:223] offset:3072
    v_and_b32 v8, 31, v0
    v_lshlrev_b32 v8, 2, v8
    buffer_load_dword v9, v8, s[96:99], 0 offen sc1
    s_waitcnt vmcnt(15)
    s_mov_b32 vcc_lo, 0
    s_mov_b32 vcc_hi, 0xff000000
    v_cndmask_b32 v238, v132, v92, vcc
    v_cndmask_b32 v239, v133, v93, vcc
    v_cndmask_b32 v240, v134, v94, vcc
    v_cndmask_b32 v241, v135, v95, vcc
    ds_bpermute_b32 v100, v10, v238
    ds_bpermute_b32 v96, v10, v128
    ds_bpermute_b32 v242, v10, v124
    ds_bpermute_b32 v101, v10, v239
    ds_bpermute_b32 v97, v10, v129
    ds_bpermute_b32 v243, v10, v125
    ds_bpermute_b32 v102, v10, v240
    ds_bpermute_b32 v98, v10, v130
    ds_bpermute_b32 v244, v10, v126
    ds_bpermute_b32 v103, v10, v241
    ds_bpermute_b32 v99, v10, v131
    ds_bpermute_b32 v245, v10, v127
    v_lshlrev_b32 v200, 16, v184
    v_and_b32 v202, 0xffff0000, v184
    v_lshlrev_b32 v204, 16, v185
    v_and_b32 v206, 0xffff0000, v185
    v_lshlrev_b32 v201, 16, v186
    v_and_b32 v203, 0xffff0000, v186
    v_lshlrev_b32 v205, 16, v187
    v_and_b32 v207, 0xffff0000, v187
    v_lshlrev_b32 v222, 16, v104
    v_and_b32 v223, 0xffff0000, v104
    v_lshlrev_b32 v224, 16, v108
    v_and_b32 v225, 0xffff0000, v108
    v_lshlrev_b32 v226, 16, v112
    v_and_b32 v227, 0xffff0000, v112
    v_lshlrev_b32 v228, 16, v116
    v_and_b32 v229, 0xffff0000, v116
    v_lshlrev_b32 v230, 16, v120
    v_and_b32 v231, 0xffff0000, v120
    v_lshlrev_b32 v232, 16, v124
    v_and_b32 v233, 0xffff0000, v124
    v_lshlrev_b32 v234, 16, v128
    v_and_b32 v235, 0xffff0000, v128
    v_lshlrev_b32 v236, 16, v132
    v_and_b32 v237, 0xffff0000, v132
    s_waitcnt lgkmcnt(0)
    v_mov_b32_dpp v96, v92 row_shl:8 row_mask:0x1 bank_mask:0x3
    v_mov_b32_dpp v97, v93 row_shl:8 row_mask:0x1 bank_mask:0x3
    v_mov_b32_dpp v98, v94 row_shl:8 row_mask:0x1 bank_mask:0x3
    v_mov_b32_dpp v99, v95 row_shl:8 row_mask:0x1 bank_mask:0x3
    s_mov_b32 exec_lo, 0xffffff00
    v_mov_b32 v92, v242
    v_mov_b32 v93, v243
    v_mov_b32 v94, v244
    v_mov_b32 v95, v245
    s_mov_b32 exec_lo, -1
    v_lshlrev_b32 v216, 16, v92
    v_and_b32 v217, 0xffff0000, v92
    v_lshlrev_b32 v218, 16, v96
    v_and_b32 v219, 0xffff0000, v96
    v_lshlrev_b32 v220, 16, v100
    v_and_b32 v221, 0xffff0000, v100
    s_waitcnt lgkmcnt(0)
    ds_read_b128 v[208:211], v7 offset:2048
    ds_read_b128 v[212:215], v7 offset:3072
    v_pk_mul_f32 v[238:239], v[222:223], v[200:201]
    v_pk_mul_f32 v[240:241], v[224:225], v[200:201]
    v_pk_mul_f32 v[242:243], v[226:227], v[200:201]
    v_pk_mul_f32 v[244:245], v[228:229], v[200:201]
    v_pk_mul_f32 v[246:247], v[230:231], v[200:201]
    v_pk_mul_f32 v[248:249], v[232:233], v[200:201]
    v_pk_mul_f32 v[250:251], v[234:235], v[200:201]
    v_pk_mul_f32 v[252:253], v[236:237], v[200:201]
    v_pk_fma_f32 v[238:239], v[220:221], v[202:203], v[238:239]
    v_pk_fma_f32 v[240:241], v[222:223], v[202:203], v[240:241]
    v_pk_fma_f32 v[242:243], v[224:225], v[202:203], v[242:243]
    v_pk_fma_f32 v[244:245], v[226:227], v[202:203], v[244:245]
    v_pk_fma_f32 v[246:247], v[228:229], v[202:203], v[246:247]
    v_pk_fma_f32 v[248:249], v[230:231], v[202:203], v[248:249]
    v_pk_fma_f32 v[250:251], v[232:233], v[202:203], v[250:251]
    v_pk_fma_f32 v[252:253], v[234:235], v[202:203], v[252:253]
    v_pk_fma_f32 v[238:239], v[218:219], v[204:205], v[238:239]
    v_pk_fma_f32 v[240:241], v[220:221], v[204:205], v[240:241]
    v_pk_fma_f32 v[242:243], v[222:223], v[204:205], v[242:243]
    v_pk_fma_f32 v[244:245], v[224:225], v[204:205], v[244:245]
    v_pk_fma_f32 v[246:247], v[226:227], v[204:205], v[246:247]
    v_pk_fma_f32 v[248:249], v[228:229], v[204:205], v[248:249]
    v_pk_fma_f32 v[250:251], v[230:231], v[204:205], v[250:251]
    v_pk_fma_f32 v[252:253], v[232:233], v[204:205], v[252:253]
    v_pk_fma_f32 v[238:239], v[216:217], v[206:207], v[238:239]
    v_pk_fma_f32 v[240:241], v[218:219], v[206:207], v[240:241]
    v_pk_fma_f32 v[242:243], v[220:221], v[206:207], v[242:243]
    v_pk_fma_f32 v[244:245], v[222:223], v[206:207], v[244:245]
    v_pk_fma_f32 v[246:247], v[224:225], v[206:207], v[246:247]
    v_pk_fma_f32 v[248:249], v[226:227], v[206:207], v[248:249]
    v_pk_fma_f32 v[250:251], v[228:229], v[206:207], v[250:251]
    v_pk_fma_f32 v[252:253], v[230:231], v[206:207], v[252:253]
    s_waitcnt vmcnt(7)
    s_waitcnt lgkmcnt(0)
    s_mov_b32 s33, 25344
    buffer_store_dwordx4 v[208:211], v5, s[20:23], s33 offen sc1
    s_mov_b32 s33, 29568
    buffer_store_dwordx4 v[212:215], v5, s[20:23], s33 offen sc1
    v_lshlrev_b32 v216, 16, v136
    v_and_b32 v217, 0xffff0000, v136
    v_lshlrev_b32 v218, 16, v140
    v_and_b32 v219, 0xffff0000, v140
    v_lshlrev_b32 v220, 16, v144
    v_and_b32 v221, 0xffff0000, v144
    v_lshlrev_b32 v222, 16, v148
    v_and_b32 v223, 0xffff0000, v148
    v_lshlrev_b32 v224, 16, v152
    v_and_b32 v225, 0xffff0000, v152
    v_lshlrev_b32 v226, 16, v156
    v_and_b32 v227, 0xffff0000, v156
    v_lshlrev_b32 v228, 16, v160
    v_and_b32 v229, 0xffff0000, v160
    v_lshlrev_b32 v230, 16, v164
    v_and_b32 v231, 0xffff0000, v164
    v_pk_mul_f32 v[238:239], v[238:239], v[216:217]
    v_pk_mul_f32 v[240:241], v[240:241], v[218:219]
    v_pk_mul_f32 v[242:243], v[242:243], v[220:221]
    v_pk_mul_f32 v[244:245], v[244:245], v[222:223]
    v_pk_mul_f32 v[246:247], v[246:247], v[224:225]
    v_pk_mul_f32 v[248:249], v[248:249], v[226:227]
    v_pk_mul_f32 v[250:251], v[250:251], v[228:229]
    v_pk_mul_f32 v[252:253], v[252:253], v[230:231]
    v_cvt_pk_bf16_f32 v216, v252, v250
    v_cvt_pk_bf16_f32 v217, v248, v246
    v_cvt_pk_bf16_f32 v218, v244, v242
    v_cvt_pk_bf16_f32 v219, v240, v238
    ds_write_b128 v6, v[216:219] offset:0
    v_cvt_pk_bf16_f32 v220, v253, v251
    v_cvt_pk_bf16_f32 v221, v249, v247
    v_cvt_pk_bf16_f32 v222, v245, v243
    v_cvt_pk_bf16_f32 v223, v241, v239
    ds_write_b128 v6, v[220:223] offset:1024
    v_lshlrev_b32 v200, 16, v188
    v_and_b32 v202, 0xffff0000, v188
    v_lshlrev_b32 v204, 16, v189
    v_and_b32 v206, 0xffff0000, v189
    v_lshlrev_b32 v201, 16, v190
    v_and_b32 v203, 0xffff0000, v190
    v_lshlrev_b32 v205, 16, v191
    v_and_b32 v207, 0xffff0000, v191
    v_lshlrev_b32 v216, 16, v93
    v_and_b32 v217, 0xffff0000, v93
    v_lshlrev_b32 v218, 16, v97
    v_and_b32 v219, 0xffff0000, v97
    v_lshlrev_b32 v220, 16, v101
    v_and_b32 v221, 0xffff0000, v101
    v_lshlrev_b32 v222, 16, v105
    v_and_b32 v223, 0xffff0000, v105
    v_lshlrev_b32 v224, 16, v109
    v_and_b32 v225, 0xffff0000, v109
    v_lshlrev_b32 v226, 16, v113
    v_and_b32 v227, 0xffff0000, v113
    v_lshlrev_b32 v228, 16, v117
    v_and_b32 v229, 0xffff0000, v117
    v_lshlrev_b32 v230, 16, v121
    v_and_b32 v231, 0xffff0000, v121
    v_lshlrev_b32 v232, 16, v125
    v_and_b32 v233, 0xffff0000, v125
    v_lshlrev_b32 v234, 16, v129
    v_and_b32 v235, 0xffff0000, v129
    v_lshlrev_b32 v236, 16, v133
    v_and_b32 v237, 0xffff0000, v133
    s_waitcnt lgkmcnt(0)
    ds_read_b128 v[208:211], v7 offset:0
    ds_read_b128 v[212:215], v7 offset:1024
    v_pk_mul_f32 v[238:239], v[222:223], v[200:201]
    v_pk_mul_f32 v[240:241], v[224:225], v[200:201]
    v_pk_mul_f32 v[242:243], v[226:227], v[200:201]
    v_pk_mul_f32 v[244:245], v[228:229], v[200:201]
    v_pk_mul_f32 v[246:247], v[230:231], v[200:201]
    v_pk_mul_f32 v[248:249], v[232:233], v[200:201]
    v_pk_mul_f32 v[250:251], v[234:235], v[200:201]
    v_pk_mul_f32 v[252:253], v[236:237], v[200:201]
    v_pk_fma_f32 v[238:239], v[220:221], v[202:203], v[238:239]
    v_pk_fma_f32 v[240:241], v[222:223], v[202:203], v[240:241]
    v_pk_fma_f32 v[242:243], v[224:225], v[202:203], v[242:243]
    v_pk_fma_f32 v[244:245], v[226:227], v[202:203], v[244:245]
    v_pk_fma_f32 v[246:247], v[228:229], v[202:203], v[246:247]
    v_pk_fma_f32 v[248:249], v[230:231], v[202:203], v[248:249]
    v_pk_fma_f32 v[250:251], v[232:233], v[202:203], v[250:251]
    v_pk_fma_f32 v[252:253], v[234:235], v[202:203], v[252:253]
    v_pk_fma_f32 v[238:239], v[218:219], v[204:205], v[238:239]
    v_pk_fma_f32 v[240:241], v[220:221], v[204:205], v[240:241]
    v_pk_fma_f32 v[242:243], v[222:223], v[204:205], v[242:243]
    v_pk_fma_f32 v[244:245], v[224:225], v[204:205], v[244:245]
    v_pk_fma_f32 v[246:247], v[226:227], v[204:205], v[246:247]
    v_pk_fma_f32 v[248:249], v[228:229], v[204:205], v[248:249]
    v_pk_fma_f32 v[250:251], v[230:231], v[204:205], v[250:251]
    v_pk_fma_f32 v[252:253], v[232:233], v[204:205], v[252:253]
    v_pk_fma_f32 v[238:239], v[216:217], v[206:207], v[238:239]
    v_pk_fma_f32 v[240:241], v[218:219], v[206:207], v[240:241]
    v_pk_fma_f32 v[242:243], v[220:221], v[206:207], v[242:243]
    v_pk_fma_f32 v[244:245], v[222:223], v[206:207], v[244:245]
    v_pk_fma_f32 v[246:247], v[224:225], v[206:207], v[246:247]
    v_pk_fma_f32 v[248:249], v[226:227], v[206:207], v[248:249]
    v_pk_fma_f32 v[250:251], v[228:229], v[206:207], v[250:251]
    v_pk_fma_f32 v[252:253], v[230:231], v[206:207], v[252:253]
    s_waitcnt lgkmcnt(0)
    s_mov_b32 s33, 270336
    buffer_store_dwordx4 v[208:211], v5, s[20:23], s33 offen sc1
    s_mov_b32 s33, 274560
    buffer_store_dwordx4 v[212:215], v5, s[20:23], s33 offen sc1
    v_lshlrev_b32 v216, 16, v137
    v_and_b32 v217, 0xffff0000, v137
    v_lshlrev_b32 v218, 16, v141
    v_and_b32 v219, 0xffff0000, v141
    v_lshlrev_b32 v220, 16, v145
    v_and_b32 v221, 0xffff0000, v145
    v_lshlrev_b32 v222, 16, v149
    v_and_b32 v223, 0xffff0000, v149
    v_lshlrev_b32 v224, 16, v153
    v_and_b32 v225, 0xffff0000, v153
    v_lshlrev_b32 v226, 16, v157
    v_and_b32 v227, 0xffff0000, v157
    v_lshlrev_b32 v228, 16, v161
    v_and_b32 v229, 0xffff0000, v161
    v_lshlrev_b32 v230, 16, v165
    v_and_b32 v231, 0xffff0000, v165
    v_pk_mul_f32 v[238:239], v[238:239], v[216:217]
    v_pk_mul_f32 v[240:241], v[240:241], v[218:219]
    v_pk_mul_f32 v[242:243], v[242:243], v[220:221]
    v_pk_mul_f32 v[244:245], v[244:245], v[222:223]
    v_pk_mul_f32 v[246:247], v[246:247], v[224:225]
    v_pk_mul_f32 v[248:249], v[248:249], v[226:227]
    v_pk_mul_f32 v[250:251], v[250:251], v[228:229]
    v_pk_mul_f32 v[252:253], v[252:253], v[230:231]
    v_cvt_pk_bf16_f32 v216, v252, v250
    v_cvt_pk_bf16_f32 v217, v248, v246
    v_cvt_pk_bf16_f32 v218, v244, v242
    v_cvt_pk_bf16_f32 v219, v240, v238
    ds_write_b128 v6, v[216:219] offset:2048
    v_cvt_pk_bf16_f32 v220, v253, v251
    v_cvt_pk_bf16_f32 v221, v249, v247
    v_cvt_pk_bf16_f32 v222, v245, v243
    v_cvt_pk_bf16_f32 v223, v241, v239
    ds_write_b128 v6, v[220:223] offset:3072
    s_waitcnt vmcnt(0)
    v_cmp_eq_u32 vcc, 0, v9
    s_cbranch_vccnz mega_kernel_g_s
mega_kernel_g_k:
    s_barrier
    v_mov_b32 v1, 1
    buffer_store_dword v1, v15, s[48:51], s92 offen sc1
    v_lshlrev_b32 v200, 16, v192
    v_and_b32 v202, 0xffff0000, v192
    v_lshlrev_b32 v204, 16, v193
    v_and_b32 v206, 0xffff0000, v193
    v_lshlrev_b32 v201, 16, v194
    v_and_b32 v203, 0xffff0000, v194
    v_lshlrev_b32 v205, 16, v195
    v_and_b32 v207, 0xffff0000, v195
    v_lshlrev_b32 v216, 16, v94
    v_and_b32 v217, 0xffff0000, v94
    v_lshlrev_b32 v218, 16, v98
    v_and_b32 v219, 0xffff0000, v98
    v_lshlrev_b32 v220, 16, v102
    v_and_b32 v221, 0xffff0000, v102
    v_lshlrev_b32 v222, 16, v106
    v_and_b32 v223, 0xffff0000, v106
    v_lshlrev_b32 v224, 16, v110
    v_and_b32 v225, 0xffff0000, v110
    v_lshlrev_b32 v226, 16, v114
    v_and_b32 v227, 0xffff0000, v114
    v_lshlrev_b32 v228, 16, v118
    v_and_b32 v229, 0xffff0000, v118
    v_lshlrev_b32 v230, 16, v122
    v_and_b32 v231, 0xffff0000, v122
    v_lshlrev_b32 v232, 16, v126
    v_and_b32 v233, 0xffff0000, v126
    v_lshlrev_b32 v234, 16, v130
    v_and_b32 v235, 0xffff0000, v130
    v_lshlrev_b32 v236, 16, v134
    v_and_b32 v237, 0xffff0000, v134
    s_waitcnt lgkmcnt(0)
    ds_read_b128 v[208:211], v7 offset:2048
    ds_read_b128 v[212:215], v7 offset:3072
    v_pk_mul_f32 v[238:239], v[222:223], v[200:201]
    v_pk_mul_f32 v[240:241], v[224:225], v[200:201]
    v_pk_mul_f32 v[242:243], v[226:227], v[200:201]
    v_pk_mul_f32 v[244:245], v[228:229], v[200:201]
    v_pk_mul_f32 v[246:247], v[230:231], v[200:201]
    v_pk_mul_f32 v[248:249], v[232:233], v[200:201]
    v_pk_mul_f32 v[250:251], v[234:235], v[200:201]
    v_pk_mul_f32 v[252:253], v[236:237], v[200:201]
    v_pk_fma_f32 v[238:239], v[220:221], v[202:203], v[238:239]
    v_pk_fma_f32 v[240:241], v[222:223], v[202:203], v[240:241]
    v_pk_fma_f32 v[242:243], v[224:225], v[202:203], v[242:243]
    v_pk_fma_f32 v[244:245], v[226:227], v[202:203], v[244:245]
    v_pk_fma_f32 v[246:247], v[228:229], v[202:203], v[246:247]
    v_pk_fma_f32 v[248:249], v[230:231], v[202:203], v[248:249]
    v_pk_fma_f32 v[250:251], v[232:233], v[202:203], v[250:251]
    v_pk_fma_f32 v[252:253], v[234:235], v[202:203], v[252:253]
    v_pk_fma_f32 v[238:239], v[218:219], v[204:205], v[238:239]
    v_pk_fma_f32 v[240:241], v[220:221], v[204:205], v[240:241]
    v_pk_fma_f32 v[242:243], v[222:223], v[204:205], v[242:243]
    v_pk_fma_f32 v[244:245], v[224:225], v[204:205], v[244:245]
    v_pk_fma_f32 v[246:247], v[226:227], v[204:205], v[246:247]
    v_pk_fma_f32 v[248:249], v[228:229], v[204:205], v[248:249]
    v_pk_fma_f32 v[250:251], v[230:231], v[204:205], v[250:251]
    v_pk_fma_f32 v[252:253], v[232:233], v[204:205], v[252:253]
    v_pk_fma_f32 v[238:239], v[216:217], v[206:207], v[238:239]
    v_pk_fma_f32 v[240:241], v[218:219], v[206:207], v[240:241]
    v_pk_fma_f32 v[242:243], v[220:221], v[206:207], v[242:243]
    v_pk_fma_f32 v[244:245], v[222:223], v[206:207], v[244:245]
    v_pk_fma_f32 v[246:247], v[224:225], v[206:207], v[246:247]
    v_pk_fma_f32 v[248:249], v[226:227], v[206:207], v[248:249]
    v_pk_fma_f32 v[250:251], v[228:229], v[206:207], v[250:251]
    v_pk_fma_f32 v[252:253], v[230:231], v[206:207], v[252:253]
    s_waitcnt lgkmcnt(0)
    s_mov_b32 s33, 278784
    buffer_store_dwordx4 v[208:211], v5, s[20:23], s33 offen sc1
    s_mov_b32 s33, 283008
    buffer_store_dwordx4 v[212:215], v5, s[20:23], s33 offen sc1
    v_lshlrev_b32 v216, 16, v138
    v_and_b32 v217, 0xffff0000, v138
    v_lshlrev_b32 v218, 16, v142
    v_and_b32 v219, 0xffff0000, v142
    v_lshlrev_b32 v220, 16, v146
    v_and_b32 v221, 0xffff0000, v146
    v_lshlrev_b32 v222, 16, v150
    v_and_b32 v223, 0xffff0000, v150
    v_lshlrev_b32 v224, 16, v154
    v_and_b32 v225, 0xffff0000, v154
    v_lshlrev_b32 v226, 16, v158
    v_and_b32 v227, 0xffff0000, v158
    v_lshlrev_b32 v228, 16, v162
    v_and_b32 v229, 0xffff0000, v162
    v_lshlrev_b32 v230, 16, v166
    v_and_b32 v231, 0xffff0000, v166
    v_pk_mul_f32 v[238:239], v[238:239], v[216:217]
    v_pk_mul_f32 v[240:241], v[240:241], v[218:219]
    v_pk_mul_f32 v[242:243], v[242:243], v[220:221]
    v_pk_mul_f32 v[244:245], v[244:245], v[222:223]
    v_pk_mul_f32 v[246:247], v[246:247], v[224:225]
    v_pk_mul_f32 v[248:249], v[248:249], v[226:227]
    v_pk_mul_f32 v[250:251], v[250:251], v[228:229]
    v_pk_mul_f32 v[252:253], v[252:253], v[230:231]
    v_cvt_pk_bf16_f32 v216, v252, v250
    v_cvt_pk_bf16_f32 v217, v248, v246
    v_cvt_pk_bf16_f32 v218, v244, v242
    v_cvt_pk_bf16_f32 v219, v240, v238
    ds_write_b128 v6, v[216:219] offset:0
    v_cvt_pk_bf16_f32 v220, v253, v251
    v_cvt_pk_bf16_f32 v221, v249, v247
    v_cvt_pk_bf16_f32 v222, v245, v243
    v_cvt_pk_bf16_f32 v223, v241, v239
    ds_write_b128 v6, v[220:223] offset:1024
    v_lshlrev_b32 v200, 16, v196
    v_and_b32 v202, 0xffff0000, v196
    v_lshlrev_b32 v204, 16, v197
    v_and_b32 v206, 0xffff0000, v197
    v_lshlrev_b32 v201, 16, v198
    v_and_b32 v203, 0xffff0000, v198
    v_lshlrev_b32 v205, 16, v199
    v_and_b32 v207, 0xffff0000, v199
    v_lshlrev_b32 v216, 16, v95
    v_and_b32 v217, 0xffff0000, v95
    v_lshlrev_b32 v218, 16, v99
    v_and_b32 v219, 0xffff0000, v99
    v_lshlrev_b32 v220, 16, v103
    v_and_b32 v221, 0xffff0000, v103
    v_lshlrev_b32 v222, 16, v107
    v_and_b32 v223, 0xffff0000, v107
    v_lshlrev_b32 v224, 16, v111
    v_and_b32 v225, 0xffff0000, v111
    v_lshlrev_b32 v226, 16, v115
    v_and_b32 v227, 0xffff0000, v115
    v_lshlrev_b32 v228, 16, v119
    v_and_b32 v229, 0xffff0000, v119
    v_lshlrev_b32 v230, 16, v123
    v_and_b32 v231, 0xffff0000, v123
    v_lshlrev_b32 v232, 16, v127
    v_and_b32 v233, 0xffff0000, v127
    v_lshlrev_b32 v234, 16, v131
    v_and_b32 v235, 0xffff0000, v131
    v_lshlrev_b32 v236, 16, v135
    v_and_b32 v237, 0xffff0000, v135
    s_waitcnt lgkmcnt(0)
    ds_read_b128 v[208:211], v7 offset:0
    ds_read_b128 v[212:215], v7 offset:1024
    v_pk_mul_f32 v[238:239], v[222:223], v[200:201]
    v_pk_mul_f32 v[240:241], v[224:225], v[200:201]
    v_pk_mul_f32 v[242:243], v[226:227], v[200:201]
    v_pk_mul_f32 v[244:245], v[228:229], v[200:201]
    v_pk_mul_f32 v[246:247], v[230:231], v[200:201]
    v_pk_mul_f32 v[248:249], v[232:233], v[200:201]
    v_pk_mul_f32 v[250:251], v[234:235], v[200:201]
    v_pk_mul_f32 v[252:253], v[236:237], v[200:201]
    v_pk_fma_f32 v[238:239], v[220:221], v[202:203], v[238:239]
    v_pk_fma_f32 v[240:241], v[222:223], v[202:203], v[240:241]
    v_pk_fma_f32 v[242:243], v[224:225], v[202:203], v[242:243]
    v_pk_fma_f32 v[244:245], v[226:227], v[202:203], v[244:245]
    v_pk_fma_f32 v[246:247], v[228:229], v[202:203], v[246:247]
    v_pk_fma_f32 v[248:249], v[230:231], v[202:203], v[248:249]
    v_pk_fma_f32 v[250:251], v[232:233], v[202:203], v[250:251]
    v_pk_fma_f32 v[252:253], v[234:235], v[202:203], v[252:253]
    v_pk_fma_f32 v[238:239], v[218:219], v[204:205], v[238:239]
    v_pk_fma_f32 v[240:241], v[220:221], v[204:205], v[240:241]
    v_pk_fma_f32 v[242:243], v[222:223], v[204:205], v[242:243]
    v_pk_fma_f32 v[244:245], v[224:225], v[204:205], v[244:245]
    v_pk_fma_f32 v[246:247], v[226:227], v[204:205], v[246:247]
    v_pk_fma_f32 v[248:249], v[228:229], v[204:205], v[248:249]
    v_pk_fma_f32 v[250:251], v[230:231], v[204:205], v[250:251]
    v_pk_fma_f32 v[252:253], v[232:233], v[204:205], v[252:253]
    v_pk_fma_f32 v[238:239], v[216:217], v[206:207], v[238:239]
    v_pk_fma_f32 v[240:241], v[218:219], v[206:207], v[240:241]
    v_pk_fma_f32 v[242:243], v[220:221], v[206:207], v[242:243]
    v_pk_fma_f32 v[244:245], v[222:223], v[206:207], v[244:245]
    v_pk_fma_f32 v[246:247], v[224:225], v[206:207], v[246:247]
    v_pk_fma_f32 v[248:249], v[226:227], v[206:207], v[248:249]
    v_pk_fma_f32 v[250:251], v[228:229], v[206:207], v[250:251]
    v_pk_fma_f32 v[252:253], v[230:231], v[206:207], v[252:253]
    s_waitcnt lgkmcnt(0)
    s_mov_b32 s33, 287232
    buffer_store_dwordx4 v[208:211], v5, s[20:23], s33 offen sc1
    s_mov_b32 s33, 291456
    buffer_store_dwordx4 v[212:215], v5, s[20:23], s33 offen sc1
    v_lshlrev_b32 v216, 16, v139
    v_and_b32 v217, 0xffff0000, v139
    v_lshlrev_b32 v218, 16, v143
    v_and_b32 v219, 0xffff0000, v143
    v_lshlrev_b32 v220, 16, v147
    v_and_b32 v221, 0xffff0000, v147
    v_lshlrev_b32 v222, 16, v151
    v_and_b32 v223, 0xffff0000, v151
    v_lshlrev_b32 v224, 16, v155
    v_and_b32 v225, 0xffff0000, v155
    v_lshlrev_b32 v226, 16, v159
    v_and_b32 v227, 0xffff0000, v159
    v_lshlrev_b32 v228, 16, v163
    v_and_b32 v229, 0xffff0000, v163
    v_lshlrev_b32 v230, 16, v167
    v_and_b32 v231, 0xffff0000, v167
    v_pk_mul_f32 v[238:239], v[238:239], v[216:217]
    v_pk_mul_f32 v[240:241], v[240:241], v[218:219]
    v_pk_mul_f32 v[242:243], v[242:243], v[220:221]
    v_pk_mul_f32 v[244:245], v[244:245], v[222:223]
    v_pk_mul_f32 v[246:247], v[246:247], v[224:225]
    v_pk_mul_f32 v[248:249], v[248:249], v[226:227]
    v_pk_mul_f32 v[250:251], v[250:251], v[228:229]
    v_pk_mul_f32 v[252:253], v[252:253], v[230:231]
    v_cvt_pk_bf16_f32 v216, v252, v250
    v_cvt_pk_bf16_f32 v217, v248, v246
    v_cvt_pk_bf16_f32 v218, v244, v242
    v_cvt_pk_bf16_f32 v219, v240, v238
    ds_write_b128 v6, v[216:219] offset:2048
    v_cvt_pk_bf16_f32 v220, v253, v251
    v_cvt_pk_bf16_f32 v221, v249, v247
    v_cvt_pk_bf16_f32 v222, v245, v243
    v_cvt_pk_bf16_f32 v223, v241, v239
    ds_write_b128 v6, v[220:223] offset:3072
    s_waitcnt lgkmcnt(0)
    ds_read_b128 v[208:211], v7 offset:2048
    ds_read_b128 v[212:215], v7 offset:3072
    s_waitcnt lgkmcnt(0)
    s_mov_b32 s33, 295680
    buffer_store_dwordx4 v[208:211], v5, s[20:23], s33 offen sc1
    s_mov_b32 s33, 299904
    buffer_store_dwordx4 v[212:215], v5, s[20:23], s33 offen sc1
    s_cmp_lt_u32 s3, 4
    s_cbranch_scc1 mega_kernel_hc
    s_add_u32 s33, s13, 0
    v_xor_b32 v8, 0, v12
    v_add_u32 v8, s33, v8
    s_add_u32 s33, s13, 4096
    v_xor_b32 v9, 64, v12
    v_add_u32 v9, s33, v9
    s_add_u32 s33, s13, 8192
    v_xor_b32 v10, 128, v12
    v_add_u32 v10, s33, v10
    s_add_u32 s33, s13, 12288
    v_xor_b32 v11, 192, v12
    v_add_u32 v11, s33, v11
    v_add_u32 v19, 16, v12
    v_xor_b32 v19, 192, v19
    v_add_u32 v19, s33, v19
    v_lshlrev_b32 v13, 16, v13
    v_lshlrev_b32 v14, 16, v14
    v_add_f32 v13, v13, v14
    v_cvt_pk_bf16_f32 v13, v13, v13
    v_and_b32 v1, 1, v0
    v_mul_u32_u24 v1, 20480, v1
    s_add_u32 s33, s13, 16384
    v_add_u32 v14, s33, v1
    s_mul_i32 s18, s35, 4224
    s_lshl_b32 s19, s35, 12
    s_add_u32 s19, s19, 8192
    s_mov_b64 s[36:37], 1
    v_and_b32 v17, 31, v0
    v_lshlrev_b32 v17, 7, v17
    s_mov_b32 s34, 0x7f000
    s_cmp_lg_u32 s3, 4
    s_cbranch_scc1 mega_kernel_kq1
    s_mov_b32 s52, 0x80000
mega_kernel_kp1:
    buffer_load_dword v16, v17, s[48:51], s34 offen sc1
    s_sub_u32 s52, s52, 1
    s_cbranch_scc1 mega_kernel_kq1
    s_waitcnt vmcnt(0)
    v_cmp_gt_i32 vcc, 1, v16
    s_cbranch_vccz mega_kernel_kq1
    s_branch mega_kernel_kp1
mega_kernel_kq1:
    s_barrier
    buffer_load_dwordx4 v[32:35], v12, s[20:23], s18 offen offset:0 sc1
    buffer_load_dwordx4 v[40:43], v12, s[20:23], s18 offen offset:1024 sc1
    buffer_load_dwordx4 v[48:51], v12, s[20:23], s18 offen offset:2048 sc1
    buffer_load_dwordx4 v[56:59], v12, s[20:23], s18 offen offset:3072 sc1
    s_add_u32 s18, s18, 4224
    buffer_load_dwordx4 v[64:67], v12, s[20:23], s18 offen offset:0 sc1
    buffer_load_dwordx4 v[72:75], v12, s[20:23], s18 offen offset:1024 sc1
    buffer_load_dwordx4 v[80:83], v12, s[20:23], s18 offen offset:2048 sc1
    buffer_load_dwordx4 v[88:91], v12, s[20:23], s18 offen offset:3072 sc1
    s_add_u32 s18, s18, 4224
    s_waitcnt vmcnt(4)
    ds_write_b128 v11, v[32:35] offset:0
    ds_write_b128 v11, v[40:43] offset:1024
    ds_write_b128 v11, v[48:51] offset:2048
    ds_write_b128 v11, v[56:59] offset:3072
    ds_read_b64 v[36:37], v19 offset:0
    ds_read_b64 v[44:45], v19 offset:1024
    ds_read_b64 v[52:53], v19 offset:2048
    ds_read_b64 v[60:61], v19 offset:3072
    v_alignbyte_b32 v96, v33, v32, 2
    v_alignbyte_b32 v97, v34, v33, 2
    v_alignbyte_b32 v98, v35, v34, 2
    v_alignbyte_b32 v100, v34, v33, 2
    v_alignbyte_b32 v101, v35, v34, 2
    v_mov_b32 v104, v33
    v_mov_b32 v105, v34
    v_mov_b32 v106, v35
    s_waitcnt lgkmcnt(3)
    v_alignbyte_b32 v99, v36, v35, 2
    v_alignbyte_b32 v102, v36, v35, 2
    v_alignbyte_b32 v103, v37, v36, 2
    v_mov_b32 v107, v36
    ds_write_b128 v10, v[96:99] offset:0
    ds_write_b128 v8, v[100:103] offset:0
    ds_write_b128 v9, v[104:107] offset:0
    v_alignbyte_b32 v108, v41, v40, 2
    v_alignbyte_b32 v109, v42, v41, 2
    v_alignbyte_b32 v110, v43, v42, 2
    v_alignbyte_b32 v112, v42, v41, 2
    v_alignbyte_b32 v113, v43, v42, 2
    v_mov_b32 v116, v41
    v_mov_b32 v117, v42
    v_mov_b32 v118, v43
    s_waitcnt lgkmcnt(5)
    v_alignbyte_b32 v111, v44, v43, 2
    v_alignbyte_b32 v114, v44, v43, 2
    v_alignbyte_b32 v115, v45, v44, 2
    v_mov_b32 v119, v44
    ds_write_b128 v10, v[108:111] offset:1024
    ds_write_b128 v8, v[112:115] offset:1024
    ds_write_b128 v9, v[116:119] offset:1024
    v_alignbyte_b32 v120, v49, v48, 2
    v_alignbyte_b32 v121, v50, v49, 2
    v_alignbyte_b32 v122, v51, v50, 2
    v_alignbyte_b32 v124, v50, v49, 2
    v_alignbyte_b32 v125, v51, v50, 2
    v_mov_b32 v128, v49
    v_mov_b32 v129, v50
    v_mov_b32 v130, v51
    s_waitcnt lgkmcnt(7)
    v_alignbyte_b32 v123, v52, v51, 2
    v_alignbyte_b32 v126, v52, v51, 2
    v_alignbyte_b32 v127, v53, v52, 2
    v_mov_b32 v131, v52
    ds_write_b128 v10, v[120:123] offset:2048
    ds_write_b128 v8, v[124:127] offset:2048
    ds_write_b128 v9, v[128:131] offset:2048
    v_alignbyte_b32 v132, v57, v56, 2
    v_alignbyte_b32 v133, v58, v57, 2
    v_alignbyte_b32 v134, v59, v58, 2
    v_alignbyte_b32 v136, v58, v57, 2
    v_alignbyte_b32 v137, v59, v58, 2
    v_mov_b32 v140, v57
    v_mov_b32 v141, v58
    v_mov_b32 v142, v59
    s_waitcnt lgkmcnt(9)
    v_writelane_b32 v60, 0, 63
    v_writelane_b32 v61, 0, 63
    v_alignbyte_b32 v135, v60, v59, 2
    v_alignbyte_b32 v138, v60, v59, 2
    v_alignbyte_b32 v139, v61, v60, 2
    v_mov_b32 v143, v60
    ds_write_b128 v10, v[132:135] offset:3072
    ds_write_b128 v8, v[136:139] offset:3072
    ds_write_b128 v9, v[140:143] offset:3072
    s_waitcnt vmcnt(0)
    s_mov_b64 exec, s[36:37]
    ds_write_b16 v14, v13
    s_mov_b64 exec, -1
    s_lshl_b64 s[36:37], s[36:37], 1
    s_waitcnt lgkmcnt(0)
    s_barrier
    v_mov_b32 v1, 2
    buffer_store_dword v1, v15, s[48:51], s92 offen sc1
    ds_write_b128 v11, v[64:67] offset:20480
    ds_write_b128 v11, v[72:75] offset:21504
    ds_write_b128 v11, v[80:83] offset:22528
    ds_write_b128 v11, v[88:91] offset:23552
    ds_read_b64 v[68:69], v19 offset:20480
    ds_read_b64 v[76:77], v19 offset:21504
    ds_read_b64 v[84:85], v19 offset:22528
    ds_read_b64 v[92:93], v19 offset:23552
    v_alignbyte_b32 v96, v65, v64, 2
    v_alignbyte_b32 v97, v66, v65, 2
    v_alignbyte_b32 v98, v67, v66, 2
    v_alignbyte_b32 v100, v66, v65, 2
    v_alignbyte_b32 v101, v67, v66, 2
    v_mov_b32 v104, v65
    v_mov_b32 v105, v66
    v_mov_b32 v106, v67
    s_waitcnt lgkmcnt(3)
    v_alignbyte_b32 v99, v68, v67, 2
    v_alignbyte_b32 v102, v68, v67, 2
    v_alignbyte_b32 v103, v69, v68, 2
    v_mov_b32 v107, v68
    ds_write_b128 v10, v[96:99] offset:20480
    ds_write_b128 v8, v[100:103] offset:20480
    ds_write_b128 v9, v[104:107] offset:20480
    v_alignbyte_b32 v108, v73, v72, 2
    v_alignbyte_b32 v109, v74, v73, 2
    v_alignbyte_b32 v110, v75, v74, 2
    v_alignbyte_b32 v112, v74, v73, 2
    v_alignbyte_b32 v113, v75, v74, 2
    v_mov_b32 v116, v73
    v_mov_b32 v117, v74
    v_mov_b32 v118, v75
    s_waitcnt lgkmcnt(5)
    v_alignbyte_b32 v111, v76, v75, 2
    v_alignbyte_b32 v114, v76, v75, 2
    v_alignbyte_b32 v115, v77, v76, 2
    v_mov_b32 v119, v76
    ds_write_b128 v10, v[108:111] offset:21504
    ds_write_b128 v8, v[112:115] offset:21504
    ds_write_b128 v9, v[116:119] offset:21504
    v_alignbyte_b32 v120, v81, v80, 2
    v_alignbyte_b32 v121, v82, v81, 2
    v_alignbyte_b32 v122, v83, v82, 2
    v_alignbyte_b32 v124, v82, v81, 2
    v_alignbyte_b32 v125, v83, v82, 2
    v_mov_b32 v128, v81
    v_mov_b32 v129, v82
    v_mov_b32 v130, v83
    s_waitcnt lgkmcnt(7)
    v_alignbyte_b32 v123, v84, v83, 2
    v_alignbyte_b32 v126, v84, v83, 2
    v_alignbyte_b32 v127, v85, v84, 2
    v_mov_b32 v131, v84
    ds_write_b128 v10, v[120:123] offset:22528
    ds_write_b128 v8, v[124:127] offset:22528
    ds_write_b128 v9, v[128:131] offset:22528
    v_alignbyte_b32 v132, v89, v88, 2
    v_alignbyte_b32 v133, v90, v89, 2
    v_alignbyte_b32 v134, v91, v90, 2
    v_alignbyte_b32 v136, v90, v89, 2
    v_alignbyte_b32 v137, v91, v90, 2
    v_mov_b32 v140, v89
    v_mov_b32 v141, v90
    v_mov_b32 v142, v91
    s_waitcnt lgkmcnt(9)
    v_writelane_b32 v92, 0, 63
    v_writelane_b32 v93, 0, 63
    v_alignbyte_b32 v135, v92, v91, 2
    v_alignbyte_b32 v138, v92, v91, 2
    v_alignbyte_b32 v139, v93, v92, 2
    v_mov_b32 v143, v92
    ds_write_b128 v10, v[132:135] offset:23552
    ds_write_b128 v8, v[136:139] offset:23552
    ds_write_b128 v9, v[140:143] offset:23552
    s_cmp_lg_u32 s3, 4
    s_cbranch_scc1 mega_kernel_kq2
    s_mov_b32 s52, 0x80000
mega_kernel_kp2:
    buffer_load_dword v16, v17, s[48:51], s34 offen sc1
    s_sub_u32 s52, s52, 1
    s_cbranch_scc1 mega_kernel_kq2
    s_waitcnt vmcnt(0)
    v_cmp_gt_i32 vcc, 2, v16
    s_cbranch_vccz mega_kernel_kq2
    s_branch mega_kernel_kp2
mega_kernel_kq2:
    s_waitcnt vmcnt(0)
    s_mov_b64 exec, s[36:37]
    ds_write_b16 v14, v13
    s_mov_b64 exec, -1
    s_lshl_b64 s[36:37], s[36:37], 1
    s_waitcnt lgkmcnt(0)
    s_barrier
    buffer_load_dwordx4 v[32:35], v12, s[20:23], s18 offen offset:0 sc1
    buffer_load_dwordx4 v[40:43], v12, s[20:23], s18 offen offset:1024 sc1
    buffer_load_dwordx4 v[48:51], v12, s[20:23], s18 offen offset:2048 sc1
    buffer_load_dwordx4 v[56:59], v12, s[20:23], s18 offen offset:3072 sc1
    s_add_u32 s18, s18, 4224
    s_mov_b32 s17, 3
mega_kernel_hl:
    s_add_u32 m0, s13, 16384
    s_nop 0
    buffer_load_dwordx4 v12, s[24:27], s19 offen offset:0 nt lds
    buffer_load_dwordx4 v12, s[24:27], s19 offen offset:1024 nt lds
    buffer_load_dwordx4 v12, s[24:27], s19 offen offset:2048 nt lds
    buffer_load_dwordx4 v12, s[24:27], s19 offen offset:3072 nt lds
    s_add_u32 s19, s19, 4096
    buffer_load_dwordx4 v[64:67], v12, s[20:23], s18 offen offset:0 sc1
    buffer_load_dwordx4 v[72:75], v12, s[20:23], s18 offen offset:1024 sc1
    buffer_load_dwordx4 v[80:83], v12, s[20:23], s18 offen offset:2048 sc1
    buffer_load_dwordx4 v[88:91], v12, s[20:23], s18 offen offset:3072 sc1
    s_add_u32 s18, s18, 4224
    s_waitcnt vmcnt(8)
    ds_write_b128 v11, v[32:35] offset:0
    ds_write_b128 v11, v[40:43] offset:1024
    ds_write_b128 v11, v[48:51] offset:2048
    ds_write_b128 v11, v[56:59] offset:3072
    ds_read_b64 v[36:37], v19 offset:0
    ds_read_b64 v[44:45], v19 offset:1024
    ds_read_b64 v[52:53], v19 offset:2048
    ds_read_b64 v[60:61], v19 offset:3072
    v_alignbyte_b32 v96, v33, v32, 2
    v_alignbyte_b32 v97, v34, v33, 2
    v_alignbyte_b32 v98, v35, v34, 2
    v_alignbyte_b32 v100, v34, v33, 2
    v_alignbyte_b32 v101, v35, v34, 2
    v_mov_b32 v104, v33
    v_mov_b32 v105, v34
    v_mov_b32 v106, v35
    s_waitcnt lgkmcnt(3)
    v_alignbyte_b32 v99, v36, v35, 2
    v_alignbyte_b32 v102, v36, v35, 2
    v_alignbyte_b32 v103, v37, v36, 2
    v_mov_b32 v107, v36
    ds_write_b128 v10, v[96:99] offset:0
    ds_write_b128 v8, v[100:103] offset:0
    ds_write_b128 v9, v[104:107] offset:0
    v_alignbyte_b32 v108, v41, v40, 2
    v_alignbyte_b32 v109, v42, v41, 2
    v_alignbyte_b32 v110, v43, v42, 2
    v_alignbyte_b32 v112, v42, v41, 2
    v_alignbyte_b32 v113, v43, v42, 2
    v_mov_b32 v116, v41
    v_mov_b32 v117, v42
    v_mov_b32 v118, v43
    s_waitcnt lgkmcnt(5)
    v_alignbyte_b32 v111, v44, v43, 2
    v_alignbyte_b32 v114, v44, v43, 2
    v_alignbyte_b32 v115, v45, v44, 2
    v_mov_b32 v119, v44
    ds_write_b128 v10, v[108:111] offset:1024
    ds_write_b128 v8, v[112:115] offset:1024
    ds_write_b128 v9, v[116:119] offset:1024
    v_alignbyte_b32 v120, v49, v48, 2
    v_alignbyte_b32 v121, v50, v49, 2
    v_alignbyte_b32 v122, v51, v50, 2
    v_alignbyte_b32 v124, v50, v49, 2
    v_alignbyte_b32 v125, v51, v50, 2
    v_mov_b32 v128, v49
    v_mov_b32 v129, v50
    v_mov_b32 v130, v51
    s_waitcnt lgkmcnt(7)
    v_alignbyte_b32 v123, v52, v51, 2
    v_alignbyte_b32 v126, v52, v51, 2
    v_alignbyte_b32 v127, v53, v52, 2
    v_mov_b32 v131, v52
    ds_write_b128 v10, v[120:123] offset:2048
    ds_write_b128 v8, v[124:127] offset:2048
    ds_write_b128 v9, v[128:131] offset:2048
    v_alignbyte_b32 v132, v57, v56, 2
    v_alignbyte_b32 v133, v58, v57, 2
    v_alignbyte_b32 v134, v59, v58, 2
    v_alignbyte_b32 v136, v58, v57, 2
    v_alignbyte_b32 v137, v59, v58, 2
    v_mov_b32 v140, v57
    v_mov_b32 v141, v58
    v_mov_b32 v142, v59
    s_waitcnt lgkmcnt(9)
    v_writelane_b32 v60, 0, 63
    v_writelane_b32 v61, 0, 63
    v_alignbyte_b32 v135, v60, v59, 2
    v_alignbyte_b32 v138, v60, v59, 2
    v_alignbyte_b32 v139, v61, v60, 2
    v_mov_b32 v143, v60
    ds_write_b128 v10, v[132:135] offset:3072
    ds_write_b128 v8, v[136:139] offset:3072
    ds_write_b128 v9, v[140:143] offset:3072
    s_waitcnt vmcnt(4)
    s_mov_b64 exec, s[36:37]
    ds_write_b16 v14, v13
    s_mov_b64 exec, -1
    s_lshl_b64 s[36:37], s[36:37], 1
    s_waitcnt lgkmcnt(0)
    s_barrier
    s_add_u32 m0, s13, 36864
    s_nop 0
    buffer_load_dwordx4 v12, s[24:27], s19 offen offset:0 nt lds
    buffer_load_dwordx4 v12, s[24:27], s19 offen offset:1024 nt lds
    buffer_load_dwordx4 v12, s[24:27], s19 offen offset:2048 nt lds
    buffer_load_dwordx4 v12, s[24:27], s19 offen offset:3072 nt lds
    s_add_u32 s19, s19, 4096
    s_cmp_eq_u32 s17, 1
    s_cselect_b32 s18, 0x7ffffff0, s18
    buffer_load_dwordx4 v[32:35], v12, s[20:23], s18 offen offset:0 sc1
    buffer_load_dwordx4 v[40:43], v12, s[20:23], s18 offen offset:1024 sc1
    buffer_load_dwordx4 v[48:51], v12, s[20:23], s18 offen offset:2048 sc1
    buffer_load_dwordx4 v[56:59], v12, s[20:23], s18 offen offset:3072 sc1
    s_add_u32 s18, s18, 4224
    s_waitcnt vmcnt(8)
    ds_write_b128 v11, v[64:67] offset:20480
    ds_write_b128 v11, v[72:75] offset:21504
    ds_write_b128 v11, v[80:83] offset:22528
    ds_write_b128 v11, v[88:91] offset:23552
    ds_read_b64 v[68:69], v19 offset:20480
    ds_read_b64 v[76:77], v19 offset:21504
    ds_read_b64 v[84:85], v19 offset:22528
    ds_read_b64 v[92:93], v19 offset:23552
    v_alignbyte_b32 v96, v65, v64, 2
    v_alignbyte_b32 v97, v66, v65, 2
    v_alignbyte_b32 v98, v67, v66, 2
    v_alignbyte_b32 v100, v66, v65, 2
    v_alignbyte_b32 v101, v67, v66, 2
    v_mov_b32 v104, v65
    v_mov_b32 v105, v66
    v_mov_b32 v106, v67
    s_waitcnt lgkmcnt(3)
    v_alignbyte_b32 v99, v68, v67, 2
    v_alignbyte_b32 v102, v68, v67, 2
    v_alignbyte_b32 v103, v69, v68, 2
    v_mov_b32 v107, v68
    ds_write_b128 v10, v[96:99] offset:20480
    ds_write_b128 v8, v[100:103] offset:20480
    ds_write_b128 v9, v[104:107] offset:20480
    v_alignbyte_b32 v108, v73, v72, 2
    v_alignbyte_b32 v109, v74, v73, 2
    v_alignbyte_b32 v110, v75, v74, 2
    v_alignbyte_b32 v112, v74, v73, 2
    v_alignbyte_b32 v113, v75, v74, 2
    v_mov_b32 v116, v73
    v_mov_b32 v117, v74
    v_mov_b32 v118, v75
    s_waitcnt lgkmcnt(5)
    v_alignbyte_b32 v111, v76, v75, 2
    v_alignbyte_b32 v114, v76, v75, 2
    v_alignbyte_b32 v115, v77, v76, 2
    v_mov_b32 v119, v76
    ds_write_b128 v10, v[108:111] offset:21504
    ds_write_b128 v8, v[112:115] offset:21504
    ds_write_b128 v9, v[116:119] offset:21504
    v_alignbyte_b32 v120, v81, v80, 2
    v_alignbyte_b32 v121, v82, v81, 2
    v_alignbyte_b32 v122, v83, v82, 2
    v_alignbyte_b32 v124, v82, v81, 2
    v_alignbyte_b32 v125, v83, v82, 2
    v_mov_b32 v128, v81
    v_mov_b32 v129, v82
    v_mov_b32 v130, v83
    s_waitcnt lgkmcnt(7)
    v_alignbyte_b32 v123, v84, v83, 2
    v_alignbyte_b32 v126, v84, v83, 2
    v_alignbyte_b32 v127, v85, v84, 2
    v_mov_b32 v131, v84
    ds_write_b128 v10, v[120:123] offset:22528
    ds_write_b128 v8, v[124:127] offset:22528
    ds_write_b128 v9, v[128:131] offset:22528
    v_alignbyte_b32 v132, v89, v88, 2
    v_alignbyte_b32 v133, v90, v89, 2
    v_alignbyte_b32 v134, v91, v90, 2
    v_alignbyte_b32 v136, v90, v89, 2
    v_alignbyte_b32 v137, v91, v90, 2
    v_mov_b32 v140, v89
    v_mov_b32 v141, v90
    v_mov_b32 v142, v91
    s_waitcnt lgkmcnt(9)
    v_writelane_b32 v92, 0, 63
    v_writelane_b32 v93, 0, 63
    v_alignbyte_b32 v135, v92, v91, 2
    v_alignbyte_b32 v138, v92, v91, 2
    v_alignbyte_b32 v139, v93, v92, 2
    v_mov_b32 v143, v92
    ds_write_b128 v10, v[132:135] offset:23552
    ds_write_b128 v8, v[136:139] offset:23552
    ds_write_b128 v9, v[140:143] offset:23552
    s_waitcnt vmcnt(4)
    s_mov_b64 exec, s[36:37]
    ds_write_b16 v14, v13
    s_mov_b64 exec, -1
    s_lshl_b64 s[36:37], s[36:37], 1
    s_waitcnt lgkmcnt(0)
    s_barrier
    s_sub_u32 s17, s17, 1
    s_cmp_lg_u32 s17, 0
    s_cbranch_scc1 mega_kernel_hl
    s_waitcnt vmcnt(0)
    s_barrier
    s_barrier
    s_endpgm
.p2align 7
mega_kernel_hc:
    s_add_u32 s28, s10, 0x2800000
    s_addc_u32 s29, s11, 0
    s_and_b32 s29, s29, 0xffff
    s_mov_b32 s30, 4194304
    s_mov_b32 s31, 0x20000
    v_lshrrev_b32 v208, 4, v0
    v_and_b32 v209, 15, v0
    v_lshrrev_b32 v210, 2, v209
    v_lshlrev_b32 v210, 3, v210
    v_lshlrev_b32 v211, 4, v208
    v_sub_u32 v211, v211, v210
    v_add_u32 v9, 24, v211
    v_and_b32 v210, 3, v0
    v_lshlrev_b32 v6, 6, v210
    v_lshl_add_u32 v10, v210, 12, s13
    v_cmp_gt_i32 s[56:57], 40, v211
    v_cmp_gt_i32 s[58:59], 32, v211
    v_lshlrev_b32 v214, 5, v209
    v_lshl_add_u32 v214, v208, 4, v214
    v_add_u32 v8, -480, v214
    s_add_u32 s16, s13, 16384
    v_add_u32 v11, s16, v8
    v_and_b32 v216, 1, v208
    v_lshlrev_b32 v216, 9, v216
    v_lshl_add_u32 v216, v209, 5, v216
    v_lshrrev_b32 v217, 1, v208
    v_lshl_add_u32 v7, v217, 4, v216
    s_mov_b32 s19, 0x7fffffff
    s_lshl_b32 s18, s35, 12
    v_mov_b32 v2, v9
    v_mov_b32 v5, v11
    v_xad_u32 v3, v2, v6, v10
    v_add_u32 v4, 8, v2
    v_xad_u32 v4, v4, v6, v10
    s_waitcnt vmcnt(0)
    s_barrier
    s_barrier
    ds_read_b128 v[112:115], v5 offset:0
    ds_read_b64 v[80:81], v3 offset:3584
    ds_read_b64 v[82:83], v4 offset:3584
    ds_read_b128 v[116:119], v5 offset:512
    ds_read_b64 v[84:85], v3 offset:3072
    ds_read_b64 v[86:87], v4 offset:3072
    ds_read_b128 v[120:123], v5 offset:1024
    ds_read_b64 v[88:89], v3 offset:2560
    ds_read_b64 v[90:91], v4 offset:2560
    ds_read_b128 v[124:127], v5 offset:1536
    ds_read_b64 v[92:93], v3 offset:2048
    ds_read_b64 v[94:95], v4 offset:2048
    ds_read_b128 v[128:131], v5 offset:2048
    ds_read_b64 v[96:97], v3 offset:1536
    ds_read_b64 v[98:99], v4 offset:1536
    ds_read_b128 v[132:135], v5 offset:2560
    ds_read_b64 v[100:101], v3 offset:1024
    ds_read_b64 v[102:103], v4 offset:1024
    ds_read_b128 v[136:139], v5 offset:3072
    ds_read_b64 v[104:105], v3 offset:512
    ds_read_b64 v[106:107], v4 offset:512
    ds_read_b128 v[140:143], v5 offset:3584
    ds_read_b64 v[108:109], v3 offset:0
    ds_read_b64 v[110:111], v4 offset:0
    v_add_u32 v2, 64, v2
    v_add_u32 v5, 64, v5
    v_xad_u32 v3, v2, v6, v10
    v_add_u32 v4, 8, v2
    v_xad_u32 v4, v4, v6, v10
    s_mov_b32 s17, 4
mega_kernel_ch:
    s_waitcnt lgkmcnt(0)
    v_mfma_f32_16x16x32_bf16 v[24:27], v[84:87], v[116:119], 0
    ds_read_b128 v[176:179], v5 offset:0
    v_cmp_le_i32 vcc, 0, v8
    v_mfma_f32_16x16x32_bf16 v[28:31], v[88:91], v[116:119], 0
    ds_read_b64 v[144:145], v3 offset:3584
    s_nop 0
    v_mfma_f32_16x16x32_bf16 v[32:35], v[92:95], v[116:119], 0
    ds_read_b64 v[146:147], v4 offset:3584
    v_cndmask_b32 v112, 0, v112, vcc
    v_mfma_f32_16x16x32_bf16 v[36:39], v[96:99], v[116:119], 0
    ds_read_b128 v[180:183], v5 offset:512
    v_cndmask_b32 v113, 0, v113, vcc
    v_mfma_f32_16x16x32_bf16 v[40:43], v[100:103], v[116:119], 0
    ds_read_b64 v[148:149], v3 offset:3072
    v_cndmask_b32 v114, 0, v114, vcc
    v_mfma_f32_16x16x32_bf16 v[44:47], v[104:107], v[116:119], 0
    ds_read_b64 v[150:151], v4 offset:3072
    v_cndmask_b32 v115, 0, v115, vcc
    v_mfma_f32_16x16x32_bf16 v[28:31], v[84:87], v[120:123], v[28:31]
    ds_read_b128 v[184:187], v5 offset:1024
    v_mfma_f32_16x16x32_bf16 v[32:35], v[88:91], v[120:123], v[32:35]
    ds_read_b64 v[152:153], v3 offset:2560
    v_mfma_f32_16x16x32_bf16 v[36:39], v[92:95], v[120:123], v[36:39]
    ds_read_b64 v[154:155], v4 offset:2560
    v_cvt_pk_bf16_f32 v48, v48, v49
    v_mfma_f32_16x16x32_bf16 v[40:43], v[96:99], v[120:123], v[40:43]
    ds_read_b128 v[188:191], v5 offset:1536
    v_mfma_f32_16x16x32_bf16 v[44:47], v[100:103], v[120:123], v[44:47]
    ds_read_b64 v[156:157], v3 offset:2048
    v_cvt_pk_bf16_f32 v49, v50, v51
    v_mfma_f32_16x16x32_bf16 v[32:35], v[84:87], v[124:127], v[32:35]
    ds_read_b64 v[158:159], v4 offset:2048
    v_mfma_f32_16x16x32_bf16 v[36:39], v[88:91], v[124:127], v[36:39]
    ds_read_b128 v[192:195], v5 offset:2048
    v_cvt_pk_bf16_f32 v50, v52, v53
    v_mfma_f32_16x16x32_bf16 v[40:43], v[92:95], v[124:127], v[40:43]
    ds_read_b64 v[160:161], v3 offset:1536
    v_mfma_f32_16x16x32_bf16 v[44:47], v[96:99], v[124:127], v[44:47]
    ds_read_b64 v[162:163], v4 offset:1536
    v_cvt_pk_bf16_f32 v51, v54, v55
    v_mfma_f32_16x16x32_bf16 v[36:39], v[84:87], v[128:131], v[36:39]
    ds_read_b128 v[196:199], v5 offset:2560
    v_mfma_f32_16x16x32_bf16 v[40:43], v[88:91], v[128:131], v[40:43]
    ds_read_b64 v[164:165], v3 offset:1024
    v_cvt_pk_bf16_f32 v56, v56, v57
    v_mfma_f32_16x16x32_bf16 v[44:47], v[92:95], v[128:131], v[44:47]
    ds_read_b64 v[166:167], v4 offset:1024
    v_mfma_f32_16x16x32_bf16 v[40:43], v[84:87], v[132:135], v[40:43]
    ds_read_b128 v[200:203], v5 offset:3072
    v_cvt_pk_bf16_f32 v57, v58, v59
    v_mfma_f32_16x16x32_bf16 v[44:47], v[88:91], v[132:135], v[44:47]
    ds_read_b64 v[168:169], v3 offset:512
    v_mfma_f32_16x16x32_bf16 v[44:47], v[84:87], v[136:139], v[44:47]
    ds_read_b64 v[170:171], v4 offset:512
    v_cvt_pk_bf16_f32 v58, v60, v61
    v_mfma_f32_16x16x32_bf16 v[16:19], v[80:83], v[112:115], 0
    ds_read_b128 v[204:207], v5 offset:3584
    v_mfma_f32_16x16x32_bf16 v[20:23], v[84:87], v[112:115], 0
    ds_read_b64 v[172:173], v3 offset:0
    v_cvt_pk_bf16_f32 v59, v62, v63
    v_mfma_f32_16x16x32_bf16 v[24:27], v[88:91], v[112:115], v[24:27]
    ds_read_b64 v[174:175], v4 offset:0
    v_mfma_f32_16x16x32_bf16 v[28:31], v[92:95], v[112:115], v[28:31]
    v_mfma_f32_16x16x32_bf16 v[32:35], v[96:99], v[112:115], v[32:35]
    v_add_u32 v2, 64, v2
    v_mfma_f32_16x16x32_bf16 v[36:39], v[100:103], v[112:115], v[36:39]
    v_add_u32 v5, 64, v5
    v_mfma_f32_16x16x32_bf16 v[40:43], v[104:107], v[112:115], v[40:43]
    v_xad_u32 v3, v2, v6, v10
    v_mfma_f32_16x16x32_bf16 v[44:47], v[108:111], v[112:115], v[44:47]
    v_add_u32 v4, 8, v2
    v_mfma_f32_16x16x32_bf16 v[20:23], v[80:83], v[116:119], v[20:23]
    v_xad_u32 v4, v4, v6, v10
    v_mfma_f32_16x16x32_bf16 v[24:27], v[80:83], v[120:123], v[24:27]
    v_cvt_pk_bf16_f32 v64, v64, v65
    v_mfma_f32_16x16x32_bf16 v[28:31], v[80:83], v[124:127], v[28:31]
    v_cvt_pk_bf16_f32 v65, v66, v67
    v_mfma_f32_16x16x32_bf16 v[32:35], v[80:83], v[128:131], v[32:35]
    v_cvt_pk_bf16_f32 v66, v68, v69
    v_mfma_f32_16x16x32_bf16 v[36:39], v[80:83], v[132:135], v[36:39]
    v_cvt_pk_bf16_f32 v67, v70, v71
    v_mfma_f32_16x16x32_bf16 v[40:43], v[80:83], v[136:139], v[40:43]
    v_mfma_f32_16x16x32_bf16 v[44:47], v[80:83], v[140:143], v[44:47]
    s_waitcnt lgkmcnt(0)
    v_mfma_f32_16x16x32_bf16 v[24:27], v[148:151], v[180:183], v[24:27]
    ds_read_b128 v[112:115], v5 offset:0
    v_cmp_le_i32 vcc, -64, v8
    v_mfma_f32_16x16x32_bf16 v[28:31], v[152:155], v[180:183], v[28:31]
    ds_read_b64 v[80:81], v3 offset:3584
    s_nop 0
    v_mfma_f32_16x16x32_bf16 v[32:35], v[156:159], v[180:183], v[32:35]
    ds_read_b64 v[82:83], v4 offset:3584
    v_cndmask_b32 v176, 0, v176, vcc
    v_mfma_f32_16x16x32_bf16 v[36:39], v[160:163], v[180:183], v[36:39]
    ds_read_b128 v[116:119], v5 offset:512
    v_cndmask_b32 v177, 0, v177, vcc
    v_mfma_f32_16x16x32_bf16 v[40:43], v[164:167], v[180:183], v[40:43]
    ds_read_b64 v[84:85], v3 offset:3072
    v_cndmask_b32 v178, 0, v178, vcc
    v_mfma_f32_16x16x32_bf16 v[44:47], v[168:171], v[180:183], v[44:47]
    ds_read_b64 v[86:87], v4 offset:3072
    v_cndmask_b32 v179, 0, v179, vcc
    v_mfma_f32_16x16x32_bf16 v[28:31], v[148:151], v[184:187], v[28:31]
    ds_read_b128 v[120:123], v5 offset:1024
    v_mfma_f32_16x16x32_bf16 v[32:35], v[152:155], v[184:187], v[32:35]
    ds_read_b64 v[88:89], v3 offset:2560
    v_mfma_f32_16x16x32_bf16 v[36:39], v[156:159], v[184:187], v[36:39]
    ds_read_b64 v[90:91], v4 offset:2560
    v_cvt_pk_bf16_f32 v72, v72, v73
    v_mfma_f32_16x16x32_bf16 v[40:43], v[160:163], v[184:187], v[40:43]
    ds_read_b128 v[124:127], v5 offset:1536
    v_mfma_f32_16x16x32_bf16 v[44:47], v[164:167], v[184:187], v[44:47]
    ds_read_b64 v[92:93], v3 offset:2048
    v_cvt_pk_bf16_f32 v73, v74, v75
    v_mfma_f32_16x16x32_bf16 v[32:35], v[148:151], v[188:191], v[32:35]
    ds_read_b64 v[94:95], v4 offset:2048
    v_mfma_f32_16x16x32_bf16 v[36:39], v[152:155], v[188:191], v[36:39]
    ds_read_b128 v[128:131], v5 offset:2048
    v_cvt_pk_bf16_f32 v74, v76, v77
    v_mfma_f32_16x16x32_bf16 v[40:43], v[156:159], v[188:191], v[40:43]
    ds_read_b64 v[96:97], v3 offset:1536
    v_mfma_f32_16x16x32_bf16 v[44:47], v[160:163], v[188:191], v[44:47]
    ds_read_b64 v[98:99], v4 offset:1536
    v_cvt_pk_bf16_f32 v75, v78, v79
    v_mfma_f32_16x16x32_bf16 v[36:39], v[148:151], v[192:195], v[36:39]
    ds_read_b128 v[132:135], v5 offset:2560
    v_mfma_f32_16x16x32_bf16 v[40:43], v[152:155], v[192:195], v[40:43]
    ds_read_b64 v[100:101], v3 offset:1024
    v_permlane16_swap_b32 v48, v50
    v_mfma_f32_16x16x32_bf16 v[44:47], v[156:159], v[192:195], v[44:47]
    ds_read_b64 v[102:103], v4 offset:1024
    v_mfma_f32_16x16x32_bf16 v[40:43], v[148:151], v[196:199], v[40:43]
    ds_read_b128 v[136:139], v5 offset:3072
    v_permlane16_swap_b32 v49, v51
    v_mfma_f32_16x16x32_bf16 v[44:47], v[152:155], v[196:199], v[44:47]
    ds_read_b64 v[104:105], v3 offset:512
    v_mfma_f32_16x16x32_bf16 v[44:47], v[148:151], v[200:203], v[44:47]
    ds_read_b64 v[106:107], v4 offset:512
    v_permlane16_swap_b32 v56, v58
    v_mfma_f32_16x16x32_bf16 v[16:19], v[144:147], v[176:179], v[16:19]
    ds_read_b128 v[140:143], v5 offset:3584
    v_mfma_f32_16x16x32_bf16 v[20:23], v[148:151], v[176:179], v[20:23]
    ds_read_b64 v[108:109], v3 offset:0
    v_permlane16_swap_b32 v57, v59
    v_mfma_f32_16x16x32_bf16 v[24:27], v[152:155], v[176:179], v[24:27]
    ds_read_b64 v[110:111], v4 offset:0
    v_mfma_f32_16x16x32_bf16 v[28:31], v[156:159], v[176:179], v[28:31]
    v_mfma_f32_16x16x32_bf16 v[32:35], v[160:163], v[176:179], v[32:35]
    v_add_u32 v2, 64, v2
    v_mfma_f32_16x16x32_bf16 v[36:39], v[164:167], v[176:179], v[36:39]
    v_add_u32 v5, 64, v5
    v_mfma_f32_16x16x32_bf16 v[40:43], v[168:171], v[176:179], v[40:43]
    v_xad_u32 v3, v2, v6, v10
    v_mfma_f32_16x16x32_bf16 v[44:47], v[172:175], v[176:179], v[44:47]
    v_add_u32 v4, 8, v2
    v_mfma_f32_16x16x32_bf16 v[20:23], v[144:147], v[180:183], v[20:23]
    v_xad_u32 v4, v4, v6, v10
    v_mfma_f32_16x16x32_bf16 v[24:27], v[144:147], v[184:187], v[24:27]
    v_permlane16_swap_b32 v64, v66
    v_mfma_f32_16x16x32_bf16 v[28:31], v[144:147], v[188:191], v[28:31]
    v_permlane16_swap_b32 v65, v67
    v_mfma_f32_16x16x32_bf16 v[32:35], v[144:147], v[192:195], v[32:35]
    v_permlane16_swap_b32 v72, v74
    v_mfma_f32_16x16x32_bf16 v[36:39], v[144:147], v[196:199], v[36:39]
    v_permlane16_swap_b32 v73, v75
    v_mfma_f32_16x16x32_bf16 v[40:43], v[144:147], v[200:203], v[40:43]
    v_mfma_f32_16x16x32_bf16 v[44:47], v[144:147], v[204:207], v[44:47]
    s_waitcnt lgkmcnt(0)
    v_mfma_f32_16x16x32_bf16 v[24:27], v[84:87], v[116:119], v[24:27]
    ds_read_b128 v[176:179], v5 offset:0
    v_cmp_le_i32 vcc, -128, v8
    v_mfma_f32_16x16x32_bf16 v[28:31], v[88:91], v[116:119], v[28:31]
    ds_read_b64 v[144:145], v3 offset:3584
    s_nop 0
    v_mfma_f32_16x16x32_bf16 v[32:35], v[92:95], v[116:119], v[32:35]
    ds_read_b64 v[146:147], v4 offset:3584
    v_cndmask_b32 v112, 0, v112, vcc
    v_mfma_f32_16x16x32_bf16 v[36:39], v[96:99], v[116:119], v[36:39]
    ds_read_b128 v[180:183], v5 offset:512
    v_cndmask_b32 v113, 0, v113, vcc
    v_mfma_f32_16x16x32_bf16 v[40:43], v[100:103], v[116:119], v[40:43]
    ds_read_b64 v[148:149], v3 offset:3072
    v_cndmask_b32 v114, 0, v114, vcc
    v_mfma_f32_16x16x32_bf16 v[44:47], v[104:107], v[116:119], v[44:47]
    ds_read_b64 v[150:151], v4 offset:3072
    v_cndmask_b32 v115, 0, v115, vcc
    v_mfma_f32_16x16x32_bf16 v[28:31], v[84:87], v[120:123], v[28:31]
    ds_read_b128 v[184:187], v5 offset:1024
    v_mfma_f32_16x16x32_bf16 v[32:35], v[88:91], v[120:123], v[32:35]
    ds_read_b64 v[152:153], v3 offset:2560
    v_mfma_f32_16x16x32_bf16 v[36:39], v[92:95], v[120:123], v[36:39]
    ds_read_b64 v[154:155], v4 offset:2560
    v_mfma_f32_16x16x32_bf16 v[40:43], v[96:99], v[120:123], v[40:43]
    ds_read_b128 v[188:191], v5 offset:1536
    v_mfma_f32_16x16x32_bf16 v[44:47], v[100:103], v[120:123], v[44:47]
    ds_read_b64 v[156:157], v3 offset:2048
    v_mfma_f32_16x16x32_bf16 v[32:35], v[84:87], v[124:127], v[32:35]
    ds_read_b64 v[158:159], v4 offset:2048
    v_mfma_f32_16x16x32_bf16 v[36:39], v[88:91], v[124:127], v[36:39]
    ds_read_b128 v[192:195], v5 offset:2048
    v_mfma_f32_16x16x32_bf16 v[40:43], v[92:95], v[124:127], v[40:43]
    ds_read_b64 v[160:161], v3 offset:1536
    v_mfma_f32_16x16x32_bf16 v[44:47], v[96:99], v[124:127], v[44:47]
    ds_read_b64 v[162:163], v4 offset:1536
    v_mfma_f32_16x16x32_bf16 v[36:39], v[84:87], v[128:131], v[36:39]
    ds_read_b128 v[196:199], v5 offset:2560
    v_mfma_f32_16x16x32_bf16 v[40:43], v[88:91], v[128:131], v[40:43]
    ds_read_b64 v[164:165], v3 offset:1024
    v_mfma_f32_16x16x32_bf16 v[44:47], v[92:95], v[128:131], v[44:47]
    ds_read_b64 v[166:167], v4 offset:1024
    v_mfma_f32_16x16x32_bf16 v[40:43], v[84:87], v[132:135], v[40:43]
    ds_read_b128 v[200:203], v5 offset:3072
    v_mfma_f32_16x16x32_bf16 v[44:47], v[88:91], v[132:135], v[44:47]
    ds_read_b64 v[168:169], v3 offset:512
    v_mfma_f32_16x16x32_bf16 v[44:47], v[84:87], v[136:139], v[44:47]
    ds_read_b64 v[170:171], v4 offset:512
    v_mfma_f32_16x16x32_bf16 v[16:19], v[80:83], v[112:115], v[16:19]
    ds_read_b128 v[204:207], v5 offset:3584
    v_mfma_f32_16x16x32_bf16 v[20:23], v[84:87], v[112:115], v[20:23]
    ds_read_b64 v[172:173], v3 offset:0
    v_mfma_f32_16x16x32_bf16 v[24:27], v[88:91], v[112:115], v[24:27]
    ds_read_b64 v[174:175], v4 offset:0
    v_mfma_f32_16x16x32_bf16 v[28:31], v[92:95], v[112:115], v[28:31]
    v_mfma_f32_16x16x32_bf16 v[32:35], v[96:99], v[112:115], v[32:35]
    v_add_u32 v2, 64, v2
    v_mfma_f32_16x16x32_bf16 v[36:39], v[100:103], v[112:115], v[36:39]
    v_add_u32 v5, 64, v5
    v_mfma_f32_16x16x32_bf16 v[40:43], v[104:107], v[112:115], v[40:43]
    v_xad_u32 v3, v2, v6, v10
    v_mfma_f32_16x16x32_bf16 v[44:47], v[108:111], v[112:115], v[44:47]
    v_add_u32 v4, 8, v2
    v_mfma_f32_16x16x32_bf16 v[20:23], v[80:83], v[116:119], v[20:23]
    v_xad_u32 v4, v4, v6, v10
    v_mfma_f32_16x16x32_bf16 v[24:27], v[80:83], v[120:123], v[24:27]
    v_mfma_f32_16x16x32_bf16 v[28:31], v[80:83], v[124:127], v[28:31]
    v_mfma_f32_16x16x32_bf16 v[32:35], v[80:83], v[128:131], v[32:35]
    v_mfma_f32_16x16x32_bf16 v[36:39], v[80:83], v[132:135], v[36:39]
    v_mfma_f32_16x16x32_bf16 v[40:43], v[80:83], v[136:139], v[40:43]
    v_mfma_f32_16x16x32_bf16 v[44:47], v[80:83], v[140:143], v[44:47]
    s_waitcnt lgkmcnt(0)
    v_mfma_f32_16x16x32_bf16 v[24:27], v[148:151], v[180:183], v[24:27]
    ds_read_b128 v[112:115], v5 offset:0
    v_cmp_le_i32 vcc, -192, v8
    v_mfma_f32_16x16x32_bf16 v[28:31], v[152:155], v[180:183], v[28:31]
    ds_read_b64 v[80:81], v3 offset:3584
    s_nop 0
    v_mfma_f32_16x16x32_bf16 v[32:35], v[156:159], v[180:183], v[32:35]
    ds_read_b64 v[82:83], v4 offset:3584
    v_cndmask_b32 v176, 0, v176, vcc
    v_mfma_f32_16x16x32_bf16 v[36:39], v[160:163], v[180:183], v[36:39]
    ds_read_b128 v[116:119], v5 offset:512
    v_cndmask_b32 v177, 0, v177, vcc
    v_mfma_f32_16x16x32_bf16 v[40:43], v[164:167], v[180:183], v[40:43]
    ds_read_b64 v[84:85], v3 offset:3072
    v_cndmask_b32 v178, 0, v178, vcc
    v_mfma_f32_16x16x32_bf16 v[44:47], v[168:171], v[180:183], v[44:47]
    ds_read_b64 v[86:87], v4 offset:3072
    v_cndmask_b32 v179, 0, v179, vcc
    v_mfma_f32_16x16x32_bf16 v[28:31], v[148:151], v[184:187], v[28:31]
    ds_read_b128 v[120:123], v5 offset:1024
    v_mfma_f32_16x16x32_bf16 v[32:35], v[152:155], v[184:187], v[32:35]
    ds_read_b64 v[88:89], v3 offset:2560
    v_mfma_f32_16x16x32_bf16 v[36:39], v[156:159], v[184:187], v[36:39]
    ds_read_b64 v[90:91], v4 offset:2560
    v_mfma_f32_16x16x32_bf16 v[40:43], v[160:163], v[184:187], v[40:43]
    ds_read_b128 v[124:127], v5 offset:1536
    v_mfma_f32_16x16x32_bf16 v[44:47], v[164:167], v[184:187], v[44:47]
    ds_read_b64 v[92:93], v3 offset:2048
    v_mfma_f32_16x16x32_bf16 v[32:35], v[148:151], v[188:191], v[32:35]
    ds_read_b64 v[94:95], v4 offset:2048
    v_mfma_f32_16x16x32_bf16 v[36:39], v[152:155], v[188:191], v[36:39]
    ds_read_b128 v[128:131], v5 offset:2048
    v_mfma_f32_16x16x32_bf16 v[40:43], v[156:159], v[188:191], v[40:43]
    ds_read_b64 v[96:97], v3 offset:1536
    v_mfma_f32_16x16x32_bf16 v[44:47], v[160:163], v[188:191], v[44:47]
    ds_read_b64 v[98:99], v4 offset:1536
    v_mfma_f32_16x16x32_bf16 v[36:39], v[148:151], v[192:195], v[36:39]
    ds_read_b128 v[132:135], v5 offset:2560
    v_mfma_f32_16x16x32_bf16 v[40:43], v[152:155], v[192:195], v[40:43]
    ds_read_b64 v[100:101], v3 offset:1024
    v_mfma_f32_16x16x32_bf16 v[44:47], v[156:159], v[192:195], v[44:47]
    ds_read_b64 v[102:103], v4 offset:1024
    v_mfma_f32_16x16x32_bf16 v[40:43], v[148:151], v[196:199], v[40:43]
    ds_read_b128 v[136:139], v5 offset:3072
    v_mfma_f32_16x16x32_bf16 v[44:47], v[152:155], v[196:199], v[44:47]
    ds_read_b64 v[104:105], v3 offset:512
    v_mfma_f32_16x16x32_bf16 v[44:47], v[148:151], v[200:203], v[44:47]
    ds_read_b64 v[106:107], v4 offset:512
    v_mfma_f32_16x16x32_bf16 v[16:19], v[144:147], v[176:179], v[16:19]
    ds_read_b128 v[140:143], v5 offset:3584
    v_mfma_f32_16x16x32_bf16 v[20:23], v[148:151], v[176:179], v[20:23]
    ds_read_b64 v[108:109], v3 offset:0
    v_mfma_f32_16x16x32_bf16 v[24:27], v[152:155], v[176:179], v[24:27]
    ds_read_b64 v[110:111], v4 offset:0
    v_mfma_f32_16x16x32_bf16 v[28:31], v[156:159], v[176:179], v[28:31]
    v_mfma_f32_16x16x32_bf16 v[32:35], v[160:163], v[176:179], v[32:35]
    v_add_u32 v2, 64, v2
    v_mfma_f32_16x16x32_bf16 v[36:39], v[164:167], v[176:179], v[36:39]
    v_add_u32 v5, 64, v5
    v_mfma_f32_16x16x32_bf16 v[40:43], v[168:171], v[176:179], v[40:43]
    v_xad_u32 v3, v2, v6, v10
    v_mfma_f32_16x16x32_bf16 v[44:47], v[172:175], v[176:179], v[44:47]
    v_add_u32 v4, 8, v2
    v_mfma_f32_16x16x32_bf16 v[20:23], v[144:147], v[180:183], v[20:23]
    v_xad_u32 v4, v4, v6, v10
    v_mfma_f32_16x16x32_bf16 v[24:27], v[144:147], v[184:187], v[24:27]
    v_mfma_f32_16x16x32_bf16 v[28:31], v[144:147], v[188:191], v[28:31]
    v_mfma_f32_16x16x32_bf16 v[32:35], v[144:147], v[192:195], v[32:35]
    v_mfma_f32_16x16x32_bf16 v[36:39], v[144:147], v[196:199], v[36:39]
    v_mfma_f32_16x16x32_bf16 v[40:43], v[144:147], v[200:203], v[40:43]
    v_mfma_f32_16x16x32_bf16 v[44:47], v[144:147], v[204:207], v[44:47]
    s_waitcnt lgkmcnt(0)
    v_mfma_f32_16x16x32_bf16 v[24:27], v[84:87], v[116:119], v[24:27]
    ds_read_b128 v[176:179], v5 offset:0
    v_cmp_le_i32 vcc, -256, v8
    v_mfma_f32_16x16x32_bf16 v[28:31], v[88:91], v[116:119], v[28:31]
    ds_read_b64 v[144:145], v3 offset:3584
    s_nop 0
    v_mfma_f32_16x16x32_bf16 v[32:35], v[92:95], v[116:119], v[32:35]
    ds_read_b64 v[146:147], v4 offset:3584
    v_cndmask_b32 v112, 0, v112, vcc
    v_mfma_f32_16x16x32_bf16 v[36:39], v[96:99], v[116:119], v[36:39]
    ds_read_b128 v[180:183], v5 offset:512
    v_cndmask_b32 v113, 0, v113, vcc
    v_mfma_f32_16x16x32_bf16 v[40:43], v[100:103], v[116:119], v[40:43]
    ds_read_b64 v[148:149], v3 offset:3072
    v_cndmask_b32 v114, 0, v114, vcc
    v_mfma_f32_16x16x32_bf16 v[44:47], v[104:107], v[116:119], v[44:47]
    ds_read_b64 v[150:151], v4 offset:3072
    v_cndmask_b32 v115, 0, v115, vcc
    v_mfma_f32_16x16x32_bf16 v[28:31], v[84:87], v[120:123], v[28:31]
    ds_read_b128 v[184:187], v5 offset:1024
    v_mfma_f32_16x16x32_bf16 v[32:35], v[88:91], v[120:123], v[32:35]
    ds_read_b64 v[152:153], v3 offset:2560
    v_mfma_f32_16x16x32_bf16 v[36:39], v[92:95], v[120:123], v[36:39]
    ds_read_b64 v[154:155], v4 offset:2560
    v_mfma_f32_16x16x32_bf16 v[40:43], v[96:99], v[120:123], v[40:43]
    ds_read_b128 v[188:191], v5 offset:1536
    v_mfma_f32_16x16x32_bf16 v[44:47], v[100:103], v[120:123], v[44:47]
    ds_read_b64 v[156:157], v3 offset:2048
    v_mfma_f32_16x16x32_bf16 v[32:35], v[84:87], v[124:127], v[32:35]
    ds_read_b64 v[158:159], v4 offset:2048
    v_mfma_f32_16x16x32_bf16 v[36:39], v[88:91], v[124:127], v[36:39]
    ds_read_b128 v[192:195], v5 offset:2048
    v_mfma_f32_16x16x32_bf16 v[40:43], v[92:95], v[124:127], v[40:43]
    ds_read_b64 v[160:161], v3 offset:1536
    v_mfma_f32_16x16x32_bf16 v[44:47], v[96:99], v[124:127], v[44:47]
    ds_read_b64 v[162:163], v4 offset:1536
    v_mfma_f32_16x16x32_bf16 v[36:39], v[84:87], v[128:131], v[36:39]
    ds_read_b128 v[196:199], v5 offset:2560
    v_mfma_f32_16x16x32_bf16 v[40:43], v[88:91], v[128:131], v[40:43]
    ds_read_b64 v[164:165], v3 offset:1024
    v_mfma_f32_16x16x32_bf16 v[44:47], v[92:95], v[128:131], v[44:47]
    ds_read_b64 v[166:167], v4 offset:1024
    v_mfma_f32_16x16x32_bf16 v[40:43], v[84:87], v[132:135], v[40:43]
    ds_read_b128 v[200:203], v5 offset:3072
    v_mfma_f32_16x16x32_bf16 v[44:47], v[88:91], v[132:135], v[44:47]
    ds_read_b64 v[168:169], v3 offset:512
    v_mfma_f32_16x16x32_bf16 v[44:47], v[84:87], v[136:139], v[44:47]
    ds_read_b64 v[170:171], v4 offset:512
    v_mfma_f32_16x16x32_bf16 v[16:19], v[80:83], v[112:115], v[16:19]
    ds_read_b128 v[204:207], v5 offset:3584
    v_mfma_f32_16x16x32_bf16 v[20:23], v[84:87], v[112:115], v[20:23]
    ds_read_b64 v[172:173], v3 offset:0
    v_mfma_f32_16x16x32_bf16 v[24:27], v[88:91], v[112:115], v[24:27]
    ds_read_b64 v[174:175], v4 offset:0
    v_mfma_f32_16x16x32_bf16 v[28:31], v[92:95], v[112:115], v[28:31]
    v_mfma_f32_16x16x32_bf16 v[32:35], v[96:99], v[112:115], v[32:35]
    v_add_u32 v2, 64, v2
    v_mfma_f32_16x16x32_bf16 v[36:39], v[100:103], v[112:115], v[36:39]
    v_add_u32 v5, 64, v5
    v_mfma_f32_16x16x32_bf16 v[40:43], v[104:107], v[112:115], v[40:43]
    v_xad_u32 v3, v2, v6, v10
    v_mfma_f32_16x16x32_bf16 v[44:47], v[108:111], v[112:115], v[44:47]
    v_add_u32 v4, 8, v2
    v_mfma_f32_16x16x32_bf16 v[20:23], v[80:83], v[116:119], v[20:23]
    v_xad_u32 v4, v4, v6, v10
    v_mfma_f32_16x16x32_bf16 v[24:27], v[80:83], v[120:123], v[24:27]
    v_mfma_f32_16x16x32_bf16 v[28:31], v[80:83], v[124:127], v[28:31]
    v_mfma_f32_16x16x32_bf16 v[32:35], v[80:83], v[128:131], v[32:35]
    v_mfma_f32_16x16x32_bf16 v[36:39], v[80:83], v[132:135], v[36:39]
    v_mfma_f32_16x16x32_bf16 v[40:43], v[80:83], v[136:139], v[40:43]
    v_mfma_f32_16x16x32_bf16 v[44:47], v[80:83], v[140:143], v[44:47]
    s_waitcnt lgkmcnt(0)
    v_mfma_f32_16x16x32_bf16 v[24:27], v[148:151], v[180:183], v[24:27]
    ds_read_b128 v[112:115], v5 offset:0
    v_cmp_le_i32 vcc, -320, v8
    v_mfma_f32_16x16x32_bf16 v[28:31], v[152:155], v[180:183], v[28:31]
    ds_read_b64 v[80:81], v3 offset:3584
    s_nop 0
    v_mfma_f32_16x16x32_bf16 v[32:35], v[156:159], v[180:183], v[32:35]
    ds_read_b64 v[82:83], v4 offset:3584
    v_cndmask_b32 v176, 0, v176, vcc
    v_mfma_f32_16x16x32_bf16 v[36:39], v[160:163], v[180:183], v[36:39]
    ds_read_b128 v[116:119], v5 offset:512
    v_cndmask_b32 v177, 0, v177, vcc
    v_mfma_f32_16x16x32_bf16 v[40:43], v[164:167], v[180:183], v[40:43]
    ds_read_b64 v[84:85], v3 offset:3072
    v_cndmask_b32 v178, 0, v178, vcc
    v_mfma_f32_16x16x32_bf16 v[44:47], v[168:171], v[180:183], v[44:47]
    ds_read_b64 v[86:87], v4 offset:3072
    v_cndmask_b32 v179, 0, v179, vcc
    v_mfma_f32_16x16x32_bf16 v[28:31], v[148:151], v[184:187], v[28:31]
    ds_read_b128 v[120:123], v5 offset:1024
    v_mfma_f32_16x16x32_bf16 v[32:35], v[152:155], v[184:187], v[32:35]
    ds_read_b64 v[88:89], v3 offset:2560
    v_mfma_f32_16x16x32_bf16 v[36:39], v[156:159], v[184:187], v[36:39]
    ds_read_b64 v[90:91], v4 offset:2560
    v_mfma_f32_16x16x32_bf16 v[40:43], v[160:163], v[184:187], v[40:43]
    ds_read_b128 v[124:127], v5 offset:1536
    v_mfma_f32_16x16x32_bf16 v[44:47], v[164:167], v[184:187], v[44:47]
    ds_read_b64 v[92:93], v3 offset:2048
    v_mfma_f32_16x16x32_bf16 v[32:35], v[148:151], v[188:191], v[32:35]
    ds_read_b64 v[94:95], v4 offset:2048
    v_mfma_f32_16x16x32_bf16 v[36:39], v[152:155], v[188:191], v[36:39]
    ds_read_b128 v[128:131], v5 offset:2048
    v_mfma_f32_16x16x32_bf16 v[40:43], v[156:159], v[188:191], v[40:43]
    ds_read_b64 v[96:97], v3 offset:1536
    v_mfma_f32_16x16x32_bf16 v[44:47], v[160:163], v[188:191], v[44:47]
    ds_read_b64 v[98:99], v4 offset:1536
    v_mfma_f32_16x16x32_bf16 v[36:39], v[148:151], v[192:195], v[36:39]
    ds_read_b128 v[132:135], v5 offset:2560
    v_mfma_f32_16x16x32_bf16 v[40:43], v[152:155], v[192:195], v[40:43]
    ds_read_b64 v[100:101], v3 offset:1024
    v_mfma_f32_16x16x32_bf16 v[44:47], v[156:159], v[192:195], v[44:47]
    ds_read_b64 v[102:103], v4 offset:1024
    v_mfma_f32_16x16x32_bf16 v[40:43], v[148:151], v[196:199], v[40:43]
    ds_read_b128 v[136:139], v5 offset:3072
    v_mfma_f32_16x16x32_bf16 v[44:47], v[152:155], v[196:199], v[44:47]
    ds_read_b64 v[104:105], v3 offset:512
    v_mfma_f32_16x16x32_bf16 v[44:47], v[148:151], v[200:203], v[44:47]
    ds_read_b64 v[106:107], v4 offset:512
    v_mfma_f32_16x16x32_bf16 v[16:19], v[144:147], v[176:179], v[16:19]
    ds_read_b128 v[140:143], v5 offset:3584
    v_mfma_f32_16x16x32_bf16 v[20:23], v[148:151], v[176:179], v[20:23]
    ds_read_b64 v[108:109], v3 offset:0
    v_mfma_f32_16x16x32_bf16 v[24:27], v[152:155], v[176:179], v[24:27]
    ds_read_b64 v[110:111], v4 offset:0
    v_mfma_f32_16x16x32_bf16 v[28:31], v[156:159], v[176:179], v[28:31]
    v_mfma_f32_16x16x32_bf16 v[32:35], v[160:163], v[176:179], v[32:35]
    v_add_u32 v2, 64, v2
    v_mfma_f32_16x16x32_bf16 v[36:39], v[164:167], v[176:179], v[36:39]
    v_add_u32 v5, 64, v5
    v_mfma_f32_16x16x32_bf16 v[40:43], v[168:171], v[176:179], v[40:43]
    v_xad_u32 v3, v2, v6, v10
    v_mfma_f32_16x16x32_bf16 v[44:47], v[172:175], v[176:179], v[44:47]
    v_add_u32 v4, 8, v2
    v_mfma_f32_16x16x32_bf16 v[20:23], v[144:147], v[180:183], v[20:23]
    v_xad_u32 v4, v4, v6, v10
    v_mfma_f32_16x16x32_bf16 v[24:27], v[144:147], v[184:187], v[24:27]
    v_mfma_f32_16x16x32_bf16 v[28:31], v[144:147], v[188:191], v[28:31]
    v_mfma_f32_16x16x32_bf16 v[32:35], v[144:147], v[192:195], v[32:35]
    v_mfma_f32_16x16x32_bf16 v[36:39], v[144:147], v[196:199], v[36:39]
    v_mfma_f32_16x16x32_bf16 v[40:43], v[144:147], v[200:203], v[40:43]
    v_mfma_f32_16x16x32_bf16 v[44:47], v[144:147], v[204:207], v[44:47]
    s_waitcnt lgkmcnt(0)
    v_mfma_f32_16x16x32_bf16 v[24:27], v[84:87], v[116:119], v[24:27]
    ds_read_b128 v[176:179], v5 offset:0
    v_cmp_le_i32 vcc, -384, v8
    v_mfma_f32_16x16x32_bf16 v[28:31], v[88:91], v[116:119], v[28:31]
    ds_read_b64 v[144:145], v3 offset:3584
    s_nop 0
    v_mfma_f32_16x16x32_bf16 v[32:35], v[92:95], v[116:119], v[32:35]
    ds_read_b64 v[146:147], v4 offset:3584
    v_cndmask_b32 v112, 0, v112, vcc
    v_mfma_f32_16x16x32_bf16 v[36:39], v[96:99], v[116:119], v[36:39]
    ds_read_b128 v[180:183], v5 offset:512
    v_cndmask_b32 v113, 0, v113, vcc
    v_mfma_f32_16x16x32_bf16 v[40:43], v[100:103], v[116:119], v[40:43]
    ds_read_b64 v[148:149], v3 offset:3072
    v_cndmask_b32 v114, 0, v114, vcc
    v_mfma_f32_16x16x32_bf16 v[44:47], v[104:107], v[116:119], v[44:47]
    ds_read_b64 v[150:151], v4 offset:3072
    v_cndmask_b32 v115, 0, v115, vcc
    v_mfma_f32_16x16x32_bf16 v[28:31], v[84:87], v[120:123], v[28:31]
    ds_read_b128 v[184:187], v5 offset:1024
    v_mfma_f32_16x16x32_bf16 v[32:35], v[88:91], v[120:123], v[32:35]
    ds_read_b64 v[152:153], v3 offset:2560
    v_mfma_f32_16x16x32_bf16 v[36:39], v[92:95], v[120:123], v[36:39]
    ds_read_b64 v[154:155], v4 offset:2560
    buffer_store_dwordx4 v[48:51], v7, s[28:31], s19 offen offset:0 sc1
    v_mfma_f32_16x16x32_bf16 v[40:43], v[96:99], v[120:123], v[40:43]
    ds_read_b128 v[188:191], v5 offset:1536
    v_mfma_f32_16x16x32_bf16 v[44:47], v[100:103], v[120:123], v[44:47]
    ds_read_b64 v[156:157], v3 offset:2048
    buffer_store_dwordx4 v[56:59], v7, s[28:31], s19 offen offset:1024 sc1
    v_mfma_f32_16x16x32_bf16 v[32:35], v[84:87], v[124:127], v[32:35]
    ds_read_b64 v[158:159], v4 offset:2048
    v_mfma_f32_16x16x32_bf16 v[36:39], v[88:91], v[124:127], v[36:39]
    ds_read_b128 v[192:195], v5 offset:2048
    buffer_store_dwordx4 v[64:67], v7, s[28:31], s19 offen offset:2048 sc1
    v_mfma_f32_16x16x32_bf16 v[40:43], v[92:95], v[124:127], v[40:43]
    ds_read_b64 v[160:161], v3 offset:1536
    v_mfma_f32_16x16x32_bf16 v[44:47], v[96:99], v[124:127], v[44:47]
    ds_read_b64 v[162:163], v4 offset:1536
    buffer_store_dwordx4 v[72:75], v7, s[28:31], s19 offen offset:3072 sc1
    v_mfma_f32_16x16x32_bf16 v[36:39], v[84:87], v[128:131], v[36:39]
    ds_read_b128 v[196:199], v5 offset:2560
    v_mfma_f32_16x16x32_bf16 v[40:43], v[88:91], v[128:131], v[40:43]
    ds_read_b64 v[164:165], v3 offset:1024
    v_mfma_f32_16x16x32_bf16 v[44:47], v[92:95], v[128:131], v[44:47]
    ds_read_b64 v[166:167], v4 offset:1024
    v_mfma_f32_16x16x32_bf16 v[40:43], v[84:87], v[132:135], v[40:43]
    ds_read_b128 v[200:203], v5 offset:3072
    v_mfma_f32_16x16x32_bf16 v[44:47], v[88:91], v[132:135], v[44:47]
    ds_read_b64 v[168:169], v3 offset:512
    v_mfma_f32_16x16x32_bf16 v[44:47], v[84:87], v[136:139], v[44:47]
    ds_read_b64 v[170:171], v4 offset:512
    v_mfma_f32_16x16x32_bf16 v[16:19], v[80:83], v[112:115], v[16:19]
    ds_read_b128 v[204:207], v5 offset:3584
    v_mfma_f32_16x16x32_bf16 v[20:23], v[84:87], v[112:115], v[20:23]
    ds_read_b64 v[172:173], v3 offset:0
    v_mfma_f32_16x16x32_bf16 v[24:27], v[88:91], v[112:115], v[24:27]
    ds_read_b64 v[174:175], v4 offset:0
    v_mfma_f32_16x16x32_bf16 v[28:31], v[92:95], v[112:115], v[28:31]
    v_mfma_f32_16x16x32_bf16 v[32:35], v[96:99], v[112:115], v[32:35]
    v_mov_b32 v2, v9
    v_mfma_f32_16x16x32_bf16 v[36:39], v[100:103], v[112:115], v[36:39]
    v_mov_b32 v5, v11
    v_mfma_f32_16x16x32_bf16 v[40:43], v[104:107], v[112:115], v[40:43]
    v_xad_u32 v3, v2, v6, v10
    v_mfma_f32_16x16x32_bf16 v[44:47], v[108:111], v[112:115], v[44:47]
    v_add_u32 v4, 8, v2
    v_mfma_f32_16x16x32_bf16 v[20:23], v[80:83], v[116:119], v[20:23]
    v_xad_u32 v4, v4, v6, v10
    v_mfma_f32_16x16x32_bf16 v[24:27], v[80:83], v[120:123], v[24:27]
    v_mfma_f32_16x16x32_bf16 v[28:31], v[80:83], v[124:127], v[28:31]
    v_mfma_f32_16x16x32_bf16 v[32:35], v[80:83], v[128:131], v[32:35]
    v_mfma_f32_16x16x32_bf16 v[36:39], v[80:83], v[132:135], v[36:39]
    v_mfma_f32_16x16x32_bf16 v[40:43], v[80:83], v[136:139], v[40:43]
    s_mov_b32 s19, s18
    s_add_u32 s18, s18, 4096
    v_mfma_f32_16x16x32_bf16 v[44:47], v[80:83], v[140:143], v[44:47]
    s_waitcnt lgkmcnt(0)
    s_barrier
    v_mfma_f32_16x16x32_bf16 v[24:27], v[148:151], v[180:183], v[24:27]
    ds_read_b128 v[112:115], v5 offset:20480
    v_cmp_le_i32 vcc, -448, v8
    v_mfma_f32_16x16x32_bf16 v[28:31], v[152:155], v[180:183], v[28:31]
    ds_read_b64 v[80:81], v3 offset:24064
    s_nop 0
    v_mfma_f32_16x16x32_bf16 v[32:35], v[156:159], v[180:183], v[32:35]
    ds_read_b64 v[82:83], v4 offset:24064
    v_cndmask_b32 v176, 0, v176, vcc
    v_mfma_f32_16x16x32_bf16 v[36:39], v[160:163], v[180:183], v[36:39]
    ds_read_b128 v[116:119], v5 offset:20992
    v_cndmask_b32 v177, 0, v177, vcc
    v_mfma_f32_16x16x32_bf16 v[40:43], v[164:167], v[180:183], v[40:43]
    ds_read_b64 v[84:85], v3 offset:23552
    v_cndmask_b32 v178, 0, v178, vcc
    v_mfma_f32_16x16x32_bf16 v[44:47], v[168:171], v[180:183], v[44:47]
    ds_read_b64 v[86:87], v4 offset:23552
    v_cndmask_b32 v179, 0, v179, vcc
    v_mfma_f32_16x16x32_bf16 v[28:31], v[148:151], v[184:187], v[28:31]
    ds_read_b128 v[120:123], v5 offset:21504
    v_cndmask_b32 v144, 0, v144, s[56:57]
    v_mfma_f32_16x16x32_bf16 v[32:35], v[152:155], v[184:187], v[32:35]
    ds_read_b64 v[88:89], v3 offset:23040
    v_cndmask_b32 v145, 0, v145, s[56:57]
    v_mfma_f32_16x16x32_bf16 v[36:39], v[156:159], v[184:187], v[36:39]
    ds_read_b64 v[90:91], v4 offset:23040
    v_cndmask_b32 v146, 0, v146, s[58:59]
    v_mfma_f32_16x16x32_bf16 v[40:43], v[160:163], v[184:187], v[40:43]
    ds_read_b128 v[124:127], v5 offset:22016
    v_cndmask_b32 v147, 0, v147, s[58:59]
    v_mfma_f32_16x16x32_bf16 v[44:47], v[164:167], v[184:187], v[44:47]
    ds_read_b64 v[92:93], v3 offset:22528
    v_mfma_f32_16x16x32_bf16 v[32:35], v[148:151], v[188:191], v[32:35]
    ds_read_b64 v[94:95], v4 offset:22528
    v_mfma_f32_16x16x32_bf16 v[36:39], v[152:155], v[188:191], v[36:39]
    ds_read_b128 v[128:131], v5 offset:22528
    v_mfma_f32_16x16x32_bf16 v[40:43], v[156:159], v[188:191], v[40:43]
    ds_read_b64 v[96:97], v3 offset:22016
    v_mfma_f32_16x16x32_bf16 v[44:47], v[160:163], v[188:191], v[44:47]
    ds_read_b64 v[98:99], v4 offset:22016
    v_mfma_f32_16x16x32_bf16 v[36:39], v[148:151], v[192:195], v[36:39]
    ds_read_b128 v[132:135], v5 offset:23040
    v_mfma_f32_16x16x32_bf16 v[40:43], v[152:155], v[192:195], v[40:43]
    ds_read_b64 v[100:101], v3 offset:21504
    v_mfma_f32_16x16x32_bf16 v[44:47], v[156:159], v[192:195], v[44:47]
    ds_read_b64 v[102:103], v4 offset:21504
    v_mfma_f32_16x16x32_bf16 v[40:43], v[148:151], v[196:199], v[40:43]
    ds_read_b128 v[136:139], v5 offset:23552
    v_mfma_f32_16x16x32_bf16 v[44:47], v[152:155], v[196:199], v[44:47]
    ds_read_b64 v[104:105], v3 offset:20992
    v_mfma_f32_16x16x32_bf16 v[44:47], v[148:151], v[200:203], v[44:47]
    ds_read_b64 v[106:107], v4 offset:20992
    v_mfma_f32_16x16x32_bf16 v[16:19], v[144:147], v[176:179], v[16:19]
    ds_read_b128 v[140:143], v5 offset:24064
    v_mfma_f32_16x16x32_bf16 v[20:23], v[148:151], v[176:179], v[20:23]
    ds_read_b64 v[108:109], v3 offset:20480
    v_mfma_f32_16x16x32_bf16 v[24:27], v[152:155], v[176:179], v[24:27]
    ds_read_b64 v[110:111], v4 offset:20480
    v_mfma_f32_16x16x32_bf16 v[28:31], v[156:159], v[176:179], v[28:31]
    v_mfma_f32_16x16x32_bf16 v[32:35], v[160:163], v[176:179], v[32:35]
    v_add_u32 v2, 64, v2
    v_mfma_f32_16x16x32_bf16 v[36:39], v[164:167], v[176:179], v[36:39]
    v_add_u32 v5, 64, v5
    v_mfma_f32_16x16x32_bf16 v[40:43], v[168:171], v[176:179], v[40:43]
    v_xad_u32 v3, v2, v6, v10
    v_mfma_f32_16x16x32_bf16 v[44:47], v[172:175], v[176:179], v[44:47]
    v_add_u32 v4, 8, v2
    v_mfma_f32_16x16x32_bf16 v[20:23], v[144:147], v[180:183], v[20:23]
    v_xad_u32 v4, v4, v6, v10
    v_mfma_f32_16x16x32_bf16 v[24:27], v[144:147], v[184:187], v[24:27]
    v_mfma_f32_16x16x32_bf16 v[28:31], v[144:147], v[188:191], v[28:31]
    v_mfma_f32_16x16x32_bf16 v[32:35], v[144:147], v[192:195], v[32:35]
    v_mfma_f32_16x16x32_bf16 v[36:39], v[144:147], v[196:199], v[36:39]
    v_mfma_f32_16x16x32_bf16 v[40:43], v[144:147], v[200:203], v[40:43]
    v_mfma_f32_16x16x32_bf16 v[44:47], v[144:147], v[204:207], v[44:47]
    s_waitcnt lgkmcnt(0)
    v_mfma_f32_16x16x32_bf16 v[56:59], v[84:87], v[116:119], 0
    ds_read_b128 v[176:179], v5 offset:20480
    v_cmp_le_i32 vcc, 0, v8
    v_mfma_f32_16x16x32_bf16 v[60:63], v[88:91], v[116:119], 0
    ds_read_b64 v[144:145], v3 offset:24064
    s_nop 0
    v_mfma_f32_16x16x32_bf16 v[64:67], v[92:95], v[116:119], 0
    ds_read_b64 v[146:147], v4 offset:24064
    v_cndmask_b32 v112, 0, v112, vcc
    v_mfma_f32_16x16x32_bf16 v[68:71], v[96:99], v[116:119], 0
    ds_read_b128 v[180:183], v5 offset:20992
    v_cndmask_b32 v113, 0, v113, vcc
    v_mfma_f32_16x16x32_bf16 v[72:75], v[100:103], v[116:119], 0
    ds_read_b64 v[148:149], v3 offset:23552
    v_cndmask_b32 v114, 0, v114, vcc
    v_mfma_f32_16x16x32_bf16 v[76:79], v[104:107], v[116:119], 0
    ds_read_b64 v[150:151], v4 offset:23552
    v_cndmask_b32 v115, 0, v115, vcc
    v_mfma_f32_16x16x32_bf16 v[60:63], v[84:87], v[120:123], v[60:63]
    ds_read_b128 v[184:187], v5 offset:21504
    v_mfma_f32_16x16x32_bf16 v[64:67], v[88:91], v[120:123], v[64:67]
    ds_read_b64 v[152:153], v3 offset:23040
    v_mfma_f32_16x16x32_bf16 v[68:71], v[92:95], v[120:123], v[68:71]
    ds_read_b64 v[154:155], v4 offset:23040
    v_cvt_pk_bf16_f32 v16, v16, v17
    v_mfma_f32_16x16x32_bf16 v[72:75], v[96:99], v[120:123], v[72:75]
    ds_read_b128 v[188:191], v5 offset:22016
    v_mfma_f32_16x16x32_bf16 v[76:79], v[100:103], v[120:123], v[76:79]
    ds_read_b64 v[156:157], v3 offset:22528
    v_cvt_pk_bf16_f32 v17, v18, v19
    v_mfma_f32_16x16x32_bf16 v[64:67], v[84:87], v[124:127], v[64:67]
    ds_read_b64 v[158:159], v4 offset:22528
    v_mfma_f32_16x16x32_bf16 v[68:71], v[88:91], v[124:127], v[68:71]
    ds_read_b128 v[192:195], v5 offset:22528
    v_cvt_pk_bf16_f32 v18, v20, v21
    v_mfma_f32_16x16x32_bf16 v[72:75], v[92:95], v[124:127], v[72:75]
    ds_read_b64 v[160:161], v3 offset:22016
    v_mfma_f32_16x16x32_bf16 v[76:79], v[96:99], v[124:127], v[76:79]
    ds_read_b64 v[162:163], v4 offset:22016
    v_cvt_pk_bf16_f32 v19, v22, v23
    v_mfma_f32_16x16x32_bf16 v[68:71], v[84:87], v[128:131], v[68:71]
    ds_read_b128 v[196:199], v5 offset:23040
    v_mfma_f32_16x16x32_bf16 v[72:75], v[88:91], v[128:131], v[72:75]
    ds_read_b64 v[164:165], v3 offset:21504
    v_cvt_pk_bf16_f32 v24, v24, v25
    v_mfma_f32_16x16x32_bf16 v[76:79], v[92:95], v[128:131], v[76:79]
    ds_read_b64 v[166:167], v4 offset:21504
    v_mfma_f32_16x16x32_bf16 v[72:75], v[84:87], v[132:135], v[72:75]
    ds_read_b128 v[200:203], v5 offset:23552
    v_cvt_pk_bf16_f32 v25, v26, v27
    v_mfma_f32_16x16x32_bf16 v[76:79], v[88:91], v[132:135], v[76:79]
    ds_read_b64 v[168:169], v3 offset:20992
    v_mfma_f32_16x16x32_bf16 v[76:79], v[84:87], v[136:139], v[76:79]
    ds_read_b64 v[170:171], v4 offset:20992
    v_cvt_pk_bf16_f32 v26, v28, v29
    v_mfma_f32_16x16x32_bf16 v[48:51], v[80:83], v[112:115], 0
    ds_read_b128 v[204:207], v5 offset:24064
    v_mfma_f32_16x16x32_bf16 v[52:55], v[84:87], v[112:115], 0
    ds_read_b64 v[172:173], v3 offset:20480
    v_cvt_pk_bf16_f32 v27, v30, v31
    v_mfma_f32_16x16x32_bf16 v[56:59], v[88:91], v[112:115], v[56:59]
    ds_read_b64 v[174:175], v4 offset:20480
    v_mfma_f32_16x16x32_bf16 v[60:63], v[92:95], v[112:115], v[60:63]
    v_mfma_f32_16x16x32_bf16 v[64:67], v[96:99], v[112:115], v[64:67]
    v_add_u32 v2, 64, v2
    v_mfma_f32_16x16x32_bf16 v[68:71], v[100:103], v[112:115], v[68:71]
    v_add_u32 v5, 64, v5
    v_mfma_f32_16x16x32_bf16 v[72:75], v[104:107], v[112:115], v[72:75]
    v_xad_u32 v3, v2, v6, v10
    v_mfma_f32_16x16x32_bf16 v[76:79], v[108:111], v[112:115], v[76:79]
    v_add_u32 v4, 8, v2
    v_mfma_f32_16x16x32_bf16 v[52:55], v[80:83], v[116:119], v[52:55]
    v_xad_u32 v4, v4, v6, v10
    v_mfma_f32_16x16x32_bf16 v[56:59], v[80:83], v[120:123], v[56:59]
    v_cvt_pk_bf16_f32 v32, v32, v33
    v_mfma_f32_16x16x32_bf16 v[60:63], v[80:83], v[124:127], v[60:63]
    v_cvt_pk_bf16_f32 v33, v34, v35
    v_mfma_f32_16x16x32_bf16 v[64:67], v[80:83], v[128:131], v[64:67]
    v_cvt_pk_bf16_f32 v34, v36, v37
    v_mfma_f32_16x16x32_bf16 v[68:71], v[80:83], v[132:135], v[68:71]
    v_cvt_pk_bf16_f32 v35, v38, v39
    v_mfma_f32_16x16x32_bf16 v[72:75], v[80:83], v[136:139], v[72:75]
    v_mfma_f32_16x16x32_bf16 v[76:79], v[80:83], v[140:143], v[76:79]
    s_waitcnt lgkmcnt(0)
    v_mfma_f32_16x16x32_bf16 v[56:59], v[148:151], v[180:183], v[56:59]
    ds_read_b128 v[112:115], v5 offset:20480
    v_cmp_le_i32 vcc, -64, v8
    v_mfma_f32_16x16x32_bf16 v[60:63], v[152:155], v[180:183], v[60:63]
    ds_read_b64 v[80:81], v3 offset:24064
    s_nop 0
    v_mfma_f32_16x16x32_bf16 v[64:67], v[156:159], v[180:183], v[64:67]
    ds_read_b64 v[82:83], v4 offset:24064
    v_cndmask_b32 v176, 0, v176, vcc
    v_mfma_f32_16x16x32_bf16 v[68:71], v[160:163], v[180:183], v[68:71]
    ds_read_b128 v[116:119], v5 offset:20992
    v_cndmask_b32 v177, 0, v177, vcc
    v_mfma_f32_16x16x32_bf16 v[72:75], v[164:167], v[180:183], v[72:75]
    ds_read_b64 v[84:85], v3 offset:23552
    v_cndmask_b32 v178, 0, v178, vcc
    v_mfma_f32_16x16x32_bf16 v[76:79], v[168:171], v[180:183], v[76:79]
    ds_read_b64 v[86:87], v4 offset:23552
    v_cndmask_b32 v179, 0, v179, vcc
    v_mfma_f32_16x16x32_bf16 v[60:63], v[148:151], v[184:187], v[60:63]
    ds_read_b128 v[120:123], v5 offset:21504
    v_mfma_f32_16x16x32_bf16 v[64:67], v[152:155], v[184:187], v[64:67]
    ds_read_b64 v[88:89], v3 offset:23040
    v_mfma_f32_16x16x32_bf16 v[68:71], v[156:159], v[184:187], v[68:71]
    ds_read_b64 v[90:91], v4 offset:23040
    v_cvt_pk_bf16_f32 v40, v40, v41
    v_mfma_f32_16x16x32_bf16 v[72:75], v[160:163], v[184:187], v[72:75]
    ds_read_b128 v[124:127], v5 offset:22016
    v_mfma_f32_16x16x32_bf16 v[76:79], v[164:167], v[184:187], v[76:79]
    ds_read_b64 v[92:93], v3 offset:22528
    v_cvt_pk_bf16_f32 v41, v42, v43
    v_mfma_f32_16x16x32_bf16 v[64:67], v[148:151], v[188:191], v[64:67]
    ds_read_b64 v[94:95], v4 offset:22528
    v_mfma_f32_16x16x32_bf16 v[68:71], v[152:155], v[188:191], v[68:71]
    ds_read_b128 v[128:131], v5 offset:22528
    v_cvt_pk_bf16_f32 v42, v44, v45
    v_mfma_f32_16x16x32_bf16 v[72:75], v[156:159], v[188:191], v[72:75]
    ds_read_b64 v[96:97], v3 offset:22016
    v_mfma_f32_16x16x32_bf16 v[76:79], v[160:163], v[188:191], v[76:79]
    ds_read_b64 v[98:99], v4 offset:22016
    v_cvt_pk_bf16_f32 v43, v46, v47
    v_mfma_f32_16x16x32_bf16 v[68:71], v[148:151], v[192:195], v[68:71]
    ds_read_b128 v[132:135], v5 offset:23040
    v_mfma_f32_16x16x32_bf16 v[72:75], v[152:155], v[192:195], v[72:75]
    ds_read_b64 v[100:101], v3 offset:21504
    v_permlane16_swap_b32 v16, v18
    v_mfma_f32_16x16x32_bf16 v[76:79], v[156:159], v[192:195], v[76:79]
    ds_read_b64 v[102:103], v4 offset:21504
    v_mfma_f32_16x16x32_bf16 v[72:75], v[148:151], v[196:199], v[72:75]
    ds_read_b128 v[136:139], v5 offset:23552
    v_permlane16_swap_b32 v17, v19
    v_mfma_f32_16x16x32_bf16 v[76:79], v[152:155], v[196:199], v[76:79]
    ds_read_b64 v[104:105], v3 offset:20992
    v_mfma_f32_16x16x32_bf16 v[76:79], v[148:151], v[200:203], v[76:79]
    ds_read_b64 v[106:107], v4 offset:20992
    v_permlane16_swap_b32 v24, v26
    v_mfma_f32_16x16x32_bf16 v[48:51], v[144:147], v[176:179], v[48:51]
    ds_read_b128 v[140:143], v5 offset:24064
    v_mfma_f32_16x16x32_bf16 v[52:55], v[148:151], v[176:179], v[52:55]
    ds_read_b64 v[108:109], v3 offset:20480
    v_permlane16_swap_b32 v25, v27
    v_mfma_f32_16x16x32_bf16 v[56:59], v[152:155], v[176:179], v[56:59]
    ds_read_b64 v[110:111], v4 offset:20480
    v_mfma_f32_16x16x32_bf16 v[60:63], v[156:159], v[176:179], v[60:63]
    v_mfma_f32_16x16x32_bf16 v[64:67], v[160:163], v[176:179], v[64:67]
    v_add_u32 v2, 64, v2
    v_mfma_f32_16x16x32_bf16 v[68:71], v[164:167], v[176:179], v[68:71]
    v_add_u32 v5, 64, v5
    v_mfma_f32_16x16x32_bf16 v[72:75], v[168:171], v[176:179], v[72:75]
    v_xad_u32 v3, v2, v6, v10
    v_mfma_f32_16x16x32_bf16 v[76:79], v[172:175], v[176:179], v[76:79]
    v_add_u32 v4, 8, v2
    v_mfma_f32_16x16x32_bf16 v[52:55], v[144:147], v[180:183], v[52:55]
    v_xad_u32 v4, v4, v6, v10
    v_mfma_f32_16x16x32_bf16 v[56:59], v[144:147], v[184:187], v[56:59]
    v_permlane16_swap_b32 v32, v34
    v_mfma_f32_16x16x32_bf16 v[60:63], v[144:147], v[188:191], v[60:63]
    v_permlane16_swap_b32 v33, v35
    v_mfma_f32_16x16x32_bf16 v[64:67], v[144:147], v[192:195], v[64:67]
    v_permlane16_swap_b32 v40, v42
    v_mfma_f32_16x16x32_bf16 v[68:71], v[144:147], v[196:199], v[68:71]
    v_permlane16_swap_b32 v41, v43
    v_mfma_f32_16x16x32_bf16 v[72:75], v[144:147], v[200:203], v[72:75]
    v_mfma_f32_16x16x32_bf16 v[76:79], v[144:147], v[204:207], v[76:79]
    s_waitcnt lgkmcnt(0)
    v_mfma_f32_16x16x32_bf16 v[56:59], v[84:87], v[116:119], v[56:59]
    ds_read_b128 v[176:179], v5 offset:20480
    v_cmp_le_i32 vcc, -128, v8
    v_mfma_f32_16x16x32_bf16 v[60:63], v[88:91], v[116:119], v[60:63]
    ds_read_b64 v[144:145], v3 offset:24064
    s_nop 0
    v_mfma_f32_16x16x32_bf16 v[64:67], v[92:95], v[116:119], v[64:67]
    ds_read_b64 v[146:147], v4 offset:24064
    v_cndmask_b32 v112, 0, v112, vcc
    v_mfma_f32_16x16x32_bf16 v[68:71], v[96:99], v[116:119], v[68:71]
    ds_read_b128 v[180:183], v5 offset:20992
    v_cndmask_b32 v113, 0, v113, vcc
    v_mfma_f32_16x16x32_bf16 v[72:75], v[100:103], v[116:119], v[72:75]
    ds_read_b64 v[148:149], v3 offset:23552
    v_cndmask_b32 v114, 0, v114, vcc
    v_mfma_f32_16x16x32_bf16 v[76:79], v[104:107], v[116:119], v[76:79]
    ds_read_b64 v[150:151], v4 offset:23552
    v_cndmask_b32 v115, 0, v115, vcc
    v_mfma_f32_16x16x32_bf16 v[60:63], v[84:87], v[120:123], v[60:63]
    ds_read_b128 v[184:187], v5 offset:21504
    v_mfma_f32_16x16x32_bf16 v[64:67], v[88:91], v[120:123], v[64:67]
    ds_read_b64 v[152:153], v3 offset:23040
    v_mfma_f32_16x16x32_bf16 v[68:71], v[92:95], v[120:123], v[68:71]
    ds_read_b64 v[154:155], v4 offset:23040
    v_mfma_f32_16x16x32_bf16 v[72:75], v[96:99], v[120:123], v[72:75]
    ds_read_b128 v[188:191], v5 offset:22016
    v_mfma_f32_16x16x32_bf16 v[76:79], v[100:103], v[120:123], v[76:79]
    ds_read_b64 v[156:157], v3 offset:22528
    v_mfma_f32_16x16x32_bf16 v[64:67], v[84:87], v[124:127], v[64:67]
    ds_read_b64 v[158:159], v4 offset:22528
    v_mfma_f32_16x16x32_bf16 v[68:71], v[88:91], v[124:127], v[68:71]
    ds_read_b128 v[192:195], v5 offset:22528
    v_mfma_f32_16x16x32_bf16 v[72:75], v[92:95], v[124:127], v[72:75]
    ds_read_b64 v[160:161], v3 offset:22016
    v_mfma_f32_16x16x32_bf16 v[76:79], v[96:99], v[124:127], v[76:79]
    ds_read_b64 v[162:163], v4 offset:22016
    v_mfma_f32_16x16x32_bf16 v[68:71], v[84:87], v[128:131], v[68:71]
    ds_read_b128 v[196:199], v5 offset:23040
    v_mfma_f32_16x16x32_bf16 v[72:75], v[88:91], v[128:131], v[72:75]
    ds_read_b64 v[164:165], v3 offset:21504
    v_mfma_f32_16x16x32_bf16 v[76:79], v[92:95], v[128:131], v[76:79]
    ds_read_b64 v[166:167], v4 offset:21504
    v_mfma_f32_16x16x32_bf16 v[72:75], v[84:87], v[132:135], v[72:75]
    ds_read_b128 v[200:203], v5 offset:23552
    v_mfma_f32_16x16x32_bf16 v[76:79], v[88:91], v[132:135], v[76:79]
    ds_read_b64 v[168:169], v3 offset:20992
    v_mfma_f32_16x16x32_bf16 v[76:79], v[84:87], v[136:139], v[76:79]
    ds_read_b64 v[170:171], v4 offset:20992
    v_mfma_f32_16x16x32_bf16 v[48:51], v[80:83], v[112:115], v[48:51]
    ds_read_b128 v[204:207], v5 offset:24064
    v_mfma_f32_16x16x32_bf16 v[52:55], v[84:87], v[112:115], v[52:55]
    ds_read_b64 v[172:173], v3 offset:20480
    v_mfma_f32_16x16x32_bf16 v[56:59], v[88:91], v[112:115], v[56:59]
    ds_read_b64 v[174:175], v4 offset:20480
    v_mfma_f32_16x16x32_bf16 v[60:63], v[92:95], v[112:115], v[60:63]
    v_mfma_f32_16x16x32_bf16 v[64:67], v[96:99], v[112:115], v[64:67]
    v_add_u32 v2, 64, v2
    v_mfma_f32_16x16x32_bf16 v[68:71], v[100:103], v[112:115], v[68:71]
    v_add_u32 v5, 64, v5
    v_mfma_f32_16x16x32_bf16 v[72:75], v[104:107], v[112:115], v[72:75]
    v_xad_u32 v3, v2, v6, v10
    v_mfma_f32_16x16x32_bf16 v[76:79], v[108:111], v[112:115], v[76:79]
    v_add_u32 v4, 8, v2
    v_mfma_f32_16x16x32_bf16 v[52:55], v[80:83], v[116:119], v[52:55]
    v_xad_u32 v4, v4, v6, v10
    v_mfma_f32_16x16x32_bf16 v[56:59], v[80:83], v[120:123], v[56:59]
    v_mfma_f32_16x16x32_bf16 v[60:63], v[80:83], v[124:127], v[60:63]
    v_mfma_f32_16x16x32_bf16 v[64:67], v[80:83], v[128:131], v[64:67]
    v_mfma_f32_16x16x32_bf16 v[68:71], v[80:83], v[132:135], v[68:71]
    v_mfma_f32_16x16x32_bf16 v[72:75], v[80:83], v[136:139], v[72:75]
    v_mfma_f32_16x16x32_bf16 v[76:79], v[80:83], v[140:143], v[76:79]
    s_waitcnt lgkmcnt(0)
    v_mfma_f32_16x16x32_bf16 v[56:59], v[148:151], v[180:183], v[56:59]
    ds_read_b128 v[112:115], v5 offset:20480
    v_cmp_le_i32 vcc, -192, v8
    v_mfma_f32_16x16x32_bf16 v[60:63], v[152:155], v[180:183], v[60:63]
    ds_read_b64 v[80:81], v3 offset:24064
    s_nop 0
    v_mfma_f32_16x16x32_bf16 v[64:67], v[156:159], v[180:183], v[64:67]
    ds_read_b64 v[82:83], v4 offset:24064
    v_cndmask_b32 v176, 0, v176, vcc
    v_mfma_f32_16x16x32_bf16 v[68:71], v[160:163], v[180:183], v[68:71]
    ds_read_b128 v[116:119], v5 offset:20992
    v_cndmask_b32 v177, 0, v177, vcc
    v_mfma_f32_16x16x32_bf16 v[72:75], v[164:167], v[180:183], v[72:75]
    ds_read_b64 v[84:85], v3 offset:23552
    v_cndmask_b32 v178, 0, v178, vcc
    v_mfma_f32_16x16x32_bf16 v[76:79], v[168:171], v[180:183], v[76:79]
    ds_read_b64 v[86:87], v4 offset:23552
    v_cndmask_b32 v179, 0, v179, vcc
    v_mfma_f32_16x16x32_bf16 v[60:63], v[148:151], v[184:187], v[60:63]
    ds_read_b128 v[120:123], v5 offset:21504
    v_mfma_f32_16x16x32_bf16 v[64:67], v[152:155], v[184:187], v[64:67]
    ds_read_b64 v[88:89], v3 offset:23040
    v_mfma_f32_16x16x32_bf16 v[68:71], v[156:159], v[184:187], v[68:71]
    ds_read_b64 v[90:91], v4 offset:23040
    v_mfma_f32_16x16x32_bf16 v[72:75], v[160:163], v[184:187], v[72:75]
    ds_read_b128 v[124:127], v5 offset:22016
    v_mfma_f32_16x16x32_bf16 v[76:79], v[164:167], v[184:187], v[76:79]
    ds_read_b64 v[92:93], v3 offset:22528
    v_mfma_f32_16x16x32_bf16 v[64:67], v[148:151], v[188:191], v[64:67]
    ds_read_b64 v[94:95], v4 offset:22528
    v_mfma_f32_16x16x32_bf16 v[68:71], v[152:155], v[188:191], v[68:71]
    ds_read_b128 v[128:131], v5 offset:22528
    v_mfma_f32_16x16x32_bf16 v[72:75], v[156:159], v[188:191], v[72:75]
    ds_read_b64 v[96:97], v3 offset:22016
    v_mfma_f32_16x16x32_bf16 v[76:79], v[160:163], v[188:191], v[76:79]
    ds_read_b64 v[98:99], v4 offset:22016
    v_mfma_f32_16x16x32_bf16 v[68:71], v[148:151], v[192:195], v[68:71]
    ds_read_b128 v[132:135], v5 offset:23040
    v_mfma_f32_16x16x32_bf16 v[72:75], v[152:155], v[192:195], v[72:75]
    ds_read_b64 v[100:101], v3 offset:21504
    v_mfma_f32_16x16x32_bf16 v[76:79], v[156:159], v[192:195], v[76:79]
    ds_read_b64 v[102:103], v4 offset:21504
    v_mfma_f32_16x16x32_bf16 v[72:75], v[148:151], v[196:199], v[72:75]
    ds_read_b128 v[136:139], v5 offset:23552
    v_mfma_f32_16x16x32_bf16 v[76:79], v[152:155], v[196:199], v[76:79]
    ds_read_b64 v[104:105], v3 offset:20992
    v_mfma_f32_16x16x32_bf16 v[76:79], v[148:151], v[200:203], v[76:79]
    ds_read_b64 v[106:107], v4 offset:20992
    v_mfma_f32_16x16x32_bf16 v[48:51], v[144:147], v[176:179], v[48:51]
    ds_read_b128 v[140:143], v5 offset:24064
    v_mfma_f32_16x16x32_bf16 v[52:55], v[148:151], v[176:179], v[52:55]
    ds_read_b64 v[108:109], v3 offset:20480
    v_mfma_f32_16x16x32_bf16 v[56:59], v[152:155], v[176:179], v[56:59]
    ds_read_b64 v[110:111], v4 offset:20480
    v_mfma_f32_16x16x32_bf16 v[60:63], v[156:159], v[176:179], v[60:63]
    v_mfma_f32_16x16x32_bf16 v[64:67], v[160:163], v[176:179], v[64:67]
    v_add_u32 v2, 64, v2
    v_mfma_f32_16x16x32_bf16 v[68:71], v[164:167], v[176:179], v[68:71]
    v_add_u32 v5, 64, v5
    v_mfma_f32_16x16x32_bf16 v[72:75], v[168:171], v[176:179], v[72:75]
    v_xad_u32 v3, v2, v6, v10
    v_mfma_f32_16x16x32_bf16 v[76:79], v[172:175], v[176:179], v[76:79]
    v_add_u32 v4, 8, v2
    v_mfma_f32_16x16x32_bf16 v[52:55], v[144:147], v[180:183], v[52:55]
    v_xad_u32 v4, v4, v6, v10
    v_mfma_f32_16x16x32_bf16 v[56:59], v[144:147], v[184:187], v[56:59]
    v_mfma_f32_16x16x32_bf16 v[60:63], v[144:147], v[188:191], v[60:63]
    v_mfma_f32_16x16x32_bf16 v[64:67], v[144:147], v[192:195], v[64:67]
    v_mfma_f32_16x16x32_bf16 v[68:71], v[144:147], v[196:199], v[68:71]
    v_mfma_f32_16x16x32_bf16 v[72:75], v[144:147], v[200:203], v[72:75]
    v_mfma_f32_16x16x32_bf16 v[76:79], v[144:147], v[204:207], v[76:79]
    s_waitcnt lgkmcnt(0)
    v_mfma_f32_16x16x32_bf16 v[56:59], v[84:87], v[116:119], v[56:59]
    ds_read_b128 v[176:179], v5 offset:20480
    v_cmp_le_i32 vcc, -256, v8
    v_mfma_f32_16x16x32_bf16 v[60:63], v[88:91], v[116:119], v[60:63]
    ds_read_b64 v[144:145], v3 offset:24064
    s_nop 0
    v_mfma_f32_16x16x32_bf16 v[64:67], v[92:95], v[116:119], v[64:67]
    ds_read_b64 v[146:147], v4 offset:24064
    v_cndmask_b32 v112, 0, v112, vcc
    v_mfma_f32_16x16x32_bf16 v[68:71], v[96:99], v[116:119], v[68:71]
    ds_read_b128 v[180:183], v5 offset:20992
    v_cndmask_b32 v113, 0, v113, vcc
    v_mfma_f32_16x16x32_bf16 v[72:75], v[100:103], v[116:119], v[72:75]
    ds_read_b64 v[148:149], v3 offset:23552
    v_cndmask_b32 v114, 0, v114, vcc
    v_mfma_f32_16x16x32_bf16 v[76:79], v[104:107], v[116:119], v[76:79]
    ds_read_b64 v[150:151], v4 offset:23552
    v_cndmask_b32 v115, 0, v115, vcc
    v_mfma_f32_16x16x32_bf16 v[60:63], v[84:87], v[120:123], v[60:63]
    ds_read_b128 v[184:187], v5 offset:21504
    v_mfma_f32_16x16x32_bf16 v[64:67], v[88:91], v[120:123], v[64:67]
    ds_read_b64 v[152:153], v3 offset:23040
    v_mfma_f32_16x16x32_bf16 v[68:71], v[92:95], v[120:123], v[68:71]
    ds_read_b64 v[154:155], v4 offset:23040
    v_mfma_f32_16x16x32_bf16 v[72:75], v[96:99], v[120:123], v[72:75]
    ds_read_b128 v[188:191], v5 offset:22016
    v_mfma_f32_16x16x32_bf16 v[76:79], v[100:103], v[120:123], v[76:79]
    ds_read_b64 v[156:157], v3 offset:22528
    v_mfma_f32_16x16x32_bf16 v[64:67], v[84:87], v[124:127], v[64:67]
    ds_read_b64 v[158:159], v4 offset:22528
    v_mfma_f32_16x16x32_bf16 v[68:71], v[88:91], v[124:127], v[68:71]
    ds_read_b128 v[192:195], v5 offset:22528
    v_mfma_f32_16x16x32_bf16 v[72:75], v[92:95], v[124:127], v[72:75]
    ds_read_b64 v[160:161], v3 offset:22016
    v_mfma_f32_16x16x32_bf16 v[76:79], v[96:99], v[124:127], v[76:79]
    ds_read_b64 v[162:163], v4 offset:22016
    v_mfma_f32_16x16x32_bf16 v[68:71], v[84:87], v[128:131], v[68:71]
    ds_read_b128 v[196:199], v5 offset:23040
    v_mfma_f32_16x16x32_bf16 v[72:75], v[88:91], v[128:131], v[72:75]
    ds_read_b64 v[164:165], v3 offset:21504
    v_mfma_f32_16x16x32_bf16 v[76:79], v[92:95], v[128:131], v[76:79]
    ds_read_b64 v[166:167], v4 offset:21504
    v_mfma_f32_16x16x32_bf16 v[72:75], v[84:87], v[132:135], v[72:75]
    ds_read_b128 v[200:203], v5 offset:23552
    v_mfma_f32_16x16x32_bf16 v[76:79], v[88:91], v[132:135], v[76:79]
    ds_read_b64 v[168:169], v3 offset:20992
    v_mfma_f32_16x16x32_bf16 v[76:79], v[84:87], v[136:139], v[76:79]
    ds_read_b64 v[170:171], v4 offset:20992
    v_mfma_f32_16x16x32_bf16 v[48:51], v[80:83], v[112:115], v[48:51]
    ds_read_b128 v[204:207], v5 offset:24064
    v_mfma_f32_16x16x32_bf16 v[52:55], v[84:87], v[112:115], v[52:55]
    ds_read_b64 v[172:173], v3 offset:20480
    v_mfma_f32_16x16x32_bf16 v[56:59], v[88:91], v[112:115], v[56:59]
    ds_read_b64 v[174:175], v4 offset:20480
    v_mfma_f32_16x16x32_bf16 v[60:63], v[92:95], v[112:115], v[60:63]
    v_mfma_f32_16x16x32_bf16 v[64:67], v[96:99], v[112:115], v[64:67]
    v_add_u32 v2, 64, v2
    v_mfma_f32_16x16x32_bf16 v[68:71], v[100:103], v[112:115], v[68:71]
    v_add_u32 v5, 64, v5
    v_mfma_f32_16x16x32_bf16 v[72:75], v[104:107], v[112:115], v[72:75]
    v_xad_u32 v3, v2, v6, v10
    v_mfma_f32_16x16x32_bf16 v[76:79], v[108:111], v[112:115], v[76:79]
    v_add_u32 v4, 8, v2
    v_mfma_f32_16x16x32_bf16 v[52:55], v[80:83], v[116:119], v[52:55]
    v_xad_u32 v4, v4, v6, v10
    v_mfma_f32_16x16x32_bf16 v[56:59], v[80:83], v[120:123], v[56:59]
    v_mfma_f32_16x16x32_bf16 v[60:63], v[80:83], v[124:127], v[60:63]
    v_mfma_f32_16x16x32_bf16 v[64:67], v[80:83], v[128:131], v[64:67]
    v_mfma_f32_16x16x32_bf16 v[68:71], v[80:83], v[132:135], v[68:71]
    v_mfma_f32_16x16x32_bf16 v[72:75], v[80:83], v[136:139], v[72:75]
    v_mfma_f32_16x16x32_bf16 v[76:79], v[80:83], v[140:143], v[76:79]
    s_waitcnt lgkmcnt(0)
    v_mfma_f32_16x16x32_bf16 v[56:59], v[148:151], v[180:183], v[56:59]
    ds_read_b128 v[112:115], v5 offset:20480
    v_cmp_le_i32 vcc, -320, v8
    v_mfma_f32_16x16x32_bf16 v[60:63], v[152:155], v[180:183], v[60:63]
    ds_read_b64 v[80:81], v3 offset:24064
    s_nop 0
    v_mfma_f32_16x16x32_bf16 v[64:67], v[156:159], v[180:183], v[64:67]
    ds_read_b64 v[82:83], v4 offset:24064
    v_cndmask_b32 v176, 0, v176, vcc
    v_mfma_f32_16x16x32_bf16 v[68:71], v[160:163], v[180:183], v[68:71]
    ds_read_b128 v[116:119], v5 offset:20992
    v_cndmask_b32 v177, 0, v177, vcc
    v_mfma_f32_16x16x32_bf16 v[72:75], v[164:167], v[180:183], v[72:75]
    ds_read_b64 v[84:85], v3 offset:23552
    v_cndmask_b32 v178, 0, v178, vcc
    v_mfma_f32_16x16x32_bf16 v[76:79], v[168:171], v[180:183], v[76:79]
    ds_read_b64 v[86:87], v4 offset:23552
    v_cndmask_b32 v179, 0, v179, vcc
    v_mfma_f32_16x16x32_bf16 v[60:63], v[148:151], v[184:187], v[60:63]
    ds_read_b128 v[120:123], v5 offset:21504
    v_mfma_f32_16x16x32_bf16 v[64:67], v[152:155], v[184:187], v[64:67]
    ds_read_b64 v[88:89], v3 offset:23040
    v_mfma_f32_16x16x32_bf16 v[68:71], v[156:159], v[184:187], v[68:71]
    ds_read_b64 v[90:91], v4 offset:23040
    v_mfma_f32_16x16x32_bf16 v[72:75], v[160:163], v[184:187], v[72:75]
    ds_read_b128 v[124:127], v5 offset:22016
    v_mfma_f32_16x16x32_bf16 v[76:79], v[164:167], v[184:187], v[76:79]
    ds_read_b64 v[92:93], v3 offset:22528
    v_mfma_f32_16x16x32_bf16 v[64:67], v[148:151], v[188:191], v[64:67]
    ds_read_b64 v[94:95], v4 offset:22528
    v_mfma_f32_16x16x32_bf16 v[68:71], v[152:155], v[188:191], v[68:71]
    ds_read_b128 v[128:131], v5 offset:22528
    v_mfma_f32_16x16x32_bf16 v[72:75], v[156:159], v[188:191], v[72:75]
    ds_read_b64 v[96:97], v3 offset:22016
    v_mfma_f32_16x16x32_bf16 v[76:79], v[160:163], v[188:191], v[76:79]
    ds_read_b64 v[98:99], v4 offset:22016
    v_mfma_f32_16x16x32_bf16 v[68:71], v[148:151], v[192:195], v[68:71]
    ds_read_b128 v[132:135], v5 offset:23040
    v_mfma_f32_16x16x32_bf16 v[72:75], v[152:155], v[192:195], v[72:75]
    ds_read_b64 v[100:101], v3 offset:21504
    v_mfma_f32_16x16x32_bf16 v[76:79], v[156:159], v[192:195], v[76:79]
    ds_read_b64 v[102:103], v4 offset:21504
    v_mfma_f32_16x16x32_bf16 v[72:75], v[148:151], v[196:199], v[72:75]
    ds_read_b128 v[136:139], v5 offset:23552
    v_mfma_f32_16x16x32_bf16 v[76:79], v[152:155], v[196:199], v[76:79]
    ds_read_b64 v[104:105], v3 offset:20992
    v_mfma_f32_16x16x32_bf16 v[76:79], v[148:151], v[200:203], v[76:79]
    ds_read_b64 v[106:107], v4 offset:20992
    v_mfma_f32_16x16x32_bf16 v[48:51], v[144:147], v[176:179], v[48:51]
    ds_read_b128 v[140:143], v5 offset:24064
    v_mfma_f32_16x16x32_bf16 v[52:55], v[148:151], v[176:179], v[52:55]
    ds_read_b64 v[108:109], v3 offset:20480
    v_mfma_f32_16x16x32_bf16 v[56:59], v[152:155], v[176:179], v[56:59]
    ds_read_b64 v[110:111], v4 offset:20480
    v_mfma_f32_16x16x32_bf16 v[60:63], v[156:159], v[176:179], v[60:63]
    v_mfma_f32_16x16x32_bf16 v[64:67], v[160:163], v[176:179], v[64:67]
    v_add_u32 v2, 64, v2
    v_mfma_f32_16x16x32_bf16 v[68:71], v[164:167], v[176:179], v[68:71]
    v_add_u32 v5, 64, v5
    v_mfma_f32_16x16x32_bf16 v[72:75], v[168:171], v[176:179], v[72:75]
    v_xad_u32 v3, v2, v6, v10
    v_mfma_f32_16x16x32_bf16 v[76:79], v[172:175], v[176:179], v[76:79]
    v_add_u32 v4, 8, v2
    v_mfma_f32_16x16x32_bf16 v[52:55], v[144:147], v[180:183], v[52:55]
    v_xad_u32 v4, v4, v6, v10
    v_mfma_f32_16x16x32_bf16 v[56:59], v[144:147], v[184:187], v[56:59]
    v_mfma_f32_16x16x32_bf16 v[60:63], v[144:147], v[188:191], v[60:63]
    v_mfma_f32_16x16x32_bf16 v[64:67], v[144:147], v[192:195], v[64:67]
    v_mfma_f32_16x16x32_bf16 v[68:71], v[144:147], v[196:199], v[68:71]
    v_mfma_f32_16x16x32_bf16 v[72:75], v[144:147], v[200:203], v[72:75]
    v_mfma_f32_16x16x32_bf16 v[76:79], v[144:147], v[204:207], v[76:79]
    s_waitcnt lgkmcnt(0)
    v_mfma_f32_16x16x32_bf16 v[56:59], v[84:87], v[116:119], v[56:59]
    ds_read_b128 v[176:179], v5 offset:20480
    v_cmp_le_i32 vcc, -384, v8
    v_mfma_f32_16x16x32_bf16 v[60:63], v[88:91], v[116:119], v[60:63]
    ds_read_b64 v[144:145], v3 offset:24064
    s_nop 0
    v_mfma_f32_16x16x32_bf16 v[64:67], v[92:95], v[116:119], v[64:67]
    ds_read_b64 v[146:147], v4 offset:24064
    v_cndmask_b32 v112, 0, v112, vcc
    v_mfma_f32_16x16x32_bf16 v[68:71], v[96:99], v[116:119], v[68:71]
    ds_read_b128 v[180:183], v5 offset:20992
    v_cndmask_b32 v113, 0, v113, vcc
    v_mfma_f32_16x16x32_bf16 v[72:75], v[100:103], v[116:119], v[72:75]
    ds_read_b64 v[148:149], v3 offset:23552
    v_cndmask_b32 v114, 0, v114, vcc
    v_mfma_f32_16x16x32_bf16 v[76:79], v[104:107], v[116:119], v[76:79]
    ds_read_b64 v[150:151], v4 offset:23552
    v_cndmask_b32 v115, 0, v115, vcc
    v_mfma_f32_16x16x32_bf16 v[60:63], v[84:87], v[120:123], v[60:63]
    ds_read_b128 v[184:187], v5 offset:21504
    v_mfma_f32_16x16x32_bf16 v[64:67], v[88:91], v[120:123], v[64:67]
    ds_read_b64 v[152:153], v3 offset:23040
    v_mfma_f32_16x16x32_bf16 v[68:71], v[92:95], v[120:123], v[68:71]
    ds_read_b64 v[154:155], v4 offset:23040
    buffer_store_dwordx4 v[16:19], v7, s[28:31], s19 offen offset:0 sc1
    v_mfma_f32_16x16x32_bf16 v[72:75], v[96:99], v[120:123], v[72:75]
    ds_read_b128 v[188:191], v5 offset:22016
    v_mfma_f32_16x16x32_bf16 v[76:79], v[100:103], v[120:123], v[76:79]
    ds_read_b64 v[156:157], v3 offset:22528
    buffer_store_dwordx4 v[24:27], v7, s[28:31], s19 offen offset:1024 sc1
    v_mfma_f32_16x16x32_bf16 v[64:67], v[84:87], v[124:127], v[64:67]
    ds_read_b64 v[158:159], v4 offset:22528
    v_mfma_f32_16x16x32_bf16 v[68:71], v[88:91], v[124:127], v[68:71]
    ds_read_b128 v[192:195], v5 offset:22528
    buffer_store_dwordx4 v[32:35], v7, s[28:31], s19 offen offset:2048 sc1
    v_mfma_f32_16x16x32_bf16 v[72:75], v[92:95], v[124:127], v[72:75]
    ds_read_b64 v[160:161], v3 offset:22016
    v_mfma_f32_16x16x32_bf16 v[76:79], v[96:99], v[124:127], v[76:79]
    ds_read_b64 v[162:163], v4 offset:22016
    buffer_store_dwordx4 v[40:43], v7, s[28:31], s19 offen offset:3072 sc1
    v_mfma_f32_16x16x32_bf16 v[68:71], v[84:87], v[128:131], v[68:71]
    ds_read_b128 v[196:199], v5 offset:23040
    v_mfma_f32_16x16x32_bf16 v[72:75], v[88:91], v[128:131], v[72:75]
    ds_read_b64 v[164:165], v3 offset:21504
    v_mfma_f32_16x16x32_bf16 v[76:79], v[92:95], v[128:131], v[76:79]
    ds_read_b64 v[166:167], v4 offset:21504
    v_mfma_f32_16x16x32_bf16 v[72:75], v[84:87], v[132:135], v[72:75]
    ds_read_b128 v[200:203], v5 offset:23552
    v_mfma_f32_16x16x32_bf16 v[76:79], v[88:91], v[132:135], v[76:79]
    ds_read_b64 v[168:169], v3 offset:20992
    v_mfma_f32_16x16x32_bf16 v[76:79], v[84:87], v[136:139], v[76:79]
    ds_read_b64 v[170:171], v4 offset:20992
    v_mfma_f32_16x16x32_bf16 v[48:51], v[80:83], v[112:115], v[48:51]
    ds_read_b128 v[204:207], v5 offset:24064
    v_mfma_f32_16x16x32_bf16 v[52:55], v[84:87], v[112:115], v[52:55]
    ds_read_b64 v[172:173], v3 offset:20480
    v_mfma_f32_16x16x32_bf16 v[56:59], v[88:91], v[112:115], v[56:59]
    ds_read_b64 v[174:175], v4 offset:20480
    v_mfma_f32_16x16x32_bf16 v[60:63], v[92:95], v[112:115], v[60:63]
    v_mfma_f32_16x16x32_bf16 v[64:67], v[96:99], v[112:115], v[64:67]
    v_mov_b32 v2, v9
    v_mfma_f32_16x16x32_bf16 v[68:71], v[100:103], v[112:115], v[68:71]
    v_mov_b32 v5, v11
    v_mfma_f32_16x16x32_bf16 v[72:75], v[104:107], v[112:115], v[72:75]
    v_xad_u32 v3, v2, v6, v10
    v_mfma_f32_16x16x32_bf16 v[76:79], v[108:111], v[112:115], v[76:79]
    v_add_u32 v4, 8, v2
    v_mfma_f32_16x16x32_bf16 v[52:55], v[80:83], v[116:119], v[52:55]
    v_xad_u32 v4, v4, v6, v10
    v_mfma_f32_16x16x32_bf16 v[56:59], v[80:83], v[120:123], v[56:59]
    v_mfma_f32_16x16x32_bf16 v[60:63], v[80:83], v[124:127], v[60:63]
    v_mfma_f32_16x16x32_bf16 v[64:67], v[80:83], v[128:131], v[64:67]
    v_mfma_f32_16x16x32_bf16 v[68:71], v[80:83], v[132:135], v[68:71]
    v_mfma_f32_16x16x32_bf16 v[72:75], v[80:83], v[136:139], v[72:75]
    s_mov_b32 s19, s18
    s_add_u32 s18, s18, 4096
    v_mfma_f32_16x16x32_bf16 v[76:79], v[80:83], v[140:143], v[76:79]
    s_waitcnt lgkmcnt(0)
    s_barrier
    v_mfma_f32_16x16x32_bf16 v[56:59], v[148:151], v[180:183], v[56:59]
    ds_read_b128 v[112:115], v5 offset:0
    v_cmp_le_i32 vcc, -448, v8
    v_mfma_f32_16x16x32_bf16 v[60:63], v[152:155], v[180:183], v[60:63]
    ds_read_b64 v[80:81], v3 offset:3584
    s_nop 0
    v_mfma_f32_16x16x32_bf16 v[64:67], v[156:159], v[180:183], v[64:67]
    ds_read_b64 v[82:83], v4 offset:3584
    v_cndmask_b32 v176, 0, v176, vcc
    v_mfma_f32_16x16x32_bf16 v[68:71], v[160:163], v[180:183], v[68:71]
    ds_read_b128 v[116:119], v5 offset:512
    v_cndmask_b32 v177, 0, v177, vcc
    v_mfma_f32_16x16x32_bf16 v[72:75], v[164:167], v[180:183], v[72:75]
    ds_read_b64 v[84:85], v3 offset:3072
    v_cndmask_b32 v178, 0, v178, vcc
    v_mfma_f32_16x16x32_bf16 v[76:79], v[168:171], v[180:183], v[76:79]
    ds_read_b64 v[86:87], v4 offset:3072
    v_cndmask_b32 v179, 0, v179, vcc
    v_mfma_f32_16x16x32_bf16 v[60:63], v[148:151], v[184:187], v[60:63]
    ds_read_b128 v[120:123], v5 offset:1024
    v_cndmask_b32 v144, 0, v144, s[56:57]
    v_mfma_f32_16x16x32_bf16 v[64:67], v[152:155], v[184:187], v[64:67]
    ds_read_b64 v[88:89], v3 offset:2560
    v_cndmask_b32 v145, 0, v145, s[56:57]
    v_mfma_f32_16x16x32_bf16 v[68:71], v[156:159], v[184:187], v[68:71]
    ds_read_b64 v[90:91], v4 offset:2560
    v_cndmask_b32 v146, 0, v146, s[58:59]
    v_mfma_f32_16x16x32_bf16 v[72:75], v[160:163], v[184:187], v[72:75]
    ds_read_b128 v[124:127], v5 offset:1536
    v_cndmask_b32 v147, 0, v147, s[58:59]
    v_mfma_f32_16x16x32_bf16 v[76:79], v[164:167], v[184:187], v[76:79]
    ds_read_b64 v[92:93], v3 offset:2048
    v_mfma_f32_16x16x32_bf16 v[64:67], v[148:151], v[188:191], v[64:67]
    ds_read_b64 v[94:95], v4 offset:2048
    v_mfma_f32_16x16x32_bf16 v[68:71], v[152:155], v[188:191], v[68:71]
    ds_read_b128 v[128:131], v5 offset:2048
    v_mfma_f32_16x16x32_bf16 v[72:75], v[156:159], v[188:191], v[72:75]
    ds_read_b64 v[96:97], v3 offset:1536
    v_mfma_f32_16x16x32_bf16 v[76:79], v[160:163], v[188:191], v[76:79]
    ds_read_b64 v[98:99], v4 offset:1536
    v_mfma_f32_16x16x32_bf16 v[68:71], v[148:151], v[192:195], v[68:71]
    ds_read_b128 v[132:135], v5 offset:2560
    v_mfma_f32_16x16x32_bf16 v[72:75], v[152:155], v[192:195], v[72:75]
    ds_read_b64 v[100:101], v3 offset:1024
    v_mfma_f32_16x16x32_bf16 v[76:79], v[156:159], v[192:195], v[76:79]
    ds_read_b64 v[102:103], v4 offset:1024
    v_mfma_f32_16x16x32_bf16 v[72:75], v[148:151], v[196:199], v[72:75]
    ds_read_b128 v[136:139], v5 offset:3072
    v_mfma_f32_16x16x32_bf16 v[76:79], v[152:155], v[196:199], v[76:79]
    ds_read_b64 v[104:105], v3 offset:512
    v_mfma_f32_16x16x32_bf16 v[76:79], v[148:151], v[200:203], v[76:79]
    ds_read_b64 v[106:107], v4 offset:512
    v_mfma_f32_16x16x32_bf16 v[48:51], v[144:147], v[176:179], v[48:51]
    ds_read_b128 v[140:143], v5 offset:3584
    v_mfma_f32_16x16x32_bf16 v[52:55], v[148:151], v[176:179], v[52:55]
    ds_read_b64 v[108:109], v3 offset:0
    v_mfma_f32_16x16x32_bf16 v[56:59], v[152:155], v[176:179], v[56:59]
    ds_read_b64 v[110:111], v4 offset:0
    v_mfma_f32_16x16x32_bf16 v[60:63], v[156:159], v[176:179], v[60:63]
    v_mfma_f32_16x16x32_bf16 v[64:67], v[160:163], v[176:179], v[64:67]
    v_add_u32 v2, 64, v2
    v_mfma_f32_16x16x32_bf16 v[68:71], v[164:167], v[176:179], v[68:71]
    v_add_u32 v5, 64, v5
    v_mfma_f32_16x16x32_bf16 v[72:75], v[168:171], v[176:179], v[72:75]
    v_xad_u32 v3, v2, v6, v10
    v_mfma_f32_16x16x32_bf16 v[76:79], v[172:175], v[176:179], v[76:79]
    v_add_u32 v4, 8, v2
    v_mfma_f32_16x16x32_bf16 v[52:55], v[144:147], v[180:183], v[52:55]
    v_xad_u32 v4, v4, v6, v10
    v_mfma_f32_16x16x32_bf16 v[56:59], v[144:147], v[184:187], v[56:59]
    v_mfma_f32_16x16x32_bf16 v[60:63], v[144:147], v[188:191], v[60:63]
    v_mfma_f32_16x16x32_bf16 v[64:67], v[144:147], v[192:195], v[64:67]
    v_mfma_f32_16x16x32_bf16 v[68:71], v[144:147], v[196:199], v[68:71]
    v_mfma_f32_16x16x32_bf16 v[72:75], v[144:147], v[200:203], v[72:75]
    v_mfma_f32_16x16x32_bf16 v[76:79], v[144:147], v[204:207], v[76:79]
    s_sub_u32 s17, s17, 1
    s_cmp_lg_u32 s17, 0
    s_cbranch_scc1 mega_kernel_ch
    s_nop 7
    v_cvt_pk_bf16_f32 v48, v48, v49
    v_cvt_pk_bf16_f32 v49, v50, v51
    v_cvt_pk_bf16_f32 v50, v52, v53
    v_cvt_pk_bf16_f32 v51, v54, v55
    v_cvt_pk_bf16_f32 v56, v56, v57
    v_cvt_pk_bf16_f32 v57, v58, v59
    v_cvt_pk_bf16_f32 v58, v60, v61
    v_cvt_pk_bf16_f32 v59, v62, v63
    v_cvt_pk_bf16_f32 v64, v64, v65
    v_cvt_pk_bf16_f32 v65, v66, v67
    v_cvt_pk_bf16_f32 v66, v68, v69
    v_cvt_pk_bf16_f32 v67, v70, v71
    v_cvt_pk_bf16_f32 v72, v72, v73
    v_cvt_pk_bf16_f32 v73, v74, v75
    v_cvt_pk_bf16_f32 v74, v76, v77
    v_cvt_pk_bf16_f32 v75, v78, v79
    s_nop 1
    v_permlane16_swap_b32 v48, v50
    v_permlane16_swap_b32 v49, v51
    v_permlane16_swap_b32 v56, v58
    v_permlane16_swap_b32 v57, v59
    v_permlane16_swap_b32 v64, v66
    v_permlane16_swap_b32 v65, v67
    v_permlane16_swap_b32 v72, v74
    v_permlane16_swap_b32 v73, v75
    buffer_store_dwordx4 v[48:51], v7, s[28:31], s19 offen offset:0 sc1
    buffer_store_dwordx4 v[56:59], v7, s[28:31], s19 offen offset:1024 sc1
    buffer_store_dwordx4 v[64:67], v7, s[28:31], s19 offen offset:2048 sc1
    buffer_store_dwordx4 v[72:75], v7, s[28:31], s19 offen offset:3072 sc1
    s_add_u32 s20, s10, 0x600000
    s_addc_u32 s21, s11, 0
    s_and_b32 s21, s21, 0xffff
    s_mov_b32 s22, 524288
    s_mov_b32 s23, 0x20000
    s_and_b32 s38, s3, 3
    s_lshr_b32 s53, s12, 1
    s_add_u32 s53, s53, 0x7e000
    s_lshl_b32 s40, s38, 2
    v_mov_b32 v1, 0x80000000
    v_cmp_eq_u32 vcc, 0, v0
    v_mov_b32 v14, s40
    v_mov_b32 v15, 0
    v_cndmask_b32 v14, v1, v14, vcc
    s_lshl_b32 s53, s12, 2
    s_add_u32 s53, s53, 0x7e000
    s_cmp_eq_u32 s38, 0
    s_cselect_b32 s53, s53, 0x7ffffff0
    s_waitcnt vmcnt(0)
    s_barrier
    s_waitcnt vmcnt(0)
    buffer_store_dword v15, v14, s[20:23], s53 offen sc1
    s_endpgm
mega_kernel_g_s:
    s_mov_b32 s52, 0x80000
mega_kernel_g_a:
    s_sub_u32 s52, s52, 1
    s_cbranch_scc1 mega_kernel_g_k
    buffer_load_dword v9, v8, s[96:99], 0 offen sc1
    s_waitcnt vmcnt(0)
    v_cmp_eq_u32 vcc, 0, v9
    s_cbranch_vccnz mega_kernel_g_a
    s_branch mega_kernel_g_k
mega_kernel_end:
    s_endpgm
.section .rodata,"a"
.p2align 6
.amdhsa_kernel mega_kernel
.amdhsa_next_free_vgpr 256
.amdhsa_next_free_sgpr 100
.amdhsa_accum_offset 256
.amdhsa_group_segment_fixed_size 0
.amdhsa_kernarg_size 112
.amdhsa_user_sgpr_count 2
.amdhsa_user_sgpr_kernarg_segment_ptr 1
.amdhsa_system_sgpr_workgroup_id_x 1
.end_amdhsa_kernel
.text
```
